```python
import torch

def _softmax(x, axis=-1):
    return torch.softmax(x, dim=axis)
def _gelu(x):
    return torch.nn.functional.gelu(x, approximate="tanh")
def _silu(x):
    return torch.nn.functional.silu(x)
def _sigmoid(x):
    return torch.sigmoid(x)
def _layernorm(x, axis=-1, eps=1e-5):
    m = x.mean(dim=axis, keepdim=True)
    v = x.var(dim=axis, keepdim=True, unbiased=False)
    return (x - m) / torch.sqrt(v + eps)
def _scatter_add(tgt, idx, src, axis=0):
    return tgt.clone().index_add_(axis, idx, src)
def _segment_sum(src, seg, n):
    out = torch.zeros((n,) + src.shape[1:], dtype=src.dtype)
    return out.index_add_(0, seg, src)
def _pad(x, pw):
    flat = tuple(v for pair in reversed(pw) for v in pair)
    return torch.nn.functional.pad(x, flat)

kernel_name = 'recurrent_scan__mha_block_cached__glu_gated_swiglu__prompt'

def setup_inputs():

    _w = (lambda a: (lambda t: t.to(torch.bfloat16) if t.is_floating_point() else t)(torch.as_tensor(a)))
    def _A_setup():
        B, Sq, D = 1, 2048, 576
        H, Sk, Dh = 32, 2048, 128
        return {
            "x": _w((lambda *s: torch.randn(*s, dtype=torch.bfloat16) * 0.05)(B, Sq, D)),
            "k_cache": _w((lambda *s: torch.randn(*s, dtype=torch.bfloat16) * 1.6)(B, H, Sk, Dh)),
            "v_cache": _w((lambda *s: torch.randn(*s, dtype=torch.bfloat16) * 1.6)(B, H, Sk, Dh)),
            "wq": _w((lambda *s: torch.randn(*s, dtype=torch.bfloat16) * 1.6)(D, H * Dh) * (D ** -0.5)),
            "wo": _w((lambda *s: torch.randn(*s, dtype=torch.bfloat16) * 1.6)(H * Dh, D) * ((H * Dh) ** -0.5)),
        }
    _A_in = _A_setup()

    def _B_setup():
        B, S, D, F = 1, 2048, 576, 4608
        return {
            "x": _w((lambda *s: torch.randn(*s, dtype=torch.bfloat16) * 0.05)(B, S, D)),
            "w1": _w((lambda *s: torch.randn(*s, dtype=torch.bfloat16) * 0.2)(D, F) * (2.0 / D) ** 0.5),
            "w3": _w((lambda *s: torch.randn(*s, dtype=torch.bfloat16) * 0.2)(D, F) * (2.0 / D) ** 0.5),
            "w2": _w((lambda *s: torch.randn(*s, dtype=torch.bfloat16) * 0.2)(F, D) * (2.0 / F) ** 0.5),
        }
    _B_in = _B_setup()

    return {
        "A_x": _A_in["x"],
        "A_k_cache": _A_in["k_cache"],
        "A_v_cache": _A_in["v_cache"],
        "A_wq": _A_in["wq"],
        "A_wo": _A_in["wo"],
        "B_x": _B_in["x"],
        "B_w1": _B_in["w1"],
        "B_w3": _B_in["w3"],
        "B_w2": _B_in["w2"],
    }

def reference(A_x, A_k_cache, A_v_cache, A_wq, A_wo, B_x, B_w1, B_w3, B_w2):
    def _A_ref(x, k_cache, v_cache, wq, wo):
        B, Sq, D = x.shape
        H, Dh = 32, 128
        q = (lambda x, *d: x.permute(*d))((x @ wq).reshape(B, Sq, H, Dh), 0, 2, 1, 3)
        scores = torch.einsum("bhqd,bhkd->bhqk", q, k_cache) * (Dh ** -0.5)
        p = _softmax(scores, axis=-1)
        o = torch.einsum("bhqk,bhkd->bhqd", p, v_cache)
        return (lambda x, *d: x.permute(*d))(o, 0, 2, 1, 3).reshape(B, Sq, H * Dh) @ wo

    def _B_ref(x, w1, w3, w2):
        gate = torch.einsum("bsd,df->bsf", x, w1)
        up = torch.einsum("bsd,df->bsf", x, w3)
        h = _silu(gate) * up
        out = torch.einsum("bsf,fd->bsd", h, w2)
        return out

    x = A_x
    xn = _layernorm(x, axis=-1)
    s = _A_ref(xn, A_k_cache, A_v_cache, A_wq, A_wo)
    g = _silu(_B_ref(xn, B_w1, B_w3, B_w2))
    return x + s * g
```

```asm
; @launch grid=(256,1,1) block=(256,1,1) lds=163840
.amdgcn_target "amdgcn-amd-amdhsa--gfx950"
.text
.globl recurrent_scan__mha_block_cached__glu_gated_swiglu__prompt_kernel
.p2align 8
.type recurrent_scan__mha_block_cached__glu_gated_swiglu__prompt_kernel,@function
recurrent_scan__mha_block_cached__glu_gated_swiglu__prompt_kernel:
s_cmp_ge_u32 s2, 256
s_cbranch_scc1 K1_end
s_load_dwordx2 s[16:17], s[0:1], 0
s_getpc_b64 s[48:49]
K1_pc0:
s_lshr_b32 s60, s2, 3
s_mul_i32 s60, s60, 20
v_lshrrev_b32 v44, 6, v0
v_mul_u32_u24 v44, 5, v44
v_and_b32 v45, 63, v0
v_min_u32 v45, 4, v45
v_add3_u32 v44, v44, v45, s60
v_lshlrev_b32 v44, 7, v44
v_min_u32 v44, K1_code_end-K1_pc0-4, v44
global_load_dword v31, v44, s[48:49]
s_mov_b32 s18, 2359296
s_mov_b32 s19, 0x20000
s_mul_i32 s62, s2, 9216
v_lshrrev_b32 v48, 5, v0
v_and_b32 v49, 31, v0
v_mul_u32_u24 v50, 1152, v48
v_lshl_add_u32 v50, v49, 4, v50
v_mov_b32 v51, 0x7f000000
v_cmp_gt_u32 vcc, 24, v49
s_nop 1
v_cndmask_b32 v50, v51, v50, vcc
s_waitcnt lgkmcnt(0)
buffer_load_dwordx4 v[52:55], v50, s[16:19], s62 offen offset:0
buffer_load_dwordx4 v[56:59], v50, s[16:19], s62 offen offset:384
buffer_load_dwordx4 v[60:63], v50, s[16:19], s62 offen offset:768
s_load_dwordx2 s[72:73], s[0:1], 24
s_load_dwordx2 s[74:75], s[0:1], 88
s_load_dwordx2 s[68:69], s[0:1], 8
s_load_dwordx2 s[70:71], s[0:1], 16
s_load_dwordx4 s[76:79], s[0:1], 48
s_load_dwordx2 s[66:67], s[0:1], 32
s_load_dwordx2 s[4:5], s[0:1], 64
s_load_dwordx2 s[6:7], s[0:1], 0
s_load_dwordx2 s[100:101], s[0:1], 72
v_lshrrev_b32 v1, 6, v0
v_and_b32 v2, 63, v0
v_readfirstlane_b32 s3, v1
s_and_b32 s32, s2, 31
s_lshr_b32 s33, s2, 5
v_lshlrev_b32 v3, 4, v2
s_lshl_b32 s39, s3, 11
s_lshl_b32 s52, s3, 10
s_lshl_b32 s60, s33, 4
s_lshl_b32 s61, s3, 2
s_add_u32 s60, s60, s61
s_mul_i32 s64, s60, 18432
s_lshl_b32 s38, s32, 8
s_add_u32 s38, s38, 2097152
v_lshrrev_b32 v32, 4, v2
v_and_b32 v33, 15, v2
v_lshrrev_b32 v34, 2, v33
v_and_b32 v35, 3, v2
s_lshl_b32 s61, s3, 3
v_add_u32 v36, s61, v32
v_lshlrev_b32 v37, 2, v32
v_xor_b32 v37, v37, v33
v_lshlrev_b32 v37, 4, v37
v_lshl_add_u32 v4, v36, 13, v37
v_add_u32 v5, 31744, v4
s_add_u32 s34, s64, 8192
s_add_u32 s35, s64, 26624
s_add_u32 s36, s64, 45056
s_add_u32 s37, s64, 63488
s_waitcnt lgkmcnt(0)
s_mov_b32 s8, s74
s_mov_b32 s9, s75
s_mov_b32 s10, 268435456
s_mov_b32 s11, 0x20000
s_mov_b32 s12, s72
s_mov_b32 s13, s73
s_mov_b32 s14, 4718592
s_mov_b32 s15, 0x20000
s_mov_b32 s60, 3277824
s_load_dword s73, s[74:75], s60
s_lshl_b32 s60, s33, 2
s_add_u32 s60, s60, s3
s_mul_i32 s60, s60, 147456
s_lshl_b32 s61, s32, 8
s_add_u32 s60, s60, s61
v_min_u32 v42, 35, v2
v_lshrrev_b32 v43, 1, v42
v_and_b32 v42, 1, v42
v_lshlrev_b32 v42, 7, v42
v_lshl_add_u32 v42, v43, 13, v42
buffer_load_dword v31, v42, s[12:15], s60 offen
s_mov_b32 s63, 0xffff0000
v_cmp_gt_u32 vcc, 24, v49
v_min_u32 v50, 24, v49
v_lshlrev_b32 v50, 7, v50
v_lshl_add_u32 v50, v48, 4, v50
v_add_u32 v50, 114688, v50
s_waitcnt vmcnt(3)
v_lshlrev_b32 v64, 16, v52
v_and_b32 v65, s63, v52
v_lshlrev_b32 v66, 16, v53
v_and_b32 v67, s63, v53
v_lshlrev_b32 v68, 16, v54
v_and_b32 v69, s63, v54
v_lshlrev_b32 v70, 16, v55
v_and_b32 v71, s63, v55
s_waitcnt vmcnt(2)
v_lshlrev_b32 v72, 16, v56
v_and_b32 v73, s63, v56
v_lshlrev_b32 v74, 16, v57
v_and_b32 v75, s63, v57
v_lshlrev_b32 v76, 16, v58
v_and_b32 v77, s63, v58
v_lshlrev_b32 v78, 16, v59
v_and_b32 v79, s63, v59
s_waitcnt vmcnt(1)
v_lshlrev_b32 v80, 16, v60
v_and_b32 v81, s63, v60
v_lshlrev_b32 v82, 16, v61
v_and_b32 v83, s63, v61
v_lshlrev_b32 v84, 16, v62
v_and_b32 v85, s63, v62
v_lshlrev_b32 v86, 16, v63
v_and_b32 v87, s63, v63
v_add_f32 v88, v64, v65
v_add_f32 v89, v66, v67
v_add_f32 v88, v88, v68
v_add_f32 v89, v89, v69
v_add_f32 v88, v88, v70
v_add_f32 v89, v89, v71
v_add_f32 v88, v88, v72
v_add_f32 v89, v89, v73
v_add_f32 v88, v88, v74
v_add_f32 v89, v89, v75
v_add_f32 v88, v88, v76
v_add_f32 v89, v89, v77
v_add_f32 v88, v88, v78
v_add_f32 v89, v89, v79
v_add_f32 v88, v88, v80
v_add_f32 v89, v89, v81
v_add_f32 v88, v88, v82
v_add_f32 v89, v89, v83
v_add_f32 v88, v88, v84
v_add_f32 v89, v89, v85
v_add_f32 v88, v88, v86
v_add_f32 v89, v89, v87
v_add_f32 v88, v88, v89
s_nop 1
v_add_f32_dpp v88, v88, v88 row_ror:8 row_mask:0xf bank_mask:0xf
s_nop 1
v_add_f32_dpp v88, v88, v88 row_ror:4 row_mask:0xf bank_mask:0xf
s_nop 1
v_add_f32_dpp v88, v88, v88 row_ror:2 row_mask:0xf bank_mask:0xf
s_nop 1
v_add_f32_dpp v88, v88, v88 row_ror:1 row_mask:0xf bank_mask:0xf
v_mov_b32 v89, v88
s_nop 1
v_permlane16_swap_b32 v88, v89
v_add_f32 v88, v88, v89
v_mul_f32 v88, 0x3ae38e39, v88
v_sub_f32 v89, v64, v88
v_sub_f32 v92, v65, v88
v_mul_f32 v90, v89, v89
v_mul_f32 v91, v92, v92
v_sub_f32 v89, v66, v88
v_sub_f32 v92, v67, v88
v_fmac_f32 v90, v89, v89
v_fmac_f32 v91, v92, v92
v_sub_f32 v89, v68, v88
v_sub_f32 v92, v69, v88
v_fmac_f32 v90, v89, v89
v_fmac_f32 v91, v92, v92
v_sub_f32 v89, v70, v88
v_sub_f32 v92, v71, v88
v_fmac_f32 v90, v89, v89
v_fmac_f32 v91, v92, v92
v_sub_f32 v89, v72, v88
v_sub_f32 v92, v73, v88
v_fmac_f32 v90, v89, v89
v_fmac_f32 v91, v92, v92
v_sub_f32 v89, v74, v88
v_sub_f32 v92, v75, v88
v_fmac_f32 v90, v89, v89
v_fmac_f32 v91, v92, v92
v_sub_f32 v89, v76, v88
v_sub_f32 v92, v77, v88
v_fmac_f32 v90, v89, v89
v_fmac_f32 v91, v92, v92
v_sub_f32 v89, v78, v88
v_sub_f32 v92, v79, v88
v_fmac_f32 v90, v89, v89
v_fmac_f32 v91, v92, v92
v_sub_f32 v89, v80, v88
v_sub_f32 v92, v81, v88
v_fmac_f32 v90, v89, v89
v_fmac_f32 v91, v92, v92
v_sub_f32 v89, v82, v88
v_sub_f32 v92, v83, v88
v_fmac_f32 v90, v89, v89
v_fmac_f32 v91, v92, v92
v_sub_f32 v89, v84, v88
v_sub_f32 v92, v85, v88
v_fmac_f32 v90, v89, v89
v_fmac_f32 v91, v92, v92
v_sub_f32 v89, v86, v88
v_sub_f32 v92, v87, v88
v_fmac_f32 v90, v89, v89
v_fmac_f32 v91, v92, v92
v_add_f32 v90, v90, v91
v_cndmask_b32 v90, 0, v90, vcc
s_nop 1
v_add_f32_dpp v90, v90, v90 row_ror:8 row_mask:0xf bank_mask:0xf
s_nop 1
v_add_f32_dpp v90, v90, v90 row_ror:4 row_mask:0xf bank_mask:0xf
s_nop 1
v_add_f32_dpp v90, v90, v90 row_ror:2 row_mask:0xf bank_mask:0xf
s_nop 1
v_add_f32_dpp v90, v90, v90 row_ror:1 row_mask:0xf bank_mask:0xf
v_mov_b32 v89, v90
s_nop 1
v_permlane16_swap_b32 v90, v89
v_add_f32 v90, v90, v89
v_mul_f32 v90, 0x3ae38e39, v90
v_cvt_pk_bf16_f32 v90, v90, v90
v_lshlrev_b32 v90, 16, v90
v_add_f32 v90, 0x3727c5ac, v90
v_cvt_pk_bf16_f32 v90, v90, v90
v_lshlrev_b32 v90, 16, v90
v_sqrt_f32 v90, v90
v_cvt_pk_bf16_f32 v88, v88, v88
v_lshlrev_b32 v88, 16, v88
v_cvt_pk_bf16_f32 v90, v90, v90
v_lshlrev_b32 v90, 16, v90
v_rcp_f32 v90, v90
s_and_saveexec_b64 s[48:49], vcc
v_sub_f32 v64, v64, v88
v_sub_f32 v65, v65, v88
v_cvt_pk_bf16_f32 v52, v64, v65
v_lshlrev_b32 v64, 16, v52
v_and_b32 v65, s63, v52
v_mul_f32 v64, v64, v90
v_mul_f32 v65, v65, v90
v_cvt_pk_bf16_f32 v52, v64, v65
v_sub_f32 v66, v66, v88
v_sub_f32 v67, v67, v88
v_cvt_pk_bf16_f32 v53, v66, v67
v_lshlrev_b32 v66, 16, v53
v_and_b32 v67, s63, v53
v_mul_f32 v66, v66, v90
v_mul_f32 v67, v67, v90
v_cvt_pk_bf16_f32 v53, v66, v67
v_sub_f32 v68, v68, v88
v_sub_f32 v69, v69, v88
v_cvt_pk_bf16_f32 v54, v68, v69
v_lshlrev_b32 v68, 16, v54
v_and_b32 v69, s63, v54
v_mul_f32 v68, v68, v90
v_mul_f32 v69, v69, v90
v_cvt_pk_bf16_f32 v54, v68, v69
v_sub_f32 v70, v70, v88
v_sub_f32 v71, v71, v88
v_cvt_pk_bf16_f32 v55, v70, v71
v_lshlrev_b32 v70, 16, v55
v_and_b32 v71, s63, v55
v_mul_f32 v70, v70, v90
v_mul_f32 v71, v71, v90
v_cvt_pk_bf16_f32 v55, v70, v71
ds_write_b128 v50, v[52:55] offset:0
v_sub_f32 v72, v72, v88
v_sub_f32 v73, v73, v88
v_cvt_pk_bf16_f32 v56, v72, v73
v_lshlrev_b32 v72, 16, v56
v_and_b32 v73, s63, v56
v_mul_f32 v72, v72, v90
v_mul_f32 v73, v73, v90
v_cvt_pk_bf16_f32 v56, v72, v73
v_sub_f32 v74, v74, v88
v_sub_f32 v75, v75, v88
v_cvt_pk_bf16_f32 v57, v74, v75
v_lshlrev_b32 v74, 16, v57
v_and_b32 v75, s63, v57
v_mul_f32 v74, v74, v90
v_mul_f32 v75, v75, v90
v_cvt_pk_bf16_f32 v57, v74, v75
v_sub_f32 v76, v76, v88
v_sub_f32 v77, v77, v88
v_cvt_pk_bf16_f32 v58, v76, v77
v_lshlrev_b32 v76, 16, v58
v_and_b32 v77, s63, v58
v_mul_f32 v76, v76, v90
v_mul_f32 v77, v77, v90
v_cvt_pk_bf16_f32 v58, v76, v77
v_sub_f32 v78, v78, v88
v_sub_f32 v79, v79, v88
v_cvt_pk_bf16_f32 v59, v78, v79
v_lshlrev_b32 v78, 16, v59
v_and_b32 v79, s63, v59
v_mul_f32 v78, v78, v90
v_mul_f32 v79, v79, v90
v_cvt_pk_bf16_f32 v59, v78, v79
ds_write_b128 v50, v[56:59] offset:3072
v_sub_f32 v80, v80, v88
v_sub_f32 v81, v81, v88
v_cvt_pk_bf16_f32 v60, v80, v81
v_lshlrev_b32 v80, 16, v60
v_and_b32 v81, s63, v60
v_mul_f32 v80, v80, v90
v_mul_f32 v81, v81, v90
v_cvt_pk_bf16_f32 v60, v80, v81
v_sub_f32 v82, v82, v88
v_sub_f32 v83, v83, v88
v_cvt_pk_bf16_f32 v61, v82, v83
v_lshlrev_b32 v82, 16, v61
v_and_b32 v83, s63, v61
v_mul_f32 v82, v82, v90
v_mul_f32 v83, v83, v90
v_cvt_pk_bf16_f32 v61, v82, v83
v_sub_f32 v84, v84, v88
v_sub_f32 v85, v85, v88
v_cvt_pk_bf16_f32 v62, v84, v85
v_lshlrev_b32 v84, 16, v62
v_and_b32 v85, s63, v62
v_mul_f32 v84, v84, v90
v_mul_f32 v85, v85, v90
v_cvt_pk_bf16_f32 v62, v84, v85
v_sub_f32 v86, v86, v88
v_sub_f32 v87, v87, v88
v_cvt_pk_bf16_f32 v63, v86, v87
v_lshlrev_b32 v86, 16, v63
v_and_b32 v87, s63, v63
v_mul_f32 v86, v86, v90
v_mul_f32 v87, v87, v90
v_cvt_pk_bf16_f32 v63, v86, v87
ds_write_b128 v50, v[60:63] offset:6144
s_mov_b64 exec, s[48:49]
s_add_u32 s60, s52, 114688
v_add_u32 v50, s60, v3
v_lshrrev_b32 v51, 3, v2
v_lshlrev_b32 v51, 8, v51
v_and_b32 v48, 7, v2
v_lshl_add_u32 v51, v48, 4, v51
s_lshr_b32 s60, s2, 1
s_mul_i32 s60, s60, 18432
s_and_b32 s61, s2, 1
s_lshl_b32 s61, s61, 7
s_add_u32 s60, s60, s61
s_add_u32 s60, s60, s39
s_add_u32 s61, s60, 8192
s_add_u32 s62, s60, 16384
s_cmp_eq_u32 s3, 0
s_cselect_b32 s62, s62, 0x40000000
s_waitcnt lgkmcnt(0)
s_barrier
ds_read_b128 v[52:55], v50 offset:0
ds_read_b128 v[56:59], v50 offset:4096
ds_read_b128 v[60:63], v50 offset:8192
s_waitcnt lgkmcnt(2)
buffer_store_dwordx4 v[52:55], v51, s[8:11], s60 offen sc1
s_waitcnt lgkmcnt(1)
buffer_store_dwordx4 v[56:59], v51, s[8:11], s61 offen sc1
s_waitcnt lgkmcnt(0)
buffer_store_dwordx4 v[60:63], v51, s[8:11], s62 offen sc1
s_add_u32 m0, s39, 0
s_nop 0
buffer_load_dwordx4 v4, s[12:15], s38 offen lds
buffer_load_dwordx4 v5, s[12:15], s38 offen offset:1024 lds
s_add_u32 s38, s38, 262144
s_add_u32 m0, s39, 8192
s_nop 0
buffer_load_dwordx4 v4, s[12:15], s38 offen lds
buffer_load_dwordx4 v5, s[12:15], s38 offen offset:1024 lds
s_add_u32 s38, s38, 262144
s_add_u32 m0, s39, 16384
s_nop 0
buffer_load_dwordx4 v4, s[12:15], s38 offen lds
buffer_load_dwordx4 v5, s[12:15], s38 offen offset:1024 lds
s_add_u32 s38, s38, 262144
s_add_u32 m0, s39, 24576
s_nop 0
buffer_load_dwordx4 v4, s[12:15], s38 offen lds
buffer_load_dwordx4 v5, s[12:15], s38 offen offset:1024 lds
s_add_u32 s38, s38, 262144
s_add_u32 m0, s39, 32768
s_nop 0
buffer_load_dwordx4 v4, s[12:15], s38 offen lds
buffer_load_dwordx4 v5, s[12:15], s38 offen offset:1024 lds
s_add_u32 s38, s38, 262144
s_add_u32 m0, s39, 40960
s_nop 0
buffer_load_dwordx4 v4, s[12:15], s38 offen lds
buffer_load_dwordx4 v5, s[12:15], s38 offen offset:1024 lds
s_add_u32 s38, s38, 262144
v_lshl_add_u32 v38, v32, 3, v34
v_lshlrev_b32 v39, 8, v38
v_lshl_add_u32 v39, v35, 4, v39
v_xor_b32 v26, 0, v34
v_lshl_add_u32 v26, v26, 6, v39
v_xor_b32 v27, 1, v34
v_lshl_add_u32 v27, v27, 6, v39
v_xor_b32 v28, 2, v34
v_lshl_add_u32 v28, v28, 6, v39
v_xor_b32 v29, 3, v34
v_lshl_add_u32 v29, v29, 6, v39
v_add_u32 v38, 0, v36
v_and_b32 v38, 15, v38
v_xor_b32 v38, v38, v33
v_lshlrev_b32 v38, 4, v38
v_lshl_add_u32 v10, v36, 8, v38
v_add_u32 v38, 0, v32
v_lshlrev_b32 v38, 1, v38
v_xor_b32 v38, v38, v33
v_lshlrev_b32 v38, 4, v38
v_lshl_add_u32 v12, v36, 8, v38
v_add_u32 v38, 4, v36
v_and_b32 v38, 15, v38
v_xor_b32 v38, v38, v33
v_lshlrev_b32 v38, 4, v38
v_lshl_add_u32 v11, v36, 8, v38
v_add_u32 v38, 4, v32
v_lshlrev_b32 v38, 1, v38
v_xor_b32 v38, v38, v33
v_lshlrev_b32 v38, 4, v38
v_lshl_add_u32 v13, v36, 8, v38
v_add_u32 v38, 0, v32
v_xor_b32 v38, v38, v33
v_lshlrev_b32 v38, 4, v38
v_lshl_add_u32 v14, v33, 8, v38
v_add_u32 v38, 4, v32
v_xor_b32 v38, v38, v33
v_lshlrev_b32 v38, 4, v38
v_lshl_add_u32 v15, v33, 8, v38
v_add_u32 v38, 8, v32
v_xor_b32 v38, v38, v33
v_lshlrev_b32 v38, 4, v38
v_lshl_add_u32 v16, v33, 8, v38
v_add_u32 v38, 12, v32
v_xor_b32 v38, v38, v33
v_lshlrev_b32 v38, 4, v38
v_lshl_add_u32 v17, v33, 8, v38
v_lshl_add_u32 v38, v32, 2, v34
v_lshlrev_b32 v39, 8, v38
v_add_u32 v39, 0x10000, v39
v_and_b32 v40, 1, v35
v_lshl_add_u32 v39, v40, 3, v39
v_and_b32 v38, 7, v38
v_lshlrev_b32 v38, 1, v38
v_lshrrev_b32 v40, 1, v35
v_xor_b32 v38, v38, v40
v_xor_b32 v41, 0, v38
v_lshl_add_u32 v18, v41, 4, v39
v_xor_b32 v41, 2, v38
v_lshl_add_u32 v19, v41, 4, v39
v_xor_b32 v41, 4, v38
v_lshl_add_u32 v20, v41, 4, v39
v_xor_b32 v41, 6, v38
v_lshl_add_u32 v21, v41, 4, v39
v_xor_b32 v41, 8, v38
v_lshl_add_u32 v22, v41, 4, v39
v_xor_b32 v41, 10, v38
v_lshl_add_u32 v23, v41, 4, v39
v_xor_b32 v41, 12, v38
v_lshl_add_u32 v24, v41, 4, v39
v_xor_b32 v41, 14, v38
v_lshl_add_u32 v25, v41, 4, v39
s_lshl_b32 s60, s2, 8
s_add_u32 s60, s60, 3145728
s_cmp_eq_u32 s3, 0
s_cselect_b32 s60, s60, 0x40000000
s_add_u32 s42, s73, 1
v_mov_b32 v50, s42
v_lshlrev_b32 v51, 2, v2
s_waitcnt vmcnt(12)
s_barrier
buffer_store_dword v50, v51, s[8:11], s60 offen sc1
s_getreg_b32 s60, hwreg(HW_REG_XCC_ID, 0, 1)
s_add_u32 s60, s60, s42
v_mov_b32 v56, s60
s_or_b32 s60, s2, s3
s_mov_b32 s61, 3276800
s_cmp_eq_u32 s60, 0
s_cselect_b32 s60, s61, 0x40000000
buffer_store_dword v56, v51, s[8:11], s60 offen sc1
s_lshl_b32 s51, s33, 13
s_add_u32 s51, s51, 3145728
v_and_b32 v51, 31, v2
v_lshlrev_b32 v51, 8, v51
s_add_u32 m0, s39, 49152
s_nop 0
buffer_load_dwordx4 v4, s[12:15], s38 offen lds
buffer_load_dwordx4 v5, s[12:15], s38 offen offset:1024 lds
s_add_u32 s38, s38, 262144
s_lshl_b32 s60, s32, 19
s_add_u32 s68, s68, s60
s_addc_u32 s69, s69, 0
s_add_u32 s70, s70, s60
s_addc_u32 s71, s71, 0
s_mov_b32 s16, s68
s_mov_b32 s17, s69
s_mov_b32 s18, 524288
s_add_u32 m0, s39, 57344
s_nop 0
buffer_load_dwordx4 v4, s[12:15], s38 offen lds
buffer_load_dwordx4 v5, s[12:15], s38 offen offset:1024 lds
s_add_u32 s38, s38, 262144
s_mov_b32 s19, 0x20000
s_mov_b32 s20, s70
s_mov_b32 s21, s71
s_mov_b32 s22, 524288
s_mov_b32 s23, 0x20000
s_mov_b32 s24, s76
s_mov_b32 s25, s77
s_mov_b32 s26, 5308416
s_add_u32 m0, s39, 65536
s_nop 0
buffer_load_dwordx4 v4, s[12:15], s38 offen lds
buffer_load_dwordx4 v5, s[12:15], s38 offen offset:1024 lds
s_add_u32 s38, s38, 262144
s_mov_b32 s27, 0x20000
s_mov_b32 s28, s78
s_mov_b32 s29, s79
s_mov_b32 s30, 5308416
s_mov_b32 s31, 0x20000
s_lshr_b32 s60, s32, 4
s_mul_i32 s60, s60, 72
s_and_b32 s61, s32, 15
s_add_u32 m0, s39, 73728
s_nop 0
buffer_load_dwordx4 v4, s[12:15], s38 offen lds
buffer_load_dwordx4 v5, s[12:15], s38 offen offset:1024 lds
s_add_u32 s38, s38, 4290510848
s_lshl_b32 s54, s61, 2
s_add_u32 s54, s54, s60
s_lshr_b32 s55, s61, 1
s_add_u32 s55, s55, s60
s_add_u32 s55, s55, 64
s_lshl_b32 s60, s33, 4
s_lshl_b32 s61, s3, 2
s_add_u32 s60, s60, s61
s_mul_i32 s60, s60, 279552
s_add_u32 m0, s39, 81920
s_nop 0
buffer_load_dwordx4 v4, s[12:15], s38 offen lds
buffer_load_dwordx4 v5, s[12:15], s38 offen offset:1024 lds
s_add_u32 s38, s38, 262144
s_add_u32 s60, s60, 4194304
s_lshl_b32 s61, s32, 12
s_add_u32 s44, s60, s61
s_add_u32 s45, s44, 279552
s_add_u32 s46, s44, 559104
s_add_u32 s47, s44, 838656
s_lshr_b32 s61, s32, 4
s_mul_i32 s61, s61, 72
s_add_u32 m0, s39, 90112
s_nop 0
buffer_load_dwordx4 v4, s[12:15], s38 offen lds
buffer_load_dwordx4 v5, s[12:15], s38 offen offset:1024 lds
s_add_u32 s38, s38, 262144
s_and_b32 s62, s32, 15
s_add_u32 s61, s61, s62
s_add_u32 s61, s61, 128
s_lshl_b32 s61, s61, 10
s_add_u32 s56, s60, s61
s_add_u32 s57, s56, 279552
s_add_u32 s58, s56, 559104
s_add_u32 s59, s56, 838656
s_add_u32 m0, s39, 98304
s_nop 0
buffer_load_dwordx4 v4, s[12:15], s38 offen lds
buffer_load_dwordx4 v5, s[12:15], s38 offen offset:1024 lds
s_add_u32 s38, s38, 262144
s_lshr_b32 s43, s62, 1
s_sub_u32 s43, s43, s62
s_add_u32 s43, s43, 16
s_lshl_b32 s43, s43, 10
s_lshl_b32 s54, s54, 6
s_lshl_b32 s55, s55, 6
s_mov_b32 s50, 0x4e800000
s_mov_b32 s53, 0xbfb8aa3b
s_add_u32 m0, s39, 106496
s_nop 0
buffer_load_dwordx4 v4, s[12:15], s38 offen lds
buffer_load_dwordx4 v5, s[12:15], s38 offen offset:1024 lds
s_add_u32 s38, s38, 262144
s_mov_b32 s40, 0
s_mov_b32 s41, 0
s_lshl_b32 s60, s3, 3
v_lshrrev_b32 v45, 3, v2
v_add_u32 v45, s60, v45
v_and_b32 v46, 2, v45
v_lshrrev_b32 v47, 1, v45
v_and_b32 v47, 4, v47
v_or_b32 v46, v46, v47
s_add_u32 m0, s39, 131072
s_nop 0
buffer_load_dwordx4 v4, s[12:15], s38 offen lds
buffer_load_dwordx4 v5, s[12:15], s38 offen offset:1024 lds
s_add_u32 s38, s38, 262144
v_and_b32 v47, 7, v2
v_xor_b32 v46, v46, v47
v_mul_u32_u24 v8, 9216, v45
v_lshl_add_u32 v8, v46, 4, v8
v_mul_u32_u24 v9, 1152, v45
v_lshl_add_u32 v9, v47, 4, v9
v_lshrrev_b32 v45, 2, v2
v_lshlrev_b32 v45, 7, v45
s_add_u32 m0, s39, 139264
s_nop 0
buffer_load_dwordx4 v4, s[12:15], s38 offen lds
buffer_load_dwordx4 v5, s[12:15], s38 offen offset:1024 lds
s_add_u32 s38, s38, 262144
v_and_b32 v46, 3, v2
v_lshl_add_u32 v45, v46, 3, v45
s_lshl_b32 s60, s3, 5
s_add_u32 s60, s60, 0x20000
v_add_u32 v1, s60, v45
s_lshl_b32 s60, s33, 2
s_add_u32 s60, s60, s3
s_mul_i32 s60, s60, 165888
s_add_u32 m0, s39, 147456
s_nop 0
buffer_load_dwordx4 v4, s[12:15], s38 offen lds
buffer_load_dwordx4 v5, s[12:15], s38 offen offset:1024 lds
s_add_u32 s38, s38, 262144
s_add_u32 s76, s60, s55
s_add_u32 s77, s60, s54
v_mul_u32_u24 v30, 9216, v2
v_mov_b32 v45, 0x7f000000
v_cmp_gt_u32 vcc, 9, v2
s_nop 1
v_cndmask_b32 v30, v45, v30, vcc
s_getpc_b64 s[78:79]
K1_pc:
s_add_u32 s78, s78, K1_after-K1_pc
s_addc_u32 s79, s79, 0
s_add_u32 m0, s39, 155648
s_nop 0
buffer_load_dwordx4 v4, s[12:15], s38 offen lds
buffer_load_dwordx4 v5, s[12:15], s38 offen offset:1024 lds
s_add_u32 s38, s38, 262144
s_lshr_b32 s60, s2, 3
s_lshl_b32 s60, s60, 2
s_add_u32 s60, s60, s3
s_mul_i32 s60, s60, 3
v_min_u32 v0, 2, v2
v_add_lshl_u32 v0, v0, s60, 7
v_min_u32 v0, K1_code_end-K1_after-4, v0
s_mov_b32 s65, 200000
s_cmp_lg_u32 s3, 0
s_cbranch_scc1 K1_lnd
K1_lnp:
buffer_load_dwordx2 v[52:53], v51, s[8:11], s51 offen sc1
s_waitcnt vmcnt(0)
v_subrev_u32 v52, s42, v52
v_subrev_u32 v53, s42, v53
v_max_u32 v52, v52, v53
v_cmp_le_u32 vcc, 8, v52
s_cbranch_vccz K1_lnd
s_sleep 2
s_sub_u32 s65, s65, 1
s_cmp_lg_u32 s65, 0
s_cbranch_scc1 K1_lnp
K1_lnd:
s_waitcnt vmcnt(0)
s_barrier
buffer_load_dwordx4 a[0:3], v3, s[8:11], s34 offen offset:0 sc1
buffer_load_dwordx4 a[4:7], v3, s[8:11], s35 offen offset:0 sc1
buffer_load_dwordx4 a[8:11], v3, s[8:11], s36 offen offset:0 sc1
buffer_load_dwordx4 a[12:15], v3, s[8:11], s37 offen offset:0 sc1
buffer_load_dwordx4 a[16:19], v3, s[8:11], s34 offen offset:1024 sc1
buffer_load_dwordx4 a[20:23], v3, s[8:11], s35 offen offset:1024 sc1
buffer_load_dwordx4 a[24:27], v3, s[8:11], s36 offen offset:1024 sc1
buffer_load_dwordx4 a[28:31], v3, s[8:11], s37 offen offset:1024 sc1
buffer_load_dwordx4 a[32:35], v3, s[8:11], s34 offen offset:2048 sc1
buffer_load_dwordx4 a[36:39], v3, s[8:11], s35 offen offset:2048 sc1
buffer_load_dwordx4 a[40:43], v3, s[8:11], s36 offen offset:2048 sc1
buffer_load_dwordx4 a[44:47], v3, s[8:11], s37 offen offset:2048 sc1
s_mov_b32 s51, s54
s_mov_b32 s42, 8
s_mov_b32 s65, 0x40000000
s_sub_u32 s60, s2, 128
s_cmp_ge_u32 s60, 72
s_cselect_b32 s61, 72, 0
s_sub_u32 s62, s60, s61
s_and_b32 s63, s62, 15
s_lshl_b32 s63, s63, 2
s_lshr_b32 s68, s62, 4
s_add_u32 s63, s63, s68
s_cmp_lt_u32 s62, 64
s_cselect_b32 s62, s63, s62
s_add_u32 s62, s62, s61
s_cmp_lt_u32 s2, 128
s_cselect_b32 s62, s2, s62
s_mul_i32 s68, s62, 36864
s_mul_i32 s69, s2, 36864
s_add_u32 s69, s69, 67108864
s_add_u32 s69, s69, s52
s_sub_u32 s72, s2, 200
s_mul_i32 s60, s72, 43
s_lshr_b32 s60, s60, 7
s_mul_i32 s61, s60, 3
s_sub_u32 s61, s72, s61
s_add_u32 s62, s60, 56
s_and_b32 s63, s62, 15
s_lshl_b32 s63, s63, 2
s_add_u32 s63, s63, 3
s_cmp_lt_u32 s62, 64
s_cselect_b32 s62, s63, s62
s_add_u32 s62, s62, 72
s_mul_i32 s71, s62, 36864
s_mul_i32 s63, s61, 384
s_add_u32 s71, s71, s63
s_mul_i32 s60, s72, 12288
s_add_u32 s60, s60, 76546048
s_add_u32 s60, s60, s52
s_cmp_lt_u32 s72, 48
s_cselect_b32 s71, s71, 0x40000000
s_cselect_b32 s72, s60, 0x40000000
s_mov_b32 s70, 0x40000000
ds_read_b64_tr_b16 v[160:161], v26 offset:0
ds_read_b64_tr_b16 v[162:163], v26 offset:1024
ds_read_b64_tr_b16 v[164:165], v26 offset:8
ds_read_b64_tr_b16 v[166:167], v26 offset:1032
ds_read_b64_tr_b16 v[168:169], v27 offset:0
ds_read_b64_tr_b16 v[170:171], v27 offset:1024
ds_read_b64_tr_b16 v[172:173], v27 offset:8
ds_read_b64_tr_b16 v[174:175], v27 offset:1032
ds_read_b64_tr_b16 v[176:177], v28 offset:0
ds_read_b64_tr_b16 v[178:179], v28 offset:1024
ds_read_b64_tr_b16 v[180:181], v28 offset:8
ds_read_b64_tr_b16 v[182:183], v28 offset:1032
ds_read_b64_tr_b16 v[184:185], v29 offset:0
ds_read_b64_tr_b16 v[186:187], v29 offset:1024
s_waitcnt vmcnt(11) lgkmcnt(12)
v_mfma_f32_16x16x32_bf16 v[32:35], v[160:163], a[0:3], 0
s_waitcnt vmcnt(10)
v_mfma_f32_16x16x32_bf16 v[36:39], v[160:163], a[4:7], 0
s_waitcnt vmcnt(9)
v_mfma_f32_16x16x32_bf16 v[40:43], v[160:163], a[8:11], 0
s_waitcnt vmcnt(8) lgkmcnt(10)
ds_read_b64_tr_b16 v[188:189], v29 offset:8
ds_read_b64_tr_b16 v[190:191], v29 offset:1032
v_mfma_f32_16x16x32_bf16 v[44:47], v[160:163], a[12:15], 0
buffer_load_dwordx4 a[48:51], v3, s[8:11], s34 offen offset:3072 sc1
v_mfma_f32_16x16x32_bf16 v[48:51], v[164:167], a[0:3], 0
v_mfma_f32_16x16x32_bf16 v[52:55], v[164:167], a[4:7], 0
v_mfma_f32_16x16x32_bf16 v[56:59], v[164:167], a[8:11], 0
ds_read_b64_tr_b16 v[160:161], v26 offset:8192
ds_read_b64_tr_b16 v[162:163], v26 offset:9216
v_mfma_f32_16x16x32_bf16 v[60:63], v[164:167], a[12:15], 0
s_waitcnt lgkmcnt(12)
ds_read_b64_tr_b16 v[164:165], v26 offset:16384
ds_read_b64_tr_b16 v[166:167], v26 offset:17408
v_mfma_f32_16x16x32_bf16 v[64:67], v[168:171], a[0:3], 0
buffer_load_dwordx4 a[52:55], v3, s[8:11], s35 offen offset:3072 sc1
v_mfma_f32_16x16x32_bf16 v[68:71], v[168:171], a[4:7], 0
v_mfma_f32_16x16x32_bf16 v[72:75], v[168:171], a[8:11], 0
v_mfma_f32_16x16x32_bf16 v[76:79], v[168:171], a[12:15], 0
s_waitcnt lgkmcnt(12)
v_mfma_f32_16x16x32_bf16 v[80:83], v[172:175], a[0:3], 0
v_mfma_f32_16x16x32_bf16 v[84:87], v[172:175], a[4:7], 0
buffer_load_dwordx4 a[56:59], v3, s[8:11], s36 offen offset:3072 sc1
v_mfma_f32_16x16x32_bf16 v[88:91], v[172:175], a[8:11], 0
ds_read_b64_tr_b16 v[168:169], v26 offset:8200
ds_read_b64_tr_b16 v[170:171], v26 offset:9224
v_mfma_f32_16x16x32_bf16 v[92:95], v[172:175], a[12:15], 0
s_waitcnt lgkmcnt(12)
ds_read_b64_tr_b16 v[172:173], v26 offset:16392
ds_read_b64_tr_b16 v[174:175], v26 offset:17416
v_mfma_f32_16x16x32_bf16 v[96:99], v[176:179], a[0:3], 0
v_mfma_f32_16x16x32_bf16 v[100:103], v[176:179], a[4:7], 0
v_mfma_f32_16x16x32_bf16 v[104:107], v[176:179], a[8:11], 0
buffer_load_dwordx4 a[60:63], v3, s[8:11], s37 offen offset:3072 sc1
v_mfma_f32_16x16x32_bf16 v[108:111], v[176:179], a[12:15], 0
s_waitcnt lgkmcnt(10)
v_mfma_f32_16x16x32_bf16 v[112:115], v[180:183], a[0:3], 0
s_add_u32 s34, s64, 12288
v_mfma_f32_16x16x32_bf16 v[116:119], v[180:183], a[4:7], 0
s_add_u32 s35, s64, 30720
v_mfma_f32_16x16x32_bf16 v[120:123], v[180:183], a[8:11], 0
s_add_u32 s36, s64, 49152
ds_read_b64_tr_b16 v[176:177], v27 offset:8192
ds_read_b64_tr_b16 v[178:179], v27 offset:9216
v_mfma_f32_16x16x32_bf16 v[124:127], v[180:183], a[12:15], 0
s_add_u32 s37, s64, 67584
ds_read_b64_tr_b16 v[180:181], v27 offset:16384
ds_read_b64_tr_b16 v[182:183], v27 offset:17408
v_mfma_f32_16x16x32_bf16 v[128:131], v[184:187], a[0:3], 0
buffer_load_dwordx4 a[64:67], v3, s[8:11], s34 offen offset:0 sc1
v_mfma_f32_16x16x32_bf16 v[132:135], v[184:187], a[4:7], 0
v_mfma_f32_16x16x32_bf16 v[136:139], v[184:187], a[8:11], 0
v_mfma_f32_16x16x32_bf16 v[140:143], v[184:187], a[12:15], 0
s_waitcnt lgkmcnt(12)
v_mfma_f32_16x16x32_bf16 v[144:147], v[188:191], a[0:3], 0
buffer_load_dwordx4 a[68:71], v3, s[8:11], s35 offen offset:0 sc1
v_mfma_f32_16x16x32_bf16 v[148:151], v[188:191], a[4:7], 0
v_mfma_f32_16x16x32_bf16 v[152:155], v[188:191], a[8:11], 0
ds_read_b64_tr_b16 v[184:185], v27 offset:8200
ds_read_b64_tr_b16 v[186:187], v27 offset:9224
v_mfma_f32_16x16x32_bf16 v[156:159], v[188:191], a[12:15], 0
s_waitcnt vmcnt(13) lgkmcnt(12)
ds_read_b64_tr_b16 v[188:189], v27 offset:16392
ds_read_b64_tr_b16 v[190:191], v27 offset:17416
v_mfma_f32_16x16x32_bf16 v[32:35], v[160:163], a[16:19], v[32:35]
s_waitcnt vmcnt(9) lgkmcnt(12)
v_mfma_f32_16x16x32_bf16 v[32:35], v[164:167], a[32:35], v[32:35]
buffer_load_dwordx4 a[72:75], v3, s[8:11], s36 offen offset:0 sc1
v_mfma_f32_16x16x32_bf16 v[36:39], v[160:163], a[20:23], v[36:39]
s_waitcnt vmcnt(9)
v_mfma_f32_16x16x32_bf16 v[36:39], v[164:167], a[36:39], v[36:39]
v_mfma_f32_16x16x32_bf16 v[40:43], v[160:163], a[24:27], v[40:43]
s_waitcnt vmcnt(8)
v_mfma_f32_16x16x32_bf16 v[40:43], v[164:167], a[40:43], v[40:43]
v_mfma_f32_16x16x32_bf16 v[44:47], v[160:163], a[28:31], v[44:47]
s_waitcnt vmcnt(7) lgkmcnt(10)
ds_read_b64_tr_b16 v[160:161], v28 offset:8192
ds_read_b64_tr_b16 v[162:163], v28 offset:9216
v_mfma_f32_16x16x32_bf16 v[44:47], v[164:167], a[44:47], v[44:47]
buffer_load_dwordx4 a[76:79], v3, s[8:11], s37 offen offset:0 sc1
v_mfma_f32_16x16x32_bf16 v[48:51], v[168:171], a[16:19], v[48:51]
s_waitcnt lgkmcnt(10)
ds_read_b64_tr_b16 v[164:165], v28 offset:16384
ds_read_b64_tr_b16 v[166:167], v28 offset:17408
v_mfma_f32_16x16x32_bf16 v[48:51], v[172:175], a[32:35], v[48:51]
v_mfma_f32_16x16x32_bf16 v[52:55], v[168:171], a[20:23], v[52:55]
v_mfma_f32_16x16x32_bf16 v[52:55], v[172:175], a[36:39], v[52:55]
buffer_load_dwordx4 a[80:83], v3, s[8:11], s34 offen offset:1024 sc1
v_mfma_f32_16x16x32_bf16 v[56:59], v[168:171], a[24:27], v[56:59]
v_mfma_f32_16x16x32_bf16 v[56:59], v[172:175], a[40:43], v[56:59]
v_mfma_f32_16x16x32_bf16 v[60:63], v[168:171], a[28:31], v[60:63]
ds_read_b64_tr_b16 v[168:169], v28 offset:8200
ds_read_b64_tr_b16 v[170:171], v28 offset:9224
v_mfma_f32_16x16x32_bf16 v[60:63], v[172:175], a[44:47], v[60:63]
s_waitcnt lgkmcnt(12)
v_mfma_f32_16x16x32_bf16 v[64:67], v[176:179], a[16:19], v[64:67]
s_waitcnt lgkmcnt(10)
ds_read_b64_tr_b16 v[172:173], v28 offset:16392
ds_read_b64_tr_b16 v[174:175], v28 offset:17416
v_mfma_f32_16x16x32_bf16 v[64:67], v[180:183], a[32:35], v[64:67]
buffer_load_dwordx4 a[84:87], v3, s[8:11], s35 offen offset:1024 sc1
v_mfma_f32_16x16x32_bf16 v[68:71], v[176:179], a[20:23], v[68:71]
v_mfma_f32_16x16x32_bf16 v[68:71], v[180:183], a[36:39], v[68:71]
v_mfma_f32_16x16x32_bf16 v[72:75], v[176:179], a[24:27], v[72:75]
v_mfma_f32_16x16x32_bf16 v[72:75], v[180:183], a[40:43], v[72:75]
buffer_load_dwordx4 a[88:91], v3, s[8:11], s36 offen offset:1024 sc1
v_mfma_f32_16x16x32_bf16 v[76:79], v[176:179], a[28:31], v[76:79]
ds_read_b64_tr_b16 v[176:177], v29 offset:8192
ds_read_b64_tr_b16 v[178:179], v29 offset:9216
v_mfma_f32_16x16x32_bf16 v[76:79], v[180:183], a[44:47], v[76:79]
s_waitcnt lgkmcnt(12)
v_mfma_f32_16x16x32_bf16 v[80:83], v[184:187], a[16:19], v[80:83]
s_waitcnt lgkmcnt(10)
ds_read_b64_tr_b16 v[180:181], v29 offset:16384
ds_read_b64_tr_b16 v[182:183], v29 offset:17408
v_mfma_f32_16x16x32_bf16 v[80:83], v[188:191], a[32:35], v[80:83]
v_mfma_f32_16x16x32_bf16 v[84:87], v[184:187], a[20:23], v[84:87]
v_mfma_f32_16x16x32_bf16 v[84:87], v[188:191], a[36:39], v[84:87]
buffer_load_dwordx4 a[92:95], v3, s[8:11], s37 offen offset:1024 sc1
v_mfma_f32_16x16x32_bf16 v[88:91], v[184:187], a[24:27], v[88:91]
v_mfma_f32_16x16x32_bf16 v[88:91], v[188:191], a[40:43], v[88:91]
v_mfma_f32_16x16x32_bf16 v[92:95], v[184:187], a[28:31], v[92:95]
s_waitcnt lgkmcnt(10)
ds_read_b64_tr_b16 v[184:185], v29 offset:8200
ds_read_b64_tr_b16 v[186:187], v29 offset:9224
v_mfma_f32_16x16x32_bf16 v[92:95], v[188:191], a[44:47], v[92:95]
buffer_load_dwordx4 a[96:99], v3, s[8:11], s34 offen offset:2048 sc1
v_mfma_f32_16x16x32_bf16 v[96:99], v[160:163], a[16:19], v[96:99]
s_waitcnt lgkmcnt(10)
ds_read_b64_tr_b16 v[188:189], v29 offset:16392
ds_read_b64_tr_b16 v[190:191], v29 offset:17416
v_mfma_f32_16x16x32_bf16 v[96:99], v[164:167], a[32:35], v[96:99]
v_mfma_f32_16x16x32_bf16 v[100:103], v[160:163], a[20:23], v[100:103]
v_mfma_f32_16x16x32_bf16 v[100:103], v[164:167], a[36:39], v[100:103]
v_mfma_f32_16x16x32_bf16 v[104:107], v[160:163], a[24:27], v[104:107]
v_mfma_f32_16x16x32_bf16 v[104:107], v[164:167], a[40:43], v[104:107]
buffer_load_dwordx4 a[100:103], v3, s[8:11], s35 offen offset:2048 sc1
v_mfma_f32_16x16x32_bf16 v[108:111], v[160:163], a[28:31], v[108:111]
ds_read_b64_tr_b16 v[160:161], v26 offset:24576
ds_read_b64_tr_b16 v[162:163], v26 offset:25600
v_mfma_f32_16x16x32_bf16 v[108:111], v[164:167], a[44:47], v[108:111]
s_waitcnt lgkmcnt(12)
v_mfma_f32_16x16x32_bf16 v[112:115], v[168:171], a[16:19], v[112:115]
s_waitcnt lgkmcnt(10)
ds_read_b64_tr_b16 v[164:165], v26 offset:32768
ds_read_b64_tr_b16 v[166:167], v26 offset:33792
v_mfma_f32_16x16x32_bf16 v[112:115], v[172:175], a[32:35], v[112:115]
buffer_load_dwordx4 a[104:107], v3, s[8:11], s36 offen offset:2048 sc1
v_mfma_f32_16x16x32_bf16 v[116:119], v[168:171], a[20:23], v[116:119]
v_mfma_f32_16x16x32_bf16 v[116:119], v[172:175], a[36:39], v[116:119]
v_mfma_f32_16x16x32_bf16 v[120:123], v[168:171], a[24:27], v[120:123]
v_mfma_f32_16x16x32_bf16 v[120:123], v[172:175], a[40:43], v[120:123]
v_mfma_f32_16x16x32_bf16 v[124:127], v[168:171], a[28:31], v[124:127]
s_waitcnt lgkmcnt(10)
ds_read_b64_tr_b16 v[168:169], v26 offset:24584
ds_read_b64_tr_b16 v[170:171], v26 offset:25608
v_mfma_f32_16x16x32_bf16 v[124:127], v[172:175], a[44:47], v[124:127]
buffer_load_dwordx4 a[108:111], v3, s[8:11], s37 offen offset:2048 sc1
v_mfma_f32_16x16x32_bf16 v[128:131], v[176:179], a[16:19], v[128:131]
s_waitcnt lgkmcnt(10)
ds_read_b64_tr_b16 v[172:173], v26 offset:32776
ds_read_b64_tr_b16 v[174:175], v26 offset:33800
v_mfma_f32_16x16x32_bf16 v[128:131], v[180:183], a[32:35], v[128:131]
v_mfma_f32_16x16x32_bf16 v[132:135], v[176:179], a[20:23], v[132:135]
v_mfma_f32_16x16x32_bf16 v[132:135], v[180:183], a[36:39], v[132:135]
buffer_load_dwordx4 a[112:115], v3, s[8:11], s34 offen offset:3072 sc1
v_mfma_f32_16x16x32_bf16 v[136:139], v[176:179], a[24:27], v[136:139]
v_mfma_f32_16x16x32_bf16 v[136:139], v[180:183], a[40:43], v[136:139]
v_mfma_f32_16x16x32_bf16 v[140:143], v[176:179], a[28:31], v[140:143]
ds_read_b64_tr_b16 v[176:177], v27 offset:24576
ds_read_b64_tr_b16 v[178:179], v27 offset:25600
v_mfma_f32_16x16x32_bf16 v[140:143], v[180:183], a[44:47], v[140:143]
s_waitcnt lgkmcnt(12)
v_mfma_f32_16x16x32_bf16 v[144:147], v[184:187], a[16:19], v[144:147]
s_waitcnt lgkmcnt(10)
ds_read_b64_tr_b16 v[180:181], v27 offset:32768
ds_read_b64_tr_b16 v[182:183], v27 offset:33792
v_mfma_f32_16x16x32_bf16 v[144:147], v[188:191], a[32:35], v[144:147]
buffer_load_dwordx4 a[116:119], v3, s[8:11], s35 offen offset:3072 sc1
v_mfma_f32_16x16x32_bf16 v[148:151], v[184:187], a[20:23], v[148:151]
v_mfma_f32_16x16x32_bf16 v[148:151], v[188:191], a[36:39], v[148:151]
v_mfma_f32_16x16x32_bf16 v[152:155], v[184:187], a[24:27], v[152:155]
v_mfma_f32_16x16x32_bf16 v[152:155], v[188:191], a[40:43], v[152:155]
buffer_load_dwordx4 a[120:123], v3, s[8:11], s36 offen offset:3072 sc1
v_mfma_f32_16x16x32_bf16 v[156:159], v[184:187], a[28:31], v[156:159]
ds_read_b64_tr_b16 v[184:185], v27 offset:24584
ds_read_b64_tr_b16 v[186:187], v27 offset:25608
v_mfma_f32_16x16x32_bf16 v[156:159], v[188:191], a[44:47], v[156:159]
s_waitcnt vmcnt(18) lgkmcnt(12)
v_mfma_f32_16x16x32_bf16 v[32:35], v[160:163], a[48:51], v[32:35]
s_waitcnt vmcnt(14) lgkmcnt(10)
ds_read_b64_tr_b16 v[188:189], v27 offset:32776
ds_read_b64_tr_b16 v[190:191], v27 offset:33800
v_mfma_f32_16x16x32_bf16 v[32:35], v[164:167], a[64:67], v[32:35]
v_mfma_f32_16x16x32_bf16 v[36:39], v[160:163], a[52:55], v[36:39]
s_waitcnt vmcnt(13)
v_mfma_f32_16x16x32_bf16 v[36:39], v[164:167], a[68:71], v[36:39]
buffer_load_dwordx4 a[124:127], v3, s[8:11], s37 offen offset:3072 sc1
v_mfma_f32_16x16x32_bf16 v[40:43], v[160:163], a[56:59], v[40:43]
s_waitcnt vmcnt(12) lgkmcnt(8)
v_mfma_f32_16x16x32_bf16 v[40:43], v[164:167], a[72:75], v[40:43]
s_add_u32 s34, s64, 16384
v_mfma_f32_16x16x32_bf16 v[44:47], v[160:163], a[60:63], v[44:47]
s_add_u32 s35, s64, 34816
ds_read_b64_tr_b16 v[160:161], v28 offset:24576
ds_read_b64_tr_b16 v[162:163], v28 offset:25600
v_mfma_f32_16x16x32_bf16 v[44:47], v[164:167], a[76:79], v[44:47]
s_add_u32 s36, s64, 53248
v_mfma_f32_16x16x32_bf16 v[48:51], v[168:171], a[48:51], v[48:51]
s_add_u32 s37, s64, 71680
ds_read_b64_tr_b16 v[164:165], v28 offset:32768
ds_read_b64_tr_b16 v[166:167], v28 offset:33792
v_mfma_f32_16x16x32_bf16 v[48:51], v[172:175], a[64:67], v[48:51]
buffer_load_dwordx4 v[192:195], v3, s[8:11], s34 offen offset:0 sc1
v_mfma_f32_16x16x32_bf16 v[52:55], v[168:171], a[52:55], v[52:55]
v_mfma_f32_16x16x32_bf16 v[52:55], v[172:175], a[68:71], v[52:55]
v_mfma_f32_16x16x32_bf16 v[56:59], v[168:171], a[56:59], v[56:59]
v_mfma_f32_16x16x32_bf16 v[56:59], v[172:175], a[72:75], v[56:59]
buffer_load_dwordx4 v[196:199], v3, s[8:11], s35 offen offset:0 sc1
v_mfma_f32_16x16x32_bf16 v[60:63], v[168:171], a[60:63], v[60:63]
ds_read_b64_tr_b16 v[168:169], v28 offset:24584
ds_read_b64_tr_b16 v[170:171], v28 offset:25608
v_mfma_f32_16x16x32_bf16 v[60:63], v[172:175], a[76:79], v[60:63]
s_waitcnt lgkmcnt(12)
v_mfma_f32_16x16x32_bf16 v[64:67], v[176:179], a[48:51], v[64:67]
s_waitcnt lgkmcnt(10)
ds_read_b64_tr_b16 v[172:173], v28 offset:32776
ds_read_b64_tr_b16 v[174:175], v28 offset:33800
v_mfma_f32_16x16x32_bf16 v[64:67], v[180:183], a[64:67], v[64:67]
buffer_load_dwordx4 v[200:203], v3, s[8:11], s36 offen offset:0 sc1
v_mfma_f32_16x16x32_bf16 v[68:71], v[176:179], a[52:55], v[68:71]
v_mfma_f32_16x16x32_bf16 v[68:71], v[180:183], a[68:71], v[68:71]
v_mfma_f32_16x16x32_bf16 v[72:75], v[176:179], a[56:59], v[72:75]
v_mfma_f32_16x16x32_bf16 v[72:75], v[180:183], a[72:75], v[72:75]
v_mfma_f32_16x16x32_bf16 v[76:79], v[176:179], a[60:63], v[76:79]
s_waitcnt lgkmcnt(10)
ds_read_b64_tr_b16 v[176:177], v29 offset:24576
ds_read_b64_tr_b16 v[178:179], v29 offset:25600
v_mfma_f32_16x16x32_bf16 v[76:79], v[180:183], a[76:79], v[76:79]
buffer_load_dwordx4 v[204:207], v3, s[8:11], s37 offen offset:0 sc1
v_mfma_f32_16x16x32_bf16 v[80:83], v[184:187], a[48:51], v[80:83]
s_waitcnt lgkmcnt(10)
ds_read_b64_tr_b16 v[180:181], v29 offset:32768
ds_read_b64_tr_b16 v[182:183], v29 offset:33792
v_mfma_f32_16x16x32_bf16 v[80:83], v[188:191], a[64:67], v[80:83]
v_mfma_f32_16x16x32_bf16 v[84:87], v[184:187], a[52:55], v[84:87]
v_mfma_f32_16x16x32_bf16 v[84:87], v[188:191], a[68:71], v[84:87]
buffer_load_dwordx4 v[208:211], v3, s[8:11], s34 offen offset:1024 sc1
v_mfma_f32_16x16x32_bf16 v[88:91], v[184:187], a[56:59], v[88:91]
v_mfma_f32_16x16x32_bf16 v[88:91], v[188:191], a[72:75], v[88:91]
v_mfma_f32_16x16x32_bf16 v[92:95], v[184:187], a[60:63], v[92:95]
ds_read_b64_tr_b16 v[184:185], v29 offset:24584
ds_read_b64_tr_b16 v[186:187], v29 offset:25608
v_mfma_f32_16x16x32_bf16 v[92:95], v[188:191], a[76:79], v[92:95]
s_waitcnt lgkmcnt(12)
v_mfma_f32_16x16x32_bf16 v[96:99], v[160:163], a[48:51], v[96:99]
s_waitcnt lgkmcnt(10)
ds_read_b64_tr_b16 v[188:189], v29 offset:32776
ds_read_b64_tr_b16 v[190:191], v29 offset:33800
v_mfma_f32_16x16x32_bf16 v[96:99], v[164:167], a[64:67], v[96:99]
buffer_load_dwordx4 v[212:215], v3, s[8:11], s35 offen offset:1024 sc1
v_mfma_f32_16x16x32_bf16 v[100:103], v[160:163], a[52:55], v[100:103]
v_mfma_f32_16x16x32_bf16 v[100:103], v[164:167], a[68:71], v[100:103]
v_mfma_f32_16x16x32_bf16 v[104:107], v[160:163], a[56:59], v[104:107]
v_mfma_f32_16x16x32_bf16 v[104:107], v[164:167], a[72:75], v[104:107]
buffer_load_dwordx4 v[216:219], v3, s[8:11], s36 offen offset:1024 sc1
v_mfma_f32_16x16x32_bf16 v[108:111], v[160:163], a[60:63], v[108:111]
ds_read_b64_tr_b16 v[160:161], v26 offset:40960
ds_read_b64_tr_b16 v[162:163], v26 offset:41984
v_mfma_f32_16x16x32_bf16 v[108:111], v[164:167], a[76:79], v[108:111]
s_waitcnt lgkmcnt(12)
v_mfma_f32_16x16x32_bf16 v[112:115], v[168:171], a[48:51], v[112:115]
s_waitcnt lgkmcnt(10)
ds_read_b64_tr_b16 v[164:165], v26 offset:49152
ds_read_b64_tr_b16 v[166:167], v26 offset:50176
v_mfma_f32_16x16x32_bf16 v[112:115], v[172:175], a[64:67], v[112:115]
v_mfma_f32_16x16x32_bf16 v[116:119], v[168:171], a[52:55], v[116:119]
v_mfma_f32_16x16x32_bf16 v[116:119], v[172:175], a[68:71], v[116:119]
buffer_load_dwordx4 v[220:223], v3, s[8:11], s37 offen offset:1024 sc1
v_mfma_f32_16x16x32_bf16 v[120:123], v[168:171], a[56:59], v[120:123]
s_waitcnt lgkmcnt(8)
v_mfma_f32_16x16x32_bf16 v[120:123], v[172:175], a[72:75], v[120:123]
s_add_u32 s34, s64, 0
v_mfma_f32_16x16x32_bf16 v[124:127], v[168:171], a[60:63], v[124:127]
s_add_u32 s35, s64, 18432
ds_read_b64_tr_b16 v[168:169], v26 offset:57344
ds_read_b64_tr_b16 v[170:171], v26 offset:58368
v_mfma_f32_16x16x32_bf16 v[124:127], v[172:175], a[76:79], v[124:127]
s_add_u32 s36, s64, 36864
v_mfma_f32_16x16x32_bf16 v[128:131], v[176:179], a[48:51], v[128:131]
s_add_u32 s37, s64, 55296
v_mfma_f32_16x16x32_bf16 v[128:131], v[180:183], a[64:67], v[128:131]
buffer_load_dwordx4 a[160:163], v3, s[8:11], s34 offen offset:0 sc1
v_mfma_f32_16x16x32_bf16 v[132:135], v[176:179], a[52:55], v[132:135]
ds_read_b64_tr_b16 v[172:173], v26 offset:40968
ds_read_b64_tr_b16 v[174:175], v26 offset:41992
v_mfma_f32_16x16x32_bf16 v[132:135], v[180:183], a[68:71], v[132:135]
v_mfma_f32_16x16x32_bf16 v[136:139], v[176:179], a[56:59], v[136:139]
v_mfma_f32_16x16x32_bf16 v[136:139], v[180:183], a[72:75], v[136:139]
buffer_load_dwordx4 a[164:167], v3, s[8:11], s35 offen offset:0 sc1
v_mfma_f32_16x16x32_bf16 v[140:143], v[176:179], a[60:63], v[140:143]
ds_read_b64_tr_b16 v[176:177], v26 offset:49160
ds_read_b64_tr_b16 v[178:179], v26 offset:50184
v_mfma_f32_16x16x32_bf16 v[140:143], v[180:183], a[76:79], v[140:143]
s_waitcnt lgkmcnt(12)
v_mfma_f32_16x16x32_bf16 v[144:147], v[184:187], a[48:51], v[144:147]
s_waitcnt lgkmcnt(10)
ds_read_b64_tr_b16 v[180:181], v26 offset:57352
ds_read_b64_tr_b16 v[182:183], v26 offset:58376
v_mfma_f32_16x16x32_bf16 v[144:147], v[188:191], a[64:67], v[144:147]
v_add_u32 v26, 0x10000, v26
v_mfma_f32_16x16x32_bf16 v[148:151], v[184:187], a[52:55], v[148:151]
v_mfma_f32_16x16x32_bf16 v[148:151], v[188:191], a[68:71], v[148:151]
buffer_load_dwordx4 a[168:171], v3, s[8:11], s36 offen offset:0 sc1
v_mfma_f32_16x16x32_bf16 v[152:155], v[184:187], a[56:59], v[152:155]
v_mfma_f32_16x16x32_bf16 v[152:155], v[188:191], a[72:75], v[152:155]
v_mfma_f32_16x16x32_bf16 v[156:159], v[184:187], a[60:63], v[156:159]
s_waitcnt vmcnt(22) lgkmcnt(10)
ds_read_b64_tr_b16 v[184:185], v27 offset:40960
ds_read_b64_tr_b16 v[186:187], v27 offset:41984
v_mfma_f32_16x16x32_bf16 v[156:159], v[188:191], a[76:79], v[156:159]
buffer_load_dwordx4 a[172:175], v3, s[8:11], s37 offen offset:0 sc1
v_mfma_f32_16x16x32_bf16 v[32:35], v[160:163], a[80:83], v[32:35]
s_waitcnt vmcnt(19) lgkmcnt(10)
v_mfma_f32_16x16x32_bf16 v[32:35], v[164:167], a[96:99], v[32:35]
s_waitcnt vmcnt(15) lgkmcnt(8)
ds_read_b64_tr_b16 v[188:189], v27 offset:49152
ds_read_b64_tr_b16 v[190:191], v27 offset:50176
v_mfma_f32_16x16x32_bf16 v[32:35], v[168:171], a[112:115], v[32:35]
v_mfma_f32_16x16x32_bf16 v[36:39], v[160:163], a[84:87], v[36:39]
v_mfma_f32_16x16x32_bf16 v[36:39], v[164:167], a[100:103], v[36:39]
s_waitcnt vmcnt(14)
v_mfma_f32_16x16x32_bf16 v[36:39], v[168:171], a[116:119], v[36:39]
buffer_load_dwordx4 a[176:179], v3, s[8:11], s34 offen offset:1024 sc1
v_mfma_f32_16x16x32_bf16 v[40:43], v[160:163], a[88:91], v[40:43]
v_mfma_f32_16x16x32_bf16 v[40:43], v[164:167], a[104:107], v[40:43]
s_waitcnt vmcnt(14)
v_mfma_f32_16x16x32_bf16 v[40:43], v[168:171], a[120:123], v[40:43]
buffer_load_dwordx4 a[180:183], v3, s[8:11], s35 offen offset:1024 sc1
v_mfma_f32_16x16x32_bf16 v[44:47], v[160:163], a[92:95], v[44:47]
v_mfma_f32_16x16x32_bf16 v[44:47], v[164:167], a[108:111], v[44:47]
s_waitcnt vmcnt(14)
ds_read_b64_tr_b16 v[160:161], v27 offset:57344
ds_read_b64_tr_b16 v[162:163], v27 offset:58368
v_mfma_f32_16x16x32_bf16 v[44:47], v[168:171], a[124:127], v[44:47]
s_waitcnt lgkmcnt(10)
v_mfma_f32_16x16x32_bf16 v[48:51], v[172:175], a[80:83], v[48:51]
s_waitcnt lgkmcnt(8)
v_mfma_f32_16x16x32_bf16 v[48:51], v[176:179], a[96:99], v[48:51]
s_waitcnt lgkmcnt(6)
ds_read_b64_tr_b16 v[164:165], v27 offset:40968
ds_read_b64_tr_b16 v[166:167], v27 offset:41992
v_mfma_f32_16x16x32_bf16 v[48:51], v[180:183], a[112:115], v[48:51]
buffer_load_dwordx4 a[184:187], v3, s[8:11], s36 offen offset:1024 sc1
v_mfma_f32_16x16x32_bf16 v[52:55], v[172:175], a[84:87], v[52:55]
v_mfma_f32_16x16x32_bf16 v[52:55], v[176:179], a[100:103], v[52:55]
ds_read_b64_tr_b16 v[168:169], v27 offset:49160
ds_read_b64_tr_b16 v[170:171], v27 offset:50184
v_mfma_f32_16x16x32_bf16 v[52:55], v[180:183], a[116:119], v[52:55]
v_mfma_f32_16x16x32_bf16 v[56:59], v[172:175], a[88:91], v[56:59]
v_mfma_f32_16x16x32_bf16 v[56:59], v[176:179], a[104:107], v[56:59]
v_mfma_f32_16x16x32_bf16 v[56:59], v[180:183], a[120:123], v[56:59]
buffer_load_dwordx4 a[188:191], v3, s[8:11], s37 offen offset:1024 sc1
v_mfma_f32_16x16x32_bf16 v[60:63], v[172:175], a[92:95], v[60:63]
v_mfma_f32_16x16x32_bf16 v[60:63], v[176:179], a[108:111], v[60:63]
ds_read_b64_tr_b16 v[172:173], v27 offset:57352
ds_read_b64_tr_b16 v[174:175], v27 offset:58376
v_mfma_f32_16x16x32_bf16 v[60:63], v[180:183], a[124:127], v[60:63]
s_waitcnt lgkmcnt(10)
v_add_u32 v27, 0x10000, v27
v_mfma_f32_16x16x32_bf16 v[64:67], v[184:187], a[80:83], v[64:67]
s_waitcnt lgkmcnt(8)
v_mfma_f32_16x16x32_bf16 v[64:67], v[188:191], a[96:99], v[64:67]
s_waitcnt lgkmcnt(6)
ds_read_b64_tr_b16 v[176:177], v28 offset:40960
ds_read_b64_tr_b16 v[178:179], v28 offset:41984
v_mfma_f32_16x16x32_bf16 v[64:67], v[160:163], a[112:115], v[64:67]
buffer_load_dwordx4 a[192:195], v3, s[8:11], s34 offen offset:2048 sc1
v_mfma_f32_16x16x32_bf16 v[68:71], v[184:187], a[84:87], v[68:71]
v_mfma_f32_16x16x32_bf16 v[68:71], v[188:191], a[100:103], v[68:71]
ds_read_b64_tr_b16 v[180:181], v28 offset:49152
ds_read_b64_tr_b16 v[182:183], v28 offset:50176
v_mfma_f32_16x16x32_bf16 v[68:71], v[160:163], a[116:119], v[68:71]
buffer_load_dwordx4 a[196:199], v3, s[8:11], s35 offen offset:2048 sc1
v_mfma_f32_16x16x32_bf16 v[72:75], v[184:187], a[88:91], v[72:75]
v_mfma_f32_16x16x32_bf16 v[72:75], v[188:191], a[104:107], v[72:75]
v_mfma_f32_16x16x32_bf16 v[72:75], v[160:163], a[120:123], v[72:75]
v_mfma_f32_16x16x32_bf16 v[76:79], v[184:187], a[92:95], v[76:79]
v_mfma_f32_16x16x32_bf16 v[76:79], v[188:191], a[108:111], v[76:79]
s_waitcnt lgkmcnt(8)
ds_read_b64_tr_b16 v[184:185], v28 offset:57344
ds_read_b64_tr_b16 v[186:187], v28 offset:58368
v_mfma_f32_16x16x32_bf16 v[76:79], v[160:163], a[124:127], v[76:79]
buffer_load_dwordx4 a[200:203], v3, s[8:11], s36 offen offset:2048 sc1
v_mfma_f32_16x16x32_bf16 v[80:83], v[164:167], a[80:83], v[80:83]
s_waitcnt lgkmcnt(8)
v_mfma_f32_16x16x32_bf16 v[80:83], v[168:171], a[96:99], v[80:83]
s_waitcnt lgkmcnt(6)
ds_read_b64_tr_b16 v[188:189], v28 offset:40968
ds_read_b64_tr_b16 v[190:191], v28 offset:41992
v_mfma_f32_16x16x32_bf16 v[80:83], v[172:175], a[112:115], v[80:83]
buffer_load_dwordx4 a[204:207], v3, s[8:11], s37 offen offset:2048 sc1
v_mfma_f32_16x16x32_bf16 v[84:87], v[164:167], a[84:87], v[84:87]
v_mfma_f32_16x16x32_bf16 v[84:87], v[168:171], a[100:103], v[84:87]
ds_read_b64_tr_b16 v[160:161], v28 offset:49160
ds_read_b64_tr_b16 v[162:163], v28 offset:50184
v_mfma_f32_16x16x32_bf16 v[84:87], v[172:175], a[116:119], v[84:87]
v_mfma_f32_16x16x32_bf16 v[88:91], v[164:167], a[88:91], v[88:91]
v_mfma_f32_16x16x32_bf16 v[88:91], v[168:171], a[104:107], v[88:91]
v_mfma_f32_16x16x32_bf16 v[88:91], v[172:175], a[120:123], v[88:91]
buffer_load_dwordx4 a[208:211], v3, s[8:11], s34 offen offset:3072 sc1
v_mfma_f32_16x16x32_bf16 v[92:95], v[164:167], a[92:95], v[92:95]
v_mfma_f32_16x16x32_bf16 v[92:95], v[168:171], a[108:111], v[92:95]
ds_read_b64_tr_b16 v[164:165], v28 offset:57352
ds_read_b64_tr_b16 v[166:167], v28 offset:58376
v_mfma_f32_16x16x32_bf16 v[92:95], v[172:175], a[124:127], v[92:95]
s_waitcnt lgkmcnt(10)
v_add_u32 v28, 0x10000, v28
v_mfma_f32_16x16x32_bf16 v[96:99], v[176:179], a[80:83], v[96:99]
s_waitcnt lgkmcnt(8)
v_mfma_f32_16x16x32_bf16 v[96:99], v[180:183], a[96:99], v[96:99]
s_waitcnt lgkmcnt(6)
ds_read_b64_tr_b16 v[168:169], v29 offset:40960
ds_read_b64_tr_b16 v[170:171], v29 offset:41984
v_mfma_f32_16x16x32_bf16 v[96:99], v[184:187], a[112:115], v[96:99]
buffer_load_dwordx4 a[212:215], v3, s[8:11], s35 offen offset:3072 sc1
v_mfma_f32_16x16x32_bf16 v[100:103], v[176:179], a[84:87], v[100:103]
v_mfma_f32_16x16x32_bf16 v[100:103], v[180:183], a[100:103], v[100:103]
ds_read_b64_tr_b16 v[172:173], v29 offset:49152
ds_read_b64_tr_b16 v[174:175], v29 offset:50176
v_mfma_f32_16x16x32_bf16 v[100:103], v[184:187], a[116:119], v[100:103]
buffer_load_dwordx4 a[216:219], v3, s[8:11], s36 offen offset:3072 sc1
v_mfma_f32_16x16x32_bf16 v[104:107], v[176:179], a[88:91], v[104:107]
v_mfma_f32_16x16x32_bf16 v[104:107], v[180:183], a[104:107], v[104:107]
v_mfma_f32_16x16x32_bf16 v[104:107], v[184:187], a[120:123], v[104:107]
v_mfma_f32_16x16x32_bf16 v[108:111], v[176:179], a[92:95], v[108:111]
v_mfma_f32_16x16x32_bf16 v[108:111], v[180:183], a[108:111], v[108:111]
s_waitcnt lgkmcnt(8)
ds_read_b64_tr_b16 v[176:177], v29 offset:57344
ds_read_b64_tr_b16 v[178:179], v29 offset:58368
v_mfma_f32_16x16x32_bf16 v[108:111], v[184:187], a[124:127], v[108:111]
buffer_load_dwordx4 a[220:223], v3, s[8:11], s37 offen offset:3072 sc1
v_mfma_f32_16x16x32_bf16 v[112:115], v[188:191], a[80:83], v[112:115]
s_waitcnt lgkmcnt(6)
v_mfma_f32_16x16x32_bf16 v[112:115], v[160:163], a[96:99], v[112:115]
s_add_u32 s34, s64, 4096
ds_read_b64_tr_b16 v[180:181], v29 offset:40968
ds_read_b64_tr_b16 v[182:183], v29 offset:41992
v_mfma_f32_16x16x32_bf16 v[112:115], v[164:167], a[112:115], v[112:115]
s_add_u32 s35, s64, 22528
v_mfma_f32_16x16x32_bf16 v[116:119], v[188:191], a[84:87], v[116:119]
s_add_u32 s36, s64, 40960
v_mfma_f32_16x16x32_bf16 v[116:119], v[160:163], a[100:103], v[116:119]
s_add_u32 s37, s64, 59392
ds_read_b64_tr_b16 v[184:185], v29 offset:49160
ds_read_b64_tr_b16 v[186:187], v29 offset:50184
v_mfma_f32_16x16x32_bf16 v[116:119], v[164:167], a[116:119], v[116:119]
buffer_load_dwordx4 a[224:227], v3, s[8:11], s34 offen offset:0 sc1
v_mfma_f32_16x16x32_bf16 v[120:123], v[188:191], a[88:91], v[120:123]
v_mfma_f32_16x16x32_bf16 v[120:123], v[160:163], a[104:107], v[120:123]
v_mfma_f32_16x16x32_bf16 v[120:123], v[164:167], a[120:123], v[120:123]
buffer_load_dwordx4 a[228:231], v3, s[8:11], s35 offen offset:0 sc1
v_mfma_f32_16x16x32_bf16 v[124:127], v[188:191], a[92:95], v[124:127]
v_mfma_f32_16x16x32_bf16 v[124:127], v[160:163], a[108:111], v[124:127]
ds_read_b64_tr_b16 v[188:189], v29 offset:57352
ds_read_b64_tr_b16 v[190:191], v29 offset:58376
v_mfma_f32_16x16x32_bf16 v[124:127], v[164:167], a[124:127], v[124:127]
s_waitcnt lgkmcnt(10)
v_add_u32 v29, 0x10000, v29
v_mfma_f32_16x16x32_bf16 v[128:131], v[168:171], a[80:83], v[128:131]
s_waitcnt lgkmcnt(8)
v_mfma_f32_16x16x32_bf16 v[128:131], v[172:175], a[96:99], v[128:131]
s_waitcnt lgkmcnt(6)
ds_read_b64_tr_b16 v[160:161], v26 offset:0
ds_read_b64_tr_b16 v[162:163], v26 offset:1024
v_mfma_f32_16x16x32_bf16 v[128:131], v[176:179], a[112:115], v[128:131]
buffer_load_dwordx4 a[232:235], v3, s[8:11], s36 offen offset:0 sc1
v_mfma_f32_16x16x32_bf16 v[132:135], v[168:171], a[84:87], v[132:135]
v_mfma_f32_16x16x32_bf16 v[132:135], v[172:175], a[100:103], v[132:135]
ds_read_b64_tr_b16 v[164:165], v26 offset:8192
ds_read_b64_tr_b16 v[166:167], v26 offset:9216
v_mfma_f32_16x16x32_bf16 v[132:135], v[176:179], a[116:119], v[132:135]
v_mfma_f32_16x16x32_bf16 v[136:139], v[168:171], a[88:91], v[136:139]
v_mfma_f32_16x16x32_bf16 v[136:139], v[172:175], a[104:107], v[136:139]
v_mfma_f32_16x16x32_bf16 v[136:139], v[176:179], a[120:123], v[136:139]
buffer_load_dwordx4 a[236:239], v3, s[8:11], s37 offen offset:0 sc1
v_mfma_f32_16x16x32_bf16 v[140:143], v[168:171], a[92:95], v[140:143]
v_mfma_f32_16x16x32_bf16 v[140:143], v[172:175], a[108:111], v[140:143]
s_waitcnt lgkmcnt(8)
ds_read_b64_tr_b16 v[168:169], v26 offset:16384
ds_read_b64_tr_b16 v[170:171], v26 offset:17408
v_mfma_f32_16x16x32_bf16 v[140:143], v[176:179], a[124:127], v[140:143]
buffer_load_dwordx4 a[240:243], v3, s[8:11], s34 offen offset:1024 sc1
v_mfma_f32_16x16x32_bf16 v[144:147], v[180:183], a[80:83], v[144:147]
s_waitcnt lgkmcnt(8)
v_mfma_f32_16x16x32_bf16 v[144:147], v[184:187], a[96:99], v[144:147]
s_waitcnt lgkmcnt(6)
ds_read_b64_tr_b16 v[172:173], v26 offset:8
ds_read_b64_tr_b16 v[174:175], v26 offset:1032
v_mfma_f32_16x16x32_bf16 v[144:147], v[188:191], a[112:115], v[144:147]
v_mfma_f32_16x16x32_bf16 v[148:151], v[180:183], a[84:87], v[148:151]
s_barrier
v_mfma_f32_16x16x32_bf16 v[148:151], v[184:187], a[100:103], v[148:151]
ds_read_b64_tr_b16 v[176:177], v26 offset:8200
ds_read_b64_tr_b16 v[178:179], v26 offset:9224
v_mfma_f32_16x16x32_bf16 v[148:151], v[188:191], a[116:119], v[148:151]
buffer_load_dwordx4 a[244:247], v3, s[8:11], s35 offen offset:1024 sc1
v_mfma_f32_16x16x32_bf16 v[152:155], v[180:183], a[88:91], v[152:155]
v_mfma_f32_16x16x32_bf16 v[152:155], v[184:187], a[104:107], v[152:155]
v_mfma_f32_16x16x32_bf16 v[152:155], v[188:191], a[120:123], v[152:155]
v_mfma_f32_16x16x32_bf16 v[156:159], v[180:183], a[92:95], v[156:159]
v_mfma_f32_16x16x32_bf16 v[156:159], v[184:187], a[108:111], v[156:159]
s_waitcnt vmcnt(29) lgkmcnt(8)
ds_read_b64_tr_b16 v[180:181], v26 offset:16392
ds_read_b64_tr_b16 v[182:183], v26 offset:17416
v_mfma_f32_16x16x32_bf16 v[156:159], v[188:191], a[124:127], v[156:159]
buffer_load_dwordx4 a[248:251], v3, s[8:11], s36 offen offset:1024 sc1
v_mfma_f32_16x16x32_bf16 v[32:35], v[160:163], v[192:195], v[32:35]
s_waitcnt vmcnt(26) lgkmcnt(8)
v_mfma_f32_16x16x32_bf16 v[32:35], v[164:167], v[208:211], v[32:35]
s_waitcnt vmcnt(22) lgkmcnt(6)
ds_read_b64_tr_b16 v[184:185], v27 offset:0
ds_read_b64_tr_b16 v[186:187], v27 offset:1024
v_mfma_f32_16x16x32_bf16 v[32:35], v[168:171], a[160:163], v[32:35]
buffer_load_dwordx4 a[252:255], v3, s[8:11], s37 offen offset:1024 sc1
v_mfma_f32_16x16x32_bf16 v[36:39], v[160:163], v[196:199], v[36:39]
v_accvgpr_write_b32 a0, 0
v_accvgpr_write_b32 a1, 0
v_mfma_f32_16x16x32_bf16 v[36:39], v[164:167], v[212:215], v[36:39]
s_waitcnt vmcnt(22)
ds_read_b64_tr_b16 v[188:189], v27 offset:8192
ds_read_b64_tr_b16 v[190:191], v27 offset:9216
v_mfma_f32_16x16x32_bf16 v[36:39], v[168:171], a[164:167], v[36:39]
v_accvgpr_write_b32 a2, 0
v_accvgpr_write_b32 a3, 0
v_mfma_f32_16x16x32_bf16 v[40:43], v[160:163], v[200:203], v[40:43]
v_accvgpr_write_b32 a4, 0
v_accvgpr_write_b32 a5, 0
v_mfma_f32_16x16x32_bf16 v[40:43], v[164:167], v[216:219], v[40:43]
s_waitcnt vmcnt(21)
v_accvgpr_write_b32 a6, 0
v_accvgpr_write_b32 a7, 0
v_mfma_f32_16x16x32_bf16 v[40:43], v[168:171], a[168:171], v[40:43]
buffer_load_dwordx4 v[224:227], v3, s[8:11], s34 offen offset:2048 sc1
v_mfma_f32_16x16x32_bf16 v[44:47], v[160:163], v[204:207], v[44:47]
v_accvgpr_write_b32 a8, 0
v_accvgpr_write_b32 a9, 0
v_mfma_f32_16x16x32_bf16 v[44:47], v[164:167], v[220:223], v[44:47]
s_waitcnt vmcnt(21)
ds_read_b64_tr_b16 v[160:161], v27 offset:16384
ds_read_b64_tr_b16 v[162:163], v27 offset:17408
v_mfma_f32_16x16x32_bf16 v[44:47], v[168:171], a[172:175], v[44:47]
s_waitcnt lgkmcnt(10)
v_accvgpr_write_b32 a10, 0
v_accvgpr_write_b32 a11, 0
v_mfma_f32_16x16x32_bf16 v[48:51], v[172:175], v[192:195], v[48:51]
s_waitcnt lgkmcnt(8)
v_accvgpr_write_b32 a12, 0
v_accvgpr_write_b32 a13, 0
v_mfma_f32_16x16x32_bf16 v[48:51], v[176:179], v[208:211], v[48:51]
s_waitcnt lgkmcnt(6)
ds_read_b64_tr_b16 v[164:165], v27 offset:8
ds_read_b64_tr_b16 v[166:167], v27 offset:1032
v_mfma_f32_16x16x32_bf16 v[48:51], v[180:183], a[160:163], v[48:51]
buffer_load_dwordx4 v[228:231], v3, s[8:11], s35 offen offset:2048 sc1
v_mfma_f32_16x16x32_bf16 v[52:55], v[172:175], v[196:199], v[52:55]
v_accvgpr_write_b32 a14, 0
v_accvgpr_write_b32 a15, 0
v_mfma_f32_16x16x32_bf16 v[52:55], v[176:179], v[212:215], v[52:55]
ds_read_b64_tr_b16 v[168:169], v27 offset:8200
ds_read_b64_tr_b16 v[170:171], v27 offset:9224
v_mfma_f32_16x16x32_bf16 v[52:55], v[180:183], a[164:167], v[52:55]
buffer_load_dwordx4 v[232:235], v3, s[8:11], s36 offen offset:2048 sc1
v_mfma_f32_16x16x32_bf16 v[56:59], v[172:175], v[200:203], v[56:59]
v_accvgpr_write_b32 a16, 0
v_accvgpr_write_b32 a17, 0
v_mfma_f32_16x16x32_bf16 v[56:59], v[176:179], v[216:219], v[56:59]
v_accvgpr_write_b32 a18, 0
v_accvgpr_write_b32 a19, 0
v_mfma_f32_16x16x32_bf16 v[56:59], v[180:183], a[168:171], v[56:59]
v_accvgpr_write_b32 a20, 0
v_accvgpr_write_b32 a21, 0
v_mfma_f32_16x16x32_bf16 v[60:63], v[172:175], v[204:207], v[60:63]
v_accvgpr_write_b32 a22, 0
v_accvgpr_write_b32 a23, 0
v_mfma_f32_16x16x32_bf16 v[60:63], v[176:179], v[220:223], v[60:63]
s_waitcnt lgkmcnt(8)
ds_read_b64_tr_b16 v[172:173], v27 offset:16392
ds_read_b64_tr_b16 v[174:175], v27 offset:17416
v_mfma_f32_16x16x32_bf16 v[60:63], v[180:183], a[172:175], v[60:63]
buffer_load_dwordx4 v[236:239], v3, s[8:11], s37 offen offset:2048 sc1
v_mfma_f32_16x16x32_bf16 v[64:67], v[184:187], v[192:195], v[64:67]
s_waitcnt lgkmcnt(8)
v_accvgpr_write_b32 a24, 0
v_accvgpr_write_b32 a25, 0
v_mfma_f32_16x16x32_bf16 v[64:67], v[188:191], v[208:211], v[64:67]
s_waitcnt lgkmcnt(6)
ds_read_b64_tr_b16 v[176:177], v28 offset:0
ds_read_b64_tr_b16 v[178:179], v28 offset:1024
v_mfma_f32_16x16x32_bf16 v[64:67], v[160:163], a[160:163], v[64:67]
v_accvgpr_write_b32 a26, 0
v_accvgpr_write_b32 a27, 0
v_mfma_f32_16x16x32_bf16 v[68:71], v[184:187], v[196:199], v[68:71]
v_accvgpr_write_b32 a28, 0
v_accvgpr_write_b32 a29, 0
v_mfma_f32_16x16x32_bf16 v[68:71], v[188:191], v[212:215], v[68:71]
ds_read_b64_tr_b16 v[180:181], v28 offset:8192
ds_read_b64_tr_b16 v[182:183], v28 offset:9216
v_mfma_f32_16x16x32_bf16 v[68:71], v[160:163], a[164:167], v[68:71]
buffer_load_dwordx4 v[240:243], v3, s[8:11], s34 offen offset:3072 sc1
v_mfma_f32_16x16x32_bf16 v[72:75], v[184:187], v[200:203], v[72:75]
v_accvgpr_write_b32 a30, 0
v_accvgpr_write_b32 a31, 0
v_mfma_f32_16x16x32_bf16 v[72:75], v[188:191], v[216:219], v[72:75]
v_accvgpr_write_b32 a32, 0
v_accvgpr_write_b32 a33, 0
v_mfma_f32_16x16x32_bf16 v[72:75], v[160:163], a[168:171], v[72:75]
buffer_load_dwordx4 v[244:247], v3, s[8:11], s35 offen offset:3072 sc1
v_mfma_f32_16x16x32_bf16 v[76:79], v[184:187], v[204:207], v[76:79]
v_accvgpr_write_b32 a34, 0
v_accvgpr_write_b32 a35, 0
v_mfma_f32_16x16x32_bf16 v[76:79], v[188:191], v[220:223], v[76:79]
ds_read_b64_tr_b16 v[184:185], v28 offset:16384
ds_read_b64_tr_b16 v[186:187], v28 offset:17408
v_mfma_f32_16x16x32_bf16 v[76:79], v[160:163], a[172:175], v[76:79]
s_waitcnt lgkmcnt(10)
v_accvgpr_write_b32 a36, 0
v_accvgpr_write_b32 a37, 0
v_mfma_f32_16x16x32_bf16 v[80:83], v[164:167], v[192:195], v[80:83]
s_waitcnt lgkmcnt(8)
v_accvgpr_write_b32 a38, 0
v_accvgpr_write_b32 a39, 0
v_mfma_f32_16x16x32_bf16 v[80:83], v[168:171], v[208:211], v[80:83]
s_waitcnt lgkmcnt(6)
ds_read_b64_tr_b16 v[188:189], v28 offset:8
ds_read_b64_tr_b16 v[190:191], v28 offset:1032
v_mfma_f32_16x16x32_bf16 v[80:83], v[172:175], a[160:163], v[80:83]
buffer_load_dwordx4 v[248:251], v3, s[8:11], s36 offen offset:3072 sc1
v_mfma_f32_16x16x32_bf16 v[84:87], v[164:167], v[196:199], v[84:87]
v_accvgpr_write_b32 a40, 0
v_accvgpr_write_b32 a41, 0
v_mfma_f32_16x16x32_bf16 v[84:87], v[168:171], v[212:215], v[84:87]
ds_read_b64_tr_b16 v[160:161], v28 offset:8200
ds_read_b64_tr_b16 v[162:163], v28 offset:9224
v_mfma_f32_16x16x32_bf16 v[84:87], v[172:175], a[164:167], v[84:87]
v_accvgpr_write_b32 a42, 0
v_accvgpr_write_b32 a43, 0
v_mfma_f32_16x16x32_bf16 v[88:91], v[164:167], v[200:203], v[88:91]
v_accvgpr_write_b32 a44, 0
v_accvgpr_write_b32 a45, 0
v_mfma_f32_16x16x32_bf16 v[88:91], v[168:171], v[216:219], v[88:91]
v_accvgpr_write_b32 a46, 0
v_accvgpr_write_b32 a47, 0
v_mfma_f32_16x16x32_bf16 v[88:91], v[172:175], a[168:171], v[88:91]
buffer_load_dwordx4 v[252:255], v3, s[8:11], s37 offen offset:3072 sc1
v_mfma_f32_16x16x32_bf16 v[92:95], v[164:167], v[204:207], v[92:95]
v_accvgpr_write_b32 a48, 0
v_accvgpr_write_b32 a49, 0
v_mfma_f32_16x16x32_bf16 v[92:95], v[168:171], v[220:223], v[92:95]
ds_read_b64_tr_b16 v[164:165], v28 offset:16392
ds_read_b64_tr_b16 v[166:167], v28 offset:17416
v_mfma_f32_16x16x32_bf16 v[92:95], v[172:175], a[172:175], v[92:95]
s_waitcnt lgkmcnt(10)
v_accvgpr_write_b32 a50, 0
v_accvgpr_write_b32 a51, 0
v_mfma_f32_16x16x32_bf16 v[96:99], v[176:179], v[192:195], v[96:99]
s_waitcnt lgkmcnt(6)
v_accvgpr_write_b32 a52, 0
v_accvgpr_write_b32 a53, 0
v_mfma_f32_16x16x32_bf16 v[96:99], v[180:183], v[208:211], v[96:99]
s_add_u32 m0, s39, 0
ds_read_b64_tr_b16 v[168:169], v29 offset:0
ds_read_b64_tr_b16 v[170:171], v29 offset:1024
v_mfma_f32_16x16x32_bf16 v[96:99], v[184:187], a[160:163], v[96:99]
buffer_load_dwordx4 v10, s[16:19], s40 offen nt lds
v_mfma_f32_16x16x32_bf16 v[100:103], v[176:179], v[196:199], v[100:103]
v_accvgpr_write_b32 a54, 0
v_accvgpr_write_b32 a55, 0
v_mfma_f32_16x16x32_bf16 v[100:103], v[180:183], v[212:215], v[100:103]
ds_read_b64_tr_b16 v[172:173], v29 offset:8192
ds_read_b64_tr_b16 v[174:175], v29 offset:9216
v_mfma_f32_16x16x32_bf16 v[100:103], v[184:187], a[164:167], v[100:103]
v_accvgpr_write_b32 a56, 0
v_accvgpr_write_b32 a57, 0
v_mfma_f32_16x16x32_bf16 v[104:107], v[176:179], v[200:203], v[104:107]
v_accvgpr_write_b32 a58, 0
v_accvgpr_write_b32 a59, 0
v_mfma_f32_16x16x32_bf16 v[104:107], v[180:183], v[216:219], v[104:107]
v_accvgpr_write_b32 a60, 0
v_accvgpr_write_b32 a61, 0
v_mfma_f32_16x16x32_bf16 v[104:107], v[184:187], a[168:171], v[104:107]
v_accvgpr_write_b32 a62, 0
v_accvgpr_write_b32 a63, 0
v_mfma_f32_16x16x32_bf16 v[108:111], v[176:179], v[204:207], v[108:111]
v_accvgpr_write_b32 a64, 0
v_accvgpr_write_b32 a65, 0
v_mfma_f32_16x16x32_bf16 v[108:111], v[180:183], v[220:223], v[108:111]
s_waitcnt lgkmcnt(8)
ds_read_b64_tr_b16 v[176:177], v29 offset:16384
ds_read_b64_tr_b16 v[178:179], v29 offset:17408
v_mfma_f32_16x16x32_bf16 v[108:111], v[184:187], a[172:175], v[108:111]
buffer_load_dwordx4 v11, s[16:19], s40 offen offset:1024 nt lds
v_mfma_f32_16x16x32_bf16 v[112:115], v[188:191], v[192:195], v[112:115]
s_waitcnt lgkmcnt(8)
v_accvgpr_write_b32 a66, 0
v_accvgpr_write_b32 a67, 0
v_mfma_f32_16x16x32_bf16 v[112:115], v[160:163], v[208:211], v[112:115]
s_waitcnt lgkmcnt(6)
ds_read_b64_tr_b16 v[180:181], v29 offset:8
ds_read_b64_tr_b16 v[182:183], v29 offset:1032
v_mfma_f32_16x16x32_bf16 v[112:115], v[164:167], a[160:163], v[112:115]
v_accvgpr_write_b32 a68, 0
v_accvgpr_write_b32 a69, 0
v_mfma_f32_16x16x32_bf16 v[116:119], v[188:191], v[196:199], v[116:119]
v_accvgpr_write_b32 a70, 0
v_accvgpr_write_b32 a71, 0
v_mfma_f32_16x16x32_bf16 v[116:119], v[160:163], v[212:215], v[116:119]
ds_read_b64_tr_b16 v[184:185], v29 offset:8200
ds_read_b64_tr_b16 v[186:187], v29 offset:9224
v_mfma_f32_16x16x32_bf16 v[116:119], v[164:167], a[164:167], v[116:119]
v_accvgpr_write_b32 a72, 0
v_accvgpr_write_b32 a73, 0
v_mfma_f32_16x16x32_bf16 v[120:123], v[188:191], v[200:203], v[120:123]
v_accvgpr_write_b32 a74, 0
v_accvgpr_write_b32 a75, 0
v_mfma_f32_16x16x32_bf16 v[120:123], v[160:163], v[216:219], v[120:123]
v_accvgpr_write_b32 a76, 0
v_accvgpr_write_b32 a77, 0
v_mfma_f32_16x16x32_bf16 v[120:123], v[164:167], a[168:171], v[120:123]
s_waitcnt lgkmcnt(8)
v_accvgpr_write_b32 a78, 0
v_accvgpr_write_b32 a79, 0
v_mfma_f32_16x16x32_bf16 v[124:127], v[188:191], v[204:207], v[124:127]
s_add_u32 s40, s40, 8192
v_accvgpr_write_b32 a80, 0
v_accvgpr_write_b32 a81, 0
v_mfma_f32_16x16x32_bf16 v[124:127], v[160:163], v[220:223], v[124:127]
s_add_u32 m0, s39, 8192
ds_read_b64_tr_b16 v[188:189], v29 offset:16392
ds_read_b64_tr_b16 v[190:191], v29 offset:17416
v_mfma_f32_16x16x32_bf16 v[124:127], v[164:167], a[172:175], v[124:127]
buffer_load_dwordx4 v10, s[16:19], s40 offen nt lds
v_mfma_f32_16x16x32_bf16 v[128:131], v[168:171], v[192:195], v[128:131]
s_waitcnt lgkmcnt(8)
v_accvgpr_write_b32 a82, 0
v_accvgpr_write_b32 a83, 0
v_mfma_f32_16x16x32_bf16 v[128:131], v[172:175], v[208:211], v[128:131]
s_waitcnt lgkmcnt(6)
ds_read_b64_tr_b16 v[160:161], v26 offset:24576
ds_read_b64_tr_b16 v[162:163], v26 offset:25600
v_mfma_f32_16x16x32_bf16 v[128:131], v[176:179], a[160:163], v[128:131]
v_accvgpr_write_b32 a84, 0
v_accvgpr_write_b32 a85, 0
v_mfma_f32_16x16x32_bf16 v[132:135], v[168:171], v[196:199], v[132:135]
v_accvgpr_write_b32 a86, 0
v_accvgpr_write_b32 a87, 0
v_mfma_f32_16x16x32_bf16 v[132:135], v[172:175], v[212:215], v[132:135]
ds_read_b64_tr_b16 v[164:165], v26 offset:32768
ds_read_b64_tr_b16 v[166:167], v26 offset:33792
v_mfma_f32_16x16x32_bf16 v[132:135], v[176:179], a[164:167], v[132:135]
v_accvgpr_write_b32 a88, 0
v_accvgpr_write_b32 a89, 0
v_mfma_f32_16x16x32_bf16 v[136:139], v[168:171], v[200:203], v[136:139]
v_accvgpr_write_b32 a90, 0
v_accvgpr_write_b32 a91, 0
v_mfma_f32_16x16x32_bf16 v[136:139], v[172:175], v[216:219], v[136:139]
v_accvgpr_write_b32 a92, 0
v_accvgpr_write_b32 a93, 0
v_mfma_f32_16x16x32_bf16 v[136:139], v[176:179], a[168:171], v[136:139]
buffer_load_dwordx4 v11, s[16:19], s40 offen offset:1024 nt lds
v_mfma_f32_16x16x32_bf16 v[140:143], v[168:171], v[204:207], v[140:143]
v_accvgpr_write_b32 a94, 0
v_accvgpr_write_b32 a95, 0
v_mfma_f32_16x16x32_bf16 v[140:143], v[172:175], v[220:223], v[140:143]
ds_read_b64_tr_b16 v[168:169], v26 offset:40960
ds_read_b64_tr_b16 v[170:171], v26 offset:41984
v_mfma_f32_16x16x32_bf16 v[140:143], v[176:179], a[172:175], v[140:143]
s_waitcnt lgkmcnt(10)
v_accvgpr_write_b32 a96, 0
v_accvgpr_write_b32 a97, 0
v_mfma_f32_16x16x32_bf16 v[144:147], v[180:183], v[192:195], v[144:147]
s_waitcnt lgkmcnt(8)
v_accvgpr_write_b32 a98, 0
v_accvgpr_write_b32 a99, 0
v_mfma_f32_16x16x32_bf16 v[144:147], v[184:187], v[208:211], v[144:147]
s_waitcnt lgkmcnt(6)
ds_read_b64_tr_b16 v[172:173], v26 offset:24584
ds_read_b64_tr_b16 v[174:175], v26 offset:25608
v_mfma_f32_16x16x32_bf16 v[144:147], v[188:191], a[160:163], v[144:147]
v_accvgpr_write_b32 a100, 0
v_accvgpr_write_b32 a101, 0
v_mfma_f32_16x16x32_bf16 v[148:151], v[180:183], v[196:199], v[148:151]
s_barrier
s_add_u32 s40, s40, 8192
v_accvgpr_write_b32 a102, 0
v_accvgpr_write_b32 a103, 0
v_mfma_f32_16x16x32_bf16 v[148:151], v[184:187], v[212:215], v[148:151]
s_add_u32 m0, s39, 122880
ds_read_b64_tr_b16 v[176:177], v26 offset:32776
ds_read_b64_tr_b16 v[178:179], v26 offset:33800
v_mfma_f32_16x16x32_bf16 v[148:151], v[188:191], a[164:167], v[148:151]
buffer_load_dwordx4 v12, s[20:23], s41 offen nt lds
v_mfma_f32_16x16x32_bf16 v[152:155], v[180:183], v[200:203], v[152:155]
v_accvgpr_write_b32 a104, 0
v_accvgpr_write_b32 a105, 0
v_mfma_f32_16x16x32_bf16 v[152:155], v[184:187], v[216:219], v[152:155]
v_accvgpr_write_b32 a106, 0
v_accvgpr_write_b32 a107, 0
v_mfma_f32_16x16x32_bf16 v[152:155], v[188:191], a[168:171], v[152:155]
v_accvgpr_write_b32 a108, 0
v_accvgpr_write_b32 a109, 0
v_mfma_f32_16x16x32_bf16 v[156:159], v[180:183], v[204:207], v[156:159]
v_accvgpr_write_b32 a110, 0
v_accvgpr_write_b32 a111, 0
v_mfma_f32_16x16x32_bf16 v[156:159], v[184:187], v[220:223], v[156:159]
ds_read_b64_tr_b16 v[180:181], v26 offset:40968
ds_read_b64_tr_b16 v[182:183], v26 offset:41992
v_mfma_f32_16x16x32_bf16 v[156:159], v[188:191], a[172:175], v[156:159]
s_waitcnt vmcnt(32) lgkmcnt(10)
v_add_u32 v26, 0x10000, v26
v_accvgpr_write_b32 a112, 0
v_mfma_f32_16x16x32_bf16 v[32:35], v[160:163], a[176:179], v[32:35]
s_waitcnt vmcnt(28) lgkmcnt(8)
v_accvgpr_write_b32 a113, 0
v_accvgpr_write_b32 a114, 0
v_mfma_f32_16x16x32_bf16 v[32:35], v[164:167], a[192:195], v[32:35]
s_waitcnt vmcnt(24) lgkmcnt(6)
ds_read_b64_tr_b16 v[184:185], v27 offset:24576
ds_read_b64_tr_b16 v[186:187], v27 offset:25600
v_mfma_f32_16x16x32_bf16 v[32:35], v[168:171], a[208:211], v[32:35]
v_accvgpr_write_b32 a115, 0
v_accvgpr_write_b32 a116, 0
v_mfma_f32_16x16x32_bf16 v[36:39], v[160:163], a[180:183], v[36:39]
v_accvgpr_write_b32 a117, 0
v_accvgpr_write_b32 a118, 0
v_mfma_f32_16x16x32_bf16 v[36:39], v[164:167], a[196:199], v[36:39]
s_waitcnt vmcnt(23)
ds_read_b64_tr_b16 v[188:189], v27 offset:32768
ds_read_b64_tr_b16 v[190:191], v27 offset:33792
v_mfma_f32_16x16x32_bf16 v[36:39], v[168:171], a[212:215], v[36:39]
buffer_load_dwordx4 v13, s[20:23], s41 offen offset:1024 nt lds
v_mfma_f32_16x16x32_bf16 v[40:43], v[160:163], a[184:187], v[40:43]
v_accvgpr_write_b32 a119, 0
v_accvgpr_write_b32 a120, 0
v_mfma_f32_16x16x32_bf16 v[40:43], v[164:167], a[200:203], v[40:43]
s_waitcnt vmcnt(23)
v_accvgpr_write_b32 a121, 0
v_accvgpr_write_b32 a122, 0
v_mfma_f32_16x16x32_bf16 v[40:43], v[168:171], a[216:219], v[40:43]
v_accvgpr_write_b32 a123, 0
v_accvgpr_write_b32 a124, 0
v_mfma_f32_16x16x32_bf16 v[44:47], v[160:163], a[188:191], v[44:47]
v_accvgpr_write_b32 a125, 0
v_accvgpr_write_b32 a126, 0
v_mfma_f32_16x16x32_bf16 v[44:47], v[164:167], a[204:207], v[44:47]
s_waitcnt vmcnt(22)
ds_read_b64_tr_b16 v[160:161], v27 offset:40960
ds_read_b64_tr_b16 v[162:163], v27 offset:41984
v_mfma_f32_16x16x32_bf16 v[44:47], v[168:171], a[220:223], v[44:47]
s_waitcnt lgkmcnt(10)
v_accvgpr_write_b32 a127, 0
v_mfma_f32_16x16x32_bf16 v[48:51], v[172:175], a[176:179], v[48:51]
s_waitcnt lgkmcnt(6)
v_mfma_f32_16x16x32_bf16 v[48:51], v[176:179], a[192:195], v[48:51]
s_add_u32 m0, s39, 16384
ds_read_b64_tr_b16 v[164:165], v27 offset:24584
ds_read_b64_tr_b16 v[166:167], v27 offset:25608
v_mfma_f32_16x16x32_bf16 v[48:51], v[180:183], a[208:211], v[48:51]
buffer_load_dwordx4 v10, s[16:19], s40 offen nt lds
v_mfma_f32_16x16x32_bf16 v[52:55], v[172:175], a[180:183], v[52:55]
v_mfma_f32_16x16x32_bf16 v[52:55], v[176:179], a[196:199], v[52:55]
ds_read_b64_tr_b16 v[168:169], v27 offset:32776
ds_read_b64_tr_b16 v[170:171], v27 offset:33800
v_mfma_f32_16x16x32_bf16 v[52:55], v[180:183], a[212:215], v[52:55]
v_mfma_f32_16x16x32_bf16 v[56:59], v[172:175], a[184:187], v[56:59]
v_mfma_f32_16x16x32_bf16 v[56:59], v[176:179], a[200:203], v[56:59]
v_mfma_f32_16x16x32_bf16 v[56:59], v[180:183], a[216:219], v[56:59]
v_mfma_f32_16x16x32_bf16 v[60:63], v[172:175], a[188:191], v[60:63]
v_mfma_f32_16x16x32_bf16 v[60:63], v[176:179], a[204:207], v[60:63]
ds_read_b64_tr_b16 v[172:173], v27 offset:40968
ds_read_b64_tr_b16 v[174:175], v27 offset:41992
v_mfma_f32_16x16x32_bf16 v[60:63], v[180:183], a[220:223], v[60:63]
s_waitcnt lgkmcnt(10)
v_add_u32 v27, 0x10000, v27
v_mfma_f32_16x16x32_bf16 v[64:67], v[184:187], a[176:179], v[64:67]
s_waitcnt lgkmcnt(8)
v_mfma_f32_16x16x32_bf16 v[64:67], v[188:191], a[192:195], v[64:67]
s_waitcnt lgkmcnt(6)
ds_read_b64_tr_b16 v[176:177], v28 offset:24576
ds_read_b64_tr_b16 v[178:179], v28 offset:25600
v_mfma_f32_16x16x32_bf16 v[64:67], v[160:163], a[208:211], v[64:67]
buffer_load_dwordx4 v11, s[16:19], s40 offen offset:1024 nt lds
v_mfma_f32_16x16x32_bf16 v[68:71], v[184:187], a[180:183], v[68:71]
s_add_u32 s40, s40, 8192
v_mfma_f32_16x16x32_bf16 v[68:71], v[188:191], a[196:199], v[68:71]
ds_read_b64_tr_b16 v[180:181], v28 offset:32768
ds_read_b64_tr_b16 v[182:183], v28 offset:33792
v_mfma_f32_16x16x32_bf16 v[68:71], v[160:163], a[212:215], v[68:71]
v_mfma_f32_16x16x32_bf16 v[72:75], v[184:187], a[184:187], v[72:75]
v_mfma_f32_16x16x32_bf16 v[72:75], v[188:191], a[200:203], v[72:75]
v_mfma_f32_16x16x32_bf16 v[72:75], v[160:163], a[216:219], v[72:75]
v_mfma_f32_16x16x32_bf16 v[76:79], v[184:187], a[188:191], v[76:79]
v_mfma_f32_16x16x32_bf16 v[76:79], v[188:191], a[204:207], v[76:79]
ds_read_b64_tr_b16 v[184:185], v28 offset:40960
ds_read_b64_tr_b16 v[186:187], v28 offset:41984
v_mfma_f32_16x16x32_bf16 v[76:79], v[160:163], a[220:223], v[76:79]
s_waitcnt lgkmcnt(10)
v_mfma_f32_16x16x32_bf16 v[80:83], v[164:167], a[176:179], v[80:83]
s_waitcnt lgkmcnt(6)
v_mfma_f32_16x16x32_bf16 v[80:83], v[168:171], a[192:195], v[80:83]
s_add_u32 m0, s39, 65536
ds_read_b64_tr_b16 v[188:189], v28 offset:24584
ds_read_b64_tr_b16 v[190:191], v28 offset:25608
v_mfma_f32_16x16x32_bf16 v[80:83], v[172:175], a[208:211], v[80:83]
buffer_load_dwordx4 v12, s[20:23], s41 offen nt lds
v_mfma_f32_16x16x32_bf16 v[84:87], v[164:167], a[180:183], v[84:87]
v_mfma_f32_16x16x32_bf16 v[84:87], v[168:171], a[196:199], v[84:87]
ds_read_b64_tr_b16 v[160:161], v28 offset:32776
ds_read_b64_tr_b16 v[162:163], v28 offset:33800
v_mfma_f32_16x16x32_bf16 v[84:87], v[172:175], a[212:215], v[84:87]
v_mfma_f32_16x16x32_bf16 v[88:91], v[164:167], a[184:187], v[88:91]
v_mfma_f32_16x16x32_bf16 v[88:91], v[168:171], a[200:203], v[88:91]
v_mfma_f32_16x16x32_bf16 v[88:91], v[172:175], a[216:219], v[88:91]
v_mfma_f32_16x16x32_bf16 v[92:95], v[164:167], a[188:191], v[92:95]
v_mfma_f32_16x16x32_bf16 v[92:95], v[168:171], a[204:207], v[92:95]
ds_read_b64_tr_b16 v[164:165], v28 offset:40968
ds_read_b64_tr_b16 v[166:167], v28 offset:41992
v_mfma_f32_16x16x32_bf16 v[92:95], v[172:175], a[220:223], v[92:95]
s_waitcnt lgkmcnt(10)
v_add_u32 v28, 0x10000, v28
v_mfma_f32_16x16x32_bf16 v[96:99], v[176:179], a[176:179], v[96:99]
s_waitcnt lgkmcnt(8)
v_mfma_f32_16x16x32_bf16 v[96:99], v[180:183], a[192:195], v[96:99]
s_waitcnt lgkmcnt(6)
ds_read_b64_tr_b16 v[168:169], v29 offset:24576
ds_read_b64_tr_b16 v[170:171], v29 offset:25600
v_mfma_f32_16x16x32_bf16 v[96:99], v[184:187], a[208:211], v[96:99]
buffer_load_dwordx4 v13, s[20:23], s41 offen offset:1024 nt lds
v_mfma_f32_16x16x32_bf16 v[100:103], v[176:179], a[180:183], v[100:103]
v_mfma_f32_16x16x32_bf16 v[100:103], v[180:183], a[196:199], v[100:103]
ds_read_b64_tr_b16 v[172:173], v29 offset:32768
ds_read_b64_tr_b16 v[174:175], v29 offset:33792
v_mfma_f32_16x16x32_bf16 v[100:103], v[184:187], a[212:215], v[100:103]
v_mfma_f32_16x16x32_bf16 v[104:107], v[176:179], a[184:187], v[104:107]
v_mfma_f32_16x16x32_bf16 v[104:107], v[180:183], a[200:203], v[104:107]
v_mfma_f32_16x16x32_bf16 v[104:107], v[184:187], a[216:219], v[104:107]
v_mfma_f32_16x16x32_bf16 v[108:111], v[176:179], a[188:191], v[108:111]
v_mfma_f32_16x16x32_bf16 v[108:111], v[180:183], a[204:207], v[108:111]
ds_read_b64_tr_b16 v[176:177], v29 offset:40960
ds_read_b64_tr_b16 v[178:179], v29 offset:41984
v_mfma_f32_16x16x32_bf16 v[108:111], v[184:187], a[220:223], v[108:111]
s_waitcnt lgkmcnt(6)
v_mfma_f32_16x16x32_bf16 v[112:115], v[188:191], a[176:179], v[112:115]
s_add_u32 s41, s41, 8192
v_mfma_f32_16x16x32_bf16 v[112:115], v[160:163], a[192:195], v[112:115]
s_add_u32 m0, s39, 24576
ds_read_b64_tr_b16 v[180:181], v29 offset:24584
ds_read_b64_tr_b16 v[182:183], v29 offset:25608
v_mfma_f32_16x16x32_bf16 v[112:115], v[164:167], a[208:211], v[112:115]
buffer_load_dwordx4 v10, s[16:19], s40 offen nt lds
v_mfma_f32_16x16x32_bf16 v[116:119], v[188:191], a[180:183], v[116:119]
v_mfma_f32_16x16x32_bf16 v[116:119], v[160:163], a[196:199], v[116:119]
ds_read_b64_tr_b16 v[184:185], v29 offset:32776
ds_read_b64_tr_b16 v[186:187], v29 offset:33800
v_mfma_f32_16x16x32_bf16 v[116:119], v[164:167], a[212:215], v[116:119]
v_mfma_f32_16x16x32_bf16 v[120:123], v[188:191], a[184:187], v[120:123]
v_mfma_f32_16x16x32_bf16 v[120:123], v[160:163], a[200:203], v[120:123]
v_mfma_f32_16x16x32_bf16 v[120:123], v[164:167], a[216:219], v[120:123]
v_mfma_f32_16x16x32_bf16 v[124:127], v[188:191], a[188:191], v[124:127]
v_mfma_f32_16x16x32_bf16 v[124:127], v[160:163], a[204:207], v[124:127]
ds_read_b64_tr_b16 v[188:189], v29 offset:40968
ds_read_b64_tr_b16 v[190:191], v29 offset:41992
v_mfma_f32_16x16x32_bf16 v[124:127], v[164:167], a[220:223], v[124:127]
s_waitcnt lgkmcnt(10)
v_add_u32 v29, 0x10000, v29
v_mfma_f32_16x16x32_bf16 v[128:131], v[168:171], a[176:179], v[128:131]
s_waitcnt lgkmcnt(8)
v_mfma_f32_16x16x32_bf16 v[128:131], v[172:175], a[192:195], v[128:131]
s_waitcnt lgkmcnt(6)
ds_read_b64_tr_b16 v[160:161], v26 offset:0
ds_read_b64_tr_b16 v[162:163], v26 offset:1024
v_mfma_f32_16x16x32_bf16 v[128:131], v[176:179], a[208:211], v[128:131]
buffer_load_dwordx4 v11, s[16:19], s40 offen offset:1024 nt lds
v_mfma_f32_16x16x32_bf16 v[132:135], v[168:171], a[180:183], v[132:135]
v_mfma_f32_16x16x32_bf16 v[132:135], v[172:175], a[196:199], v[132:135]
ds_read_b64_tr_b16 v[164:165], v26 offset:8192
ds_read_b64_tr_b16 v[166:167], v26 offset:9216
v_mfma_f32_16x16x32_bf16 v[132:135], v[176:179], a[212:215], v[132:135]
v_mfma_f32_16x16x32_bf16 v[136:139], v[168:171], a[184:187], v[136:139]
v_mfma_f32_16x16x32_bf16 v[136:139], v[172:175], a[200:203], v[136:139]
v_mfma_f32_16x16x32_bf16 v[136:139], v[176:179], a[216:219], v[136:139]
v_mfma_f32_16x16x32_bf16 v[140:143], v[168:171], a[188:191], v[140:143]
v_mfma_f32_16x16x32_bf16 v[140:143], v[172:175], a[204:207], v[140:143]
ds_read_b64_tr_b16 v[168:169], v26 offset:16384
ds_read_b64_tr_b16 v[170:171], v26 offset:17408
v_mfma_f32_16x16x32_bf16 v[140:143], v[176:179], a[220:223], v[140:143]
s_waitcnt lgkmcnt(6)
v_mfma_f32_16x16x32_bf16 v[144:147], v[180:183], a[176:179], v[144:147]
s_add_u32 s40, s40, 8192
v_mfma_f32_16x16x32_bf16 v[144:147], v[184:187], a[192:195], v[144:147]
s_add_u32 m0, s39, 73728
ds_read_b64_tr_b16 v[172:173], v26 offset:24576
ds_read_b64_tr_b16 v[174:175], v26 offset:25600
v_mfma_f32_16x16x32_bf16 v[144:147], v[188:191], a[208:211], v[144:147]
buffer_load_dwordx4 v12, s[20:23], s41 offen nt lds
v_mfma_f32_16x16x32_bf16 v[148:151], v[180:183], a[180:183], v[148:151]
s_barrier
v_mfma_f32_16x16x32_bf16 v[148:151], v[184:187], a[196:199], v[148:151]
ds_read_b64_tr_b16 v[176:177], v26 offset:8
ds_read_b64_tr_b16 v[178:179], v26 offset:1032
v_mfma_f32_16x16x32_bf16 v[148:151], v[188:191], a[212:215], v[148:151]
v_mfma_f32_16x16x32_bf16 v[152:155], v[180:183], a[184:187], v[152:155]
v_mfma_f32_16x16x32_bf16 v[152:155], v[184:187], a[200:203], v[152:155]
v_mfma_f32_16x16x32_bf16 v[152:155], v[188:191], a[216:219], v[152:155]
v_mfma_f32_16x16x32_bf16 v[156:159], v[180:183], a[188:191], v[156:159]
v_mfma_f32_16x16x32_bf16 v[156:159], v[184:187], a[204:207], v[156:159]
ds_read_b64_tr_b16 v[180:181], v26 offset:8200
ds_read_b64_tr_b16 v[182:183], v26 offset:9224
v_mfma_f32_16x16x32_bf16 v[156:159], v[188:191], a[220:223], v[156:159]
s_waitcnt vmcnt(28) lgkmcnt(10)
v_mfma_f32_16x16x32_bf16 v[32:35], v[160:163], a[224:227], v[32:35]
s_waitcnt vmcnt(24) lgkmcnt(8)
v_mfma_f32_16x16x32_bf16 v[32:35], v[164:167], a[240:243], v[32:35]
s_waitcnt vmcnt(20) lgkmcnt(6)
v_mfma_f32_16x16x32_bf16 v[32:35], v[168:171], v[224:227], v[32:35]
s_waitcnt vmcnt(16) lgkmcnt(4)
ds_read_b64_tr_b16 v[184:185], v26 offset:16392
ds_read_b64_tr_b16 v[186:187], v26 offset:17416
v_mfma_f32_16x16x32_bf16 v[32:35], v[172:175], v[240:243], v[32:35]
buffer_load_dwordx4 v13, s[20:23], s41 offen offset:1024 nt lds
v_mfma_f32_16x16x32_bf16 v[36:39], v[160:163], a[228:231], v[36:39]
v_mfma_f32_16x16x32_bf16 v[36:39], v[164:167], a[244:247], v[36:39]
ds_read_b64_tr_b16 v[188:189], v26 offset:24584
ds_read_b64_tr_b16 v[190:191], v26 offset:25608
v_mfma_f32_16x16x32_bf16 v[36:39], v[168:171], v[228:231], v[36:39]
s_waitcnt vmcnt(16)
v_mfma_f32_16x16x32_bf16 v[36:39], v[172:175], v[244:247], v[36:39]
v_mfma_f32_16x16x32_bf16 v[40:43], v[160:163], a[232:235], v[40:43]
v_mfma_f32_16x16x32_bf16 v[40:43], v[164:167], a[248:251], v[40:43]
v_mfma_f32_16x16x32_bf16 v[40:43], v[168:171], v[232:235], v[40:43]
s_waitcnt vmcnt(15)
v_mfma_f32_16x16x32_bf16 v[40:43], v[172:175], v[248:251], v[40:43]
v_mfma_f32_16x16x32_bf16 v[44:47], v[160:163], a[236:239], v[44:47]
s_waitcnt vmcnt(14) lgkmcnt(6)
v_mfma_f32_16x16x32_bf16 v[44:47], v[164:167], a[252:255], v[44:47]
s_add_u32 s41, s41, 8192
v_mfma_f32_16x16x32_bf16 v[44:47], v[168:171], v[236:239], v[44:47]
s_add_u32 m0, s39, 32768
ds_read_b64_tr_b16 v[160:161], v27 offset:0
ds_read_b64_tr_b16 v[162:163], v27 offset:1024
v_mfma_f32_16x16x32_bf16 v[44:47], v[172:175], v[252:255], v[44:47]
buffer_load_dwordx4 v10, s[16:19], s40 offen nt lds
v_mfma_f32_16x16x32_bf16 v[48:51], v[176:179], a[224:227], v[48:51]
s_waitcnt lgkmcnt(6)
v_mfma_f32_16x16x32_bf16 v[48:51], v[180:183], a[240:243], v[48:51]
s_waitcnt lgkmcnt(4)
v_mfma_f32_16x16x32_bf16 v[48:51], v[184:187], v[224:227], v[48:51]
s_waitcnt lgkmcnt(2)
ds_read_b64_tr_b16 v[164:165], v27 offset:8192
ds_read_b64_tr_b16 v[166:167], v27 offset:9216
v_mfma_f32_16x16x32_bf16 v[48:51], v[188:191], v[240:243], v[48:51]
v_mfma_f32_16x16x32_bf16 v[52:55], v[176:179], a[228:231], v[52:55]
ds_read_b64_tr_b16 v[168:169], v27 offset:16384
ds_read_b64_tr_b16 v[170:171], v27 offset:17408
v_mfma_f32_16x16x32_bf16 v[52:55], v[180:183], a[244:247], v[52:55]
ds_read_b64_tr_b16 v[172:173], v27 offset:24576
ds_read_b64_tr_b16 v[174:175], v27 offset:25600
v_mfma_f32_16x16x32_bf16 v[52:55], v[184:187], v[228:231], v[52:55]
v_mfma_f32_16x16x32_bf16 v[52:55], v[188:191], v[244:247], v[52:55]
v_mfma_f32_16x16x32_bf16 v[56:59], v[176:179], a[232:235], v[56:59]
v_mfma_f32_16x16x32_bf16 v[56:59], v[180:183], a[248:251], v[56:59]
v_mfma_f32_16x16x32_bf16 v[56:59], v[184:187], v[232:235], v[56:59]
v_mfma_f32_16x16x32_bf16 v[56:59], v[188:191], v[248:251], v[56:59]
buffer_load_dwordx4 v11, s[16:19], s40 offen offset:1024 nt lds
v_mfma_f32_16x16x32_bf16 v[60:63], v[176:179], a[236:239], v[60:63]
v_mfma_f32_16x16x32_bf16 v[60:63], v[180:183], a[252:255], v[60:63]
v_mfma_f32_16x16x32_bf16 v[60:63], v[184:187], v[236:239], v[60:63]
ds_read_b64_tr_b16 v[176:177], v27 offset:8
ds_read_b64_tr_b16 v[178:179], v27 offset:1032
v_mfma_f32_16x16x32_bf16 v[60:63], v[188:191], v[252:255], v[60:63]
s_waitcnt lgkmcnt(8)
v_mfma_f32_16x16x32_bf16 v[64:67], v[160:163], a[224:227], v[64:67]
s_waitcnt lgkmcnt(6)
v_mfma_f32_16x16x32_bf16 v[64:67], v[164:167], a[240:243], v[64:67]
s_waitcnt lgkmcnt(4)
v_mfma_f32_16x16x32_bf16 v[64:67], v[168:171], v[224:227], v[64:67]
s_waitcnt lgkmcnt(2)
ds_read_b64_tr_b16 v[180:181], v27 offset:8200
ds_read_b64_tr_b16 v[182:183], v27 offset:9224
v_mfma_f32_16x16x32_bf16 v[64:67], v[172:175], v[240:243], v[64:67]
v_mfma_f32_16x16x32_bf16 v[68:71], v[160:163], a[228:231], v[68:71]
ds_read_b64_tr_b16 v[184:185], v27 offset:16392
ds_read_b64_tr_b16 v[186:187], v27 offset:17416
v_mfma_f32_16x16x32_bf16 v[68:71], v[164:167], a[244:247], v[68:71]
s_add_u32 s40, s40, 8192
ds_read_b64_tr_b16 v[188:189], v27 offset:24584
ds_read_b64_tr_b16 v[190:191], v27 offset:25608
v_mfma_f32_16x16x32_bf16 v[68:71], v[168:171], v[228:231], v[68:71]
s_add_u32 m0, s39, 81920
v_mfma_f32_16x16x32_bf16 v[68:71], v[172:175], v[244:247], v[68:71]
buffer_load_dwordx4 v12, s[20:23], s41 offen nt lds
v_mfma_f32_16x16x32_bf16 v[72:75], v[160:163], a[232:235], v[72:75]
v_mfma_f32_16x16x32_bf16 v[72:75], v[164:167], a[248:251], v[72:75]
v_mfma_f32_16x16x32_bf16 v[72:75], v[168:171], v[232:235], v[72:75]
v_mfma_f32_16x16x32_bf16 v[72:75], v[172:175], v[248:251], v[72:75]
v_mfma_f32_16x16x32_bf16 v[76:79], v[160:163], a[236:239], v[76:79]
v_mfma_f32_16x16x32_bf16 v[76:79], v[164:167], a[252:255], v[76:79]
v_mfma_f32_16x16x32_bf16 v[76:79], v[168:171], v[236:239], v[76:79]
ds_read_b64_tr_b16 v[160:161], v28 offset:0
ds_read_b64_tr_b16 v[162:163], v28 offset:1024
v_mfma_f32_16x16x32_bf16 v[76:79], v[172:175], v[252:255], v[76:79]
s_waitcnt lgkmcnt(8)
v_mfma_f32_16x16x32_bf16 v[80:83], v[176:179], a[224:227], v[80:83]
s_waitcnt lgkmcnt(6)
v_mfma_f32_16x16x32_bf16 v[80:83], v[180:183], a[240:243], v[80:83]
s_waitcnt lgkmcnt(4)
v_mfma_f32_16x16x32_bf16 v[80:83], v[184:187], v[224:227], v[80:83]
s_waitcnt lgkmcnt(2)
ds_read_b64_tr_b16 v[164:165], v28 offset:8192
ds_read_b64_tr_b16 v[166:167], v28 offset:9216
v_mfma_f32_16x16x32_bf16 v[80:83], v[188:191], v[240:243], v[80:83]
buffer_load_dwordx4 v13, s[20:23], s41 offen offset:1024 nt lds
v_mfma_f32_16x16x32_bf16 v[84:87], v[176:179], a[228:231], v[84:87]
ds_read_b64_tr_b16 v[168:169], v28 offset:16384
ds_read_b64_tr_b16 v[170:171], v28 offset:17408
v_mfma_f32_16x16x32_bf16 v[84:87], v[180:183], a[244:247], v[84:87]
ds_read_b64_tr_b16 v[172:173], v28 offset:24576
ds_read_b64_tr_b16 v[174:175], v28 offset:25600
v_mfma_f32_16x16x32_bf16 v[84:87], v[184:187], v[228:231], v[84:87]
v_mfma_f32_16x16x32_bf16 v[84:87], v[188:191], v[244:247], v[84:87]
v_mfma_f32_16x16x32_bf16 v[88:91], v[176:179], a[232:235], v[88:91]
v_mfma_f32_16x16x32_bf16 v[88:91], v[180:183], a[248:251], v[88:91]
v_mfma_f32_16x16x32_bf16 v[88:91], v[184:187], v[232:235], v[88:91]
v_mfma_f32_16x16x32_bf16 v[88:91], v[188:191], v[248:251], v[88:91]
v_mfma_f32_16x16x32_bf16 v[92:95], v[176:179], a[236:239], v[92:95]
s_waitcnt lgkmcnt(6)
v_mfma_f32_16x16x32_bf16 v[92:95], v[180:183], a[252:255], v[92:95]
s_add_u32 s41, s41, 8192
v_mfma_f32_16x16x32_bf16 v[92:95], v[184:187], v[236:239], v[92:95]
s_add_u32 m0, s39, 40960
ds_read_b64_tr_b16 v[176:177], v28 offset:8
ds_read_b64_tr_b16 v[178:179], v28 offset:1032
v_mfma_f32_16x16x32_bf16 v[92:95], v[188:191], v[252:255], v[92:95]
buffer_load_dwordx4 v10, s[16:19], s40 offen nt lds
v_mfma_f32_16x16x32_bf16 v[96:99], v[160:163], a[224:227], v[96:99]
s_waitcnt lgkmcnt(6)
v_mfma_f32_16x16x32_bf16 v[96:99], v[164:167], a[240:243], v[96:99]
s_waitcnt lgkmcnt(4)
v_mfma_f32_16x16x32_bf16 v[96:99], v[168:171], v[224:227], v[96:99]
s_waitcnt lgkmcnt(2)
ds_read_b64_tr_b16 v[180:181], v28 offset:8200
ds_read_b64_tr_b16 v[182:183], v28 offset:9224
v_mfma_f32_16x16x32_bf16 v[96:99], v[172:175], v[240:243], v[96:99]
v_mfma_f32_16x16x32_bf16 v[100:103], v[160:163], a[228:231], v[100:103]
ds_read_b64_tr_b16 v[184:185], v28 offset:16392
ds_read_b64_tr_b16 v[186:187], v28 offset:17416
v_mfma_f32_16x16x32_bf16 v[100:103], v[164:167], a[244:247], v[100:103]
ds_read_b64_tr_b16 v[188:189], v28 offset:24584
ds_read_b64_tr_b16 v[190:191], v28 offset:25608
v_mfma_f32_16x16x32_bf16 v[100:103], v[168:171], v[228:231], v[100:103]
v_mfma_f32_16x16x32_bf16 v[100:103], v[172:175], v[244:247], v[100:103]
v_mfma_f32_16x16x32_bf16 v[104:107], v[160:163], a[232:235], v[104:107]
v_mfma_f32_16x16x32_bf16 v[104:107], v[164:167], a[248:251], v[104:107]
v_mfma_f32_16x16x32_bf16 v[104:107], v[168:171], v[232:235], v[104:107]
v_mfma_f32_16x16x32_bf16 v[104:107], v[172:175], v[248:251], v[104:107]
buffer_load_dwordx4 v11, s[16:19], s40 offen offset:1024 nt lds
v_mfma_f32_16x16x32_bf16 v[108:111], v[160:163], a[236:239], v[108:111]
s_add_u32 s40, s40, 8192
v_mfma_f32_16x16x32_bf16 v[108:111], v[164:167], a[252:255], v[108:111]
v_mfma_f32_16x16x32_bf16 v[108:111], v[168:171], v[236:239], v[108:111]
ds_read_b64_tr_b16 v[160:161], v29 offset:0
ds_read_b64_tr_b16 v[162:163], v29 offset:1024
v_mfma_f32_16x16x32_bf16 v[108:111], v[172:175], v[252:255], v[108:111]
s_waitcnt lgkmcnt(8)
v_mfma_f32_16x16x32_bf16 v[112:115], v[176:179], a[224:227], v[112:115]
s_waitcnt lgkmcnt(6)
v_mfma_f32_16x16x32_bf16 v[112:115], v[180:183], a[240:243], v[112:115]
s_waitcnt lgkmcnt(4)
v_mfma_f32_16x16x32_bf16 v[112:115], v[184:187], v[224:227], v[112:115]
s_waitcnt lgkmcnt(2)
ds_read_b64_tr_b16 v[164:165], v29 offset:8192
ds_read_b64_tr_b16 v[166:167], v29 offset:9216
v_mfma_f32_16x16x32_bf16 v[112:115], v[188:191], v[240:243], v[112:115]
v_mfma_f32_16x16x32_bf16 v[116:119], v[176:179], a[228:231], v[116:119]
ds_read_b64_tr_b16 v[168:169], v29 offset:16384
ds_read_b64_tr_b16 v[170:171], v29 offset:17408
v_mfma_f32_16x16x32_bf16 v[116:119], v[180:183], a[244:247], v[116:119]
ds_read_b64_tr_b16 v[172:173], v29 offset:24576
ds_read_b64_tr_b16 v[174:175], v29 offset:25600
v_mfma_f32_16x16x32_bf16 v[116:119], v[184:187], v[228:231], v[116:119]
s_add_u32 m0, s39, 90112
v_mfma_f32_16x16x32_bf16 v[116:119], v[188:191], v[244:247], v[116:119]
buffer_load_dwordx4 v12, s[20:23], s41 offen nt lds
v_mfma_f32_16x16x32_bf16 v[120:123], v[176:179], a[232:235], v[120:123]
v_mfma_f32_16x16x32_bf16 v[120:123], v[180:183], a[248:251], v[120:123]
v_mfma_f32_16x16x32_bf16 v[120:123], v[184:187], v[232:235], v[120:123]
v_mfma_f32_16x16x32_bf16 v[120:123], v[188:191], v[248:251], v[120:123]
v_mfma_f32_16x16x32_bf16 v[124:127], v[176:179], a[236:239], v[124:127]
v_mfma_f32_16x16x32_bf16 v[124:127], v[180:183], a[252:255], v[124:127]
v_mfma_f32_16x16x32_bf16 v[124:127], v[184:187], v[236:239], v[124:127]
ds_read_b64_tr_b16 v[176:177], v29 offset:8
ds_read_b64_tr_b16 v[178:179], v29 offset:1032
v_mfma_f32_16x16x32_bf16 v[124:127], v[188:191], v[252:255], v[124:127]
s_waitcnt lgkmcnt(8)
v_mfma_f32_16x16x32_bf16 v[128:131], v[160:163], a[224:227], v[128:131]
s_waitcnt lgkmcnt(6)
v_mfma_f32_16x16x32_bf16 v[128:131], v[164:167], a[240:243], v[128:131]
s_waitcnt lgkmcnt(4)
v_mfma_f32_16x16x32_bf16 v[128:131], v[168:171], v[224:227], v[128:131]
s_waitcnt lgkmcnt(2)
ds_read_b64_tr_b16 v[180:181], v29 offset:8200
ds_read_b64_tr_b16 v[182:183], v29 offset:9224
v_mfma_f32_16x16x32_bf16 v[128:131], v[172:175], v[240:243], v[128:131]
buffer_load_dwordx4 v13, s[20:23], s41 offen offset:1024 nt lds
v_mfma_f32_16x16x32_bf16 v[132:135], v[160:163], a[228:231], v[132:135]
ds_read_b64_tr_b16 v[184:185], v29 offset:16392
ds_read_b64_tr_b16 v[186:187], v29 offset:17416
v_mfma_f32_16x16x32_bf16 v[132:135], v[164:167], a[244:247], v[132:135]
ds_read_b64_tr_b16 v[188:189], v29 offset:24584
ds_read_b64_tr_b16 v[190:191], v29 offset:25608
v_mfma_f32_16x16x32_bf16 v[132:135], v[168:171], v[228:231], v[132:135]
v_mfma_f32_16x16x32_bf16 v[132:135], v[172:175], v[244:247], v[132:135]
v_mfma_f32_16x16x32_bf16 v[136:139], v[160:163], a[232:235], v[136:139]
v_mfma_f32_16x16x32_bf16 v[136:139], v[164:167], a[248:251], v[136:139]
v_mfma_f32_16x16x32_bf16 v[136:139], v[168:171], v[232:235], v[136:139]
v_mfma_f32_16x16x32_bf16 v[136:139], v[172:175], v[248:251], v[136:139]
v_mfma_f32_16x16x32_bf16 v[140:143], v[160:163], a[236:239], v[140:143]
s_mov_b32 s14, 5308416
v_mfma_f32_16x16x32_bf16 v[140:143], v[164:167], a[252:255], v[140:143]
v_mfma_f32_16x16x32_bf16 v[140:143], v[168:171], v[236:239], v[140:143]
s_cmp_lt_u32 s2, 128
s_cselect_b32 s12, s66, s4
s_cselect_b32 s13, s67, s5
s_cselect_b32 s14, 4718592, s14
v_mfma_f32_16x16x32_bf16 v[140:143], v[172:175], v[252:255], v[140:143]
s_waitcnt lgkmcnt(4)
v_mfma_f32_16x16x32_bf16 v[144:147], v[176:179], a[224:227], v[144:147]
s_lshl_b32 s38, s2, 2
v_mfma_f32_16x16x32_bf16 v[144:147], v[180:183], a[240:243], v[144:147]
s_waitcnt lgkmcnt(0)
v_mfma_f32_16x16x32_bf16 v[144:147], v[184:187], v[224:227], v[144:147]
s_add_u32 s38, s38, s3
v_mfma_f32_16x16x32_bf16 v[144:147], v[188:191], v[240:243], v[144:147]
v_mfma_f32_16x16x32_bf16 v[148:151], v[176:179], a[228:231], v[148:151]
s_mul_i32 s38, s38, 10240
v_mfma_f32_16x16x32_bf16 v[148:151], v[180:183], a[244:247], v[148:151]
v_mfma_f32_16x16x32_bf16 v[148:151], v[184:187], v[228:231], v[148:151]
s_add_u32 s38, s38, 50331648
v_mfma_f32_16x16x32_bf16 v[148:151], v[188:191], v[244:247], v[148:151]
v_mfma_f32_16x16x32_bf16 v[152:155], v[176:179], a[232:235], v[152:155]
v_mfma_f32_16x16x32_bf16 v[152:155], v[180:183], a[248:251], v[152:155]
v_mfma_f32_16x16x32_bf16 v[152:155], v[184:187], v[232:235], v[152:155]
v_mfma_f32_16x16x32_bf16 v[152:155], v[188:191], v[248:251], v[152:155]
v_mfma_f32_16x16x32_bf16 v[156:159], v[176:179], a[236:239], v[156:159]
v_mfma_f32_16x16x32_bf16 v[156:159], v[180:183], a[252:255], v[156:159]
v_mfma_f32_16x16x32_bf16 v[156:159], v[184:187], v[236:239], v[156:159]
s_waitcnt vmcnt(12)
v_mfma_f32_16x16x32_bf16 v[156:159], v[188:191], v[252:255], v[156:159]
s_mov_b32 s60, 0x3e0293ee
s_mov_b32 s61, 0x3e0293ee
s_waitcnt lgkmcnt(0)
s_barrier
ds_read_b128 a[128:131], v14 offset:0
ds_read_b128 a[132:135], v15 offset:0
ds_read_b128 a[136:139], v16 offset:0
ds_read_b128 a[140:143], v17 offset:0
ds_read_b64_tr_b16 a[144:145], v18 offset:57344
ds_read_b64_tr_b16 a[146:147], v18 offset:61440
ds_read_b64_tr_b16 a[148:149], v19 offset:57344
ds_read_b64_tr_b16 a[150:151], v19 offset:61440
s_add_u32 m0, s52, 139264
s_nop 0
buffer_load_dwordx4 v8, s[24:27], s51 offen lds
s_add_u32 m0, s52, 143360
s_nop 0
buffer_load_dwordx4 v8, s[28:31], s51 offen lds
s_add_u32 s51, s51, 294912
v_pk_mul_f32 v[32:33], v[32:33], s[60:61]
v_pk_mul_f32 v[34:35], v[34:35], s[60:61]
v_cvt_pk_bf16_f32 v160, v32, v33
v_cvt_pk_bf16_f32 v161, v34, v35
v_pk_mul_f32 v[48:49], v[48:49], s[60:61]
v_pk_mul_f32 v[50:51], v[50:51], s[60:61]
v_cvt_pk_bf16_f32 v162, v48, v49
v_cvt_pk_bf16_f32 v163, v50, v51
v_pk_mul_f32 v[36:37], v[36:37], s[60:61]
v_pk_mul_f32 v[38:39], v[38:39], s[60:61]
v_cvt_pk_bf16_f32 v176, v36, v37
v_cvt_pk_bf16_f32 v177, v38, v39
v_pk_mul_f32 v[52:53], v[52:53], s[60:61]
v_pk_mul_f32 v[54:55], v[54:55], s[60:61]
v_cvt_pk_bf16_f32 v178, v52, v53
v_cvt_pk_bf16_f32 v179, v54, v55
v_pk_mul_f32 v[40:41], v[40:41], s[60:61]
v_pk_mul_f32 v[42:43], v[42:43], s[60:61]
v_cvt_pk_bf16_f32 v192, v40, v41
v_cvt_pk_bf16_f32 v193, v42, v43
v_pk_mul_f32 v[56:57], v[56:57], s[60:61]
v_pk_mul_f32 v[58:59], v[58:59], s[60:61]
v_cvt_pk_bf16_f32 v194, v56, v57
v_cvt_pk_bf16_f32 v195, v58, v59
v_pk_mul_f32 v[44:45], v[44:45], s[60:61]
v_pk_mul_f32 v[46:47], v[46:47], s[60:61]
v_cvt_pk_bf16_f32 v208, v44, v45
v_cvt_pk_bf16_f32 v209, v46, v47
v_pk_mul_f32 v[60:61], v[60:61], s[60:61]
v_pk_mul_f32 v[62:63], v[62:63], s[60:61]
v_cvt_pk_bf16_f32 v210, v60, v61
v_cvt_pk_bf16_f32 v211, v62, v63
s_add_u32 m0, s52, 147456
s_nop 0
buffer_load_dwordx4 v8, s[24:27], s51 offen lds
s_add_u32 m0, s52, 151552
s_nop 0
buffer_load_dwordx4 v8, s[28:31], s51 offen lds
s_add_u32 s51, s51, 294912
v_pk_mul_f32 v[64:65], v[64:65], s[60:61]
v_pk_mul_f32 v[66:67], v[66:67], s[60:61]
v_cvt_pk_bf16_f32 v164, v64, v65
v_cvt_pk_bf16_f32 v165, v66, v67
v_pk_mul_f32 v[80:81], v[80:81], s[60:61]
v_pk_mul_f32 v[82:83], v[82:83], s[60:61]
v_cvt_pk_bf16_f32 v166, v80, v81
v_cvt_pk_bf16_f32 v167, v82, v83
v_pk_mul_f32 v[68:69], v[68:69], s[60:61]
v_pk_mul_f32 v[70:71], v[70:71], s[60:61]
v_cvt_pk_bf16_f32 v180, v68, v69
v_cvt_pk_bf16_f32 v181, v70, v71
v_pk_mul_f32 v[84:85], v[84:85], s[60:61]
v_pk_mul_f32 v[86:87], v[86:87], s[60:61]
v_cvt_pk_bf16_f32 v182, v84, v85
v_cvt_pk_bf16_f32 v183, v86, v87
v_pk_mul_f32 v[72:73], v[72:73], s[60:61]
v_pk_mul_f32 v[74:75], v[74:75], s[60:61]
v_cvt_pk_bf16_f32 v196, v72, v73
v_cvt_pk_bf16_f32 v197, v74, v75
v_pk_mul_f32 v[88:89], v[88:89], s[60:61]
v_pk_mul_f32 v[90:91], v[90:91], s[60:61]
v_cvt_pk_bf16_f32 v198, v88, v89
v_cvt_pk_bf16_f32 v199, v90, v91
v_pk_mul_f32 v[76:77], v[76:77], s[60:61]
v_pk_mul_f32 v[78:79], v[78:79], s[60:61]
v_cvt_pk_bf16_f32 v212, v76, v77
v_cvt_pk_bf16_f32 v213, v78, v79
v_pk_mul_f32 v[92:93], v[92:93], s[60:61]
v_pk_mul_f32 v[94:95], v[94:95], s[60:61]
v_cvt_pk_bf16_f32 v214, v92, v93
v_cvt_pk_bf16_f32 v215, v94, v95
s_add_u32 m0, s52, 155648
s_nop 0
buffer_load_dwordx4 v8, s[24:27], s51 offen lds
s_add_u32 m0, s52, 159744
s_nop 0
buffer_load_dwordx4 v8, s[28:31], s51 offen lds
s_add_u32 s51, s51, 294912
v_pk_mul_f32 v[96:97], v[96:97], s[60:61]
v_pk_mul_f32 v[98:99], v[98:99], s[60:61]
v_cvt_pk_bf16_f32 v168, v96, v97
v_cvt_pk_bf16_f32 v169, v98, v99
v_pk_mul_f32 v[112:113], v[112:113], s[60:61]
v_pk_mul_f32 v[114:115], v[114:115], s[60:61]
v_cvt_pk_bf16_f32 v170, v112, v113
v_cvt_pk_bf16_f32 v171, v114, v115
v_pk_mul_f32 v[100:101], v[100:101], s[60:61]
v_pk_mul_f32 v[102:103], v[102:103], s[60:61]
v_cvt_pk_bf16_f32 v184, v100, v101
v_cvt_pk_bf16_f32 v185, v102, v103
v_pk_mul_f32 v[116:117], v[116:117], s[60:61]
v_pk_mul_f32 v[118:119], v[118:119], s[60:61]
v_cvt_pk_bf16_f32 v186, v116, v117
v_cvt_pk_bf16_f32 v187, v118, v119
v_pk_mul_f32 v[104:105], v[104:105], s[60:61]
v_pk_mul_f32 v[106:107], v[106:107], s[60:61]
v_cvt_pk_bf16_f32 v200, v104, v105
v_cvt_pk_bf16_f32 v201, v106, v107
v_pk_mul_f32 v[120:121], v[120:121], s[60:61]
v_pk_mul_f32 v[122:123], v[122:123], s[60:61]
v_cvt_pk_bf16_f32 v202, v120, v121
v_cvt_pk_bf16_f32 v203, v122, v123
v_pk_mul_f32 v[108:109], v[108:109], s[60:61]
v_pk_mul_f32 v[110:111], v[110:111], s[60:61]
v_cvt_pk_bf16_f32 v216, v108, v109
v_cvt_pk_bf16_f32 v217, v110, v111
v_pk_mul_f32 v[124:125], v[124:125], s[60:61]
v_pk_mul_f32 v[126:127], v[126:127], s[60:61]
v_cvt_pk_bf16_f32 v218, v124, v125
v_cvt_pk_bf16_f32 v219, v126, v127
v_pk_mul_f32 v[128:129], v[128:129], s[60:61]
v_pk_mul_f32 v[130:131], v[130:131], s[60:61]
v_cvt_pk_bf16_f32 v172, v128, v129
v_cvt_pk_bf16_f32 v173, v130, v131
v_pk_mul_f32 v[144:145], v[144:145], s[60:61]
v_pk_mul_f32 v[146:147], v[146:147], s[60:61]
v_cvt_pk_bf16_f32 v174, v144, v145
v_cvt_pk_bf16_f32 v175, v146, v147
v_pk_mul_f32 v[132:133], v[132:133], s[60:61]
v_pk_mul_f32 v[134:135], v[134:135], s[60:61]
v_cvt_pk_bf16_f32 v188, v132, v133
v_cvt_pk_bf16_f32 v189, v134, v135
v_pk_mul_f32 v[148:149], v[148:149], s[60:61]
v_pk_mul_f32 v[150:151], v[150:151], s[60:61]
v_cvt_pk_bf16_f32 v190, v148, v149
v_cvt_pk_bf16_f32 v191, v150, v151
v_pk_mul_f32 v[136:137], v[136:137], s[60:61]
v_pk_mul_f32 v[138:139], v[138:139], s[60:61]
v_cvt_pk_bf16_f32 v204, v136, v137
v_cvt_pk_bf16_f32 v205, v138, v139
v_pk_mul_f32 v[152:153], v[152:153], s[60:61]
v_pk_mul_f32 v[154:155], v[154:155], s[60:61]
v_cvt_pk_bf16_f32 v206, v152, v153
v_cvt_pk_bf16_f32 v207, v154, v155
v_pk_mul_f32 v[140:141], v[140:141], s[60:61]
v_pk_mul_f32 v[142:143], v[142:143], s[60:61]
v_cvt_pk_bf16_f32 v220, v140, v141
v_cvt_pk_bf16_f32 v221, v142, v143
v_pk_mul_f32 v[156:157], v[156:157], s[60:61]
v_pk_mul_f32 v[158:159], v[158:159], s[60:61]
v_cvt_pk_bf16_f32 v222, v156, v157
v_cvt_pk_bf16_f32 v223, v158, v159
s_waitcnt lgkmcnt(7)
v_mfma_f32_16x16x32_bf16 v[32:35], a[128:131], v[160:163], 0
v_mov_b32 v112, 0
v_mov_b32 v113, 0
v_mfma_f32_16x16x32_bf16 v[36:39], a[128:131], v[176:179], 0
v_mov_b32 v114, 0
v_mov_b32 v115, 0
v_mfma_f32_16x16x32_bf16 v[40:43], a[128:131], v[192:195], 0
v_mov_b32 v116, 0
v_mov_b32 v117, 0
v_mfma_f32_16x16x32_bf16 v[44:47], a[128:131], v[208:211], 0
s_waitcnt lgkmcnt(6)
ds_read_b128 a[128:131], v14 offset:4096
v_mov_b32 v118, 0
v_mov_b32 v119, 0
v_mfma_f32_16x16x32_bf16 v[32:35], a[132:135], v[164:167], v[32:35]
v_mov_b32 v120, 0
v_mov_b32 v121, 0
v_mfma_f32_16x16x32_bf16 v[36:39], a[132:135], v[180:183], v[36:39]
v_mov_b32 v122, 0
v_mov_b32 v123, 0
v_mfma_f32_16x16x32_bf16 v[40:43], a[132:135], v[196:199], v[40:43]
v_mov_b32 v124, 0
v_mov_b32 v125, 0
v_mfma_f32_16x16x32_bf16 v[44:47], a[132:135], v[212:215], v[44:47]
s_waitcnt lgkmcnt(6)
ds_read_b128 a[132:135], v15 offset:4096
v_mov_b32 v126, 0
v_mov_b32 v127, 0
v_mfma_f32_16x16x32_bf16 v[32:35], a[136:139], v[168:171], v[32:35]
v_mov_b32 v148, 0
v_mov_b32 v156, 0
v_mfma_f32_16x16x32_bf16 v[36:39], a[136:139], v[184:187], v[36:39]
v_mov_b32 v150, 0
v_mov_b32 v157, 0
v_mfma_f32_16x16x32_bf16 v[40:43], a[136:139], v[200:203], v[40:43]
v_mov_b32 v152, 0
v_mov_b32 v158, 0
v_mfma_f32_16x16x32_bf16 v[44:47], a[136:139], v[216:219], v[44:47]
s_waitcnt lgkmcnt(6)
ds_read_b128 a[136:139], v16 offset:4096
v_mov_b32 v2, 0
v_mov_b32 v159, 0
v_mfma_f32_16x16x32_bf16 v[32:35], a[140:143], v[172:175], v[32:35]
v_mov_b32 v144, -1
v_mov_b32 v145, -1
v_mfma_f32_16x16x32_bf16 v[36:39], a[140:143], v[188:191], v[36:39]
v_mov_b32 v146, -1
v_mov_b32 v147, -1
v_mfma_f32_16x16x32_bf16 v[40:43], a[140:143], v[204:207], v[40:43]
v_mfma_f32_16x16x32_bf16 v[44:47], a[140:143], v[220:223], v[44:47]
s_waitcnt lgkmcnt(2)
ds_read_b128 a[140:143], v17 offset:4096
v_mfma_f32_16x16x32_bf16 v[48:51], a[128:131], v[160:163], 0
v_mfma_f32_16x16x32_bf16 v[52:55], a[128:131], v[176:179], 0
v_mfma_f32_16x16x32_bf16 v[56:59], a[128:131], v[192:195], 0
v_mfma_f32_16x16x32_bf16 v[60:63], a[128:131], v[208:211], 0
s_waitcnt lgkmcnt(2)
ds_read_b128 a[128:131], v14 offset:8192
v_mfma_f32_16x16x32_bf16 v[48:51], a[132:135], v[164:167], v[48:51]
v_mfma_f32_16x16x32_bf16 v[52:55], a[132:135], v[180:183], v[52:55]
v_mfma_f32_16x16x32_bf16 v[56:59], a[132:135], v[196:199], v[56:59]
v_max3_f32 v4, v32, v33, v34
v_max_f32 v4, v4, v35
v_mfma_f32_16x16x32_bf16 v[60:63], a[132:135], v[212:215], v[60:63]
s_waitcnt lgkmcnt(2)
ds_read_b128 a[132:135], v15 offset:8192
v_mfma_f32_16x16x32_bf16 v[48:51], a[136:139], v[168:171], v[48:51]
v_max3_f32 v5, v36, v37, v38
v_max_f32 v5, v5, v39
v_mfma_f32_16x16x32_bf16 v[52:55], a[136:139], v[184:187], v[52:55]
v_mfma_f32_16x16x32_bf16 v[56:59], a[136:139], v[200:203], v[56:59]
v_max3_f32 v6, v40, v41, v42
v_max_f32 v6, v6, v43
v_mfma_f32_16x16x32_bf16 v[60:63], a[136:139], v[216:219], v[60:63]
s_waitcnt lgkmcnt(2)
ds_read_b128 a[136:139], v16 offset:8192
v_mfma_f32_16x16x32_bf16 v[48:51], a[140:143], v[172:175], v[48:51]
v_max3_f32 v7, v44, v45, v46
v_max_f32 v7, v7, v47
v_mfma_f32_16x16x32_bf16 v[52:55], a[140:143], v[188:191], v[52:55]
v_mfma_f32_16x16x32_bf16 v[56:59], a[140:143], v[204:207], v[56:59]
v_mfma_f32_16x16x32_bf16 v[60:63], a[140:143], v[220:223], v[60:63]
ds_read_b128 a[140:143], v17 offset:8192
s_nop 1
v_max3_f32 v4, v4, v48, v49
s_nop 1
v_max3_f32 v5, v5, v52, v53
v_max3_f32 v6, v6, v56, v57
v_max3_f32 v7, v7, v60, v61
v_max3_f32 v4, v4, v50, v51
v_max3_f32 v5, v5, v54, v55
v_max3_f32 v6, v6, v58, v59
v_max3_f32 v7, v7, v62, v63
v_mov_b32 v26, v4
v_mov_b32 v27, v5
v_mov_b32 v28, v6
v_mov_b32 v29, v7
v_permlane16_swap_b32 v4, v26
v_permlane16_swap_b32 v5, v27
v_permlane16_swap_b32 v6, v28
v_permlane16_swap_b32 v7, v29
v_max_f32 v4, v4, v26
v_max_f32 v5, v5, v27
v_max_f32 v6, v6, v28
v_max_f32 v7, v7, v29
v_mov_b32 v26, v4
v_mov_b32 v27, v5
v_mov_b32 v28, v6
v_mov_b32 v29, v7
v_permlane32_swap_b32 v4, v26
v_permlane32_swap_b32 v5, v27
v_permlane32_swap_b32 v6, v28
v_permlane32_swap_b32 v7, v29
v_max_f32 v4, v4, v26
v_max_f32 v5, v5, v27
v_max_f32 v6, v6, v28
v_max_f32 v7, v7, v29
v_sub_f32 v128, 0, v4
v_sub_f32 v129, 0, v4
v_sub_f32 v130, 0, v4
v_sub_f32 v131, 0, v4
v_sub_f32 v132, 0, v5
v_sub_f32 v133, 0, v5
v_sub_f32 v134, 0, v5
v_sub_f32 v135, 0, v5
v_sub_f32 v136, 0, v6
v_sub_f32 v137, 0, v6
v_sub_f32 v138, 0, v6
v_sub_f32 v139, 0, v6
v_sub_f32 v140, 0, v7
v_sub_f32 v141, 0, v7
v_sub_f32 v142, 0, v7
v_sub_f32 v143, 0, v7
v_pk_add_f32 v[32:33], v[32:33], v[128:129]
v_pk_add_f32 v[34:35], v[34:35], v[128:129]
v_pk_add_f32 v[36:37], v[36:37], v[132:133]
v_pk_add_f32 v[38:39], v[38:39], v[132:133]
v_pk_add_f32 v[40:41], v[40:41], v[136:137]
v_pk_add_f32 v[42:43], v[42:43], v[136:137]
v_pk_add_f32 v[44:45], v[44:45], v[140:141]
v_pk_add_f32 v[46:47], v[46:47], v[140:141]
v_pk_add_f32 v[48:49], v[48:49], v[128:129]
v_pk_add_f32 v[50:51], v[50:51], v[128:129]
v_pk_add_f32 v[52:53], v[52:53], v[132:133]
v_pk_add_f32 v[54:55], v[54:55], v[132:133]
v_pk_add_f32 v[56:57], v[56:57], v[136:137]
v_pk_add_f32 v[58:59], v[58:59], v[136:137]
v_pk_add_f32 v[60:61], v[60:61], v[140:141]
v_pk_add_f32 v[62:63], v[62:63], v[140:141]
v_and_b32 v4, 48, v3
v_min_u32 v4, 1, v4
v_add_u32 v4, -1, v4
v_and_b32 v4, 0x3f803f80, v4
v_mov_b32 v5, v4
v_mov_b32 v6, v4
v_mov_b32 v7, v4
buffer_store_dwordx4 v[144:147], v3, s[8:11], s38 offen sc1
s_add_u32 s38, s38, 1024
K1_loop:
s_waitcnt lgkmcnt(3)
v_mfma_f32_16x16x32_bf16 v[64:67], a[128:131], v[160:163], v[128:131]
s_waitcnt lgkmcnt(2)
v_exp_f32 v144, v32
v_mfma_f32_16x16x32_bf16 v[64:67], a[132:135], v[164:167], v[64:67]
s_waitcnt lgkmcnt(0)
v_exp_f32 v145, v33
v_mfma_f32_16x16x32_bf16 v[64:67], a[136:139], v[168:171], v[64:67]
s_add_u32 s41, s41, 8192
v_add_f32 v156, v156, v148
v_add_f32 v157, v157, v150
v_mfma_f32_16x16x32_bf16 v[64:67], a[140:143], v[172:175], v[64:67]
v_exp_f32 v146, v34
v_mfma_f32_16x16x32_bf16 a[0:3], a[144:147], v[112:115], a[0:3]
v_exp_f32 v147, v35
v_mfma_f32_16x16x32_bf16 a[4:7], a[144:147], v[116:119], a[4:7]
ds_read_b64_tr_b16 a[152:153], v20 offset:57344
ds_read_b64_tr_b16 a[154:155], v20 offset:61440
v_mfma_f32_16x16x32_bf16 a[8:11], a[144:147], v[120:123], a[8:11]
v_cvt_pk_bf16_f32 v96, v144, v145
v_cvt_pk_bf16_f32 v97, v146, v147
v_mfma_f32_16x16x32_bf16 a[12:15], a[144:147], v[124:127], a[12:15]
v_exp_f32 v144, v48
v_mfma_f32_16x16x32_bf16 v[68:71], a[128:131], v[176:179], v[132:135]
v_exp_f32 v145, v49
v_mfma_f32_16x16x32_bf16 v[68:71], a[132:135], v[180:183], v[68:71]
v_exp_f32 v146, v50
v_mfma_f32_16x16x32_bf16 v[68:71], a[136:139], v[184:187], v[68:71]
v_exp_f32 v147, v51
v_mfma_f32_16x16x32_bf16 v[68:71], a[140:143], v[188:191], v[68:71]
v_cvt_pk_bf16_f32 v98, v144, v145
v_cvt_pk_bf16_f32 v99, v146, v147
v_mfma_f32_16x16x32_bf16 a[16:19], a[148:151], v[112:115], a[16:19]
s_add_u32 m0, s39, 49152
v_exp_f32 v144, v36
v_mfma_f32_16x16x32_bf16 a[20:23], a[148:151], v[116:119], a[20:23]
ds_read_b64_tr_b16 a[156:157], v21 offset:57344
ds_read_b64_tr_b16 a[158:159], v21 offset:61440
v_mfma_f32_16x16x32_bf16 a[24:27], a[148:151], v[120:123], a[24:27]
buffer_load_dwordx4 v10, s[16:19], s40 offen nt lds
v_mfma_f32_16x16x32_bf16 a[28:31], a[148:151], v[124:127], a[28:31]
v_exp_f32 v145, v37
v_mfma_f32_16x16x32_bf16 v[72:75], a[128:131], v[192:195], v[136:139]
v_exp_f32 v146, v38
v_mfma_f32_16x16x32_bf16 v[72:75], a[132:135], v[196:199], v[72:75]
ds_read_b64_tr_b16 a[144:145], v22 offset:57344
ds_read_b64_tr_b16 a[146:147], v22 offset:61440
v_mfma_f32_16x16x32_bf16 v[72:75], a[136:139], v[200:203], v[72:75]
v_exp_f32 v147, v39
v_mfma_f32_16x16x32_bf16 v[72:75], a[140:143], v[204:207], v[72:75]
v_add_f32 v158, v158, v152
v_cvt_pk_bf16_f32 v100, v144, v145
v_mfma_f32_16x16x32_bf16 v[148:151], v[4:7], v[96:99], 0
v_exp_f32 v144, v52
v_mfma_f32_16x16x32_bf16 v[76:79], a[128:131], v[208:211], v[140:143]
ds_read_b128 a[128:131], v14 offset:12288
v_mfma_f32_16x16x32_bf16 v[76:79], a[132:135], v[212:215], v[76:79]
ds_read_b128 a[132:135], v15 offset:12288
v_mfma_f32_16x16x32_bf16 v[76:79], a[136:139], v[216:219], v[76:79]
ds_read_b128 a[136:139], v16 offset:12288
v_mfma_f32_16x16x32_bf16 v[76:79], a[140:143], v[220:223], v[76:79]
s_waitcnt lgkmcnt(7)
ds_read_b128 a[140:143], v17 offset:12288
v_cvt_pk_bf16_f32 v101, v146, v147
v_mfma_f32_16x16x32_bf16 a[32:35], a[152:155], v[112:115], a[32:35]
v_exp_f32 v145, v53
v_mfma_f32_16x16x32_bf16 a[36:39], a[152:155], v[116:119], a[36:39]
v_exp_f32 v146, v54
v_mfma_f32_16x16x32_bf16 a[40:43], a[152:155], v[120:123], a[40:43]
v_exp_f32 v147, v55
v_mfma_f32_16x16x32_bf16 a[44:47], a[152:155], v[124:127], a[44:47]
s_waitcnt lgkmcnt(6)
v_cvt_pk_bf16_f32 v102, v144, v145
v_cvt_pk_bf16_f32 v103, v146, v147
v_mfma_f32_16x16x32_bf16 a[48:51], a[156:159], v[112:115], a[48:51]
v_exp_f32 v144, v40
v_mfma_f32_16x16x32_bf16 a[52:55], a[156:159], v[116:119], a[52:55]
ds_read_b64_tr_b16 a[148:149], v23 offset:57344
ds_read_b64_tr_b16 a[150:151], v23 offset:61440
v_mfma_f32_16x16x32_bf16 a[56:59], a[156:159], v[120:123], a[56:59]
buffer_load_dwordx4 v11, s[16:19], s40 offen offset:1024 nt lds
v_mfma_f32_16x16x32_bf16 a[60:63], a[156:159], v[124:127], a[60:63]
s_waitcnt lgkmcnt(4)
v_exp_f32 v145, v41
v_mfma_f32_16x16x32_bf16 v[80:83], a[128:131], v[160:163], v[128:131]
s_add_u32 s40, s40, 8192
v_exp_f32 v146, v42
v_mfma_f32_16x16x32_bf16 v[80:83], a[132:135], v[164:167], v[80:83]
s_waitcnt lgkmcnt(3)
v_exp_f32 v147, v43
v_mfma_f32_16x16x32_bf16 v[80:83], a[136:139], v[168:171], v[80:83]
s_waitcnt lgkmcnt(2)
v_add_f32 v159, v159, v2
v_cvt_pk_bf16_f32 v104, v144, v145
v_mfma_f32_16x16x32_bf16 v[80:83], a[140:143], v[172:175], v[80:83]
v_exp_f32 v144, v56
v_mfma_f32_16x16x32_bf16 v[150:153], v[4:7], v[100:103], 0
v_exp_f32 v145, v57
v_mfma_f32_16x16x32_bf16 a[64:67], a[144:147], v[112:115], a[64:67]
v_cvt_pk_bf16_f32 v105, v146, v147
v_cvt_pk_bf16_f32 v106, v144, v145
v_mfma_f32_16x16x32_bf16 a[68:71], a[144:147], v[116:119], a[68:71]
ds_read_b64_tr_b16 a[152:153], v24 offset:57344
ds_read_b64_tr_b16 a[154:155], v24 offset:61440
v_mfma_f32_16x16x32_bf16 a[72:75], a[144:147], v[120:123], a[72:75]
v_exp_f32 v146, v58
v_mfma_f32_16x16x32_bf16 a[76:79], a[144:147], v[124:127], a[76:79]
v_exp_f32 v147, v59
v_mfma_f32_16x16x32_bf16 v[84:87], a[128:131], v[176:179], v[132:135]
v_exp_f32 v144, v44
v_mfma_f32_16x16x32_bf16 v[84:87], a[132:135], v[180:183], v[84:87]
v_exp_f32 v145, v45
v_mfma_f32_16x16x32_bf16 v[84:87], a[136:139], v[184:187], v[84:87]
v_cvt_pk_bf16_f32 v107, v146, v147
v_add_f32 v2, v144, v145
v_mfma_f32_16x16x32_bf16 v[84:87], a[140:143], v[188:191], v[84:87]
s_waitcnt lgkmcnt(2)
v_exp_f32 v146, v46
v_mfma_f32_16x16x32_bf16 a[80:83], a[148:151], v[112:115], a[80:83]
s_add_u32 m0, s39, 98304
v_exp_f32 v147, v47
v_mfma_f32_16x16x32_bf16 a[84:87], a[148:151], v[116:119], a[84:87]
ds_read_b64_tr_b16 a[156:157], v25 offset:57344
ds_read_b64_tr_b16 a[158:159], v25 offset:61440
v_mfma_f32_16x16x32_bf16 a[88:91], a[148:151], v[120:123], a[88:91]
buffer_load_dwordx4 v12, s[20:23], s41 offen nt lds
v_mfma_f32_16x16x32_bf16 a[92:95], a[148:151], v[124:127], a[92:95]
v_cvt_pk_bf16_f32 v108, v144, v145
v_add_f32 v2, v2, v146
v_mfma_f32_16x16x32_bf16 v[152:155], v[4:7], v[104:107], 0
v_exp_f32 v144, v60
v_mfma_f32_16x16x32_bf16 v[88:91], a[128:131], v[192:195], v[136:139]
v_exp_f32 v145, v61
v_mfma_f32_16x16x32_bf16 v[88:91], a[132:135], v[196:199], v[88:91]
v_add_f32 v2, v2, v147
v_cvt_pk_bf16_f32 v109, v146, v147
v_mfma_f32_16x16x32_bf16 v[88:91], a[136:139], v[200:203], v[88:91]
v_exp_f32 v146, v62
v_mfma_f32_16x16x32_bf16 v[88:91], a[140:143], v[204:207], v[88:91]
v_exp_f32 v147, v63
v_mfma_f32_16x16x32_bf16 v[92:95], a[128:131], v[208:211], v[140:143]
ds_read_b128 a[128:131], v14 offset:16384
v_mfma_f32_16x16x32_bf16 v[92:95], a[132:135], v[212:215], v[92:95]
ds_read_b128 a[132:135], v15 offset:16384
v_mfma_f32_16x16x32_bf16 v[92:95], a[136:139], v[216:219], v[92:95]
ds_read_b128 a[136:139], v16 offset:16384
v_mfma_f32_16x16x32_bf16 v[92:95], a[140:143], v[220:223], v[92:95]
s_waitcnt lgkmcnt(5)
ds_read_b128 a[140:143], v17 offset:16384
v_add_f32 v2, v2, v144
v_mfma_f32_16x16x32_bf16 a[96:99], a[152:155], v[112:115], a[96:99]
v_max3_f32 v149, v148, v150, v152
v_add_f32 v2, v2, v145
v_mfma_f32_16x16x32_bf16 a[100:103], a[152:155], v[116:119], a[100:103]
ds_read_b64_tr_b16 a[144:145], v18 offset:0
ds_read_b64_tr_b16 a[146:147], v18 offset:4096
v_mfma_f32_16x16x32_bf16 a[104:107], a[152:155], v[120:123], a[104:107]
v_cvt_pk_bf16_f32 v110, v144, v145
v_add_f32 v2, v2, v146
v_mfma_f32_16x16x32_bf16 a[108:111], a[152:155], v[124:127], a[108:111]
s_waitcnt lgkmcnt(6)
v_add_f32 v2, v2, v147
v_max_f32 v149, v149, v2
v_mfma_f32_16x16x32_bf16 a[112:115], a[156:159], v[112:115], a[112:115]
v_cmp_lt_f32 vcc, s50, v149
v_cvt_pk_bf16_f32 v111, v146, v147
v_mfma_f32_16x16x32_bf16 a[116:119], a[156:159], v[116:119], a[116:119]
buffer_load_dwordx4 v13, s[20:23], s41 offen offset:1024 nt lds
v_mfma_f32_16x16x32_bf16 a[120:123], a[156:159], v[120:123], a[120:123]
s_waitcnt lgkmcnt(5)
ds_read_b64_tr_b16 a[148:149], v19 offset:0
v_mfma_f32_16x16x32_bf16 a[124:127], a[156:159], v[124:127], a[124:127]
s_cbranch_vccnz K1_slow0
K1_back0:
ds_read_b64_tr_b16 a[150:151], v19 offset:4096
v_mfma_f32_16x16x32_bf16 v[32:35], a[128:131], v[160:163], v[128:131]
s_waitcnt lgkmcnt(6)
v_exp_f32 v144, v64
v_mfma_f32_16x16x32_bf16 v[32:35], a[132:135], v[164:167], v[32:35]
s_waitcnt lgkmcnt(4)
v_exp_f32 v145, v65
v_mfma_f32_16x16x32_bf16 v[32:35], a[136:139], v[168:171], v[32:35]
s_add_u32 s41, s41, 8192
v_add_f32 v156, v156, v148
v_mfma_f32_16x16x32_bf16 v[32:35], a[140:143], v[172:175], v[32:35]
s_waitcnt lgkmcnt(2)
v_exp_f32 v146, v66
v_mfma_f32_16x16x32_bf16 a[0:3], a[144:147], v[96:99], a[0:3]
s_add_u32 m0, s52, 131072
v_exp_f32 v147, v67
v_mfma_f32_16x16x32_bf16 a[4:7], a[144:147], v[100:103], a[4:7]
ds_read_b64_tr_b16 a[152:153], v20 offset:0
ds_read_b64_tr_b16 a[154:155], v20 offset:4096
v_mfma_f32_16x16x32_bf16 a[8:11], a[144:147], v[104:107], a[8:11]
buffer_load_dwordx4 v9, s[12:15], s68 offen nt lds
v_mfma_f32_16x16x32_bf16 a[12:15], a[144:147], v[108:111], a[12:15]
v_add_f32 v157, v157, v150
v_cvt_pk_bf16_f32 v112, v144, v145
v_mfma_f32_16x16x32_bf16 v[36:39], a[128:131], v[176:179], v[132:135]
v_exp_f32 v144, v80
v_mfma_f32_16x16x32_bf16 v[36:39], a[132:135], v[180:183], v[36:39]
v_exp_f32 v145, v81
v_mfma_f32_16x16x32_bf16 v[36:39], a[136:139], v[184:187], v[36:39]
v_cvt_pk_bf16_f32 v113, v146, v147
v_mfma_f32_16x16x32_bf16 v[36:39], a[140:143], v[188:191], v[36:39]
s_waitcnt lgkmcnt(2)
v_exp_f32 v146, v82
v_mfma_f32_16x16x32_bf16 a[16:19], a[148:151], v[96:99], a[16:19]
s_add_u32 m0, s39, 57344
v_exp_f32 v147, v83
v_mfma_f32_16x16x32_bf16 a[20:23], a[148:151], v[100:103], a[20:23]
ds_read_b64_tr_b16 a[156:157], v21 offset:0
ds_read_b64_tr_b16 a[158:159], v21 offset:4096
v_mfma_f32_16x16x32_bf16 a[24:27], a[148:151], v[104:107], a[24:27]
buffer_load_dwordx4 v10, s[16:19], s40 offen nt lds
v_mfma_f32_16x16x32_bf16 a[28:31], a[148:151], v[108:111], a[28:31]
v_cvt_pk_bf16_f32 v114, v144, v145
v_cvt_pk_bf16_f32 v115, v146, v147
v_mfma_f32_16x16x32_bf16 v[40:43], a[128:131], v[192:195], v[136:139]
v_exp_f32 v144, v68
v_mfma_f32_16x16x32_bf16 v[40:43], a[132:135], v[196:199], v[40:43]
ds_read_b64_tr_b16 a[144:145], v22 offset:0
ds_read_b64_tr_b16 a[146:147], v22 offset:4096
v_mfma_f32_16x16x32_bf16 v[40:43], a[136:139], v[200:203], v[40:43]
v_exp_f32 v145, v69
v_mfma_f32_16x16x32_bf16 v[40:43], a[140:143], v[204:207], v[40:43]
v_exp_f32 v146, v70
v_mfma_f32_16x16x32_bf16 v[148:151], v[4:7], v[112:115], 0
v_exp_f32 v147, v71
v_mfma_f32_16x16x32_bf16 v[44:47], a[128:131], v[208:211], v[140:143]
ds_read_b128 a[128:131], v14 offset:20480
v_mfma_f32_16x16x32_bf16 v[44:47], a[132:135], v[212:215], v[44:47]
ds_read_b128 a[132:135], v15 offset:20480
v_add_f32 v158, v158, v152
v_mfma_f32_16x16x32_bf16 v[44:47], a[136:139], v[216:219], v[44:47]
ds_read_b128 a[136:139], v16 offset:20480
v_cvt_pk_bf16_f32 v116, v144, v145
v_mfma_f32_16x16x32_bf16 v[44:47], a[140:143], v[220:223], v[44:47]
s_waitcnt lgkmcnt(7)
ds_read_b128 a[140:143], v17 offset:20480
v_cvt_pk_bf16_f32 v117, v146, v147
v_mfma_f32_16x16x32_bf16 a[32:35], a[152:155], v[96:99], a[32:35]
v_exp_f32 v144, v84
v_mfma_f32_16x16x32_bf16 a[36:39], a[152:155], v[100:103], a[36:39]
v_exp_f32 v145, v85
v_mfma_f32_16x16x32_bf16 a[40:43], a[152:155], v[104:107], a[40:43]
v_exp_f32 v146, v86
v_mfma_f32_16x16x32_bf16 a[44:47], a[152:155], v[108:111], a[44:47]
s_waitcnt lgkmcnt(6)
v_exp_f32 v147, v87
v_mfma_f32_16x16x32_bf16 a[48:51], a[156:159], v[96:99], a[48:51]
v_cvt_pk_bf16_f32 v118, v144, v145
v_cvt_pk_bf16_f32 v119, v146, v147
v_mfma_f32_16x16x32_bf16 a[52:55], a[156:159], v[100:103], a[52:55]
ds_read_b64_tr_b16 a[148:149], v23 offset:0
ds_read_b64_tr_b16 a[150:151], v23 offset:4096
v_mfma_f32_16x16x32_bf16 a[56:59], a[156:159], v[104:107], a[56:59]
buffer_load_dwordx4 v11, s[16:19], s40 offen offset:1024 nt lds
v_mfma_f32_16x16x32_bf16 a[60:63], a[156:159], v[108:111], a[60:63]
s_waitcnt lgkmcnt(4)
v_exp_f32 v144, v72
v_mfma_f32_16x16x32_bf16 v[48:51], a[128:131], v[160:163], v[128:131]
s_add_u32 s40, s40, 8192
v_exp_f32 v145, v73
v_mfma_f32_16x16x32_bf16 v[48:51], a[132:135], v[164:167], v[48:51]
s_waitcnt lgkmcnt(3)
v_exp_f32 v146, v74
v_mfma_f32_16x16x32_bf16 v[48:51], a[136:139], v[168:171], v[48:51]
s_waitcnt lgkmcnt(2)
v_exp_f32 v147, v75
v_mfma_f32_16x16x32_bf16 v[48:51], a[140:143], v[172:175], v[48:51]
v_add_f32 v159, v159, v2
v_cvt_pk_bf16_f32 v120, v144, v145
v_mfma_f32_16x16x32_bf16 v[150:153], v[4:7], v[116:119], 0
v_exp_f32 v144, v88
v_mfma_f32_16x16x32_bf16 a[64:67], a[144:147], v[96:99], a[64:67]
v_exp_f32 v145, v89
v_mfma_f32_16x16x32_bf16 a[68:71], a[144:147], v[100:103], a[68:71]
ds_read_b64_tr_b16 a[152:153], v24 offset:0
ds_read_b64_tr_b16 a[154:155], v24 offset:4096
v_mfma_f32_16x16x32_bf16 a[72:75], a[144:147], v[104:107], a[72:75]
v_cvt_pk_bf16_f32 v121, v146, v147
v_cvt_pk_bf16_f32 v122, v144, v145
v_mfma_f32_16x16x32_bf16 a[76:79], a[144:147], v[108:111], a[76:79]
v_exp_f32 v146, v90
v_mfma_f32_16x16x32_bf16 v[52:55], a[128:131], v[176:179], v[132:135]
v_exp_f32 v147, v91
v_mfma_f32_16x16x32_bf16 v[52:55], a[132:135], v[180:183], v[52:55]
v_exp_f32 v144, v76
v_mfma_f32_16x16x32_bf16 v[52:55], a[136:139], v[184:187], v[52:55]
v_exp_f32 v145, v77
v_mfma_f32_16x16x32_bf16 v[52:55], a[140:143], v[188:191], v[52:55]
s_waitcnt lgkmcnt(2)
v_cvt_pk_bf16_f32 v123, v146, v147
v_add_f32 v2, v144, v145
v_mfma_f32_16x16x32_bf16 a[80:83], a[148:151], v[96:99], a[80:83]
s_add_u32 m0, s39, 106496
v_exp_f32 v146, v78
v_mfma_f32_16x16x32_bf16 a[84:87], a[148:151], v[100:103], a[84:87]
ds_read_b64_tr_b16 a[156:157], v25 offset:0
ds_read_b64_tr_b16 a[158:159], v25 offset:4096
v_mfma_f32_16x16x32_bf16 a[88:91], a[148:151], v[104:107], a[88:91]
buffer_load_dwordx4 v12, s[20:23], s41 offen nt lds
v_mfma_f32_16x16x32_bf16 a[92:95], a[148:151], v[108:111], a[92:95]
v_exp_f32 v147, v79
v_mfma_f32_16x16x32_bf16 v[152:155], v[4:7], v[120:123], 0
v_cvt_pk_bf16_f32 v124, v144, v145
v_add_f32 v2, v2, v146
v_mfma_f32_16x16x32_bf16 v[56:59], a[128:131], v[192:195], v[136:139]
v_exp_f32 v144, v92
v_mfma_f32_16x16x32_bf16 v[56:59], a[132:135], v[196:199], v[56:59]
v_exp_f32 v145, v93
v_mfma_f32_16x16x32_bf16 v[56:59], a[136:139], v[200:203], v[56:59]
v_add_f32 v2, v2, v147
v_cvt_pk_bf16_f32 v125, v146, v147
v_mfma_f32_16x16x32_bf16 v[56:59], a[140:143], v[204:207], v[56:59]
v_exp_f32 v146, v94
v_mfma_f32_16x16x32_bf16 v[60:63], a[128:131], v[208:211], v[140:143]
s_waitcnt vmcnt(14)
s_barrier
ds_read_b128 a[128:131], v14 offset:24576
v_mfma_f32_16x16x32_bf16 v[60:63], a[132:135], v[212:215], v[60:63]
ds_read_b128 a[132:135], v15 offset:24576
v_add_f32 v2, v2, v144
v_mfma_f32_16x16x32_bf16 v[60:63], a[136:139], v[216:219], v[60:63]
ds_read_b128 a[136:139], v16 offset:24576
v_max3_f32 v149, v148, v150, v152
v_mfma_f32_16x16x32_bf16 v[60:63], a[140:143], v[220:223], v[60:63]
s_waitcnt lgkmcnt(5)
ds_read_b128 a[140:143], v17 offset:24576
v_add_f32 v2, v2, v145
v_mfma_f32_16x16x32_bf16 a[96:99], a[152:155], v[96:99], a[96:99]
v_exp_f32 v147, v95
v_mfma_f32_16x16x32_bf16 a[100:103], a[152:155], v[100:103], a[100:103]
ds_read_b64_tr_b16 a[144:145], v18 offset:8192
ds_read_b64_tr_b16 a[146:147], v18 offset:12288
v_mfma_f32_16x16x32_bf16 a[104:107], a[152:155], v[104:107], a[104:107]
v_cvt_pk_bf16_f32 v126, v144, v145
v_add_f32 v2, v2, v146
v_mfma_f32_16x16x32_bf16 a[108:111], a[152:155], v[108:111], a[108:111]
s_waitcnt lgkmcnt(6)
v_add_f32 v2, v2, v147
v_max_f32 v149, v149, v2
v_mfma_f32_16x16x32_bf16 a[112:115], a[156:159], v[96:99], a[112:115]
v_cmp_lt_f32 vcc, s50, v149
v_cvt_pk_bf16_f32 v127, v146, v147
v_mfma_f32_16x16x32_bf16 a[116:119], a[156:159], v[100:103], a[116:119]
buffer_load_dwordx4 v13, s[20:23], s41 offen offset:1024 nt lds
v_mfma_f32_16x16x32_bf16 a[120:123], a[156:159], v[104:107], a[120:123]
s_waitcnt lgkmcnt(5)
ds_read_b64_tr_b16 a[148:149], v19 offset:8192
v_mfma_f32_16x16x32_bf16 a[124:127], a[156:159], v[108:111], a[124:127]
s_cbranch_vccnz K1_slow1
K1_back1:
ds_read_b64_tr_b16 a[150:151], v19 offset:12288
v_mfma_f32_16x16x32_bf16 v[64:67], a[128:131], v[160:163], v[128:131]
s_waitcnt lgkmcnt(6)
v_add_f32 v156, v156, v148
v_add_f32 v157, v157, v150
v_mfma_f32_16x16x32_bf16 v[64:67], a[132:135], v[164:167], v[64:67]
s_waitcnt lgkmcnt(4)
v_mov_b32 v148, -1
v_mov_b32 v149, -1
v_mfma_f32_16x16x32_bf16 v[64:67], a[136:139], v[168:171], v[64:67]
s_add_u32 s41, s41, 8192
v_mov_b32 v150, -1
v_mov_b32 v151, -1
v_mfma_f32_16x16x32_bf16 v[64:67], a[140:143], v[172:175], v[64:67]
s_waitcnt lgkmcnt(2)
v_exp_f32 v144, v32
v_mfma_f32_16x16x32_bf16 a[0:3], a[144:147], v[112:115], a[0:3]
v_exp_f32 v145, v33
v_mfma_f32_16x16x32_bf16 a[4:7], a[144:147], v[116:119], a[4:7]
ds_read_b64_tr_b16 a[152:153], v20 offset:8192
ds_read_b64_tr_b16 a[154:155], v20 offset:12288
v_mfma_f32_16x16x32_bf16 a[8:11], a[144:147], v[120:123], a[8:11]
buffer_store_dwordx4 v[148:151], v3, s[8:11], s38 offen sc1
v_mfma_f32_16x16x32_bf16 a[12:15], a[144:147], v[124:127], a[12:15]
v_exp_f32 v146, v34
v_mfma_f32_16x16x32_bf16 v[68:71], a[128:131], v[176:179], v[132:135]
v_exp_f32 v147, v35
v_mfma_f32_16x16x32_bf16 v[68:71], a[132:135], v[180:183], v[68:71]
v_cvt_pk_bf16_f32 v96, v144, v145
v_cvt_pk_bf16_f32 v97, v146, v147
v_mfma_f32_16x16x32_bf16 v[68:71], a[136:139], v[184:187], v[68:71]
v_exp_f32 v144, v48
v_mfma_f32_16x16x32_bf16 v[68:71], a[140:143], v[188:191], v[68:71]
s_waitcnt lgkmcnt(2)
v_exp_f32 v145, v49
v_mfma_f32_16x16x32_bf16 a[16:19], a[148:151], v[112:115], a[16:19]
s_add_u32 m0, s39, 0
v_exp_f32 v146, v50
v_mfma_f32_16x16x32_bf16 a[20:23], a[148:151], v[116:119], a[20:23]
ds_read_b64_tr_b16 a[156:157], v21 offset:8192
ds_read_b64_tr_b16 a[158:159], v21 offset:12288
v_mfma_f32_16x16x32_bf16 a[24:27], a[148:151], v[120:123], a[24:27]
buffer_load_dwordx4 v10, s[16:19], s40 offen nt lds
v_mfma_f32_16x16x32_bf16 a[28:31], a[148:151], v[124:127], a[28:31]
v_exp_f32 v147, v51
v_mfma_f32_16x16x32_bf16 v[72:75], a[128:131], v[192:195], v[136:139]
v_cvt_pk_bf16_f32 v98, v144, v145
v_cvt_pk_bf16_f32 v99, v146, v147
v_mfma_f32_16x16x32_bf16 v[72:75], a[132:135], v[196:199], v[72:75]
ds_read_b64_tr_b16 a[144:145], v22 offset:8192
ds_read_b64_tr_b16 a[146:147], v22 offset:12288
v_mfma_f32_16x16x32_bf16 v[72:75], a[136:139], v[200:203], v[72:75]
v_exp_f32 v144, v36
v_mfma_f32_16x16x32_bf16 v[72:75], a[140:143], v[204:207], v[72:75]
v_exp_f32 v145, v37
v_mfma_f32_16x16x32_bf16 v[148:151], v[4:7], v[96:99], 0
v_exp_f32 v146, v38
v_mfma_f32_16x16x32_bf16 v[76:79], a[128:131], v[208:211], v[140:143]
ds_read_b128 a[128:131], v14 offset:28672
v_add_f32 v158, v158, v152
v_mfma_f32_16x16x32_bf16 v[76:79], a[132:135], v[212:215], v[76:79]
ds_read_b128 a[132:135], v15 offset:28672
v_exp_f32 v147, v39
v_mfma_f32_16x16x32_bf16 v[76:79], a[136:139], v[216:219], v[76:79]
ds_read_b128 a[136:139], v16 offset:28672
v_cvt_pk_bf16_f32 v100, v144, v145
v_mfma_f32_16x16x32_bf16 v[76:79], a[140:143], v[220:223], v[76:79]
s_waitcnt lgkmcnt(7)
ds_read_b128 a[140:143], v17 offset:28672
v_cvt_pk_bf16_f32 v101, v146, v147
v_mfma_f32_16x16x32_bf16 a[32:35], a[152:155], v[112:115], a[32:35]
v_exp_f32 v144, v52
v_mfma_f32_16x16x32_bf16 a[36:39], a[152:155], v[116:119], a[36:39]
v_exp_f32 v145, v53
v_mfma_f32_16x16x32_bf16 a[40:43], a[152:155], v[120:123], a[40:43]
v_exp_f32 v146, v54
v_mfma_f32_16x16x32_bf16 a[44:47], a[152:155], v[124:127], a[44:47]
s_waitcnt lgkmcnt(6)
ds_read_b64_tr_b16 v[26:27], v1 offset:4096
ds_read_b64_tr_b16 v[28:29], v1 offset:6144
v_mfma_f32_16x16x32_bf16 a[48:51], a[156:159], v[112:115], a[48:51]
v_exp_f32 v147, v55
v_mfma_f32_16x16x32_bf16 a[52:55], a[156:159], v[116:119], a[52:55]
ds_read_b64_tr_b16 a[148:149], v23 offset:8192
ds_read_b64_tr_b16 a[150:151], v23 offset:12288
v_mfma_f32_16x16x32_bf16 a[56:59], a[156:159], v[120:123], a[56:59]
buffer_load_dwordx4 v11, s[16:19], s40 offen offset:1024 nt lds
v_mfma_f32_16x16x32_bf16 a[60:63], a[156:159], v[124:127], a[60:63]
s_waitcnt lgkmcnt(6)
v_cvt_pk_bf16_f32 v102, v144, v145
v_cvt_pk_bf16_f32 v103, v146, v147
v_mfma_f32_16x16x32_bf16 v[80:83], a[128:131], v[160:163], v[128:131]
s_add_u32 s40, s40, 8192
v_exp_f32 v144, v40
v_mfma_f32_16x16x32_bf16 v[80:83], a[132:135], v[164:167], v[80:83]
s_waitcnt lgkmcnt(5)
v_exp_f32 v145, v41
v_mfma_f32_16x16x32_bf16 v[80:83], a[136:139], v[168:171], v[80:83]
s_waitcnt lgkmcnt(4)
v_exp_f32 v146, v42
v_mfma_f32_16x16x32_bf16 v[80:83], a[140:143], v[172:175], v[80:83]
v_exp_f32 v147, v43
v_mfma_f32_16x16x32_bf16 v[150:153], v[4:7], v[100:103], 0
v_add_f32 v159, v159, v2
v_cvt_pk_bf16_f32 v104, v144, v145
v_mfma_f32_16x16x32_bf16 a[64:67], a[144:147], v[112:115], a[64:67]
v_exp_f32 v144, v56
v_mfma_f32_16x16x32_bf16 a[68:71], a[144:147], v[116:119], a[68:71]
ds_read_b64_tr_b16 a[152:153], v24 offset:8192
ds_read_b64_tr_b16 a[154:155], v24 offset:12288
v_mfma_f32_16x16x32_bf16 a[72:75], a[144:147], v[120:123], a[72:75]
v_exp_f32 v145, v57
v_mfma_f32_16x16x32_bf16 a[76:79], a[144:147], v[124:127], a[76:79]
s_add_u32 s38, s38, 1024
v_cvt_pk_bf16_f32 v105, v146, v147
v_cvt_pk_bf16_f32 v106, v144, v145
v_mfma_f32_16x16x32_bf16 v[84:87], a[128:131], v[176:179], v[132:135]
v_exp_f32 v146, v58
v_mfma_f32_16x16x32_bf16 v[84:87], a[132:135], v[180:183], v[84:87]
v_exp_f32 v147, v59
v_mfma_f32_16x16x32_bf16 v[84:87], a[136:139], v[184:187], v[84:87]
v_exp_f32 v144, v44
v_mfma_f32_16x16x32_bf16 v[84:87], a[140:143], v[188:191], v[84:87]
s_waitcnt lgkmcnt(2)
v_exp_f32 v145, v45
v_mfma_f32_16x16x32_bf16 a[80:83], a[148:151], v[112:115], a[80:83]
s_add_u32 m0, s39, 114688
v_cvt_pk_bf16_f32 v107, v146, v147
v_add_f32 v2, v144, v145
v_mfma_f32_16x16x32_bf16 a[84:87], a[148:151], v[116:119], a[84:87]
ds_read_b64_tr_b16 a[156:157], v25 offset:8192
ds_read_b64_tr_b16 a[158:159], v25 offset:12288
v_mfma_f32_16x16x32_bf16 a[88:91], a[148:151], v[120:123], a[88:91]
buffer_load_dwordx4 v12, s[20:23], s41 offen nt lds
v_mfma_f32_16x16x32_bf16 a[92:95], a[148:151], v[124:127], a[92:95]
v_exp_f32 v146, v46
v_mfma_f32_16x16x32_bf16 v[152:155], v[4:7], v[104:107], 0
v_exp_f32 v147, v47
v_mfma_f32_16x16x32_bf16 v[88:91], a[128:131], v[192:195], v[136:139]
v_cvt_pk_bf16_f32 v108, v144, v145
v_add_f32 v2, v2, v146
v_mfma_f32_16x16x32_bf16 v[88:91], a[132:135], v[196:199], v[88:91]
v_exp_f32 v144, v60
v_mfma_f32_16x16x32_bf16 v[88:91], a[136:139], v[200:203], v[88:91]
v_exp_f32 v145, v61
v_mfma_f32_16x16x32_bf16 v[88:91], a[140:143], v[204:207], v[88:91]
v_add_f32 v2, v2, v147
v_cvt_pk_bf16_f32 v109, v146, v147
v_mfma_f32_16x16x32_bf16 v[92:95], a[128:131], v[208:211], v[140:143]
ds_read_b128 a[128:131], v14 offset:32768
v_add_f32 v2, v2, v144
v_mfma_f32_16x16x32_bf16 v[92:95], a[132:135], v[212:215], v[92:95]
ds_read_b128 a[132:135], v15 offset:32768
v_max3_f32 v149, v148, v150, v152
v_mfma_f32_16x16x32_bf16 v[92:95], a[136:139], v[216:219], v[92:95]
ds_read_b128 a[136:139], v16 offset:32768
v_add_f32 v2, v2, v145
v_mfma_f32_16x16x32_bf16 v[92:95], a[140:143], v[220:223], v[92:95]
s_waitcnt lgkmcnt(5)
ds_read_b128 a[140:143], v17 offset:32768
v_cvt_pk_bf16_f32 v110, v144, v145
v_mfma_f32_16x16x32_bf16 a[96:99], a[152:155], v[112:115], a[96:99]
v_exp_f32 v146, v62
v_mfma_f32_16x16x32_bf16 a[100:103], a[152:155], v[116:119], a[100:103]
ds_read_b64_tr_b16 a[144:145], v18 offset:16384
ds_read_b64_tr_b16 a[146:147], v18 offset:20480
v_mfma_f32_16x16x32_bf16 a[104:107], a[152:155], v[120:123], a[104:107]
v_exp_f32 v147, v63
v_mfma_f32_16x16x32_bf16 a[108:111], a[152:155], v[124:127], a[108:111]
s_waitcnt lgkmcnt(6)
v_add_f32 v2, v2, v146
v_add_f32 v2, v2, v147
v_mfma_f32_16x16x32_bf16 a[112:115], a[156:159], v[112:115], a[112:115]
v_max_f32_e64 v149, v149, v2
v_cmp_lt_f32 vcc, s50, v149
v_cvt_pk_bf16_f32 v111, v146, v147
v_mfma_f32_16x16x32_bf16 a[116:119], a[156:159], v[116:119], a[116:119]
buffer_load_dwordx4 v13, s[20:23], s41 offen offset:1024 nt lds
v_mfma_f32_16x16x32_bf16 a[120:123], a[156:159], v[120:123], a[120:123]
s_waitcnt lgkmcnt(5)
ds_read_b64_tr_b16 a[148:149], v19 offset:16384
v_mfma_f32_16x16x32_bf16 a[124:127], a[156:159], v[124:127], a[124:127]
s_cbranch_vccnz K1_slow2
K1_back2:
ds_read_b64_tr_b16 a[150:151], v19 offset:20480
v_mfma_f32_16x16x32_bf16 v[32:35], a[128:131], v[160:163], v[128:131]
s_waitcnt lgkmcnt(6)
v_exp_f32 v144, v64
v_mfma_f32_16x16x32_bf16 v[32:35], a[132:135], v[164:167], v[32:35]
s_waitcnt lgkmcnt(4)
v_exp_f32 v145, v65
v_mfma_f32_16x16x32_bf16 v[32:35], a[136:139], v[168:171], v[32:35]
s_add_u32 s41, s41, 8192
v_add_f32 v156, v156, v148
v_add_f32 v157, v157, v150
v_mfma_f32_16x16x32_bf16 v[32:35], a[140:143], v[172:175], v[32:35]
s_waitcnt lgkmcnt(2)
v_exp_f32 v146, v66
v_mfma_f32_16x16x32_bf16 a[0:3], a[144:147], v[96:99], a[0:3]
v_exp_f32 v147, v67
v_mfma_f32_16x16x32_bf16 a[4:7], a[144:147], v[100:103], a[4:7]
ds_read_b64_tr_b16 a[152:153], v20 offset:16384
ds_read_b64_tr_b16 a[154:155], v20 offset:20480
v_mfma_f32_16x16x32_bf16 a[8:11], a[144:147], v[104:107], a[8:11]
buffer_store_dwordx4 v[26:29], v3, s[8:11], s70 offen sc1
v_mfma_f32_16x16x32_bf16 a[12:15], a[144:147], v[108:111], a[12:15]
buffer_load_dword v31, v30, s[24:27], s65 offen
v_mfma_f32_16x16x32_bf16 v[36:39], a[128:131], v[176:179], v[132:135]
v_cvt_pk_bf16_f32 v112, v144, v145
v_cvt_pk_bf16_f32 v113, v146, v147
v_mfma_f32_16x16x32_bf16 v[36:39], a[132:135], v[180:183], v[36:39]
v_exp_f32 v144, v80
v_mfma_f32_16x16x32_bf16 v[36:39], a[136:139], v[184:187], v[36:39]
v_exp_f32 v145, v81
v_mfma_f32_16x16x32_bf16 v[36:39], a[140:143], v[188:191], v[36:39]
s_waitcnt lgkmcnt(2)
v_exp_f32 v146, v82
v_mfma_f32_16x16x32_bf16 a[16:19], a[148:151], v[96:99], a[16:19]
s_add_u32 m0, s39, 8192
v_exp_f32 v147, v83
v_mfma_f32_16x16x32_bf16 a[20:23], a[148:151], v[100:103], a[20:23]
ds_read_b64_tr_b16 a[156:157], v21 offset:16384
ds_read_b64_tr_b16 a[158:159], v21 offset:20480
v_mfma_f32_16x16x32_bf16 a[24:27], a[148:151], v[104:107], a[24:27]
buffer_load_dwordx4 v10, s[16:19], s40 offen nt lds
v_mfma_f32_16x16x32_bf16 a[28:31], a[148:151], v[108:111], a[28:31]
v_cvt_pk_bf16_f32 v114, v144, v145
v_cvt_pk_bf16_f32 v115, v146, v147
v_mfma_f32_16x16x32_bf16 v[40:43], a[128:131], v[192:195], v[136:139]
v_exp_f32 v144, v68
v_mfma_f32_16x16x32_bf16 v[40:43], a[132:135], v[196:199], v[40:43]
ds_read_b64_tr_b16 a[144:145], v22 offset:16384
ds_read_b64_tr_b16 a[146:147], v22 offset:20480
v_mfma_f32_16x16x32_bf16 v[40:43], a[136:139], v[200:203], v[40:43]
v_exp_f32 v145, v69
v_mfma_f32_16x16x32_bf16 v[40:43], a[140:143], v[204:207], v[40:43]
v_exp_f32 v146, v70
v_mfma_f32_16x16x32_bf16 v[148:151], v[4:7], v[112:115], 0
v_exp_f32 v147, v71
v_mfma_f32_16x16x32_bf16 v[44:47], a[128:131], v[208:211], v[140:143]
ds_read_b128 a[128:131], v14 offset:36864
v_mfma_f32_16x16x32_bf16 v[44:47], a[132:135], v[212:215], v[44:47]
ds_read_b128 a[132:135], v15 offset:36864
v_add_f32 v158, v158, v152
v_mfma_f32_16x16x32_bf16 v[44:47], a[136:139], v[216:219], v[44:47]
ds_read_b128 a[136:139], v16 offset:36864
v_cvt_pk_bf16_f32 v116, v144, v145
v_mfma_f32_16x16x32_bf16 v[44:47], a[140:143], v[220:223], v[44:47]
s_waitcnt lgkmcnt(7)
ds_read_b128 a[140:143], v17 offset:36864
v_cvt_pk_bf16_f32 v117, v146, v147
v_mfma_f32_16x16x32_bf16 a[32:35], a[152:155], v[96:99], a[32:35]
v_exp_f32 v144, v84
v_mfma_f32_16x16x32_bf16 a[36:39], a[152:155], v[100:103], a[36:39]
v_exp_f32 v145, v85
v_mfma_f32_16x16x32_bf16 a[40:43], a[152:155], v[104:107], a[40:43]
v_exp_f32 v146, v86
v_mfma_f32_16x16x32_bf16 a[44:47], a[152:155], v[108:111], a[44:47]
s_waitcnt lgkmcnt(6)
v_exp_f32 v147, v87
v_mfma_f32_16x16x32_bf16 a[48:51], a[156:159], v[96:99], a[48:51]
v_cvt_pk_bf16_f32 v118, v144, v145
v_cvt_pk_bf16_f32 v119, v146, v147
v_mfma_f32_16x16x32_bf16 a[52:55], a[156:159], v[100:103], a[52:55]
ds_read_b64_tr_b16 a[148:149], v23 offset:16384
ds_read_b64_tr_b16 a[150:151], v23 offset:20480
v_mfma_f32_16x16x32_bf16 a[56:59], a[156:159], v[104:107], a[56:59]
buffer_load_dwordx4 v11, s[16:19], s40 offen offset:1024 nt lds
v_mfma_f32_16x16x32_bf16 a[60:63], a[156:159], v[108:111], a[60:63]
s_waitcnt lgkmcnt(2)
v_exp_f32 v144, v72
v_mfma_f32_16x16x32_bf16 v[48:51], a[128:131], v[160:163], v[128:131]
s_add_u32 s40, s40, 8192
v_exp_f32 v145, v73
v_mfma_f32_16x16x32_bf16 v[48:51], a[132:135], v[164:167], v[48:51]
s_mov_b32 s70, s69
v_exp_f32 v146, v74
v_mfma_f32_16x16x32_bf16 v[48:51], a[136:139], v[168:171], v[48:51]
s_add_u32 s68, s68, 128
v_exp_f32 v147, v75
v_mfma_f32_16x16x32_bf16 v[48:51], a[140:143], v[172:175], v[48:51]
s_add_u32 s69, s69, 4096
v_add_f32 v159, v159, v2
v_cvt_pk_bf16_f32 v120, v144, v145
v_mfma_f32_16x16x32_bf16 v[150:153], v[4:7], v[116:119], 0
v_exp_f32 v144, v88
v_mfma_f32_16x16x32_bf16 a[64:67], a[144:147], v[96:99], a[64:67]
s_cmp_eq_u32 s42, 4
v_exp_f32 v145, v89
v_mfma_f32_16x16x32_bf16 a[68:71], a[144:147], v[100:103], a[68:71]
s_cselect_b32 s68, s71, s68
ds_read_b64_tr_b16 a[152:153], v24 offset:16384
ds_read_b64_tr_b16 a[154:155], v24 offset:20480
v_mfma_f32_16x16x32_bf16 a[72:75], a[144:147], v[104:107], a[72:75]
s_cselect_b32 s69, s72, s69
v_cvt_pk_bf16_f32 v121, v146, v147
v_cvt_pk_bf16_f32 v122, v144, v145
v_mfma_f32_16x16x32_bf16 a[76:79], a[144:147], v[108:111], a[76:79]
v_exp_f32 v146, v90
v_mfma_f32_16x16x32_bf16 v[52:55], a[128:131], v[176:179], v[132:135]
v_exp_f32 v147, v91
v_mfma_f32_16x16x32_bf16 v[52:55], a[132:135], v[180:183], v[52:55]
v_exp_f32 v144, v76
v_mfma_f32_16x16x32_bf16 v[52:55], a[136:139], v[184:187], v[52:55]
v_exp_f32 v145, v77
v_mfma_f32_16x16x32_bf16 v[52:55], a[140:143], v[188:191], v[52:55]
s_waitcnt lgkmcnt(2)
v_cvt_pk_bf16_f32 v123, v146, v147
v_add_f32 v2, v144, v145
v_mfma_f32_16x16x32_bf16 a[80:83], a[148:151], v[96:99], a[80:83]
s_add_u32 m0, s39, 122880
v_exp_f32 v146, v78
v_mfma_f32_16x16x32_bf16 a[84:87], a[148:151], v[100:103], a[84:87]
ds_read_b64_tr_b16 a[156:157], v25 offset:16384
ds_read_b64_tr_b16 a[158:159], v25 offset:20480
v_mfma_f32_16x16x32_bf16 a[88:91], a[148:151], v[104:107], a[88:91]
buffer_load_dwordx4 v12, s[20:23], s41 offen nt lds
v_mfma_f32_16x16x32_bf16 a[92:95], a[148:151], v[108:111], a[92:95]
v_exp_f32 v147, v79
v_mfma_f32_16x16x32_bf16 v[152:155], v[4:7], v[120:123], 0
v_cvt_pk_bf16_f32 v124, v144, v145
v_add_f32 v2, v2, v146
v_mfma_f32_16x16x32_bf16 v[56:59], a[128:131], v[192:195], v[136:139]
v_exp_f32 v144, v92
v_mfma_f32_16x16x32_bf16 v[56:59], a[132:135], v[196:199], v[56:59]
v_exp_f32 v145, v93
v_mfma_f32_16x16x32_bf16 v[56:59], a[136:139], v[200:203], v[56:59]
v_add_f32 v2, v2, v147
v_cvt_pk_bf16_f32 v125, v146, v147
v_mfma_f32_16x16x32_bf16 v[56:59], a[140:143], v[204:207], v[56:59]
v_exp_f32 v146, v94
v_mfma_f32_16x16x32_bf16 v[60:63], a[128:131], v[208:211], v[140:143]
s_waitcnt vmcnt(15)
s_barrier
ds_read_b128 a[128:131], v14 offset:40960
v_mfma_f32_16x16x32_bf16 v[60:63], a[132:135], v[212:215], v[60:63]
ds_read_b128 a[132:135], v15 offset:40960
v_add_f32 v2, v2, v144
v_mfma_f32_16x16x32_bf16 v[60:63], a[136:139], v[216:219], v[60:63]
ds_read_b128 a[136:139], v16 offset:40960
v_max3_f32 v149, v148, v150, v152
v_mfma_f32_16x16x32_bf16 v[60:63], a[140:143], v[220:223], v[60:63]
s_waitcnt lgkmcnt(5)
ds_read_b128 a[140:143], v17 offset:40960
v_add_f32 v2, v2, v145
v_mfma_f32_16x16x32_bf16 a[96:99], a[152:155], v[96:99], a[96:99]
v_exp_f32 v147, v95
v_mfma_f32_16x16x32_bf16 a[100:103], a[152:155], v[100:103], a[100:103]
ds_read_b64_tr_b16 a[144:145], v18 offset:24576
ds_read_b64_tr_b16 a[146:147], v18 offset:28672
v_mfma_f32_16x16x32_bf16 a[104:107], a[152:155], v[104:107], a[104:107]
v_cvt_pk_bf16_f32 v126, v144, v145
v_add_f32 v2, v2, v146
v_mfma_f32_16x16x32_bf16 a[108:111], a[152:155], v[108:111], a[108:111]
s_waitcnt lgkmcnt(6)
v_add_f32 v2, v2, v147
v_max_f32_e64 v149, v149, v2
v_mfma_f32_16x16x32_bf16 a[112:115], a[156:159], v[96:99], a[112:115]
v_cmp_lt_f32 vcc, s50, v149
v_cvt_pk_bf16_f32 v127, v146, v147
v_mfma_f32_16x16x32_bf16 a[116:119], a[156:159], v[100:103], a[116:119]
buffer_load_dwordx4 v13, s[20:23], s41 offen offset:1024 nt lds
v_mfma_f32_16x16x32_bf16 a[120:123], a[156:159], v[104:107], a[120:123]
s_waitcnt lgkmcnt(5)
ds_read_b64_tr_b16 a[148:149], v19 offset:24576
v_mfma_f32_16x16x32_bf16 a[124:127], a[156:159], v[108:111], a[124:127]
s_cbranch_vccnz K1_slow3
K1_back3:
ds_read_b64_tr_b16 a[150:151], v19 offset:28672
v_mfma_f32_16x16x32_bf16 v[64:67], a[128:131], v[160:163], v[128:131]
s_waitcnt lgkmcnt(6)
v_exp_f32 v144, v32
v_mfma_f32_16x16x32_bf16 v[64:67], a[132:135], v[164:167], v[64:67]
s_waitcnt lgkmcnt(4)
v_exp_f32 v145, v33
v_mfma_f32_16x16x32_bf16 v[64:67], a[136:139], v[168:171], v[64:67]
s_add_u32 s41, s41, 8192
v_add_f32 v156, v156, v148
v_add_f32 v157, v157, v150
v_mfma_f32_16x16x32_bf16 v[64:67], a[140:143], v[172:175], v[64:67]
s_waitcnt lgkmcnt(2)
v_exp_f32 v146, v34
v_mfma_f32_16x16x32_bf16 a[0:3], a[144:147], v[112:115], a[0:3]
v_exp_f32 v147, v35
v_mfma_f32_16x16x32_bf16 a[4:7], a[144:147], v[116:119], a[4:7]
ds_read_b64_tr_b16 a[152:153], v20 offset:24576
ds_read_b64_tr_b16 a[154:155], v20 offset:28672
v_mfma_f32_16x16x32_bf16 a[8:11], a[144:147], v[120:123], a[8:11]
v_cvt_pk_bf16_f32 v96, v144, v145
v_cvt_pk_bf16_f32 v97, v146, v147
v_mfma_f32_16x16x32_bf16 a[12:15], a[144:147], v[124:127], a[12:15]
v_exp_f32 v144, v48
v_mfma_f32_16x16x32_bf16 v[68:71], a[128:131], v[176:179], v[132:135]
v_exp_f32 v145, v49
v_mfma_f32_16x16x32_bf16 v[68:71], a[132:135], v[180:183], v[68:71]
v_exp_f32 v146, v50
v_mfma_f32_16x16x32_bf16 v[68:71], a[136:139], v[184:187], v[68:71]
v_exp_f32 v147, v51
v_mfma_f32_16x16x32_bf16 v[68:71], a[140:143], v[188:191], v[68:71]
s_waitcnt lgkmcnt(2)
v_cvt_pk_bf16_f32 v98, v144, v145
v_cvt_pk_bf16_f32 v99, v146, v147
v_mfma_f32_16x16x32_bf16 a[16:19], a[148:151], v[112:115], a[16:19]
s_add_u32 m0, s39, 16384
v_exp_f32 v144, v36
v_mfma_f32_16x16x32_bf16 a[20:23], a[148:151], v[116:119], a[20:23]
ds_read_b64_tr_b16 a[156:157], v21 offset:24576
ds_read_b64_tr_b16 a[158:159], v21 offset:28672
v_mfma_f32_16x16x32_bf16 a[24:27], a[148:151], v[120:123], a[24:27]
buffer_load_dwordx4 v10, s[16:19], s40 offen nt lds
v_mfma_f32_16x16x32_bf16 a[28:31], a[148:151], v[124:127], a[28:31]
v_exp_f32 v145, v37
v_mfma_f32_16x16x32_bf16 v[72:75], a[128:131], v[192:195], v[136:139]
v_exp_f32 v146, v38
v_mfma_f32_16x16x32_bf16 v[72:75], a[132:135], v[196:199], v[72:75]
ds_read_b64_tr_b16 a[144:145], v22 offset:24576
ds_read_b64_tr_b16 a[146:147], v22 offset:28672
v_mfma_f32_16x16x32_bf16 v[72:75], a[136:139], v[200:203], v[72:75]
v_exp_f32 v147, v39
v_mfma_f32_16x16x32_bf16 v[72:75], a[140:143], v[204:207], v[72:75]
v_add_f32 v158, v158, v152
v_cvt_pk_bf16_f32 v100, v144, v145
v_mfma_f32_16x16x32_bf16 v[148:151], v[4:7], v[96:99], 0
v_exp_f32 v144, v52
v_mfma_f32_16x16x32_bf16 v[76:79], a[128:131], v[208:211], v[140:143]
ds_read_b128 a[128:131], v14 offset:45056
v_mfma_f32_16x16x32_bf16 v[76:79], a[132:135], v[212:215], v[76:79]
ds_read_b128 a[132:135], v15 offset:45056
v_mfma_f32_16x16x32_bf16 v[76:79], a[136:139], v[216:219], v[76:79]
ds_read_b128 a[136:139], v16 offset:45056
v_mfma_f32_16x16x32_bf16 v[76:79], a[140:143], v[220:223], v[76:79]
s_waitcnt lgkmcnt(7)
ds_read_b128 a[140:143], v17 offset:45056
v_cvt_pk_bf16_f32 v101, v146, v147
v_mfma_f32_16x16x32_bf16 a[32:35], a[152:155], v[112:115], a[32:35]
v_exp_f32 v145, v53
v_mfma_f32_16x16x32_bf16 a[36:39], a[152:155], v[116:119], a[36:39]
v_exp_f32 v146, v54
v_mfma_f32_16x16x32_bf16 a[40:43], a[152:155], v[120:123], a[40:43]
v_exp_f32 v147, v55
v_mfma_f32_16x16x32_bf16 a[44:47], a[152:155], v[124:127], a[44:47]
s_waitcnt lgkmcnt(6)
v_cvt_pk_bf16_f32 v102, v144, v145
v_cvt_pk_bf16_f32 v103, v146, v147
v_mfma_f32_16x16x32_bf16 a[48:51], a[156:159], v[112:115], a[48:51]
v_exp_f32 v144, v40
v_mfma_f32_16x16x32_bf16 a[52:55], a[156:159], v[116:119], a[52:55]
ds_read_b64_tr_b16 a[148:149], v23 offset:24576
ds_read_b64_tr_b16 a[150:151], v23 offset:28672
v_mfma_f32_16x16x32_bf16 a[56:59], a[156:159], v[120:123], a[56:59]
buffer_load_dwordx4 v11, s[16:19], s40 offen offset:1024 nt lds
v_mfma_f32_16x16x32_bf16 a[60:63], a[156:159], v[124:127], a[60:63]
s_waitcnt lgkmcnt(4)
v_exp_f32 v145, v41
v_mfma_f32_16x16x32_bf16 v[80:83], a[128:131], v[160:163], v[128:131]
s_add_u32 s40, s40, 8192
v_exp_f32 v146, v42
v_mfma_f32_16x16x32_bf16 v[80:83], a[132:135], v[164:167], v[80:83]
s_waitcnt lgkmcnt(3)
v_exp_f32 v147, v43
v_mfma_f32_16x16x32_bf16 v[80:83], a[136:139], v[168:171], v[80:83]
s_waitcnt lgkmcnt(2)
v_add_f32 v159, v159, v2
v_cvt_pk_bf16_f32 v104, v144, v145
v_mfma_f32_16x16x32_bf16 v[80:83], a[140:143], v[172:175], v[80:83]
v_exp_f32 v144, v56
v_mfma_f32_16x16x32_bf16 v[150:153], v[4:7], v[100:103], 0
v_exp_f32 v145, v57
v_mfma_f32_16x16x32_bf16 a[64:67], a[144:147], v[112:115], a[64:67]
v_cvt_pk_bf16_f32 v105, v146, v147
v_cvt_pk_bf16_f32 v106, v144, v145
v_mfma_f32_16x16x32_bf16 a[68:71], a[144:147], v[116:119], a[68:71]
ds_read_b64_tr_b16 a[152:153], v24 offset:24576
ds_read_b64_tr_b16 a[154:155], v24 offset:28672
v_mfma_f32_16x16x32_bf16 a[72:75], a[144:147], v[120:123], a[72:75]
v_exp_f32 v146, v58
v_mfma_f32_16x16x32_bf16 a[76:79], a[144:147], v[124:127], a[76:79]
v_exp_f32 v147, v59
v_mfma_f32_16x16x32_bf16 v[84:87], a[128:131], v[176:179], v[132:135]
v_exp_f32 v144, v44
v_mfma_f32_16x16x32_bf16 v[84:87], a[132:135], v[180:183], v[84:87]
v_exp_f32 v145, v45
v_mfma_f32_16x16x32_bf16 v[84:87], a[136:139], v[184:187], v[84:87]
v_cvt_pk_bf16_f32 v107, v146, v147
v_add_f32 v2, v144, v145
v_mfma_f32_16x16x32_bf16 v[84:87], a[140:143], v[188:191], v[84:87]
s_waitcnt lgkmcnt(2)
v_exp_f32 v146, v46
v_mfma_f32_16x16x32_bf16 a[80:83], a[148:151], v[112:115], a[80:83]
s_add_u32 m0, s39, 65536
v_exp_f32 v147, v47
v_mfma_f32_16x16x32_bf16 a[84:87], a[148:151], v[116:119], a[84:87]
ds_read_b64_tr_b16 a[156:157], v25 offset:24576
ds_read_b64_tr_b16 a[158:159], v25 offset:28672
v_mfma_f32_16x16x32_bf16 a[88:91], a[148:151], v[120:123], a[88:91]
buffer_load_dwordx4 v12, s[20:23], s41 offen nt lds
v_mfma_f32_16x16x32_bf16 a[92:95], a[148:151], v[124:127], a[92:95]
v_cvt_pk_bf16_f32 v108, v144, v145
v_add_f32 v2, v2, v146
v_mfma_f32_16x16x32_bf16 v[152:155], v[4:7], v[104:107], 0
v_exp_f32 v144, v60
v_mfma_f32_16x16x32_bf16 v[88:91], a[128:131], v[192:195], v[136:139]
v_exp_f32 v145, v61
v_mfma_f32_16x16x32_bf16 v[88:91], a[132:135], v[196:199], v[88:91]
v_add_f32 v2, v2, v147
v_cvt_pk_bf16_f32 v109, v146, v147
v_mfma_f32_16x16x32_bf16 v[88:91], a[136:139], v[200:203], v[88:91]
v_exp_f32 v146, v62
v_mfma_f32_16x16x32_bf16 v[88:91], a[140:143], v[204:207], v[88:91]
v_exp_f32 v147, v63
v_mfma_f32_16x16x32_bf16 v[92:95], a[128:131], v[208:211], v[140:143]
ds_read_b128 a[128:131], v14 offset:49152
v_mfma_f32_16x16x32_bf16 v[92:95], a[132:135], v[212:215], v[92:95]
ds_read_b128 a[132:135], v15 offset:49152
v_mfma_f32_16x16x32_bf16 v[92:95], a[136:139], v[216:219], v[92:95]
ds_read_b128 a[136:139], v16 offset:49152
v_mfma_f32_16x16x32_bf16 v[92:95], a[140:143], v[220:223], v[92:95]
s_waitcnt lgkmcnt(5)
ds_read_b128 a[140:143], v17 offset:49152
v_add_f32_e64 v2, v2, v144
v_mfma_f32_16x16x32_bf16 a[96:99], a[152:155], v[112:115], a[96:99]
v_max3_f32 v149, v148, v150, v152
v_add_f32_e64 v2, v2, v145
v_mfma_f32_16x16x32_bf16 a[100:103], a[152:155], v[116:119], a[100:103]
ds_read_b64_tr_b16 a[144:145], v18 offset:32768
ds_read_b64_tr_b16 a[146:147], v18 offset:36864
v_mfma_f32_16x16x32_bf16 a[104:107], a[152:155], v[120:123], a[104:107]
v_cvt_pk_bf16_f32 v110, v144, v145
v_add_f32_e64 v2, v2, v146
v_mfma_f32_16x16x32_bf16 a[108:111], a[152:155], v[124:127], a[108:111]
s_waitcnt lgkmcnt(6)
v_add_f32_e64 v2, v2, v147
v_max_f32_e64 v149, v149, v2
v_mfma_f32_16x16x32_bf16 a[112:115], a[156:159], v[112:115], a[112:115]
v_cmp_lt_f32 vcc, s50, v149
v_cvt_pk_bf16_f32 v111, v146, v147
v_mfma_f32_16x16x32_bf16 a[116:119], a[156:159], v[116:119], a[116:119]
buffer_load_dwordx4 v13, s[20:23], s41 offen offset:1024 nt lds
v_mfma_f32_16x16x32_bf16 a[120:123], a[156:159], v[120:123], a[120:123]
s_waitcnt lgkmcnt(5)
ds_read_b64_tr_b16 a[148:149], v19 offset:32768
v_mfma_f32_16x16x32_bf16 a[124:127], a[156:159], v[124:127], a[124:127]
s_cbranch_vccnz K1_slow4
K1_back4:
ds_read_b64_tr_b16 a[150:151], v19 offset:36864
v_mfma_f32_16x16x32_bf16 v[32:35], a[128:131], v[160:163], v[128:131]
s_waitcnt lgkmcnt(6)
v_exp_f32 v144, v64
v_mfma_f32_16x16x32_bf16 v[32:35], a[132:135], v[164:167], v[32:35]
s_waitcnt lgkmcnt(4)
v_exp_f32 v145, v65
v_mfma_f32_16x16x32_bf16 v[32:35], a[136:139], v[168:171], v[32:35]
s_add_u32 s41, s41, 8192
v_add_f32 v156, v156, v148
v_add_f32 v157, v157, v150
v_mfma_f32_16x16x32_bf16 v[32:35], a[140:143], v[172:175], v[32:35]
s_waitcnt lgkmcnt(2)
v_exp_f32 v146, v66
v_mfma_f32_16x16x32_bf16 a[0:3], a[144:147], v[96:99], a[0:3]
s_add_u32 m0, s52, 135168
v_exp_f32 v147, v67
v_mfma_f32_16x16x32_bf16 a[4:7], a[144:147], v[100:103], a[4:7]
ds_read_b64_tr_b16 a[152:153], v20 offset:32768
ds_read_b64_tr_b16 a[154:155], v20 offset:36864
v_mfma_f32_16x16x32_bf16 a[8:11], a[144:147], v[104:107], a[8:11]
buffer_load_dwordx4 v9, s[12:15], s68 offen nt lds
v_mfma_f32_16x16x32_bf16 a[12:15], a[144:147], v[108:111], a[12:15]
global_load_dword v31, v0, s[78:79]
v_mfma_f32_16x16x32_bf16 v[36:39], a[128:131], v[176:179], v[132:135]
v_cvt_pk_bf16_f32 v112, v144, v145
v_cvt_pk_bf16_f32 v113, v146, v147
v_mfma_f32_16x16x32_bf16 v[36:39], a[132:135], v[180:183], v[36:39]
v_exp_f32 v144, v80
v_mfma_f32_16x16x32_bf16 v[36:39], a[136:139], v[184:187], v[36:39]
v_exp_f32 v145, v81
v_mfma_f32_16x16x32_bf16 v[36:39], a[140:143], v[188:191], v[36:39]
s_waitcnt lgkmcnt(2)
v_exp_f32 v146, v82
v_mfma_f32_16x16x32_bf16 a[16:19], a[148:151], v[96:99], a[16:19]
s_add_u32 m0, s39, 24576
v_exp_f32 v147, v83
v_mfma_f32_16x16x32_bf16 a[20:23], a[148:151], v[100:103], a[20:23]
ds_read_b64_tr_b16 a[156:157], v21 offset:32768
ds_read_b64_tr_b16 a[158:159], v21 offset:36864
v_mfma_f32_16x16x32_bf16 a[24:27], a[148:151], v[104:107], a[24:27]
buffer_load_dwordx4 v10, s[16:19], s40 offen nt lds
v_mfma_f32_16x16x32_bf16 a[28:31], a[148:151], v[108:111], a[28:31]
v_cvt_pk_bf16_f32 v114, v144, v145
v_cvt_pk_bf16_f32 v115, v146, v147
v_mfma_f32_16x16x32_bf16 v[40:43], a[128:131], v[192:195], v[136:139]
v_exp_f32 v144, v68
v_mfma_f32_16x16x32_bf16 v[40:43], a[132:135], v[196:199], v[40:43]
ds_read_b64_tr_b16 a[144:145], v22 offset:32768
ds_read_b64_tr_b16 a[146:147], v22 offset:36864
v_mfma_f32_16x16x32_bf16 v[40:43], a[136:139], v[200:203], v[40:43]
v_exp_f32 v145, v69
v_mfma_f32_16x16x32_bf16 v[40:43], a[140:143], v[204:207], v[40:43]
v_exp_f32 v146, v70
v_mfma_f32_16x16x32_bf16 v[148:151], v[4:7], v[112:115], 0
v_exp_f32 v147, v71
v_mfma_f32_16x16x32_bf16 v[44:47], a[128:131], v[208:211], v[140:143]
ds_read_b128 a[128:131], v14 offset:53248
v_mfma_f32_16x16x32_bf16 v[44:47], a[132:135], v[212:215], v[44:47]
ds_read_b128 a[132:135], v15 offset:53248
v_add_f32 v158, v158, v152
v_mfma_f32_16x16x32_bf16 v[44:47], a[136:139], v[216:219], v[44:47]
ds_read_b128 a[136:139], v16 offset:53248
v_cvt_pk_bf16_f32 v116, v144, v145
v_mfma_f32_16x16x32_bf16 v[44:47], a[140:143], v[220:223], v[44:47]
s_waitcnt lgkmcnt(7)
ds_read_b128 a[140:143], v17 offset:53248
v_cvt_pk_bf16_f32 v117, v146, v147
v_mfma_f32_16x16x32_bf16 a[32:35], a[152:155], v[96:99], a[32:35]
v_exp_f32 v144, v84
v_mfma_f32_16x16x32_bf16 a[36:39], a[152:155], v[100:103], a[36:39]
v_exp_f32 v145, v85
v_mfma_f32_16x16x32_bf16 a[40:43], a[152:155], v[104:107], a[40:43]
v_exp_f32 v146, v86
v_mfma_f32_16x16x32_bf16 a[44:47], a[152:155], v[108:111], a[44:47]
s_waitcnt lgkmcnt(6)
v_exp_f32 v147, v87
v_mfma_f32_16x16x32_bf16 a[48:51], a[156:159], v[96:99], a[48:51]
v_cvt_pk_bf16_f32 v118, v144, v145
v_cvt_pk_bf16_f32 v119, v146, v147
v_mfma_f32_16x16x32_bf16 a[52:55], a[156:159], v[100:103], a[52:55]
ds_read_b64_tr_b16 a[148:149], v23 offset:32768
ds_read_b64_tr_b16 a[150:151], v23 offset:36864
v_mfma_f32_16x16x32_bf16 a[56:59], a[156:159], v[104:107], a[56:59]
buffer_load_dwordx4 v11, s[16:19], s40 offen offset:1024 nt lds
v_mfma_f32_16x16x32_bf16 a[60:63], a[156:159], v[108:111], a[60:63]
s_waitcnt lgkmcnt(4)
v_exp_f32 v144, v72
v_mfma_f32_16x16x32_bf16 v[48:51], a[128:131], v[160:163], v[128:131]
s_add_u32 s40, s40, 8192
v_exp_f32 v145, v73
v_mfma_f32_16x16x32_bf16 v[48:51], a[132:135], v[164:167], v[48:51]
s_waitcnt lgkmcnt(3)
v_exp_f32 v146, v74
v_mfma_f32_16x16x32_bf16 v[48:51], a[136:139], v[168:171], v[48:51]
s_waitcnt lgkmcnt(2)
v_exp_f32 v147, v75
v_mfma_f32_16x16x32_bf16 v[48:51], a[140:143], v[172:175], v[48:51]
v_add_f32 v159, v159, v2
v_cvt_pk_bf16_f32 v120, v144, v145
v_mfma_f32_16x16x32_bf16 v[150:153], v[4:7], v[116:119], 0
v_exp_f32 v144, v88
v_mfma_f32_16x16x32_bf16 a[64:67], a[144:147], v[96:99], a[64:67]
v_exp_f32 v145, v89
v_mfma_f32_16x16x32_bf16 a[68:71], a[144:147], v[100:103], a[68:71]
ds_read_b64_tr_b16 a[152:153], v24 offset:32768
ds_read_b64_tr_b16 a[154:155], v24 offset:36864
v_mfma_f32_16x16x32_bf16 a[72:75], a[144:147], v[104:107], a[72:75]
v_cvt_pk_bf16_f32 v121, v146, v147
v_cvt_pk_bf16_f32 v122, v144, v145
v_mfma_f32_16x16x32_bf16 a[76:79], a[144:147], v[108:111], a[76:79]
v_exp_f32 v146, v90
v_mfma_f32_16x16x32_bf16 v[52:55], a[128:131], v[176:179], v[132:135]
v_exp_f32 v147, v91
v_mfma_f32_16x16x32_bf16 v[52:55], a[132:135], v[180:183], v[52:55]
v_exp_f32 v144, v76
v_mfma_f32_16x16x32_bf16 v[52:55], a[136:139], v[184:187], v[52:55]
v_exp_f32 v145, v77
v_mfma_f32_16x16x32_bf16 v[52:55], a[140:143], v[188:191], v[52:55]
s_waitcnt lgkmcnt(2)
v_cvt_pk_bf16_f32 v123, v146, v147
v_add_f32 v2, v144, v145
v_mfma_f32_16x16x32_bf16 a[80:83], a[148:151], v[96:99], a[80:83]
s_add_u32 m0, s39, 73728
v_exp_f32 v146, v78
v_mfma_f32_16x16x32_bf16 a[84:87], a[148:151], v[100:103], a[84:87]
ds_read_b64_tr_b16 a[156:157], v25 offset:32768
ds_read_b64_tr_b16 a[158:159], v25 offset:36864
v_mfma_f32_16x16x32_bf16 a[88:91], a[148:151], v[104:107], a[88:91]
buffer_load_dwordx4 v12, s[20:23], s41 offen nt lds
v_mfma_f32_16x16x32_bf16 a[92:95], a[148:151], v[108:111], a[92:95]
v_exp_f32 v147, v79
v_mfma_f32_16x16x32_bf16 v[152:155], v[4:7], v[120:123], 0
v_cvt_pk_bf16_f32 v124, v144, v145
v_add_f32 v2, v2, v146
v_mfma_f32_16x16x32_bf16 v[56:59], a[128:131], v[192:195], v[136:139]
v_exp_f32 v144, v92
v_mfma_f32_16x16x32_bf16 v[56:59], a[132:135], v[196:199], v[56:59]
v_exp_f32 v145, v93
v_mfma_f32_16x16x32_bf16 v[56:59], a[136:139], v[200:203], v[56:59]
v_add_f32 v2, v2, v147
v_cvt_pk_bf16_f32 v125, v146, v147
v_mfma_f32_16x16x32_bf16 v[56:59], a[140:143], v[204:207], v[56:59]
v_exp_f32 v146, v94
v_mfma_f32_16x16x32_bf16 v[60:63], a[128:131], v[208:211], v[140:143]
s_waitcnt vmcnt(15)
s_barrier
ds_read_b128 a[128:131], v14 offset:57344
v_mfma_f32_16x16x32_bf16 v[60:63], a[132:135], v[212:215], v[60:63]
ds_read_b128 a[132:135], v15 offset:57344
v_add_f32 v2, v2, v144
v_mfma_f32_16x16x32_bf16 v[60:63], a[136:139], v[216:219], v[60:63]
ds_read_b128 a[136:139], v16 offset:57344
v_max3_f32 v149, v148, v150, v152
v_mfma_f32_16x16x32_bf16 v[60:63], a[140:143], v[220:223], v[60:63]
s_waitcnt lgkmcnt(5)
ds_read_b128 a[140:143], v17 offset:57344
v_add_f32_e64 v2, v2, v145
v_mfma_f32_16x16x32_bf16 a[96:99], a[152:155], v[96:99], a[96:99]
v_exp_f32_e64 v147, v95
v_mfma_f32_16x16x32_bf16 a[100:103], a[152:155], v[100:103], a[100:103]
ds_read_b64_tr_b16 a[144:145], v18 offset:40960
ds_read_b64_tr_b16 a[146:147], v18 offset:45056
v_mfma_f32_16x16x32_bf16 a[104:107], a[152:155], v[104:107], a[104:107]
v_cvt_pk_bf16_f32 v126, v144, v145
v_add_f32_e64 v2, v2, v146
v_mfma_f32_16x16x32_bf16 a[108:111], a[152:155], v[108:111], a[108:111]
s_waitcnt lgkmcnt(6)
v_add_f32_e64 v2, v2, v147
v_max_f32_e64 v149, v149, v2
v_mfma_f32_16x16x32_bf16 a[112:115], a[156:159], v[96:99], a[112:115]
v_cmp_lt_f32 vcc, s50, v149
v_cvt_pk_bf16_f32 v127, v146, v147
v_mfma_f32_16x16x32_bf16 a[116:119], a[156:159], v[100:103], a[116:119]
buffer_load_dwordx4 v13, s[20:23], s41 offen offset:1024 nt lds
v_mfma_f32_16x16x32_bf16 a[120:123], a[156:159], v[104:107], a[120:123]
s_waitcnt lgkmcnt(5)
ds_read_b64_tr_b16 a[148:149], v19 offset:40960
v_mfma_f32_16x16x32_bf16 a[124:127], a[156:159], v[108:111], a[124:127]
s_cbranch_vccnz K1_slow5
K1_back5:
ds_read_b64_tr_b16 a[150:151], v19 offset:45056
v_mfma_f32_16x16x32_bf16 v[64:67], a[128:131], v[160:163], v[128:131]
s_waitcnt lgkmcnt(6)
v_exp_f32 v144, v32
v_mfma_f32_16x16x32_bf16 v[64:67], a[132:135], v[164:167], v[64:67]
s_waitcnt lgkmcnt(4)
v_exp_f32 v145, v33
v_mfma_f32_16x16x32_bf16 v[64:67], a[136:139], v[168:171], v[64:67]
s_add_u32 s41, s41, 8192
v_add_f32 v156, v156, v148
v_add_f32 v157, v157, v150
v_mfma_f32_16x16x32_bf16 v[64:67], a[140:143], v[172:175], v[64:67]
s_waitcnt lgkmcnt(2)
v_exp_f32 v146, v34
v_mfma_f32_16x16x32_bf16 a[0:3], a[144:147], v[112:115], a[0:3]
v_exp_f32 v147, v35
v_mfma_f32_16x16x32_bf16 a[4:7], a[144:147], v[116:119], a[4:7]
ds_read_b64_tr_b16 a[152:153], v20 offset:40960
ds_read_b64_tr_b16 a[154:155], v20 offset:45056
v_mfma_f32_16x16x32_bf16 a[8:11], a[144:147], v[120:123], a[8:11]
v_cvt_pk_bf16_f32 v96, v144, v145
v_cvt_pk_bf16_f32 v97, v146, v147
v_mfma_f32_16x16x32_bf16 a[12:15], a[144:147], v[124:127], a[12:15]
v_exp_f32 v144, v48
v_mfma_f32_16x16x32_bf16 v[68:71], a[128:131], v[176:179], v[132:135]
v_exp_f32 v145, v49
v_mfma_f32_16x16x32_bf16 v[68:71], a[132:135], v[180:183], v[68:71]
v_exp_f32 v146, v50
v_mfma_f32_16x16x32_bf16 v[68:71], a[136:139], v[184:187], v[68:71]
v_exp_f32 v147, v51
v_mfma_f32_16x16x32_bf16 v[68:71], a[140:143], v[188:191], v[68:71]
s_waitcnt lgkmcnt(2)
v_cvt_pk_bf16_f32 v98, v144, v145
v_cvt_pk_bf16_f32 v99, v146, v147
v_mfma_f32_16x16x32_bf16 a[16:19], a[148:151], v[112:115], a[16:19]
s_add_u32 m0, s39, 32768
v_exp_f32 v144, v36
v_mfma_f32_16x16x32_bf16 a[20:23], a[148:151], v[116:119], a[20:23]
ds_read_b64_tr_b16 a[156:157], v21 offset:40960
ds_read_b64_tr_b16 a[158:159], v21 offset:45056
v_mfma_f32_16x16x32_bf16 a[24:27], a[148:151], v[120:123], a[24:27]
buffer_load_dwordx4 v10, s[16:19], s40 offen nt lds
v_mfma_f32_16x16x32_bf16 a[28:31], a[148:151], v[124:127], a[28:31]
v_exp_f32 v145, v37
v_mfma_f32_16x16x32_bf16 v[72:75], a[128:131], v[192:195], v[136:139]
v_exp_f32 v146, v38
v_mfma_f32_16x16x32_bf16 v[72:75], a[132:135], v[196:199], v[72:75]
ds_read_b64_tr_b16 a[144:145], v22 offset:40960
ds_read_b64_tr_b16 a[146:147], v22 offset:45056
v_mfma_f32_16x16x32_bf16 v[72:75], a[136:139], v[200:203], v[72:75]
v_exp_f32 v147, v39
v_mfma_f32_16x16x32_bf16 v[72:75], a[140:143], v[204:207], v[72:75]
v_add_f32 v158, v158, v152
v_cvt_pk_bf16_f32 v100, v144, v145
v_mfma_f32_16x16x32_bf16 v[148:151], v[4:7], v[96:99], 0
v_exp_f32 v144, v52
v_mfma_f32_16x16x32_bf16 v[76:79], a[128:131], v[208:211], v[140:143]
ds_read_b128 a[128:131], v14 offset:61440
v_mfma_f32_16x16x32_bf16 v[76:79], a[132:135], v[212:215], v[76:79]
ds_read_b128 a[132:135], v15 offset:61440
v_mfma_f32_16x16x32_bf16 v[76:79], a[136:139], v[216:219], v[76:79]
ds_read_b128 a[136:139], v16 offset:61440
v_mfma_f32_16x16x32_bf16 v[76:79], a[140:143], v[220:223], v[76:79]
s_waitcnt lgkmcnt(7)
ds_read_b128 a[140:143], v17 offset:61440
v_cvt_pk_bf16_f32 v101, v146, v147
v_mfma_f32_16x16x32_bf16 a[32:35], a[152:155], v[112:115], a[32:35]
v_exp_f32 v145, v53
v_mfma_f32_16x16x32_bf16 a[36:39], a[152:155], v[116:119], a[36:39]
v_exp_f32 v146, v54
v_mfma_f32_16x16x32_bf16 a[40:43], a[152:155], v[120:123], a[40:43]
v_exp_f32 v147, v55
v_mfma_f32_16x16x32_bf16 a[44:47], a[152:155], v[124:127], a[44:47]
s_waitcnt lgkmcnt(6)
ds_read_b64_tr_b16 v[26:27], v1 offset:0
ds_read_b64_tr_b16 v[28:29], v1 offset:2048
v_mfma_f32_16x16x32_bf16 a[48:51], a[156:159], v[112:115], a[48:51]
v_cvt_pk_bf16_f32 v102, v144, v145
v_cvt_pk_bf16_f32 v103, v146, v147
v_mfma_f32_16x16x32_bf16 a[52:55], a[156:159], v[116:119], a[52:55]
ds_read_b64_tr_b16 a[148:149], v23 offset:40960
ds_read_b64_tr_b16 a[150:151], v23 offset:45056
v_mfma_f32_16x16x32_bf16 a[56:59], a[156:159], v[120:123], a[56:59]
buffer_load_dwordx4 v11, s[16:19], s40 offen offset:1024 nt lds
v_mfma_f32_16x16x32_bf16 a[60:63], a[156:159], v[124:127], a[60:63]
s_waitcnt lgkmcnt(6)
v_exp_f32 v144, v40
v_mfma_f32_16x16x32_bf16 v[80:83], a[128:131], v[160:163], v[128:131]
s_add_u32 s40, s40, 8192
v_exp_f32 v145, v41
v_mfma_f32_16x16x32_bf16 v[80:83], a[132:135], v[164:167], v[80:83]
s_waitcnt lgkmcnt(5)
v_exp_f32 v146, v42
v_mfma_f32_16x16x32_bf16 v[80:83], a[136:139], v[168:171], v[80:83]
s_waitcnt lgkmcnt(4)
v_exp_f32 v147, v43
v_mfma_f32_16x16x32_bf16 v[80:83], a[140:143], v[172:175], v[80:83]
v_add_f32 v159, v159, v2
v_cvt_pk_bf16_f32 v104, v144, v145
v_mfma_f32_16x16x32_bf16 v[150:153], v[4:7], v[100:103], 0
v_exp_f32 v144, v56
v_mfma_f32_16x16x32_bf16 a[64:67], a[144:147], v[112:115], a[64:67]
v_exp_f32 v145, v57
v_mfma_f32_16x16x32_bf16 a[68:71], a[144:147], v[116:119], a[68:71]
ds_read_b64_tr_b16 a[152:153], v24 offset:40960
ds_read_b64_tr_b16 a[154:155], v24 offset:45056
v_mfma_f32_16x16x32_bf16 a[72:75], a[144:147], v[120:123], a[72:75]
v_cvt_pk_bf16_f32 v105, v146, v147
v_cvt_pk_bf16_f32 v106, v144, v145
v_mfma_f32_16x16x32_bf16 a[76:79], a[144:147], v[124:127], a[76:79]
v_exp_f32 v146, v58
v_mfma_f32_16x16x32_bf16 v[84:87], a[128:131], v[176:179], v[132:135]
v_exp_f32 v147, v59
v_mfma_f32_16x16x32_bf16 v[84:87], a[132:135], v[180:183], v[84:87]
v_exp_f32 v144, v44
v_mfma_f32_16x16x32_bf16 v[84:87], a[136:139], v[184:187], v[84:87]
v_exp_f32 v145, v45
v_mfma_f32_16x16x32_bf16 v[84:87], a[140:143], v[188:191], v[84:87]
s_waitcnt lgkmcnt(2)
v_cvt_pk_bf16_f32 v107, v146, v147
v_add_f32 v2, v144, v145
v_mfma_f32_16x16x32_bf16 a[80:83], a[148:151], v[112:115], a[80:83]
s_add_u32 m0, s39, 81920
v_exp_f32 v146, v46
v_mfma_f32_16x16x32_bf16 a[84:87], a[148:151], v[116:119], a[84:87]
ds_read_b64_tr_b16 a[156:157], v25 offset:40960
ds_read_b64_tr_b16 a[158:159], v25 offset:45056
v_mfma_f32_16x16x32_bf16 a[88:91], a[148:151], v[120:123], a[88:91]
buffer_load_dwordx4 v12, s[20:23], s41 offen nt lds
v_mfma_f32_16x16x32_bf16 a[92:95], a[148:151], v[124:127], a[92:95]
v_exp_f32 v147, v47
v_mfma_f32_16x16x32_bf16 v[152:155], v[4:7], v[104:107], 0
v_cvt_pk_bf16_f32 v108, v144, v145
v_add_f32 v2, v2, v146
v_mfma_f32_16x16x32_bf16 v[88:91], a[128:131], v[192:195], v[136:139]
v_exp_f32 v144, v60
v_mfma_f32_16x16x32_bf16 v[88:91], a[132:135], v[196:199], v[88:91]
v_exp_f32 v145, v61
v_mfma_f32_16x16x32_bf16 v[88:91], a[136:139], v[200:203], v[88:91]
v_add_f32 v2, v2, v147
v_cvt_pk_bf16_f32 v109, v146, v147
v_mfma_f32_16x16x32_bf16 v[88:91], a[140:143], v[204:207], v[88:91]
v_exp_f32 v146, v62
v_mfma_f32_16x16x32_bf16 v[92:95], a[128:131], v[208:211], v[140:143]
ds_read_b128 a[128:131], v14 offset:0
v_mfma_f32_16x16x32_bf16 v[92:95], a[132:135], v[212:215], v[92:95]
ds_read_b128 a[132:135], v15 offset:0
v_add_f32 v2, v2, v144
v_mfma_f32_16x16x32_bf16 v[92:95], a[136:139], v[216:219], v[92:95]
ds_read_b128 a[136:139], v16 offset:0
v_max3_f32 v149, v148, v150, v152
v_mfma_f32_16x16x32_bf16 v[92:95], a[140:143], v[220:223], v[92:95]
s_waitcnt lgkmcnt(5)
ds_read_b128 a[140:143], v17 offset:0
v_add_f32 v2, v2, v145
v_mfma_f32_16x16x32_bf16 a[96:99], a[152:155], v[112:115], a[96:99]
v_exp_f32 v147, v63
v_mfma_f32_16x16x32_bf16 a[100:103], a[152:155], v[116:119], a[100:103]
ds_read_b64_tr_b16 a[144:145], v18 offset:49152
ds_read_b64_tr_b16 a[146:147], v18 offset:53248
v_mfma_f32_16x16x32_bf16 a[104:107], a[152:155], v[120:123], a[104:107]
v_cvt_pk_bf16_f32 v110, v144, v145
v_add_f32 v2, v2, v146
v_mfma_f32_16x16x32_bf16 a[108:111], a[152:155], v[124:127], a[108:111]
s_waitcnt lgkmcnt(6)
v_add_f32 v2, v2, v147
v_max_f32_e64 v149, v149, v2
v_mfma_f32_16x16x32_bf16 a[112:115], a[156:159], v[112:115], a[112:115]
v_cmp_lt_f32 vcc, s50, v149
v_cvt_pk_bf16_f32 v111, v146, v147
v_mfma_f32_16x16x32_bf16 a[116:119], a[156:159], v[116:119], a[116:119]
buffer_load_dwordx4 v13, s[20:23], s41 offen offset:1024 nt lds
v_mfma_f32_16x16x32_bf16 a[120:123], a[156:159], v[120:123], a[120:123]
s_waitcnt lgkmcnt(5)
ds_read_b64_tr_b16 a[148:149], v19 offset:49152
v_mfma_f32_16x16x32_bf16 a[124:127], a[156:159], v[124:127], a[124:127]
s_cbranch_vccnz K1_slow6
K1_back6:
ds_read_b64_tr_b16 a[150:151], v19 offset:53248
v_mfma_f32_16x16x32_bf16 v[32:35], a[128:131], v[160:163], v[128:131]
s_waitcnt lgkmcnt(6)
v_exp_f32 v144, v64
v_mfma_f32_16x16x32_bf16 v[32:35], a[132:135], v[164:167], v[32:35]
s_waitcnt lgkmcnt(4)
v_exp_f32 v145, v65
v_mfma_f32_16x16x32_bf16 v[32:35], a[136:139], v[168:171], v[32:35]
s_add_u32 s41, s41, 8192
v_add_f32 v156, v156, v148
v_add_f32 v157, v157, v150
v_mfma_f32_16x16x32_bf16 v[32:35], a[140:143], v[172:175], v[32:35]
s_waitcnt lgkmcnt(2)
v_exp_f32 v146, v66
v_mfma_f32_16x16x32_bf16 a[0:3], a[144:147], v[96:99], a[0:3]
v_exp_f32 v147, v67
v_mfma_f32_16x16x32_bf16 a[4:7], a[144:147], v[100:103], a[4:7]
ds_read_b64_tr_b16 a[152:153], v20 offset:49152
ds_read_b64_tr_b16 a[154:155], v20 offset:53248
v_mfma_f32_16x16x32_bf16 a[8:11], a[144:147], v[104:107], a[8:11]
buffer_store_dwordx4 v[26:29], v3, s[8:11], s70 offen sc1
v_mfma_f32_16x16x32_bf16 a[12:15], a[144:147], v[108:111], a[12:15]
buffer_load_dword v31, v30, s[28:31], s65 offen
v_mfma_f32_16x16x32_bf16 v[36:39], a[128:131], v[176:179], v[132:135]
v_cvt_pk_bf16_f32 v112, v144, v145
v_cvt_pk_bf16_f32 v113, v146, v147
v_mfma_f32_16x16x32_bf16 v[36:39], a[132:135], v[180:183], v[36:39]
v_exp_f32 v144, v80
v_mfma_f32_16x16x32_bf16 v[36:39], a[136:139], v[184:187], v[36:39]
v_exp_f32 v145, v81
v_mfma_f32_16x16x32_bf16 v[36:39], a[140:143], v[188:191], v[36:39]
s_waitcnt lgkmcnt(2)
v_exp_f32 v146, v82
v_mfma_f32_16x16x32_bf16 a[16:19], a[148:151], v[96:99], a[16:19]
s_add_u32 m0, s39, 40960
v_exp_f32 v147, v83
v_mfma_f32_16x16x32_bf16 a[20:23], a[148:151], v[100:103], a[20:23]
ds_read_b64_tr_b16 a[156:157], v21 offset:49152
ds_read_b64_tr_b16 a[158:159], v21 offset:53248
v_mfma_f32_16x16x32_bf16 a[24:27], a[148:151], v[104:107], a[24:27]
buffer_load_dwordx4 v10, s[16:19], s40 offen nt lds
v_mfma_f32_16x16x32_bf16 a[28:31], a[148:151], v[108:111], a[28:31]
v_cvt_pk_bf16_f32 v114, v144, v145
v_cvt_pk_bf16_f32 v115, v146, v147
v_mfma_f32_16x16x32_bf16 v[40:43], a[128:131], v[192:195], v[136:139]
s_add_u32 s65, s65, 82944
v_exp_f32 v144, v68
v_mfma_f32_16x16x32_bf16 v[40:43], a[132:135], v[196:199], v[40:43]
s_cmp_eq_u32 s42, 7
ds_read_b64_tr_b16 a[144:145], v22 offset:49152
ds_read_b64_tr_b16 a[146:147], v22 offset:53248
v_mfma_f32_16x16x32_bf16 v[40:43], a[136:139], v[200:203], v[40:43]
s_cselect_b32 s65, s76, s65
v_exp_f32 v145, v69
v_mfma_f32_16x16x32_bf16 v[40:43], a[140:143], v[204:207], v[40:43]
s_add_u32 s60, s77, 128
v_exp_f32 v146, v70
v_mfma_f32_16x16x32_bf16 v[148:151], v[4:7], v[112:115], 0
s_waitcnt lgkmcnt(4)
v_exp_f32 v147, v71
v_mfma_f32_16x16x32_bf16 v[44:47], a[128:131], v[208:211], v[140:143]
s_cmp_eq_u32 s42, 5
ds_read_b128 a[128:131], v14 offset:4096
v_mfma_f32_16x16x32_bf16 v[44:47], a[132:135], v[212:215], v[44:47]
s_cselect_b32 s65, s60, s65
ds_read_b128 a[132:135], v15 offset:4096
v_add_f32 v158, v158, v152
v_mfma_f32_16x16x32_bf16 v[44:47], a[136:139], v[216:219], v[44:47]
s_cmp_eq_u32 s42, 3
ds_read_b128 a[136:139], v16 offset:4096
v_cvt_pk_bf16_f32 v116, v144, v145
v_mfma_f32_16x16x32_bf16 v[44:47], a[140:143], v[220:223], v[44:47]
s_cselect_b32 s65, s77, s65
ds_read_b128 a[140:143], v17 offset:4096
v_cvt_pk_bf16_f32 v117, v146, v147
v_mfma_f32_16x16x32_bf16 a[32:35], a[152:155], v[96:99], a[32:35]
v_exp_f32 v144, v84
v_mfma_f32_16x16x32_bf16 a[36:39], a[152:155], v[100:103], a[36:39]
v_exp_f32 v145, v85
v_mfma_f32_16x16x32_bf16 a[40:43], a[152:155], v[104:107], a[40:43]
v_exp_f32 v146, v86
v_mfma_f32_16x16x32_bf16 a[44:47], a[152:155], v[108:111], a[44:47]
s_waitcnt lgkmcnt(6)
v_exp_f32 v147, v87
v_mfma_f32_16x16x32_bf16 a[48:51], a[156:159], v[96:99], a[48:51]
v_cvt_pk_bf16_f32 v118, v144, v145
v_cvt_pk_bf16_f32 v119, v146, v147
v_mfma_f32_16x16x32_bf16 a[52:55], a[156:159], v[100:103], a[52:55]
ds_read_b64_tr_b16 a[148:149], v23 offset:49152
ds_read_b64_tr_b16 a[150:151], v23 offset:53248
v_mfma_f32_16x16x32_bf16 a[56:59], a[156:159], v[104:107], a[56:59]
buffer_load_dwordx4 v11, s[16:19], s40 offen offset:1024 nt lds
v_mfma_f32_16x16x32_bf16 a[60:63], a[156:159], v[108:111], a[60:63]
s_waitcnt lgkmcnt(2)
v_exp_f32 v144, v72
v_mfma_f32_16x16x32_bf16 v[48:51], a[128:131], v[160:163], v[128:131]
s_add_u32 s40, s40, 8192
v_exp_f32 v145, v73
v_mfma_f32_16x16x32_bf16 v[48:51], a[132:135], v[164:167], v[48:51]
s_mov_b32 s70, s69
v_exp_f32 v146, v74
v_mfma_f32_16x16x32_bf16 v[48:51], a[136:139], v[168:171], v[48:51]
s_add_u32 s68, s68, 128
v_exp_f32 v147, v75
v_mfma_f32_16x16x32_bf16 v[48:51], a[140:143], v[172:175], v[48:51]
s_add_u32 s69, s69, 4096
v_add_f32 v159, v159, v2
v_cvt_pk_bf16_f32 v120, v144, v145
v_mfma_f32_16x16x32_bf16 v[150:153], v[4:7], v[116:119], 0
v_exp_f32 v144, v88
v_mfma_f32_16x16x32_bf16 a[64:67], a[144:147], v[96:99], a[64:67]
s_cmp_eq_u32 s42, 3
v_exp_f32 v145, v89
v_mfma_f32_16x16x32_bf16 a[68:71], a[144:147], v[100:103], a[68:71]
s_cselect_b32 s68, 0x40000000, s68
ds_read_b64_tr_b16 a[152:153], v24 offset:49152
ds_read_b64_tr_b16 a[154:155], v24 offset:53248
v_mfma_f32_16x16x32_bf16 a[72:75], a[144:147], v[104:107], a[72:75]
s_cselect_b32 s69, 0x40000000, s69
v_cvt_pk_bf16_f32 v121, v146, v147
v_cvt_pk_bf16_f32 v122, v144, v145
v_mfma_f32_16x16x32_bf16 a[76:79], a[144:147], v[108:111], a[76:79]
v_exp_f32 v146, v90
v_mfma_f32_16x16x32_bf16 v[52:55], a[128:131], v[176:179], v[132:135]
v_exp_f32 v147, v91
v_mfma_f32_16x16x32_bf16 v[52:55], a[132:135], v[180:183], v[52:55]
v_exp_f32 v144, v76
v_mfma_f32_16x16x32_bf16 v[52:55], a[136:139], v[184:187], v[52:55]
v_exp_f32 v145, v77
v_mfma_f32_16x16x32_bf16 v[52:55], a[140:143], v[188:191], v[52:55]
s_waitcnt lgkmcnt(2)
v_cvt_pk_bf16_f32 v123, v146, v147
v_add_f32 v2, v144, v145
v_mfma_f32_16x16x32_bf16 a[80:83], a[148:151], v[96:99], a[80:83]
s_add_u32 m0, s39, 90112
v_exp_f32 v146, v78
v_mfma_f32_16x16x32_bf16 a[84:87], a[148:151], v[100:103], a[84:87]
ds_read_b64_tr_b16 a[156:157], v25 offset:49152
ds_read_b64_tr_b16 a[158:159], v25 offset:53248
v_mfma_f32_16x16x32_bf16 a[88:91], a[148:151], v[104:107], a[88:91]
buffer_load_dwordx4 v12, s[20:23], s41 offen nt lds
v_mfma_f32_16x16x32_bf16 a[92:95], a[148:151], v[108:111], a[92:95]
v_exp_f32 v147, v79
v_mfma_f32_16x16x32_bf16 v[152:155], v[4:7], v[120:123], 0
v_cvt_pk_bf16_f32 v124, v144, v145
v_add_f32 v2, v2, v146
v_mfma_f32_16x16x32_bf16 v[56:59], a[128:131], v[192:195], v[136:139]
v_exp_f32 v144, v92
v_mfma_f32_16x16x32_bf16 v[56:59], a[132:135], v[196:199], v[56:59]
v_exp_f32 v145, v93
v_mfma_f32_16x16x32_bf16 v[56:59], a[136:139], v[200:203], v[56:59]
v_add_f32 v2, v2, v147
v_cvt_pk_bf16_f32 v125, v146, v147
v_mfma_f32_16x16x32_bf16 v[56:59], a[140:143], v[204:207], v[56:59]
v_exp_f32 v146, v94
v_mfma_f32_16x16x32_bf16 v[60:63], a[128:131], v[208:211], v[140:143]
s_waitcnt vmcnt(15)
s_barrier
ds_read_b128 a[128:131], v14 offset:8192
v_mfma_f32_16x16x32_bf16 v[60:63], a[132:135], v[212:215], v[60:63]
ds_read_b128 a[132:135], v15 offset:8192
v_add_f32 v2, v2, v144
v_mfma_f32_16x16x32_bf16 v[60:63], a[136:139], v[216:219], v[60:63]
ds_read_b128 a[136:139], v16 offset:8192
v_max3_f32 v149, v148, v150, v152
v_mfma_f32_16x16x32_bf16 v[60:63], a[140:143], v[220:223], v[60:63]
s_waitcnt lgkmcnt(5)
ds_read_b128 a[140:143], v17 offset:8192
v_add_f32 v2, v2, v145
v_mfma_f32_16x16x32_bf16 a[96:99], a[152:155], v[96:99], a[96:99]
v_exp_f32 v147, v95
v_mfma_f32_16x16x32_bf16 a[100:103], a[152:155], v[100:103], a[100:103]
ds_read_b64_tr_b16 a[144:145], v18 offset:57344
ds_read_b64_tr_b16 a[146:147], v18 offset:61440
v_mfma_f32_16x16x32_bf16 a[104:107], a[152:155], v[104:107], a[104:107]
s_sub_u32 s42, s42, 1
v_cvt_pk_bf16_f32 v126, v144, v145
v_add_f32 v2, v2, v146
v_mfma_f32_16x16x32_bf16 a[108:111], a[152:155], v[108:111], a[108:111]
s_waitcnt lgkmcnt(6)
v_add_f32 v2, v2, v147
v_max_f32 v149, v149, v2
v_mfma_f32_16x16x32_bf16 a[112:115], a[156:159], v[96:99], a[112:115]
v_cmp_lt_f32 vcc, s50, v149
v_cvt_pk_bf16_f32 v127, v146, v147
v_mfma_f32_16x16x32_bf16 a[116:119], a[156:159], v[100:103], a[116:119]
buffer_load_dwordx4 v13, s[20:23], s41 offen offset:1024 nt lds
v_mfma_f32_16x16x32_bf16 a[120:123], a[156:159], v[104:107], a[120:123]
ds_read_b64_tr_b16 a[148:149], v19 offset:57344
v_mfma_f32_16x16x32_bf16 a[124:127], a[156:159], v[108:111], a[124:127]
s_cbranch_vccnz K1_slow7
K1_back7:
ds_read_b64_tr_b16 a[150:151], v19 offset:61440
s_cmp_lg_u32 s42, 0
s_cbranch_scc1 K1_loop
K1_after:
s_waitcnt lgkmcnt(2)
v_mfma_f32_16x16x32_bf16 a[0:3], a[144:147], v[112:115], a[0:3]
s_waitcnt vmcnt(0)
s_barrier
v_add_f32 v159, v159, v2
v_lshrrev_b32 v2, 4, v3
v_mfma_f32_16x16x32_bf16 a[4:7], a[144:147], v[116:119], a[4:7]
s_waitcnt lgkmcnt(0)
ds_read_b64_tr_b16 a[152:153], v20 offset:57344
ds_read_b64_tr_b16 a[154:155], v20 offset:61440
v_mfma_f32_16x16x32_bf16 a[8:11], a[144:147], v[120:123], a[8:11]
s_add_u32 s34, s64, 8192
v_lshrrev_b32 v128, 4, v2
v_and_b32 v129, 15, v2
v_mfma_f32_16x16x32_bf16 a[12:15], a[144:147], v[124:127], a[12:15]
s_add_u32 m0, s52, 0
s_add_u32 s35, s64, 26624
v_lshrrev_b32 v130, 2, v129
v_and_b32 v131, 3, v2
v_mfma_f32_16x16x32_bf16 a[16:19], a[148:151], v[112:115], a[16:19]
buffer_load_dwordx4 v8, s[24:27], s51 offen lds
v_mfma_f32_16x16x32_bf16 a[20:23], a[148:151], v[116:119], a[20:23]
s_add_u32 s36, s64, 45056
s_add_u32 s37, s64, 63488
ds_read_b64_tr_b16 a[156:157], v21 offset:57344
ds_read_b64_tr_b16 a[158:159], v21 offset:61440
v_mfma_f32_16x16x32_bf16 a[24:27], a[148:151], v[120:123], a[24:27]
v_lshl_add_u32 v132, v128, 3, v130
v_lshlrev_b32 v133, 7, v132
v_mfma_f32_16x16x32_bf16 a[28:31], a[148:151], v[124:127], a[28:31]
s_waitcnt lgkmcnt(2)
v_lshl_add_u32 v133, v131, 3, v133
v_lshrrev_b32 v4, 1, v130
v_mfma_f32_16x16x32_bf16 a[32:35], a[152:155], v[112:115], a[32:35]
v_lshl_add_u32 v133, v4, 5, v133
v_and_b32 v132, 1, v128
v_lshl_add_u32 v4, v132, 6, v133
v_mfma_f32_16x16x32_bf16 a[36:39], a[152:155], v[116:119], a[36:39]
s_add_u32 m0, s52, 4096
ds_read_b64_tr_b16 a[144:145], v22 offset:57344
ds_read_b64_tr_b16 a[146:147], v22 offset:61440
v_mfma_f32_16x16x32_bf16 a[40:43], a[152:155], v[120:123], a[40:43]
buffer_load_dwordx4 v8, s[28:31], s51 offen lds
v_mfma_f32_16x16x32_bf16 a[44:47], a[152:155], v[124:127], a[44:47]
s_waitcnt lgkmcnt(2)
v_xor_b32 v5, 32, v4
v_add_u32 v28, 0x20000, v4
v_mfma_f32_16x16x32_bf16 a[48:51], a[156:159], v[112:115], a[48:51]
v_add_u32 v29, 0x20000, v5
v_add_u32 v6, 0x10000, v4
v_mfma_f32_16x16x32_bf16 a[52:55], a[156:159], v[116:119], a[52:55]
s_waitcnt lgkmcnt(0)
ds_read_b64_tr_b16 a[148:149], v23 offset:57344
ds_read_b64_tr_b16 a[150:151], v23 offset:61440
v_mfma_f32_16x16x32_bf16 a[56:59], a[156:159], v[120:123], a[56:59]
buffer_load_dwordx4 v[192:195], v3, s[8:11], s34 offen offset:0 sc1
v_add_u32 v7, 0x10000, v5
v_mfma_f32_16x16x32_bf16 a[60:63], a[156:159], v[124:127], a[60:63]
s_add_u32 s51, s51, 294912
s_add_u32 m0, s52, 8192
v_mfma_f32_16x16x32_bf16 a[64:67], a[144:147], v[112:115], a[64:67]
buffer_load_dwordx4 v8, s[24:27], s51 offen lds
v_add_f32 v156, v156, v148
v_mfma_f32_16x16x32_bf16 a[68:71], a[144:147], v[116:119], a[68:71]
ds_read_b64_tr_b16 a[152:153], v24 offset:57344
ds_read_b64_tr_b16 a[154:155], v24 offset:61440
v_add_f32 v157, v157, v150
v_mfma_f32_16x16x32_bf16 a[72:75], a[144:147], v[120:123], a[72:75]
ds_read_b64_tr_b16 v[160:161], v28 offset:8192
ds_read_b64_tr_b16 v[162:163], v28 offset:8704
v_add_f32 v158, v158, v152
v_mfma_f32_16x16x32_bf16 a[76:79], a[144:147], v[124:127], a[76:79]
s_waitcnt lgkmcnt(4)
ds_read_b64_tr_b16 v[164:165], v28 offset:16384
ds_read_b64_tr_b16 v[166:167], v28 offset:16896
v_mfma_f32_16x16x32_bf16 a[80:83], a[148:151], v[112:115], a[80:83]
ds_read_b64_tr_b16 v[168:169], v28 offset:24576
ds_read_b64_tr_b16 v[170:171], v28 offset:25088
v_mfma_f32_16x16x32_bf16 a[84:87], a[148:151], v[116:119], a[84:87]
ds_read_b64_tr_b16 a[156:157], v25 offset:57344
ds_read_b64_tr_b16 a[158:159], v25 offset:61440
v_mfma_f32_16x16x32_bf16 a[88:91], a[148:151], v[120:123], a[88:91]
ds_read_b64_tr_b16 v[172:173], v29 offset:8192
ds_read_b64_tr_b16 v[174:175], v29 offset:8704
v_mfma_f32_16x16x32_bf16 a[92:95], a[148:151], v[124:127], a[92:95]
s_waitcnt lgkmcnt(2)
ds_read_b64_tr_b16 v[176:177], v29 offset:16384
ds_read_b64_tr_b16 v[178:179], v29 offset:16896
v_mfma_f32_16x16x32_bf16 a[96:99], a[152:155], v[112:115], a[96:99]
s_add_u32 m0, s52, 12288
ds_read_b64_tr_b16 v[180:181], v29 offset:24576
ds_read_b64_tr_b16 v[182:183], v29 offset:25088
v_mfma_f32_16x16x32_bf16 a[100:103], a[152:155], v[116:119], a[100:103]
buffer_load_dwordx4 v8, s[28:31], s51 offen lds
v_mfma_f32_16x16x32_bf16 a[104:107], a[152:155], v[120:123], a[104:107]
s_add_u32 s51, s51, 294912
v_mov_b32 v137, v159
s_nop 1
v_permlane16_swap_b32 v159, v137
v_mfma_f32_16x16x32_bf16 a[108:111], a[152:155], v[124:127], a[108:111]
s_add_u32 m0, s52, 16384
v_add_f32 v159, v159, v137
v_mov_b32 v137, v159
v_mfma_f32_16x16x32_bf16 a[112:115], a[156:159], v[112:115], a[112:115]
buffer_load_dwordx4 v8, s[24:27], s51 offen lds
v_mfma_f32_16x16x32_bf16 a[116:119], a[156:159], v[116:119], a[116:119]
v_permlane32_swap_b32 v159, v137
v_add_f32 v159, v159, v137
v_mfma_f32_16x16x32_bf16 a[120:123], a[156:159], v[120:123], a[120:123]
ds_read_b64_tr_b16 v[184:185], v28 offset:12288
ds_read_b64_tr_b16 v[186:187], v28 offset:12800
v_mfma_f32_16x16x32_bf16 a[124:127], a[156:159], v[124:127], a[124:127]
ds_read_b64_tr_b16 v[188:189], v28 offset:20480
ds_read_b64_tr_b16 v[190:191], v28 offset:20992
v_mfma_f32_16x16x32_bf16 v[32:35], v[160:163], a[160:163], 0
v_rcp_f32 v30, v156
v_mfma_f32_16x16x32_bf16 v[32:35], v[164:167], a[176:179], v[32:35]
s_add_u32 m0, s52, 20480
v_rcp_f32 v31, v157
v_mfma_f32_16x16x32_bf16 v[32:35], v[168:171], a[192:195], v[32:35]
buffer_load_dwordx4 v8, s[28:31], s51 offen lds
v_mfma_f32_16x16x32_bf16 v[36:39], v[160:163], a[164:167], 0
v_rcp_f32 v0, v158
v_mfma_f32_16x16x32_bf16 v[36:39], v[164:167], a[180:183], v[36:39]
v_rcp_f32 v13, v159
v_mfma_f32_16x16x32_bf16 v[36:39], v[168:171], a[196:199], v[36:39]
buffer_load_dwordx4 v[196:199], v3, s[8:11], s35 offen offset:0 sc1
v_mfma_f32_16x16x32_bf16 v[40:43], v[160:163], a[168:171], 0
s_add_u32 s51, s51, 294912
v_mfma_f32_16x16x32_bf16 v[40:43], v[164:167], a[184:187], v[40:43]
s_add_u32 m0, s52, 24576
v_mfma_f32_16x16x32_bf16 v[40:43], v[168:171], a[200:203], v[40:43]
buffer_load_dwordx4 v8, s[24:27], s51 offen lds
v_accvgpr_read_b32 v144, a0
v_mfma_f32_16x16x32_bf16 v[44:47], v[160:163], a[172:175], 0
v_accvgpr_read_b32 v145, a1
v_accvgpr_read_b32 v146, a2
v_mfma_f32_16x16x32_bf16 v[44:47], v[164:167], a[188:191], v[44:47]
s_waitcnt lgkmcnt(8)
ds_read_b64_tr_b16 v[160:161], v28 offset:28672
ds_read_b64_tr_b16 v[162:163], v28 offset:29184
v_mfma_f32_16x16x32_bf16 v[44:47], v[168:171], a[204:207], v[44:47]
buffer_load_dwordx4 v[200:203], v3, s[8:11], s36 offen offset:0 sc1
v_accvgpr_read_b32 v147, a3
v_accvgpr_read_b32 v148, a16
v_accvgpr_read_b32 v149, a17
v_accvgpr_read_b32 v150, a18
v_mfma_f32_16x16x32_bf16 v[48:51], v[172:175], a[160:163], 0
s_waitcnt lgkmcnt(6)
v_xor_b32 v28, 64, v28
v_accvgpr_read_b32 v151, a19
v_mfma_f32_16x16x32_bf16 v[48:51], v[176:179], a[176:179], v[48:51]
s_add_u32 m0, s52, 28672
ds_read_b64_tr_b16 v[164:165], v29 offset:12288
ds_read_b64_tr_b16 v[166:167], v29 offset:12800
v_mfma_f32_16x16x32_bf16 v[48:51], v[180:183], a[192:195], v[48:51]
buffer_load_dwordx4 v8, s[28:31], s51 offen lds
v_mul_f32 v144, v144, v30
v_mul_f32 v145, v145, v30
v_mul_f32 v146, v146, v30
v_mfma_f32_16x16x32_bf16 v[52:55], v[172:175], a[164:167], 0
v_mul_f32 v147, v147, v30
v_mul_f32 v148, v148, v30
v_mfma_f32_16x16x32_bf16 v[52:55], v[176:179], a[180:183], v[52:55]
ds_read_b64_tr_b16 v[168:169], v29 offset:20480
ds_read_b64_tr_b16 v[170:171], v29 offset:20992
v_mfma_f32_16x16x32_bf16 v[52:55], v[180:183], a[196:199], v[52:55]
buffer_load_dwordx4 v[204:207], v3, s[8:11], s37 offen offset:0 sc1
v_mul_f32 v149, v149, v30
v_mul_f32 v150, v150, v30
v_mul_f32 v151, v151, v30
v_cvt_pk_bf16_f32 v96, v144, v145
v_mfma_f32_16x16x32_bf16 v[56:59], v[172:175], a[168:171], 0
s_add_u32 s51, s51, 294912
v_cvt_pk_bf16_f32 v97, v146, v147
v_cvt_pk_bf16_f32 v98, v148, v149
v_mfma_f32_16x16x32_bf16 v[56:59], v[176:179], a[184:187], v[56:59]
s_add_u32 m0, s52, 32768
v_cvt_pk_bf16_f32 v99, v150, v151
v_accvgpr_read_b32 v152, a4
v_mfma_f32_16x16x32_bf16 v[56:59], v[180:183], a[200:203], v[56:59]
buffer_load_dwordx4 v8, s[24:27], s51 offen lds
v_accvgpr_read_b32 v153, a5
v_accvgpr_read_b32 v154, a6
v_accvgpr_read_b32 v155, a7
v_accvgpr_read_b32 v156, a20
v_mfma_f32_16x16x32_bf16 v[60:63], v[172:175], a[172:175], 0
v_accvgpr_read_b32 v157, a21
v_accvgpr_read_b32 v158, a22
v_mfma_f32_16x16x32_bf16 v[60:63], v[176:179], a[188:191], v[60:63]
s_waitcnt lgkmcnt(8)
ds_read_b64_tr_b16 v[172:173], v29 offset:28672
ds_read_b64_tr_b16 v[174:175], v29 offset:29184
v_mfma_f32_16x16x32_bf16 v[60:63], v[180:183], a[204:207], v[60:63]
buffer_load_dwordx4 v[208:211], v3, s[8:11], s34 offen offset:1024 sc1
v_accvgpr_read_b32 v159, a23
v_mul_f32 v152, v152, v31
v_mul_f32 v153, v153, v31
v_mul_f32 v154, v154, v31
v_mfma_f32_16x16x32_bf16 v[64:67], v[184:187], a[160:163], 0
s_waitcnt lgkmcnt(6)
v_xor_b32 v29, 64, v29
v_mul_f32 v155, v155, v31
v_mfma_f32_16x16x32_bf16 v[64:67], v[188:191], a[176:179], v[64:67]
s_add_u32 m0, s52, 36864
v_mul_f32 v156, v156, v31
v_mul_f32 v157, v157, v31
v_mfma_f32_16x16x32_bf16 v[64:67], v[160:163], a[192:195], v[64:67]
buffer_load_dwordx4 v8, s[28:31], s51 offen lds
v_mul_f32 v158, v158, v31
v_mul_f32 v159, v159, v31
v_cvt_pk_bf16_f32 v100, v152, v153
v_cvt_pk_bf16_f32 v101, v154, v155
v_mfma_f32_16x16x32_bf16 v[68:71], v[184:187], a[164:167], 0
v_cvt_pk_bf16_f32 v102, v156, v157
v_cvt_pk_bf16_f32 v103, v158, v159
v_mfma_f32_16x16x32_bf16 v[68:71], v[188:191], a[180:183], v[68:71]
v_accvgpr_read_b32 v144, a8
v_accvgpr_read_b32 v145, a9
v_mfma_f32_16x16x32_bf16 v[68:71], v[160:163], a[196:199], v[68:71]
buffer_load_dwordx4 v[212:215], v3, s[8:11], s35 offen offset:1024 sc1
v_accvgpr_read_b32 v146, a10
v_accvgpr_read_b32 v147, a11
v_accvgpr_read_b32 v148, a24
v_mfma_f32_16x16x32_bf16 v[72:75], v[184:187], a[168:171], 0
s_add_u32 s51, s51, 294912
v_accvgpr_read_b32 v149, a25
v_accvgpr_read_b32 v150, a26
v_mfma_f32_16x16x32_bf16 v[72:75], v[188:191], a[184:187], v[72:75]
s_add_u32 m0, s52, 40960
v_accvgpr_read_b32 v151, a27
v_mul_f32 v144, v144, v0
v_mfma_f32_16x16x32_bf16 v[72:75], v[160:163], a[200:203], v[72:75]
buffer_load_dwordx4 v8, s[24:27], s51 offen lds
v_mul_f32 v145, v145, v0
v_mul_f32 v146, v146, v0
v_mul_f32 v147, v147, v0
v_mul_f32 v148, v148, v0
v_mfma_f32_16x16x32_bf16 v[76:79], v[184:187], a[172:175], 0
s_waitcnt lgkmcnt(0)
v_mul_f32 v149, v149, v0
v_mul_f32 v150, v150, v0
v_mfma_f32_16x16x32_bf16 v[76:79], v[188:191], a[188:191], v[76:79]
s_waitcnt vmcnt(10)
s_barrier
v_mul_f32 v151, v151, v0
v_cvt_pk_bf16_f32 v104, v144, v145
v_mfma_f32_16x16x32_bf16 v[76:79], v[160:163], a[204:207], v[76:79]
buffer_load_dwordx4 v[216:219], v3, s[8:11], s36 offen offset:1024 sc1
v_cvt_pk_bf16_f32 v105, v146, v147
v_cvt_pk_bf16_f32 v106, v148, v149
v_cvt_pk_bf16_f32 v107, v150, v151
v_accvgpr_read_b32 v152, a12
v_mfma_f32_16x16x32_bf16 v[80:83], v[164:167], a[160:163], 0
ds_read_b64_tr_b16 v[176:177], v4 offset:0
ds_read_b64_tr_b16 v[178:179], v4 offset:512
v_mfma_f32_16x16x32_bf16 v[80:83], v[168:171], a[176:179], v[80:83]
ds_read_b64_tr_b16 v[180:181], v4 offset:8192
ds_read_b64_tr_b16 v[182:183], v4 offset:8704
v_mfma_f32_16x16x32_bf16 v[80:83], v[172:175], a[192:195], v[80:83]
ds_read_b64_tr_b16 v[184:185], v4 offset:16384
ds_read_b64_tr_b16 v[186:187], v4 offset:16896
v_accvgpr_read_b32 v153, a13
v_accvgpr_read_b32 v154, a14
v_accvgpr_read_b32 v155, a15
v_accvgpr_read_b32 v156, a28
v_mfma_f32_16x16x32_bf16 v[84:87], v[164:167], a[164:167], 0
v_accvgpr_read_b32 v157, a29
v_accvgpr_read_b32 v158, a30
v_mfma_f32_16x16x32_bf16 v[84:87], v[168:171], a[180:183], v[84:87]
s_add_u32 m0, s52, 45056
ds_read_b64_tr_b16 v[188:189], v5 offset:0
ds_read_b64_tr_b16 v[190:191], v5 offset:512
v_mfma_f32_16x16x32_bf16 v[84:87], v[172:175], a[196:199], v[84:87]
buffer_load_dwordx4 v8, s[28:31], s51 offen lds
v_accvgpr_read_b32 v159, a31
v_mul_f32 v152, v152, v13
v_mul_f32 v153, v153, v13
v_mfma_f32_16x16x32_bf16 v[88:91], v[164:167], a[168:171], 0
s_add_u32 s51, s51, 294912
v_mul_f32 v154, v154, v13
v_mul_f32 v155, v155, v13
v_mfma_f32_16x16x32_bf16 v[88:91], v[168:171], a[184:187], v[88:91]
s_add_u32 m0, s52, 49152
ds_read_b64_tr_b16 v[160:161], v5 offset:8192
ds_read_b64_tr_b16 v[162:163], v5 offset:8704
v_mfma_f32_16x16x32_bf16 v[88:91], v[172:175], a[200:203], v[88:91]
buffer_load_dwordx4 v8, s[24:27], s51 offen lds
v_mul_f32 v156, v156, v13
v_mul_f32 v157, v157, v13
v_mul_f32 v158, v158, v13
v_mul_f32 v159, v159, v13
v_mfma_f32_16x16x32_bf16 v[92:95], v[164:167], a[172:175], 0
v_cvt_pk_bf16_f32 v108, v152, v153
v_cvt_pk_bf16_f32 v109, v154, v155
v_mfma_f32_16x16x32_bf16 v[92:95], v[168:171], a[188:191], v[92:95]
s_waitcnt lgkmcnt(8)
ds_read_b64_tr_b16 v[164:165], v5 offset:16384
ds_read_b64_tr_b16 v[166:167], v5 offset:16896
v_mfma_f32_16x16x32_bf16 v[92:95], v[172:175], a[204:207], v[92:95]
buffer_load_dwordx4 v[220:223], v3, s[8:11], s37 offen offset:1024 sc1
v_cvt_pk_bf16_f32 v110, v156, v157
v_cvt_pk_bf16_f32 v111, v158, v159
v_mfma_f32_16x16x32_bf16 v[32:35], v[176:179], a[208:211], v[32:35]
s_waitcnt lgkmcnt(6)
v_mfma_f32_16x16x32_bf16 v[32:35], v[180:183], a[224:227], v[32:35]
s_add_u32 m0, s52, 53248
ds_read_b64_tr_b16 v[168:169], v4 offset:4096
ds_read_b64_tr_b16 v[170:171], v4 offset:4608
v_mfma_f32_16x16x32_bf16 v[32:35], v[184:187], a[240:243], v[32:35]
buffer_load_dwordx4 v8, s[28:31], s51 offen lds
v_mfma_f32_16x16x32_bf16 v[36:39], v[176:179], a[212:215], v[36:39]
v_mfma_f32_16x16x32_bf16 v[36:39], v[180:183], a[228:231], v[36:39]
ds_read_b64_tr_b16 v[172:173], v4 offset:12288
ds_read_b64_tr_b16 v[174:175], v4 offset:12800
v_mfma_f32_16x16x32_bf16 v[36:39], v[184:187], a[244:247], v[36:39]
buffer_load_dwordx4 a[128:131], v3, s[8:11], s34 offen offset:2048 sc1
v_accvgpr_read_b32 v144, a32
v_accvgpr_read_b32 v145, a33
v_mfma_f32_16x16x32_bf16 v[40:43], v[176:179], a[216:219], v[40:43]
s_add_u32 s51, s51, 294912
v_accvgpr_read_b32 v146, a34
v_accvgpr_read_b32 v147, a35
v_mfma_f32_16x16x32_bf16 v[40:43], v[180:183], a[232:235], v[40:43]
s_add_u32 m0, s52, 57344
v_accvgpr_read_b32 v148, a48
v_accvgpr_read_b32 v149, a49
v_mfma_f32_16x16x32_bf16 v[40:43], v[184:187], a[248:251], v[40:43]
buffer_load_dwordx4 v8, s[24:27], s51 offen lds
v_accvgpr_read_b32 v150, a50
v_accvgpr_read_b32 v151, a51
v_mul_f32 v144, v144, v30
v_mul_f32 v145, v145, v30
v_mfma_f32_16x16x32_bf16 v[44:47], v[176:179], a[220:223], v[44:47]
v_mul_f32 v146, v146, v30
v_mul_f32 v147, v147, v30
v_mfma_f32_16x16x32_bf16 v[44:47], v[180:183], a[236:239], v[44:47]
s_waitcnt lgkmcnt(8)
ds_read_b64_tr_b16 v[176:177], v4 offset:20480
ds_read_b64_tr_b16 v[178:179], v4 offset:20992
v_mfma_f32_16x16x32_bf16 v[44:47], v[184:187], a[252:255], v[44:47]
buffer_load_dwordx4 a[132:135], v3, s[8:11], s35 offen offset:2048 sc1
v_mul_f32 v148, v148, v30
v_mul_f32 v149, v149, v30
v_mul_f32 v150, v150, v30
v_mfma_f32_16x16x32_bf16 v[48:51], v[188:191], a[208:211], v[48:51]
s_waitcnt lgkmcnt(6)
v_mul_f32 v151, v151, v30
v_cvt_pk_bf16_f32 v112, v144, v145
v_mfma_f32_16x16x32_bf16 v[48:51], v[160:163], a[224:227], v[48:51]
s_add_u32 m0, s52, 61440
ds_read_b64_tr_b16 v[180:181], v5 offset:4096
ds_read_b64_tr_b16 v[182:183], v5 offset:4608
v_mfma_f32_16x16x32_bf16 v[48:51], v[164:167], a[240:243], v[48:51]
buffer_load_dwordx4 v8, s[28:31], s51 offen lds
v_cvt_pk_bf16_f32 v113, v146, v147
v_cvt_pk_bf16_f32 v114, v148, v149
v_cvt_pk_bf16_f32 v115, v150, v151
v_accvgpr_read_b32 v152, a36
v_mfma_f32_16x16x32_bf16 v[52:55], v[188:191], a[212:215], v[52:55]
v_accvgpr_read_b32 v153, a37
v_accvgpr_read_b32 v154, a38
v_mfma_f32_16x16x32_bf16 v[52:55], v[160:163], a[228:231], v[52:55]
ds_read_b64_tr_b16 v[184:185], v5 offset:12288
ds_read_b64_tr_b16 v[186:187], v5 offset:12800
v_mfma_f32_16x16x32_bf16 v[52:55], v[164:167], a[244:247], v[52:55]
buffer_load_dwordx4 a[136:139], v3, s[8:11], s36 offen offset:2048 sc1
v_accvgpr_read_b32 v155, a39
v_accvgpr_read_b32 v156, a52
v_accvgpr_read_b32 v157, a53
v_mfma_f32_16x16x32_bf16 v[56:59], v[188:191], a[216:219], v[56:59]
s_add_u32 s51, s51, 294912
v_accvgpr_read_b32 v158, a54
v_accvgpr_read_b32 v159, a55
v_mfma_f32_16x16x32_bf16 v[56:59], v[160:163], a[232:235], v[56:59]
s_add_u32 m0, s52, 65536
v_mul_f32 v152, v152, v31
v_mul_f32 v153, v153, v31
v_mfma_f32_16x16x32_bf16 v[56:59], v[164:167], a[248:251], v[56:59]
buffer_load_dwordx4 v8, s[24:27], s51 offen lds
v_mul_f32 v154, v154, v31
v_mul_f32 v155, v155, v31
v_mul_f32 v156, v156, v31
v_mul_f32 v157, v157, v31
v_mfma_f32_16x16x32_bf16 v[60:63], v[188:191], a[220:223], v[60:63]
v_mul_f32 v158, v158, v31
v_mul_f32 v159, v159, v31
v_mfma_f32_16x16x32_bf16 v[60:63], v[160:163], a[236:239], v[60:63]
s_waitcnt lgkmcnt(8)
ds_read_b64_tr_b16 v[188:189], v5 offset:20480
ds_read_b64_tr_b16 v[190:191], v5 offset:20992
v_mfma_f32_16x16x32_bf16 v[60:63], v[164:167], a[252:255], v[60:63]
buffer_load_dwordx4 a[140:143], v3, s[8:11], s37 offen offset:2048 sc1
v_cvt_pk_bf16_f32 v116, v152, v153
v_cvt_pk_bf16_f32 v117, v154, v155
v_cvt_pk_bf16_f32 v118, v156, v157
v_cvt_pk_bf16_f32 v119, v158, v159
v_mfma_f32_16x16x32_bf16 v[64:67], v[168:171], a[208:211], v[64:67]
s_waitcnt lgkmcnt(6)
v_accvgpr_read_b32 v144, a40
v_accvgpr_read_b32 v145, a41
v_mfma_f32_16x16x32_bf16 v[64:67], v[172:175], a[224:227], v[64:67]
s_add_u32 m0, s52, 69632
v_accvgpr_read_b32 v146, a42
v_accvgpr_read_b32 v147, a43
v_mfma_f32_16x16x32_bf16 v[64:67], v[176:179], a[240:243], v[64:67]
buffer_load_dwordx4 v8, s[28:31], s51 offen lds
v_accvgpr_read_b32 v148, a56
v_accvgpr_read_b32 v149, a57
v_accvgpr_read_b32 v150, a58
v_mfma_f32_16x16x32_bf16 v[68:71], v[168:171], a[212:215], v[68:71]
v_accvgpr_read_b32 v151, a59
v_mul_f32 v144, v144, v0
v_mfma_f32_16x16x32_bf16 v[68:71], v[172:175], a[228:231], v[68:71]
v_mul_f32 v145, v145, v0
v_mul_f32 v146, v146, v0
v_mfma_f32_16x16x32_bf16 v[68:71], v[176:179], a[244:247], v[68:71]
buffer_load_dwordx4 a[144:147], v3, s[8:11], s34 offen offset:3072 sc1
v_mul_f32 v147, v147, v0
v_mul_f32 v148, v148, v0
v_mul_f32 v149, v149, v0
v_mul_f32 v150, v150, v0
v_mfma_f32_16x16x32_bf16 v[72:75], v[168:171], a[216:219], v[72:75]
s_add_u32 s51, s51, 294912
v_mul_f32 v151, v151, v0
v_cvt_pk_bf16_f32 v120, v144, v145
v_mfma_f32_16x16x32_bf16 v[72:75], v[172:175], a[232:235], v[72:75]
s_add_u32 m0, s52, 73728
v_cvt_pk_bf16_f32 v121, v146, v147
v_cvt_pk_bf16_f32 v122, v148, v149
v_mfma_f32_16x16x32_bf16 v[72:75], v[176:179], a[248:251], v[72:75]
buffer_load_dwordx4 v8, s[24:27], s51 offen lds
v_cvt_pk_bf16_f32 v123, v150, v151
v_accvgpr_read_b32 v152, a44
v_accvgpr_read_b32 v153, a45
v_accvgpr_read_b32 v154, a46
v_mfma_f32_16x16x32_bf16 v[76:79], v[168:171], a[220:223], v[76:79]
s_waitcnt lgkmcnt(0)
v_accvgpr_read_b32 v155, a47
v_accvgpr_read_b32 v156, a60
v_mfma_f32_16x16x32_bf16 v[76:79], v[172:175], a[236:239], v[76:79]
s_waitcnt vmcnt(13)
s_barrier
v_accvgpr_read_b32 v157, a61
v_accvgpr_read_b32 v158, a62
v_mfma_f32_16x16x32_bf16 v[76:79], v[176:179], a[252:255], v[76:79]
buffer_load_dwordx4 a[148:151], v3, s[8:11], s35 offen offset:3072 sc1
v_accvgpr_read_b32 v159, a63
v_mul_f32 v152, v152, v13
v_mul_f32 v153, v153, v13
v_mfma_f32_16x16x32_bf16 v[80:83], v[180:183], a[208:211], v[80:83]
ds_read_b64_tr_b16 v[160:161], v4 offset:24576
ds_read_b64_tr_b16 v[162:163], v4 offset:25088
v_mfma_f32_16x16x32_bf16 v[80:83], v[184:187], a[224:227], v[80:83]
ds_read_b64_tr_b16 v[164:165], v4 offset:32768
ds_read_b64_tr_b16 v[166:167], v4 offset:33280
v_mfma_f32_16x16x32_bf16 v[80:83], v[188:191], a[240:243], v[80:83]
ds_read_b64_tr_b16 v[168:169], v4 offset:40960
ds_read_b64_tr_b16 v[170:171], v4 offset:41472
v_mul_f32 v154, v154, v13
v_mul_f32 v155, v155, v13
v_mul_f32 v156, v156, v13
v_mul_f32 v157, v157, v13
v_mfma_f32_16x16x32_bf16 v[84:87], v[180:183], a[212:215], v[84:87]
v_mul_f32 v158, v158, v13
v_mul_f32 v159, v159, v13
v_mfma_f32_16x16x32_bf16 v[84:87], v[184:187], a[228:231], v[84:87]
s_add_u32 m0, s52, 77824
ds_read_b64_tr_b16 v[172:173], v5 offset:24576
ds_read_b64_tr_b16 v[174:175], v5 offset:25088
v_mfma_f32_16x16x32_bf16 v[84:87], v[188:191], a[244:247], v[84:87]
buffer_load_dwordx4 v8, s[28:31], s51 offen lds
v_cvt_pk_bf16_f32 v124, v152, v153
v_cvt_pk_bf16_f32 v125, v154, v155
v_cvt_pk_bf16_f32 v126, v156, v157
v_cvt_pk_bf16_f32 v127, v158, v159
v_mfma_f32_16x16x32_bf16 v[88:91], v[180:183], a[216:219], v[88:91]
s_add_u32 s51, s51, 294912
v_mfma_f32_16x16x32_bf16 v[88:91], v[184:187], a[232:235], v[88:91]
s_add_u32 m0, s52, 81920
ds_read_b64_tr_b16 v[176:177], v5 offset:32768
ds_read_b64_tr_b16 v[178:179], v5 offset:33280
v_mfma_f32_16x16x32_bf16 v[88:91], v[188:191], a[248:251], v[88:91]
buffer_load_dwordx4 v8, s[24:27], s51 offen lds
v_mfma_f32_16x16x32_bf16 v[92:95], v[180:183], a[220:223], v[92:95]
v_mfma_f32_16x16x32_bf16 v[92:95], v[184:187], a[236:239], v[92:95]
s_waitcnt lgkmcnt(8)
ds_read_b64_tr_b16 v[180:181], v5 offset:40960
ds_read_b64_tr_b16 v[182:183], v5 offset:41472
v_mfma_f32_16x16x32_bf16 v[92:95], v[188:191], a[252:255], v[92:95]
buffer_load_dwordx4 a[152:155], v3, s[8:11], s36 offen offset:3072 sc1
v_mfma_f32_16x16x32_bf16 v[32:35], v[160:163], v[224:227], v[32:35]
s_waitcnt lgkmcnt(6)
v_accvgpr_read_b32 v144, a96
v_accvgpr_read_b32 v145, a97
v_mfma_f32_16x16x32_bf16 v[32:35], v[164:167], v[240:243], v[32:35]
s_add_u32 m0, s52, 86016
ds_read_b64_tr_b16 v[184:185], v4 offset:28672
ds_read_b64_tr_b16 v[186:187], v4 offset:29184
v_mfma_f32_16x16x32_bf16 v[32:35], v[168:171], v[192:195], v[32:35]
buffer_load_dwordx4 v8, s[28:31], s51 offen lds
v_accvgpr_read_b32 v146, a98
v_accvgpr_read_b32 v147, a99
v_accvgpr_read_b32 v148, a112
v_mfma_f32_16x16x32_bf16 v[36:39], v[160:163], v[228:231], v[36:39]
v_accvgpr_read_b32 v149, a113
v_accvgpr_read_b32 v150, a114
v_mfma_f32_16x16x32_bf16 v[36:39], v[164:167], v[244:247], v[36:39]
ds_read_b64_tr_b16 v[188:189], v4 offset:36864
ds_read_b64_tr_b16 v[190:191], v4 offset:37376
v_mfma_f32_16x16x32_bf16 v[36:39], v[168:171], v[196:199], v[36:39]
buffer_load_dwordx4 a[156:159], v3, s[8:11], s37 offen offset:3072 sc1
v_accvgpr_read_b32 v151, a115
v_mul_f32 v144, v144, v30
v_mul_f32 v145, v145, v30
v_mfma_f32_16x16x32_bf16 v[40:43], v[160:163], v[232:235], v[40:43]
s_add_u32 s51, s51, 294912
v_mul_f32 v146, v146, v30
v_mul_f32 v147, v147, v30
v_mfma_f32_16x16x32_bf16 v[40:43], v[164:167], v[248:251], v[40:43]
s_add_u32 m0, s52, 90112
v_mul_f32 v148, v148, v30
v_mul_f32 v149, v149, v30
v_mfma_f32_16x16x32_bf16 v[40:43], v[168:171], v[200:203], v[40:43]
buffer_load_dwordx4 v8, s[24:27], s51 offen lds
v_mul_f32 v150, v150, v30
v_mul_f32 v151, v151, v30
v_cvt_pk_bf16_f32 v128, v144, v145
v_mfma_f32_16x16x32_bf16 v[44:47], v[160:163], v[236:239], v[44:47]
s_waitcnt lgkmcnt(6)
v_cvt_pk_bf16_f32 v129, v146, v147
v_cvt_pk_bf16_f32 v130, v148, v149
v_mfma_f32_16x16x32_bf16 v[44:47], v[164:167], v[252:255], v[44:47]
s_add_u32 s34, s64, 12288
ds_read_b64_tr_b16 v[160:161], v4 offset:45056
ds_read_b64_tr_b16 v[162:163], v4 offset:45568
v_mfma_f32_16x16x32_bf16 v[44:47], v[168:171], v[204:207], v[44:47]
s_add_u32 s35, s64, 30720
v_cvt_pk_bf16_f32 v131, v150, v151
v_accvgpr_read_b32 v152, a100
v_accvgpr_read_b32 v153, a101
v_accvgpr_read_b32 v154, a102
v_accvgpr_read_b32 v155, a103
v_accvgpr_read_b32 v156, a116
v_mfma_f32_16x16x32_bf16 v[48:51], v[172:175], v[224:227], v[48:51]
s_add_u32 s36, s64, 49152
v_accvgpr_read_b32 v157, a117
v_accvgpr_read_b32 v158, a118
v_mfma_f32_16x16x32_bf16 v[48:51], v[176:179], v[240:243], v[48:51]
s_add_u32 m0, s52, 94208
s_add_u32 s37, s64, 67584
ds_read_b64_tr_b16 v[164:165], v5 offset:28672
ds_read_b64_tr_b16 v[166:167], v5 offset:29184
s_waitcnt lgkmcnt(8)
v_mfma_f32_16x16x32_bf16 v[48:51], v[180:183], v[192:195], v[48:51]
buffer_load_dwordx4 v8, s[28:31], s51 offen lds
v_accvgpr_read_b32 v159, a119
v_mul_f32 v152, v152, v31
v_mul_f32 v153, v153, v31
v_mfma_f32_16x16x32_bf16 v[52:55], v[172:175], v[228:231], v[52:55]
v_mul_f32 v154, v154, v31
v_mul_f32 v155, v155, v31
v_mfma_f32_16x16x32_bf16 v[52:55], v[176:179], v[244:247], v[52:55]
ds_read_b64_tr_b16 v[168:169], v5 offset:36864
ds_read_b64_tr_b16 v[170:171], v5 offset:37376
v_mfma_f32_16x16x32_bf16 v[52:55], v[180:183], v[196:199], v[52:55]
buffer_load_dwordx4 a[0:3], v3, s[8:11], s34 offen offset:0 sc1
v_mul_f32 v156, v156, v31
v_mul_f32 v157, v157, v31
v_mul_f32 v158, v158, v31
v_mfma_f32_16x16x32_bf16 v[56:59], v[172:175], v[232:235], v[56:59]
s_add_u32 s51, s51, 294912
v_mul_f32 v159, v159, v31
v_cvt_pk_bf16_f32 v132, v152, v153
v_mfma_f32_16x16x32_bf16 v[56:59], v[176:179], v[248:251], v[56:59]
s_add_u32 m0, s52, 98304
v_cvt_pk_bf16_f32 v133, v154, v155
v_cvt_pk_bf16_f32 v134, v156, v157
v_mfma_f32_16x16x32_bf16 v[56:59], v[180:183], v[200:203], v[56:59]
buffer_load_dwordx4 v8, s[24:27], s51 offen lds
v_cvt_pk_bf16_f32 v135, v158, v159
v_accvgpr_read_b32 v144, a104
v_accvgpr_read_b32 v145, a105
v_accvgpr_read_b32 v146, a106
v_mfma_f32_16x16x32_bf16 v[60:63], v[172:175], v[236:239], v[60:63]
v_accvgpr_read_b32 v147, a107
v_accvgpr_read_b32 v148, a120
v_mfma_f32_16x16x32_bf16 v[60:63], v[176:179], v[252:255], v[60:63]
s_waitcnt lgkmcnt(8)
ds_read_b64_tr_b16 v[172:173], v5 offset:45056
ds_read_b64_tr_b16 v[174:175], v5 offset:45568
v_mfma_f32_16x16x32_bf16 v[60:63], v[180:183], v[204:207], v[60:63]
buffer_load_dwordx4 a[4:7], v3, s[8:11], s35 offen offset:0 sc1
v_accvgpr_read_b32 v149, a121
v_accvgpr_read_b32 v150, a122
v_accvgpr_read_b32 v151, a123
v_mfma_f32_16x16x32_bf16 v[64:67], v[184:187], v[224:227], v[64:67]
s_waitcnt lgkmcnt(6)
v_mul_f32 v144, v144, v0
v_mul_f32 v145, v145, v0
v_mfma_f32_16x16x32_bf16 v[64:67], v[188:191], v[240:243], v[64:67]
s_add_u32 m0, s52, 102400
v_mul_f32 v146, v146, v0
v_mul_f32 v147, v147, v0
v_mfma_f32_16x16x32_bf16 v[64:67], v[160:163], v[192:195], v[64:67]
buffer_load_dwordx4 v8, s[28:31], s51 offen lds
v_mul_f32 v148, v148, v0
v_mul_f32 v149, v149, v0
v_mul_f32 v150, v150, v0
v_mfma_f32_16x16x32_bf16 v[68:71], v[184:187], v[228:231], v[68:71]
v_mul_f32 v151, v151, v0
v_cvt_pk_bf16_f32 v136, v144, v145
v_mfma_f32_16x16x32_bf16 v[68:71], v[188:191], v[244:247], v[68:71]
v_cvt_pk_bf16_f32 v137, v146, v147
v_cvt_pk_bf16_f32 v138, v148, v149
v_mfma_f32_16x16x32_bf16 v[68:71], v[160:163], v[196:199], v[68:71]
buffer_load_dwordx4 a[8:11], v3, s[8:11], s36 offen offset:0 sc1
v_cvt_pk_bf16_f32 v139, v150, v151
v_accvgpr_read_b32 v152, a108
v_accvgpr_read_b32 v153, a109
v_accvgpr_read_b32 v154, a110
v_mfma_f32_16x16x32_bf16 v[72:75], v[184:187], v[232:235], v[72:75]
s_add_u32 s51, s51, 294912
v_accvgpr_read_b32 v155, a111
v_accvgpr_read_b32 v156, a124
v_mfma_f32_16x16x32_bf16 v[72:75], v[188:191], v[248:251], v[72:75]
s_add_u32 m0, s52, 106496
v_accvgpr_read_b32 v157, a125
v_accvgpr_read_b32 v158, a126
v_mfma_f32_16x16x32_bf16 v[72:75], v[160:163], v[200:203], v[72:75]
buffer_load_dwordx4 v8, s[24:27], s51 offen lds
v_accvgpr_read_b32 v159, a127
v_mul_f32 v152, v152, v13
v_mul_f32 v153, v153, v13
v_mfma_f32_16x16x32_bf16 v[76:79], v[184:187], v[236:239], v[76:79]
s_waitcnt lgkmcnt(0)
v_mul_f32 v154, v154, v13
v_mul_f32 v155, v155, v13
v_mfma_f32_16x16x32_bf16 v[76:79], v[188:191], v[252:255], v[76:79]
s_waitcnt vmcnt(9)
s_barrier
v_mul_f32 v156, v156, v13
v_mul_f32 v157, v157, v13
v_mfma_f32_16x16x32_bf16 v[76:79], v[160:163], v[204:207], v[76:79]
buffer_load_dwordx4 a[12:15], v3, s[8:11], s37 offen offset:0 sc1
v_mul_f32 v158, v158, v13
v_mul_f32 v159, v159, v13
v_cvt_pk_bf16_f32 v140, v152, v153
v_mfma_f32_16x16x32_bf16 v[80:83], v[164:167], v[224:227], v[80:83]
ds_read_b64_tr_b16 v[176:177], v4 offset:49152
ds_read_b64_tr_b16 v[178:179], v4 offset:49664
v_mfma_f32_16x16x32_bf16 v[80:83], v[168:171], v[240:243], v[80:83]
ds_read_b64_tr_b16 v[180:181], v4 offset:57344
ds_read_b64_tr_b16 v[182:183], v4 offset:57856
v_mfma_f32_16x16x32_bf16 v[80:83], v[172:175], v[192:195], v[80:83]
ds_read_b64_tr_b16 v[184:185], v6 offset:0
ds_read_b64_tr_b16 v[186:187], v6 offset:512
v_cvt_pk_bf16_f32 v141, v154, v155
v_cvt_pk_bf16_f32 v142, v156, v157
v_cvt_pk_bf16_f32 v143, v158, v159
v_mfma_f32_16x16x32_bf16 v[84:87], v[164:167], v[228:231], v[84:87]
v_mfma_f32_16x16x32_bf16 v[84:87], v[168:171], v[244:247], v[84:87]
s_add_u32 m0, s52, 110592
ds_read_b64_tr_b16 v[188:189], v5 offset:49152
ds_read_b64_tr_b16 v[190:191], v5 offset:49664
v_mfma_f32_16x16x32_bf16 v[84:87], v[172:175], v[196:199], v[84:87]
buffer_load_dwordx4 v8, s[28:31], s51 offen lds
v_mfma_f32_16x16x32_bf16 v[88:91], v[164:167], v[232:235], v[88:91]
s_add_u32 s51, s51, 294912
v_mfma_f32_16x16x32_bf16 v[88:91], v[168:171], v[248:251], v[88:91]
s_add_u32 m0, s52, 114688
ds_read_b64_tr_b16 v[160:161], v5 offset:57344
ds_read_b64_tr_b16 v[162:163], v5 offset:57856
v_mfma_f32_16x16x32_bf16 v[88:91], v[172:175], v[200:203], v[88:91]
buffer_load_dwordx4 v8, s[24:27], s51 offen lds
v_accvgpr_read_b32 v144, a64
v_mfma_f32_16x16x32_bf16 v[92:95], v[164:167], v[236:239], v[92:95]
v_accvgpr_read_b32 v145, a65
v_accvgpr_read_b32 v146, a66
v_mfma_f32_16x16x32_bf16 v[92:95], v[168:171], v[252:255], v[92:95]
s_waitcnt lgkmcnt(8)
ds_read_b64_tr_b16 v[164:165], v7 offset:0
ds_read_b64_tr_b16 v[166:167], v7 offset:512
v_mfma_f32_16x16x32_bf16 v[92:95], v[172:175], v[204:207], v[92:95]
buffer_load_dwordx4 a[16:19], v3, s[8:11], s34 offen offset:1024 sc1
v_accvgpr_read_b32 v147, a67
v_accvgpr_read_b32 v148, a80
v_accvgpr_read_b32 v149, a81
v_accvgpr_read_b32 v150, a82
v_accvgpr_read_b32 v151, a83
v_mfma_f32_16x16x32_bf16 v[32:35], v[176:179], v[208:211], v[32:35]
s_waitcnt lgkmcnt(6)
v_mul_f32 v144, v144, v30
v_mul_f32 v145, v145, v30
v_mfma_f32_16x16x32_bf16 v[32:35], v[180:183], a[128:131], v[32:35]
s_add_u32 m0, s52, 118784
ds_read_b64_tr_b16 v[168:169], v4 offset:53248
ds_read_b64_tr_b16 v[170:171], v4 offset:53760
v_mfma_f32_16x16x32_bf16 v[32:35], v[184:187], a[144:147], v[32:35]
buffer_load_dwordx4 v8, s[28:31], s51 offen lds
v_mul_f32 v146, v146, v30
v_mul_f32 v147, v147, v30
v_mul_f32 v148, v148, v30
v_mul_f32 v149, v149, v30
v_mul_f32 v150, v150, v30
v_mul_f32 v151, v151, v30
v_mfma_f32_16x16x32_bf16 v[36:39], v[176:179], v[212:215], v[36:39]
s_add_u32 s51, s51, 294912
v_cvt_pk_bf16_f32 v14, v144, v145
v_cvt_pk_bf16_f32 v15, v146, v147
v_mfma_f32_16x16x32_bf16 v[36:39], v[180:183], a[132:135], v[36:39]
ds_read_b64_tr_b16 v[172:173], v4 offset:61440
ds_read_b64_tr_b16 v[174:175], v4 offset:61952
v_mfma_f32_16x16x32_bf16 v[36:39], v[184:187], a[148:151], v[36:39]
buffer_load_dwordx4 a[20:23], v3, s[8:11], s35 offen offset:1024 sc1
v_cvt_pk_bf16_f32 v16, v148, v149
v_cvt_pk_bf16_f32 v17, v150, v151
v_accvgpr_write_b32 a96, v14
v_accvgpr_write_b32 a97, v15
v_accvgpr_write_b32 a98, v16
v_mfma_f32_16x16x32_bf16 v[40:43], v[176:179], v[216:219], v[40:43]
v_xor_b32 v4, 64, v4
v_accvgpr_write_b32 a99, v17
v_mfma_f32_16x16x32_bf16 v[40:43], v[180:183], a[136:139], v[40:43]
v_accvgpr_read_b32 v152, a68
v_accvgpr_read_b32 v153, a69
v_mfma_f32_16x16x32_bf16 v[40:43], v[184:187], a[152:155], v[40:43]
buffer_load_dwordx4 a[24:27], v3, s[8:11], s36 offen offset:1024 sc1
v_accvgpr_read_b32 v154, a70
v_accvgpr_read_b32 v155, a71
v_accvgpr_read_b32 v156, a84
v_accvgpr_read_b32 v157, a85
v_accvgpr_read_b32 v158, a86
v_mfma_f32_16x16x32_bf16 v[44:47], v[176:179], v[220:223], v[44:47]
v_accvgpr_read_b32 v159, a87
v_mul_f32 v152, v152, v31
v_mfma_f32_16x16x32_bf16 v[44:47], v[180:183], a[140:143], v[44:47]
s_waitcnt vmcnt(15) lgkmcnt(8)
ds_read_b64_tr_b16 v[176:177], v6 offset:4096
ds_read_b64_tr_b16 v[178:179], v6 offset:4608
v_mfma_f32_16x16x32_bf16 v[44:47], v[184:187], a[156:159], v[44:47]
buffer_load_dwordx4 a[28:31], v3, s[8:11], s37 offen offset:1024 sc1
v_mul_f32 v153, v153, v31
v_mul_f32 v154, v154, v31
v_mul_f32 v155, v155, v31
v_mul_f32 v156, v156, v31
v_mul_f32 v157, v157, v31
v_mfma_f32_16x16x32_bf16 v[48:51], v[188:191], v[208:211], v[48:51]
s_waitcnt lgkmcnt(8)
v_mul_f32 v158, v158, v31
v_mul_f32 v159, v159, v31
v_mfma_f32_16x16x32_bf16 v[48:51], v[160:163], a[128:131], v[48:51]
s_waitcnt lgkmcnt(6)
ds_read_b64_tr_b16 v[180:181], v5 offset:53248
ds_read_b64_tr_b16 v[182:183], v5 offset:53760
v_mfma_f32_16x16x32_bf16 v[48:51], v[164:167], a[144:147], v[48:51]
buffer_load_dwordx4 a[32:35], v3, s[8:11], s34 offen offset:2048 sc1
v_cvt_pk_bf16_f32 v18, v152, v153
v_cvt_pk_bf16_f32 v19, v154, v155
v_cvt_pk_bf16_f32 v20, v156, v157
v_cvt_pk_bf16_f32 v21, v158, v159
v_accvgpr_write_b32 a100, v18
v_accvgpr_write_b32 a101, v19
v_mfma_f32_16x16x32_bf16 v[52:55], v[188:191], v[212:215], v[52:55]
v_accvgpr_write_b32 a102, v20
v_accvgpr_write_b32 a103, v21
v_mfma_f32_16x16x32_bf16 v[52:55], v[160:163], a[132:135], v[52:55]
ds_read_b64_tr_b16 v[184:185], v5 offset:61440
ds_read_b64_tr_b16 v[186:187], v5 offset:61952
v_mfma_f32_16x16x32_bf16 v[52:55], v[164:167], a[148:151], v[52:55]
buffer_load_dwordx4 a[36:39], v3, s[8:11], s35 offen offset:2048 sc1
v_accvgpr_read_b32 v144, a72
v_accvgpr_read_b32 v145, a73
v_accvgpr_read_b32 v146, a74
v_accvgpr_read_b32 v147, a75
v_accvgpr_read_b32 v148, a88
v_mfma_f32_16x16x32_bf16 v[56:59], v[188:191], v[216:219], v[56:59]
v_xor_b32 v5, 64, v5
v_accvgpr_read_b32 v149, a89
v_mfma_f32_16x16x32_bf16 v[56:59], v[160:163], a[136:139], v[56:59]
v_accvgpr_read_b32 v150, a90
v_accvgpr_read_b32 v151, a91
v_mfma_f32_16x16x32_bf16 v[56:59], v[164:167], a[152:155], v[56:59]
buffer_load_dwordx4 a[40:43], v3, s[8:11], s36 offen offset:2048 sc1
v_mul_f32 v144, v144, v0
v_mul_f32 v145, v145, v0
v_mul_f32 v146, v146, v0
v_mul_f32 v147, v147, v0
v_mul_f32 v148, v148, v0
v_mfma_f32_16x16x32_bf16 v[60:63], v[188:191], v[220:223], v[60:63]
v_mul_f32 v149, v149, v0
v_mul_f32 v150, v150, v0
v_mfma_f32_16x16x32_bf16 v[60:63], v[160:163], a[140:143], v[60:63]
s_waitcnt lgkmcnt(8)
ds_read_b64_tr_b16 v[188:189], v7 offset:4096
ds_read_b64_tr_b16 v[190:191], v7 offset:4608
v_mfma_f32_16x16x32_bf16 v[60:63], v[164:167], a[156:159], v[60:63]
buffer_load_dwordx4 a[44:47], v3, s[8:11], s37 offen offset:2048 sc1
v_mul_f32 v151, v151, v0
v_cvt_pk_bf16_f32 v14, v144, v145
v_cvt_pk_bf16_f32 v15, v146, v147
v_cvt_pk_bf16_f32 v16, v148, v149
v_cvt_pk_bf16_f32 v17, v150, v151
v_mfma_f32_16x16x32_bf16 v[64:67], v[168:171], v[208:211], v[64:67]
s_waitcnt lgkmcnt(8)
v_accvgpr_write_b32 a104, v14
v_accvgpr_write_b32 a105, v15
v_mfma_f32_16x16x32_bf16 v[64:67], v[172:175], a[128:131], v[64:67]
s_waitcnt lgkmcnt(6)
ds_read_b64_tr_b16 v[160:161], v6 offset:8192
ds_read_b64_tr_b16 v[162:163], v6 offset:8704
v_mfma_f32_16x16x32_bf16 v[64:67], v[176:179], a[144:147], v[64:67]
buffer_load_dwordx4 a[48:51], v3, s[8:11], s34 offen offset:3072 sc1
v_accvgpr_write_b32 a106, v16
v_accvgpr_write_b32 a107, v17
v_accvgpr_read_b32 v152, a76
v_accvgpr_read_b32 v153, a77
v_accvgpr_read_b32 v154, a78
v_mfma_f32_16x16x32_bf16 v[68:71], v[168:171], v[212:215], v[68:71]
v_accvgpr_read_b32 v155, a79
v_accvgpr_read_b32 v156, a92
v_mfma_f32_16x16x32_bf16 v[68:71], v[172:175], a[132:135], v[68:71]
ds_read_b64_tr_b16 v[164:165], v6 offset:16384
ds_read_b64_tr_b16 v[166:167], v6 offset:16896
v_mfma_f32_16x16x32_bf16 v[68:71], v[176:179], a[148:151], v[68:71]
buffer_load_dwordx4 a[52:55], v3, s[8:11], s35 offen offset:3072 sc1
v_accvgpr_read_b32 v157, a93
v_accvgpr_read_b32 v158, a94
v_accvgpr_read_b32 v159, a95
v_mul_f32 v152, v152, v13
v_mul_f32 v153, v153, v13
v_mul_f32 v154, v154, v13
v_mfma_f32_16x16x32_bf16 v[72:75], v[168:171], v[216:219], v[72:75]
v_mul_f32 v155, v155, v13
v_mul_f32 v156, v156, v13
v_mfma_f32_16x16x32_bf16 v[72:75], v[172:175], a[136:139], v[72:75]
v_mul_f32 v157, v157, v13
v_mul_f32 v158, v158, v13
v_mfma_f32_16x16x32_bf16 v[72:75], v[176:179], a[152:155], v[72:75]
buffer_load_dwordx4 a[56:59], v3, s[8:11], s36 offen offset:3072 sc1
v_mul_f32 v159, v159, v13
v_cvt_pk_bf16_f32 v18, v152, v153
v_cvt_pk_bf16_f32 v19, v154, v155
v_cvt_pk_bf16_f32 v20, v156, v157
v_cvt_pk_bf16_f32 v21, v158, v159
v_mfma_f32_16x16x32_bf16 v[76:79], v[168:171], v[220:223], v[76:79]
v_accvgpr_write_b32 a108, v18
v_accvgpr_write_b32 a109, v19
v_mfma_f32_16x16x32_bf16 v[76:79], v[172:175], a[140:143], v[76:79]
s_waitcnt lgkmcnt(8)
ds_read_b64_tr_b16 v[168:169], v7 offset:8192
ds_read_b64_tr_b16 v[170:171], v7 offset:8704
v_mfma_f32_16x16x32_bf16 v[76:79], v[176:179], a[156:159], v[76:79]
buffer_load_dwordx4 a[60:63], v3, s[8:11], s37 offen offset:3072 sc1
v_accvgpr_write_b32 a110, v20
v_accvgpr_write_b32 a111, v21
v_mfma_f32_16x16x32_bf16 v[80:83], v[180:183], v[208:211], v[80:83]
s_waitcnt lgkmcnt(8)
v_accvgpr_write_b32 a112, v128
v_accvgpr_write_b32 a113, v129
v_mfma_f32_16x16x32_bf16 v[80:83], v[184:187], a[128:131], v[80:83]
s_waitcnt lgkmcnt(6)
ds_read_b64_tr_b16 v[172:173], v7 offset:16384
ds_read_b64_tr_b16 v[174:175], v7 offset:16896
v_mfma_f32_16x16x32_bf16 v[80:83], v[188:191], a[144:147], v[80:83]
v_accvgpr_write_b32 a114, v130
v_accvgpr_write_b32 a115, v131
v_mfma_f32_16x16x32_bf16 v[84:87], v[180:183], v[212:215], v[84:87]
v_accvgpr_write_b32 a116, v132
v_accvgpr_write_b32 a117, v133
v_mfma_f32_16x16x32_bf16 v[84:87], v[184:187], a[132:135], v[84:87]
ds_read_b64_tr_b16 v[176:177], v6 offset:12288
ds_read_b64_tr_b16 v[178:179], v6 offset:12800
v_mfma_f32_16x16x32_bf16 v[84:87], v[188:191], a[148:151], v[84:87]
v_accvgpr_write_b32 a118, v134
v_accvgpr_write_b32 a119, v135
v_mfma_f32_16x16x32_bf16 v[88:91], v[180:183], v[216:219], v[88:91]
v_accvgpr_write_b32 a120, v136
v_accvgpr_write_b32 a121, v137
v_mfma_f32_16x16x32_bf16 v[88:91], v[184:187], a[136:139], v[88:91]
s_waitcnt vmcnt(21) lgkmcnt(8)
v_accvgpr_write_b32 a122, v138
v_accvgpr_write_b32 a123, v139
v_mfma_f32_16x16x32_bf16 v[88:91], v[188:191], a[152:155], v[88:91]
s_add_u32 s34, s64, 16384
v_accvgpr_write_b32 a124, v140
v_accvgpr_write_b32 a125, v141
v_mfma_f32_16x16x32_bf16 v[92:95], v[180:183], v[220:223], v[92:95]
s_add_u32 s35, s64, 34816
v_accvgpr_write_b32 a126, v142
v_accvgpr_write_b32 a127, v143
v_mfma_f32_16x16x32_bf16 v[92:95], v[184:187], a[140:143], v[92:95]
s_add_u32 s36, s64, 53248
ds_read_b64_tr_b16 v[180:181], v6 offset:20480
ds_read_b64_tr_b16 v[182:183], v6 offset:20992
v_mfma_f32_16x16x32_bf16 v[92:95], v[188:191], a[156:159], v[92:95]
s_add_u32 s37, s64, 71680
v_lshlrev_b32 v31, 2, v2
v_mfma_f32_16x16x32_bf16 v[32:35], v[160:163], a[0:3], v[32:35]
s_waitcnt vmcnt(12) lgkmcnt(8)
ds_read_b64_tr_b16 v[184:185], v7 offset:12288
ds_read_b64_tr_b16 v[186:187], v7 offset:12800
v_mfma_f32_16x16x32_bf16 v[32:35], v[164:167], a[16:19], v[32:35]
buffer_load_dwordx4 a[64:67], v3, s[8:11], s34 offen offset:0 sc1
v_mfma_f32_16x16x32_bf16 v[36:39], v[160:163], a[4:7], v[36:39]
s_waitcnt vmcnt(11)
ds_read_b64_tr_b16 v[188:189], v7 offset:20480
ds_read_b64_tr_b16 v[190:191], v7 offset:20992
v_mfma_f32_16x16x32_bf16 v[36:39], v[164:167], a[20:23], v[36:39]
buffer_load_dwordx4 a[68:71], v3, s[8:11], s35 offen offset:0 sc1
v_mfma_f32_16x16x32_bf16 v[40:43], v[160:163], a[8:11], v[40:43]
s_waitcnt vmcnt(11)
v_mfma_f32_16x16x32_bf16 v[40:43], v[164:167], a[24:27], v[40:43]
buffer_load_dwordx4 a[72:75], v3, s[8:11], s36 offen offset:0 sc1
v_mfma_f32_16x16x32_bf16 v[44:47], v[160:163], a[12:15], v[44:47]
s_waitcnt vmcnt(11) lgkmcnt(10)
v_mfma_f32_16x16x32_bf16 v[44:47], v[164:167], a[28:31], v[44:47]
buffer_load_dwordx4 a[76:79], v3, s[8:11], s37 offen offset:0 sc1
v_mfma_f32_16x16x32_bf16 v[48:51], v[168:171], a[0:3], v[48:51]
s_waitcnt lgkmcnt(8)
v_mfma_f32_16x16x32_bf16 v[48:51], v[172:175], a[16:19], v[48:51]
buffer_load_dwordx4 a[80:83], v3, s[8:11], s34 offen offset:1024 sc1
v_mfma_f32_16x16x32_bf16 v[52:55], v[168:171], a[4:7], v[52:55]
v_mfma_f32_16x16x32_bf16 v[52:55], v[172:175], a[20:23], v[52:55]
buffer_load_dwordx4 a[84:87], v3, s[8:11], s35 offen offset:1024 sc1
v_mfma_f32_16x16x32_bf16 v[56:59], v[168:171], a[8:11], v[56:59]
v_mfma_f32_16x16x32_bf16 v[56:59], v[172:175], a[24:27], v[56:59]
buffer_load_dwordx4 a[88:91], v3, s[8:11], s36 offen offset:1024 sc1
v_mfma_f32_16x16x32_bf16 v[60:63], v[168:171], a[12:15], v[60:63]
s_waitcnt lgkmcnt(6)
v_mfma_f32_16x16x32_bf16 v[60:63], v[172:175], a[28:31], v[60:63]
buffer_load_dwordx4 a[92:95], v3, s[8:11], s37 offen offset:1024 sc1
v_mfma_f32_16x16x32_bf16 v[64:67], v[176:179], a[0:3], v[64:67]
s_waitcnt lgkmcnt(4)
v_mfma_f32_16x16x32_bf16 v[64:67], v[180:183], a[16:19], v[64:67]
s_waitcnt lgkmcnt(0)
v_mfma_f32_16x16x32_bf16 v[68:71], v[176:179], a[4:7], v[68:71]
s_barrier
v_mfma_f32_16x16x32_bf16 v[68:71], v[180:183], a[20:23], v[68:71]
buffer_store_dwordx4 v[96:99], v3, s[8:11], s44 offen offset:0 sc1
v_mfma_f32_16x16x32_bf16 v[72:75], v[176:179], a[8:11], v[72:75]
ds_read_b64_tr_b16 v[160:161], v6 offset:24576
ds_read_b64_tr_b16 v[162:163], v6 offset:25088
v_mfma_f32_16x16x32_bf16 v[72:75], v[180:183], a[24:27], v[72:75]
ds_read_b64_tr_b16 v[164:165], v6 offset:32768
ds_read_b64_tr_b16 v[166:167], v6 offset:33280
v_mfma_f32_16x16x32_bf16 v[76:79], v[176:179], a[12:15], v[76:79]
ds_read_b64_tr_b16 v[168:169], v7 offset:24576
ds_read_b64_tr_b16 v[170:171], v7 offset:25088
v_mfma_f32_16x16x32_bf16 v[76:79], v[180:183], a[28:31], v[76:79]
v_mfma_f32_16x16x32_bf16 v[80:83], v[184:187], a[0:3], v[80:83]
ds_read_b64_tr_b16 v[172:173], v7 offset:32768
ds_read_b64_tr_b16 v[174:175], v7 offset:33280
v_mfma_f32_16x16x32_bf16 v[80:83], v[188:191], a[16:19], v[80:83]
v_mfma_f32_16x16x32_bf16 v[84:87], v[184:187], a[4:7], v[84:87]
ds_read_b64_tr_b16 v[176:177], v6 offset:28672
ds_read_b64_tr_b16 v[178:179], v6 offset:29184
v_mfma_f32_16x16x32_bf16 v[84:87], v[188:191], a[20:23], v[84:87]
buffer_store_dwordx4 v[100:103], v3, s[8:11], s45 offen offset:0 sc1
v_mfma_f32_16x16x32_bf16 v[88:91], v[184:187], a[8:11], v[88:91]
ds_read_b64_tr_b16 v[180:181], v6 offset:36864
ds_read_b64_tr_b16 v[182:183], v6 offset:37376
v_mfma_f32_16x16x32_bf16 v[88:91], v[188:191], a[24:27], v[88:91]
v_mfma_f32_16x16x32_bf16 v[92:95], v[184:187], a[12:15], v[92:95]
ds_read_b64_tr_b16 v[184:185], v7 offset:28672
ds_read_b64_tr_b16 v[186:187], v7 offset:29184
v_mfma_f32_16x16x32_bf16 v[92:95], v[188:191], a[28:31], v[92:95]
s_waitcnt vmcnt(17) lgkmcnt(12)
v_mfma_f32_16x16x32_bf16 v[32:35], v[160:163], a[32:35], v[32:35]
s_waitcnt vmcnt(13) lgkmcnt(10)
ds_read_b64_tr_b16 v[188:189], v7 offset:36864
ds_read_b64_tr_b16 v[190:191], v7 offset:37376
v_mfma_f32_16x16x32_bf16 v[32:35], v[164:167], a[48:51], v[32:35]
v_mfma_f32_16x16x32_bf16 v[36:39], v[160:163], a[36:39], v[36:39]
s_waitcnt vmcnt(12)
v_mfma_f32_16x16x32_bf16 v[36:39], v[164:167], a[52:55], v[36:39]
buffer_store_dwordx4 v[104:107], v3, s[8:11], s46 offen offset:0 sc1
v_mfma_f32_16x16x32_bf16 v[40:43], v[160:163], a[40:43], v[40:43]
s_waitcnt vmcnt(12)
v_mfma_f32_16x16x32_bf16 v[40:43], v[164:167], a[56:59], v[40:43]
v_mfma_f32_16x16x32_bf16 v[44:47], v[160:163], a[44:47], v[44:47]
s_waitcnt vmcnt(11)
ds_read_b64_tr_b16 v[160:161], v6 offset:40960
ds_read_b64_tr_b16 v[162:163], v6 offset:41472
v_mfma_f32_16x16x32_bf16 v[44:47], v[164:167], a[60:63], v[44:47]
s_waitcnt lgkmcnt(12)
v_mfma_f32_16x16x32_bf16 v[48:51], v[168:171], a[32:35], v[48:51]
s_waitcnt lgkmcnt(10)
ds_read_b64_tr_b16 v[164:165], v6 offset:49152
ds_read_b64_tr_b16 v[166:167], v6 offset:49664
v_mfma_f32_16x16x32_bf16 v[48:51], v[172:175], a[48:51], v[48:51]
v_mfma_f32_16x16x32_bf16 v[52:55], v[168:171], a[36:39], v[52:55]
v_mfma_f32_16x16x32_bf16 v[52:55], v[172:175], a[52:55], v[52:55]
buffer_store_dwordx4 v[108:111], v3, s[8:11], s47 offen offset:0 sc1
v_mfma_f32_16x16x32_bf16 v[56:59], v[168:171], a[40:43], v[56:59]
v_mfma_f32_16x16x32_bf16 v[56:59], v[172:175], a[56:59], v[56:59]
v_mfma_f32_16x16x32_bf16 v[60:63], v[168:171], a[44:47], v[60:63]
ds_read_b64_tr_b16 v[168:169], v7 offset:40960
ds_read_b64_tr_b16 v[170:171], v7 offset:41472
v_mfma_f32_16x16x32_bf16 v[60:63], v[172:175], a[60:63], v[60:63]
s_waitcnt lgkmcnt(12)
v_mfma_f32_16x16x32_bf16 v[64:67], v[176:179], a[32:35], v[64:67]
s_waitcnt lgkmcnt(10)
ds_read_b64_tr_b16 v[172:173], v7 offset:49152
ds_read_b64_tr_b16 v[174:175], v7 offset:49664
v_mfma_f32_16x16x32_bf16 v[64:67], v[180:183], a[48:51], v[64:67]
v_mfma_f32_16x16x32_bf16 v[68:71], v[176:179], a[36:39], v[68:71]
v_mfma_f32_16x16x32_bf16 v[68:71], v[180:183], a[52:55], v[68:71]
buffer_store_dwordx4 v[112:115], v3, s[8:11], s44 offen offset:1024 sc1
v_mfma_f32_16x16x32_bf16 v[72:75], v[176:179], a[40:43], v[72:75]
v_mfma_f32_16x16x32_bf16 v[72:75], v[180:183], a[56:59], v[72:75]
v_mfma_f32_16x16x32_bf16 v[76:79], v[176:179], a[44:47], v[76:79]
ds_read_b64_tr_b16 v[176:177], v6 offset:45056
ds_read_b64_tr_b16 v[178:179], v6 offset:45568
v_mfma_f32_16x16x32_bf16 v[76:79], v[180:183], a[60:63], v[76:79]
s_waitcnt lgkmcnt(12)
v_mfma_f32_16x16x32_bf16 v[80:83], v[184:187], a[32:35], v[80:83]
s_waitcnt lgkmcnt(10)
ds_read_b64_tr_b16 v[180:181], v6 offset:53248
ds_read_b64_tr_b16 v[182:183], v6 offset:53760
v_mfma_f32_16x16x32_bf16 v[80:83], v[188:191], a[48:51], v[80:83]
v_mfma_f32_16x16x32_bf16 v[84:87], v[184:187], a[36:39], v[84:87]
v_xor_b32 v6, 64, v6
v_mfma_f32_16x16x32_bf16 v[84:87], v[188:191], a[52:55], v[84:87]
buffer_store_dwordx4 v[116:119], v3, s[8:11], s45 offen offset:1024 sc1
v_mfma_f32_16x16x32_bf16 v[88:91], v[184:187], a[40:43], v[88:91]
v_mfma_f32_16x16x32_bf16 v[88:91], v[188:191], a[56:59], v[88:91]
v_mfma_f32_16x16x32_bf16 v[92:95], v[184:187], a[44:47], v[92:95]
ds_read_b64_tr_b16 v[184:185], v7 offset:45056
ds_read_b64_tr_b16 v[186:187], v7 offset:45568
v_mfma_f32_16x16x32_bf16 v[92:95], v[188:191], a[60:63], v[92:95]
s_waitcnt vmcnt(13) lgkmcnt(12)
v_mfma_f32_16x16x32_bf16 v[32:35], v[160:163], a[64:67], v[32:35]
s_waitcnt vmcnt(9) lgkmcnt(10)
ds_read_b64_tr_b16 v[188:189], v7 offset:53248
ds_read_b64_tr_b16 v[190:191], v7 offset:53760
v_mfma_f32_16x16x32_bf16 v[32:35], v[164:167], a[80:83], v[32:35]
v_mfma_f32_16x16x32_bf16 v[36:39], v[160:163], a[68:71], v[36:39]
s_waitcnt vmcnt(8)
v_xor_b32 v7, 64, v7
v_mfma_f32_16x16x32_bf16 v[36:39], v[164:167], a[84:87], v[36:39]
buffer_store_dwordx4 v[120:123], v3, s[8:11], s46 offen offset:1024 sc1
v_mfma_f32_16x16x32_bf16 v[40:43], v[160:163], a[72:75], v[40:43]
s_waitcnt vmcnt(8)
v_mfma_f32_16x16x32_bf16 v[40:43], v[164:167], a[88:91], v[40:43]
v_mfma_f32_16x16x32_bf16 v[44:47], v[160:163], a[76:79], v[44:47]
s_waitcnt vmcnt(7)
ds_read_b64_tr_b16 v[160:161], v28 offset:8192
ds_read_b64_tr_b16 v[162:163], v28 offset:8704
v_mfma_f32_16x16x32_bf16 v[44:47], v[164:167], a[92:95], v[44:47]
s_waitcnt lgkmcnt(12)
v_mfma_f32_16x16x32_bf16 v[48:51], v[168:171], a[64:67], v[48:51]
s_waitcnt lgkmcnt(10)
ds_read_b64_tr_b16 v[164:165], v28 offset:16384
ds_read_b64_tr_b16 v[166:167], v28 offset:16896
v_mfma_f32_16x16x32_bf16 v[48:51], v[172:175], a[80:83], v[48:51]
v_mfma_f32_16x16x32_bf16 v[52:55], v[168:171], a[68:71], v[52:55]
v_mfma_f32_16x16x32_bf16 v[52:55], v[172:175], a[84:87], v[52:55]
buffer_store_dwordx4 v[124:127], v3, s[8:11], s47 offen offset:1024 sc1
v_mfma_f32_16x16x32_bf16 v[56:59], v[168:171], a[72:75], v[56:59]
v_mfma_f32_16x16x32_bf16 v[56:59], v[172:175], a[88:91], v[56:59]
v_mfma_f32_16x16x32_bf16 v[60:63], v[168:171], a[76:79], v[60:63]
ds_read_b64_tr_b16 v[168:169], v28 offset:24576
ds_read_b64_tr_b16 v[170:171], v28 offset:25088
v_mfma_f32_16x16x32_bf16 v[60:63], v[172:175], a[92:95], v[60:63]
s_waitcnt lgkmcnt(12)
v_mfma_f32_16x16x32_bf16 v[64:67], v[176:179], a[64:67], v[64:67]
s_waitcnt lgkmcnt(10)
v_mfma_f32_16x16x32_bf16 v[64:67], v[180:183], a[80:83], v[64:67]
v_mfma_f32_16x16x32_bf16 v[68:71], v[176:179], a[68:71], v[68:71]
ds_read_b64_tr_b16 v[172:173], v29 offset:8192
ds_read_b64_tr_b16 v[174:175], v29 offset:8704
v_mfma_f32_16x16x32_bf16 v[68:71], v[180:183], a[84:87], v[68:71]
v_mfma_f32_16x16x32_bf16 v[72:75], v[176:179], a[72:75], v[72:75]
v_mfma_f32_16x16x32_bf16 v[72:75], v[180:183], a[88:91], v[72:75]
v_mfma_f32_16x16x32_bf16 v[76:79], v[176:179], a[76:79], v[76:79]
ds_read_b64_tr_b16 v[176:177], v29 offset:16384
ds_read_b64_tr_b16 v[178:179], v29 offset:16896
v_mfma_f32_16x16x32_bf16 v[76:79], v[180:183], a[92:95], v[76:79]
s_waitcnt lgkmcnt(12)
v_mfma_f32_16x16x32_bf16 v[80:83], v[184:187], a[64:67], v[80:83]
s_waitcnt lgkmcnt(10)
ds_read_b64_tr_b16 v[180:181], v29 offset:24576
ds_read_b64_tr_b16 v[182:183], v29 offset:25088
v_mfma_f32_16x16x32_bf16 v[80:83], v[188:191], a[80:83], v[80:83]
v_mfma_f32_16x16x32_bf16 v[84:87], v[184:187], a[68:71], v[84:87]
v_mfma_f32_16x16x32_bf16 v[84:87], v[188:191], a[84:87], v[84:87]
v_mfma_f32_16x16x32_bf16 v[88:91], v[184:187], a[72:75], v[88:91]
v_mfma_f32_16x16x32_bf16 v[88:91], v[188:191], a[88:91], v[88:91]
v_mfma_f32_16x16x32_bf16 v[92:95], v[184:187], a[76:79], v[92:95]
ds_read_b64_tr_b16 v[184:185], v28 offset:12288
ds_read_b64_tr_b16 v[186:187], v28 offset:12800
v_mfma_f32_16x16x32_bf16 v[92:95], v[188:191], a[92:95], v[92:95]
s_waitcnt lgkmcnt(12)
v_mfma_f32_16x16x32_bf16 v[96:99], v[160:163], a[160:163], 0
s_waitcnt lgkmcnt(10)
v_mfma_f32_16x16x32_bf16 v[96:99], v[164:167], a[176:179], v[96:99]
s_waitcnt lgkmcnt(8)
ds_read_b64_tr_b16 v[188:189], v28 offset:20480
ds_read_b64_tr_b16 v[190:191], v28 offset:20992
v_mfma_f32_16x16x32_bf16 v[96:99], v[168:171], a[192:195], v[96:99]
s_lshl_b32 s69, s2, 8
s_add_u32 s69, s69, 3145728
v_mfma_f32_16x16x32_bf16 v[100:103], v[160:163], a[164:167], 0
v_mfma_f32_16x16x32_bf16 v[100:103], v[164:167], a[180:183], v[100:103]
v_mul_f32 v14, s53, v32
v_mul_f32 v15, s53, v33
v_mfma_f32_16x16x32_bf16 v[100:103], v[168:171], a[196:199], v[100:103]
s_cmp_eq_u32 s3, 0
s_cselect_b32 s69, s69, 0x40000000
v_mul_f32 v16, s53, v34
v_mul_f32 v17, s53, v35
v_mfma_f32_16x16x32_bf16 v[104:107], v[160:163], a[168:171], 0
v_exp_f32 v14, v14
v_mfma_f32_16x16x32_bf16 v[104:107], v[164:167], a[184:187], v[104:107]
v_exp_f32 v15, v15
v_mfma_f32_16x16x32_bf16 v[104:107], v[168:171], a[200:203], v[104:107]
buffer_store_dwordx4 a[96:99], v3, s[8:11], s44 offen offset:2048 sc1
v_mfma_f32_16x16x32_bf16 v[108:111], v[160:163], a[172:175], 0
v_exp_f32 v16, v16
v_mfma_f32_16x16x32_bf16 v[108:111], v[164:167], a[188:191], v[108:111]
ds_read_b64_tr_b16 v[160:161], v28 offset:28672
ds_read_b64_tr_b16 v[162:163], v28 offset:29184
v_mfma_f32_16x16x32_bf16 v[108:111], v[168:171], a[204:207], v[108:111]
s_waitcnt lgkmcnt(10)
v_exp_f32 v17, v17
v_mfma_f32_16x16x32_bf16 v[112:115], v[172:175], a[160:163], 0
s_waitcnt lgkmcnt(8)
v_xor_b32 v28, 64, v28
v_mul_f32 v64, v32, v64
v_mfma_f32_16x16x32_bf16 v[112:115], v[176:179], a[176:179], v[112:115]
s_waitcnt lgkmcnt(6)
ds_read_b64_tr_b16 v[164:165], v29 offset:12288
ds_read_b64_tr_b16 v[166:167], v29 offset:12800
v_mfma_f32_16x16x32_bf16 v[112:115], v[180:183], a[192:195], v[112:115]
v_mul_f32 v65, v33, v65
v_mul_f32 v66, v34, v66
v_mfma_f32_16x16x32_bf16 v[116:119], v[172:175], a[164:167], 0
v_mul_f32 v67, v35, v67
v_add_f32 v14, 1.0, v14
v_mfma_f32_16x16x32_bf16 v[116:119], v[176:179], a[180:183], v[116:119]
ds_read_b64_tr_b16 v[168:169], v29 offset:20480
ds_read_b64_tr_b16 v[170:171], v29 offset:20992
v_mfma_f32_16x16x32_bf16 v[116:119], v[180:183], a[196:199], v[116:119]
v_add_f32 v15, 1.0, v15
v_add_f32 v16, 1.0, v16
v_mfma_f32_16x16x32_bf16 v[120:123], v[172:175], a[168:171], 0
v_add_f32 v17, 1.0, v17
v_mfma_f32_16x16x32_bf16 v[120:123], v[176:179], a[184:187], v[120:123]
v_rcp_f32 v14, v14
v_mfma_f32_16x16x32_bf16 v[120:123], v[180:183], a[200:203], v[120:123]
buffer_store_dwordx4 a[100:103], v3, s[8:11], s45 offen offset:2048 sc1
v_mfma_f32_16x16x32_bf16 v[124:127], v[172:175], a[172:175], 0
v_rcp_f32 v15, v15
v_mfma_f32_16x16x32_bf16 v[124:127], v[176:179], a[188:191], v[124:127]
ds_read_b64_tr_b16 v[172:173], v29 offset:28672
ds_read_b64_tr_b16 v[174:175], v29 offset:29184
v_mfma_f32_16x16x32_bf16 v[124:127], v[180:183], a[204:207], v[124:127]
s_waitcnt lgkmcnt(10)
v_rcp_f32 v16, v16
v_mfma_f32_16x16x32_bf16 v[128:131], v[184:187], a[160:163], 0
s_waitcnt lgkmcnt(8)
v_xor_b32 v29, 64, v29
v_mfma_f32_16x16x32_bf16 v[128:131], v[188:191], a[176:179], v[128:131]
s_waitcnt lgkmcnt(6)
ds_read_b64_tr_b16 v[176:177], v4 offset:0
ds_read_b64_tr_b16 v[178:179], v4 offset:512
v_mfma_f32_16x16x32_bf16 v[128:131], v[160:163], a[192:195], v[128:131]
v_rcp_f32 v17, v17
v_mfma_f32_16x16x32_bf16 v[132:135], v[184:187], a[164:167], 0
v_mul_f32 v64, v64, v14
v_mul_f32 v65, v65, v15
v_mfma_f32_16x16x32_bf16 v[132:135], v[188:191], a[180:183], v[132:135]
ds_read_b64_tr_b16 v[180:181], v4 offset:8192
ds_read_b64_tr_b16 v[182:183], v4 offset:8704
v_mfma_f32_16x16x32_bf16 v[132:135], v[160:163], a[196:199], v[132:135]
v_mul_f32 v66, v66, v16
v_mul_f32 v67, v67, v17
v_mfma_f32_16x16x32_bf16 v[136:139], v[184:187], a[168:171], 0
v_cvt_pk_bf16_f32 v32, v64, v65
v_cvt_pk_bf16_f32 v33, v66, v67
v_mfma_f32_16x16x32_bf16 v[136:139], v[188:191], a[184:187], v[136:139]
v_mul_f32 v18, s53, v48
v_mul_f32 v19, s53, v49
v_mfma_f32_16x16x32_bf16 v[136:139], v[160:163], a[200:203], v[136:139]
buffer_store_dwordx4 a[104:107], v3, s[8:11], s46 offen offset:2048 sc1
v_mfma_f32_16x16x32_bf16 v[140:143], v[184:187], a[172:175], 0
v_mul_f32 v20, s53, v50
v_mul_f32 v21, s53, v51
v_mfma_f32_16x16x32_bf16 v[140:143], v[188:191], a[188:191], v[140:143]
ds_read_b64_tr_b16 v[184:185], v4 offset:16384
ds_read_b64_tr_b16 v[186:187], v4 offset:16896
v_mfma_f32_16x16x32_bf16 v[140:143], v[160:163], a[204:207], v[140:143]
s_waitcnt lgkmcnt(10)
v_exp_f32 v18, v18
v_mfma_f32_16x16x32_bf16 v[144:147], v[164:167], a[160:163], 0
s_waitcnt lgkmcnt(8)
v_exp_f32 v19, v19
v_mfma_f32_16x16x32_bf16 v[144:147], v[168:171], a[176:179], v[144:147]
s_waitcnt lgkmcnt(6)
ds_read_b64_tr_b16 v[188:189], v5 offset:0
ds_read_b64_tr_b16 v[190:191], v5 offset:512
v_mfma_f32_16x16x32_bf16 v[144:147], v[172:175], a[192:195], v[144:147]
v_exp_f32 v20, v20
v_mfma_f32_16x16x32_bf16 v[148:151], v[164:167], a[164:167], 0
v_exp_f32 v21, v21
v_mfma_f32_16x16x32_bf16 v[148:151], v[168:171], a[180:183], v[148:151]
ds_read_b64_tr_b16 v[160:161], v5 offset:8192
ds_read_b64_tr_b16 v[162:163], v5 offset:8704
v_mfma_f32_16x16x32_bf16 v[148:151], v[172:175], a[196:199], v[148:151]
v_mul_f32 v80, v48, v80
v_mul_f32 v81, v49, v81
v_mul_f32 v82, v50, v82
v_mfma_f32_16x16x32_bf16 v[152:155], v[164:167], a[168:171], 0
v_mul_f32 v83, v51, v83
v_add_f32 v18, 1.0, v18
v_mfma_f32_16x16x32_bf16 v[152:155], v[168:171], a[184:187], v[152:155]
v_add_f32 v19, 1.0, v19
v_add_f32 v20, 1.0, v20
v_mfma_f32_16x16x32_bf16 v[152:155], v[172:175], a[200:203], v[152:155]
buffer_store_dwordx4 a[108:111], v3, s[8:11], s47 offen offset:2048 sc1
v_mfma_f32_16x16x32_bf16 v[156:159], v[164:167], a[172:175], 0
v_add_f32 v21, 1.0, v21
v_mfma_f32_16x16x32_bf16 v[156:159], v[168:171], a[188:191], v[156:159]
ds_read_b64_tr_b16 v[164:165], v5 offset:16384
ds_read_b64_tr_b16 v[166:167], v5 offset:16896
v_mfma_f32_16x16x32_bf16 v[156:159], v[172:175], a[204:207], v[156:159]
s_waitcnt lgkmcnt(10)
v_rcp_f32 v18, v18
v_mfma_f32_16x16x32_bf16 v[96:99], v[176:179], a[208:211], v[96:99]
s_waitcnt lgkmcnt(8)
v_rcp_f32 v19, v19
v_mfma_f32_16x16x32_bf16 v[96:99], v[180:183], a[224:227], v[96:99]
s_waitcnt lgkmcnt(6)
ds_read_b64_tr_b16 v[168:169], v4 offset:4096
ds_read_b64_tr_b16 v[170:171], v4 offset:4608
v_mfma_f32_16x16x32_bf16 v[96:99], v[184:187], a[240:243], v[96:99]
v_rcp_f32 v20, v20
v_mfma_f32_16x16x32_bf16 v[100:103], v[176:179], a[212:215], v[100:103]
v_rcp_f32 v21, v21
v_mfma_f32_16x16x32_bf16 v[100:103], v[180:183], a[228:231], v[100:103]
ds_read_b64_tr_b16 v[172:173], v4 offset:12288
ds_read_b64_tr_b16 v[174:175], v4 offset:12800
v_mfma_f32_16x16x32_bf16 v[100:103], v[184:187], a[244:247], v[100:103]
v_mul_f32 v80, v80, v18
v_mul_f32 v81, v81, v19
v_mfma_f32_16x16x32_bf16 v[104:107], v[176:179], a[216:219], v[104:107]
v_mul_f32 v82, v82, v20
v_mul_f32 v83, v83, v21
v_mfma_f32_16x16x32_bf16 v[104:107], v[180:183], a[232:235], v[104:107]
v_cvt_pk_bf16_f32 v34, v80, v81
v_cvt_pk_bf16_f32 v35, v82, v83
v_mfma_f32_16x16x32_bf16 v[104:107], v[184:187], a[248:251], v[104:107]
v_mul_f32 v14, s53, v36
v_mul_f32 v15, s53, v37
v_mfma_f32_16x16x32_bf16 v[108:111], v[176:179], a[220:223], v[108:111]
v_mul_f32 v16, s53, v38
v_mul_f32 v17, s53, v39
v_mfma_f32_16x16x32_bf16 v[108:111], v[180:183], a[236:239], v[108:111]
ds_read_b64_tr_b16 v[176:177], v4 offset:20480
ds_read_b64_tr_b16 v[178:179], v4 offset:20992
v_mfma_f32_16x16x32_bf16 v[108:111], v[184:187], a[252:255], v[108:111]
s_waitcnt lgkmcnt(10)
v_exp_f32 v14, v14
v_mfma_f32_16x16x32_bf16 v[112:115], v[188:191], a[208:211], v[112:115]
s_waitcnt lgkmcnt(8)
v_exp_f32 v15, v15
v_mfma_f32_16x16x32_bf16 v[112:115], v[160:163], a[224:227], v[112:115]
s_waitcnt lgkmcnt(6)
ds_read_b64_tr_b16 v[180:181], v5 offset:4096
ds_read_b64_tr_b16 v[182:183], v5 offset:4608
v_mfma_f32_16x16x32_bf16 v[112:115], v[164:167], a[240:243], v[112:115]
v_exp_f32 v16, v16
v_mfma_f32_16x16x32_bf16 v[116:119], v[188:191], a[212:215], v[116:119]
v_exp_f32 v17, v17
v_mfma_f32_16x16x32_bf16 v[116:119], v[160:163], a[228:231], v[116:119]
ds_read_b64_tr_b16 v[184:185], v5 offset:12288
ds_read_b64_tr_b16 v[186:187], v5 offset:12800
v_mfma_f32_16x16x32_bf16 v[116:119], v[164:167], a[244:247], v[116:119]
v_mul_f32 v68, v36, v68
v_mul_f32 v69, v37, v69
v_mul_f32 v70, v38, v70
v_mfma_f32_16x16x32_bf16 v[120:123], v[188:191], a[216:219], v[120:123]
v_mul_f32 v71, v39, v71
v_add_f32 v14, 1.0, v14
v_mfma_f32_16x16x32_bf16 v[120:123], v[160:163], a[232:235], v[120:123]
v_add_f32 v15, 1.0, v15
v_add_f32 v16, 1.0, v16
v_mfma_f32_16x16x32_bf16 v[120:123], v[164:167], a[248:251], v[120:123]
v_add_f32 v17, 1.0, v17
v_mfma_f32_16x16x32_bf16 v[124:127], v[188:191], a[220:223], v[124:127]
v_rcp_f32 v14, v14
v_mfma_f32_16x16x32_bf16 v[124:127], v[160:163], a[236:239], v[124:127]
ds_read_b64_tr_b16 v[188:189], v5 offset:20480
ds_read_b64_tr_b16 v[190:191], v5 offset:20992
v_mfma_f32_16x16x32_bf16 v[124:127], v[164:167], a[252:255], v[124:127]
s_waitcnt lgkmcnt(10)
v_rcp_f32 v15, v15
v_mfma_f32_16x16x32_bf16 v[128:131], v[168:171], a[208:211], v[128:131]
s_waitcnt lgkmcnt(8)
v_rcp_f32 v16, v16
v_mfma_f32_16x16x32_bf16 v[128:131], v[172:175], a[224:227], v[128:131]
s_waitcnt lgkmcnt(6)
ds_read_b64_tr_b16 v[160:161], v4 offset:24576
ds_read_b64_tr_b16 v[162:163], v4 offset:25088
v_mfma_f32_16x16x32_bf16 v[128:131], v[176:179], a[240:243], v[128:131]
v_rcp_f32 v17, v17
v_mfma_f32_16x16x32_bf16 v[132:135], v[168:171], a[212:215], v[132:135]
v_mul_f32 v68, v68, v14
v_mul_f32 v69, v69, v15
v_mfma_f32_16x16x32_bf16 v[132:135], v[172:175], a[228:231], v[132:135]
ds_read_b64_tr_b16 v[164:165], v4 offset:32768
ds_read_b64_tr_b16 v[166:167], v4 offset:33280
v_mfma_f32_16x16x32_bf16 v[132:135], v[176:179], a[244:247], v[132:135]
v_mul_f32 v70, v70, v16
v_mul_f32 v71, v71, v17
v_mfma_f32_16x16x32_bf16 v[136:139], v[168:171], a[216:219], v[136:139]
v_cvt_pk_bf16_f32 v36, v68, v69
v_cvt_pk_bf16_f32 v37, v70, v71
v_mfma_f32_16x16x32_bf16 v[136:139], v[172:175], a[232:235], v[136:139]
v_mul_f32 v18, s53, v52
v_mul_f32 v19, s53, v53
v_mfma_f32_16x16x32_bf16 v[136:139], v[176:179], a[248:251], v[136:139]
v_mul_f32 v20, s53, v54
v_mul_f32 v21, s53, v55
v_mfma_f32_16x16x32_bf16 v[140:143], v[168:171], a[220:223], v[140:143]
v_exp_f32 v18, v18
v_mfma_f32_16x16x32_bf16 v[140:143], v[172:175], a[236:239], v[140:143]
ds_read_b64_tr_b16 v[168:169], v4 offset:40960
ds_read_b64_tr_b16 v[170:171], v4 offset:41472
v_mfma_f32_16x16x32_bf16 v[140:143], v[176:179], a[252:255], v[140:143]
s_waitcnt lgkmcnt(10)
v_exp_f32 v19, v19
v_mfma_f32_16x16x32_bf16 v[144:147], v[180:183], a[208:211], v[144:147]
s_waitcnt lgkmcnt(8)
v_exp_f32 v20, v20
v_mfma_f32_16x16x32_bf16 v[144:147], v[184:187], a[224:227], v[144:147]
s_waitcnt lgkmcnt(6)
ds_read_b64_tr_b16 v[172:173], v5 offset:24576
ds_read_b64_tr_b16 v[174:175], v5 offset:25088
v_mfma_f32_16x16x32_bf16 v[144:147], v[188:191], a[240:243], v[144:147]
v_exp_f32 v21, v21
v_mfma_f32_16x16x32_bf16 v[148:151], v[180:183], a[212:215], v[148:151]
s_barrier
v_mul_f32 v84, v52, v84
v_mul_f32 v85, v53, v85
v_mfma_f32_16x16x32_bf16 v[148:151], v[184:187], a[228:231], v[148:151]
ds_read_b64_tr_b16 v[176:177], v5 offset:32768
ds_read_b64_tr_b16 v[178:179], v5 offset:33280
v_mfma_f32_16x16x32_bf16 v[148:151], v[188:191], a[244:247], v[148:151]
v_mul_f32 v86, v54, v86
v_mul_f32 v87, v55, v87
v_mfma_f32_16x16x32_bf16 v[152:155], v[180:183], a[216:219], v[152:155]
s_add_u32 s51, s54, 128
v_add_f32 v18, 1.0, v18
v_add_f32 v19, 1.0, v19
v_mfma_f32_16x16x32_bf16 v[152:155], v[184:187], a[232:235], v[152:155]
s_add_u32 m0, s52, 139264
v_add_f32 v20, 1.0, v20
v_add_f32 v21, 1.0, v21
v_mfma_f32_16x16x32_bf16 v[152:155], v[188:191], a[248:251], v[152:155]
buffer_load_dwordx4 v8, s[24:27], s51 offen lds
v_mfma_f32_16x16x32_bf16 v[156:159], v[180:183], a[220:223], v[156:159]
v_rcp_f32 v18, v18
v_mfma_f32_16x16x32_bf16 v[156:159], v[184:187], a[236:239], v[156:159]
ds_read_b64_tr_b16 v[180:181], v5 offset:40960
ds_read_b64_tr_b16 v[182:183], v5 offset:41472
v_mfma_f32_16x16x32_bf16 v[156:159], v[188:191], a[252:255], v[156:159]
s_waitcnt lgkmcnt(10)
v_rcp_f32 v19, v19
v_mfma_f32_16x16x32_bf16 v[96:99], v[160:163], v[224:227], v[96:99]
s_waitcnt lgkmcnt(6)
v_rcp_f32 v20, v20
v_mfma_f32_16x16x32_bf16 v[96:99], v[164:167], v[240:243], v[96:99]
s_add_u32 m0, s52, 143360
ds_read_b64_tr_b16 v[184:185], v4 offset:28672
ds_read_b64_tr_b16 v[186:187], v4 offset:29184
v_mfma_f32_16x16x32_bf16 v[96:99], v[168:171], v[192:195], v[96:99]
buffer_load_dwordx4 v8, s[28:31], s51 offen lds
v_mfma_f32_16x16x32_bf16 v[100:103], v[160:163], v[228:231], v[100:103]
v_rcp_f32 v21, v21
v_mfma_f32_16x16x32_bf16 v[100:103], v[164:167], v[244:247], v[100:103]
ds_read_b64_tr_b16 v[188:189], v4 offset:36864
ds_read_b64_tr_b16 v[190:191], v4 offset:37376
v_mfma_f32_16x16x32_bf16 v[100:103], v[168:171], v[196:199], v[100:103]
v_mul_f32 v84, v84, v18
v_mul_f32 v85, v85, v19
v_mul_f32 v86, v86, v20
v_mfma_f32_16x16x32_bf16 v[104:107], v[160:163], v[232:235], v[104:107]
s_add_u32 s51, s51, 294912
v_mul_f32 v87, v87, v21
v_cvt_pk_bf16_f32 v38, v84, v85
v_mfma_f32_16x16x32_bf16 v[104:107], v[164:167], v[248:251], v[104:107]
s_add_u32 m0, s52, 147456
v_cvt_pk_bf16_f32 v39, v86, v87
v_mul_f32 v14, s53, v40
v_mfma_f32_16x16x32_bf16 v[104:107], v[168:171], v[200:203], v[104:107]
buffer_load_dwordx4 v8, s[24:27], s51 offen lds
v_mfma_f32_16x16x32_bf16 v[108:111], v[160:163], v[236:239], v[108:111]
v_mul_f32 v15, s53, v41
v_mul_f32 v16, s53, v42
v_mfma_f32_16x16x32_bf16 v[108:111], v[164:167], v[252:255], v[108:111]
ds_read_b64_tr_b16 v[160:161], v4 offset:45056
ds_read_b64_tr_b16 v[162:163], v4 offset:45568
v_mfma_f32_16x16x32_bf16 v[108:111], v[168:171], v[204:207], v[108:111]
s_waitcnt lgkmcnt(10)
v_mul_f32 v17, s53, v43
v_mfma_f32_16x16x32_bf16 v[112:115], v[172:175], v[224:227], v[112:115]
s_waitcnt lgkmcnt(6)
v_exp_f32 v14, v14
v_mfma_f32_16x16x32_bf16 v[112:115], v[176:179], v[240:243], v[112:115]
s_add_u32 m0, s52, 151552
ds_read_b64_tr_b16 v[164:165], v5 offset:28672
ds_read_b64_tr_b16 v[166:167], v5 offset:29184
v_mfma_f32_16x16x32_bf16 v[112:115], v[180:183], v[192:195], v[112:115]
buffer_load_dwordx4 v8, s[28:31], s51 offen lds
v_mfma_f32_16x16x32_bf16 v[116:119], v[172:175], v[228:231], v[116:119]
v_exp_f32 v15, v15
v_mfma_f32_16x16x32_bf16 v[116:119], v[176:179], v[244:247], v[116:119]
ds_read_b64_tr_b16 v[168:169], v5 offset:36864
ds_read_b64_tr_b16 v[170:171], v5 offset:37376
v_mfma_f32_16x16x32_bf16 v[116:119], v[180:183], v[196:199], v[116:119]
v_exp_f32 v16, v16
v_mfma_f32_16x16x32_bf16 v[120:123], v[172:175], v[232:235], v[120:123]
v_exp_f32 v17, v17
v_mfma_f32_16x16x32_bf16 v[120:123], v[176:179], v[248:251], v[120:123]
v_mul_f32 v72, v40, v72
v_mul_f32 v73, v41, v73
v_mfma_f32_16x16x32_bf16 v[120:123], v[180:183], v[200:203], v[120:123]
s_waitcnt lgkmcnt(8)
v_mul_f32 v74, v42, v74
v_mul_f32 v75, v43, v75
v_mfma_f32_16x16x32_bf16 v[124:127], v[172:175], v[236:239], v[124:127]
s_add_u32 s51, s51, 294912
v_add_f32 v14, 1.0, v14
v_add_f32 v15, 1.0, v15
v_mfma_f32_16x16x32_bf16 v[124:127], v[176:179], v[252:255], v[124:127]
s_add_u32 m0, s52, 155648
ds_read_b64_tr_b16 v[172:173], v5 offset:45056
ds_read_b64_tr_b16 v[174:175], v5 offset:45568
v_mfma_f32_16x16x32_bf16 v[124:127], v[180:183], v[204:207], v[124:127]
buffer_load_dwordx4 v8, s[24:27], s51 offen lds
v_mfma_f32_16x16x32_bf16 v[128:131], v[184:187], v[224:227], v[128:131]
s_waitcnt lgkmcnt(8)
v_add_f32 v16, 1.0, v16
v_add_f32 v17, 1.0, v17
v_mfma_f32_16x16x32_bf16 v[128:131], v[188:191], v[240:243], v[128:131]
s_waitcnt lgkmcnt(6)
ds_read_b64_tr_b16 v[176:177], v4 offset:49152
ds_read_b64_tr_b16 v[178:179], v4 offset:49664
v_mfma_f32_16x16x32_bf16 v[128:131], v[160:163], v[192:195], v[128:131]
v_rcp_f32 v14, v14
v_mfma_f32_16x16x32_bf16 v[132:135], v[184:187], v[228:231], v[132:135]
v_rcp_f32 v15, v15
v_mfma_f32_16x16x32_bf16 v[132:135], v[188:191], v[244:247], v[132:135]
s_add_u32 m0, s52, 159744
ds_read_b64_tr_b16 v[180:181], v4 offset:57344
ds_read_b64_tr_b16 v[182:183], v4 offset:57856
v_mfma_f32_16x16x32_bf16 v[132:135], v[160:163], v[196:199], v[132:135]
buffer_load_dwordx4 v8, s[28:31], s51 offen lds
v_mfma_f32_16x16x32_bf16 v[136:139], v[184:187], v[232:235], v[136:139]
v_rcp_f32 v16, v16
v_mfma_f32_16x16x32_bf16 v[136:139], v[188:191], v[248:251], v[136:139]
v_rcp_f32 v17, v17
v_mfma_f32_16x16x32_bf16 v[136:139], v[160:163], v[200:203], v[136:139]
s_waitcnt lgkmcnt(8)
v_mul_f32 v72, v72, v14
v_mul_f32 v73, v73, v15
v_mul_f32 v74, v74, v16
v_mfma_f32_16x16x32_bf16 v[140:143], v[184:187], v[236:239], v[140:143]
s_add_u32 s51, s51, 294912
v_mul_f32 v75, v75, v17
v_cvt_pk_bf16_f32 v40, v72, v73
v_mfma_f32_16x16x32_bf16 v[140:143], v[188:191], v[252:255], v[140:143]
s_add_u32 m0, s52, 0
ds_read_b64_tr_b16 v[184:185], v6 offset:0
ds_read_b64_tr_b16 v[186:187], v6 offset:512
v_mfma_f32_16x16x32_bf16 v[140:143], v[160:163], v[204:207], v[140:143]
buffer_load_dwordx4 v8, s[24:27], s51 offen lds
v_mfma_f32_16x16x32_bf16 v[144:147], v[164:167], v[224:227], v[144:147]
s_waitcnt lgkmcnt(8)
v_cvt_pk_bf16_f32 v41, v74, v75
v_mul_f32 v18, s53, v56
v_mfma_f32_16x16x32_bf16 v[144:147], v[168:171], v[240:243], v[144:147]
s_waitcnt lgkmcnt(6)
ds_read_b64_tr_b16 v[188:189], v5 offset:49152
ds_read_b64_tr_b16 v[190:191], v5 offset:49664
v_mfma_f32_16x16x32_bf16 v[144:147], v[172:175], v[192:195], v[144:147]
v_mul_f32 v19, s53, v57
v_mul_f32 v20, s53, v58
v_mfma_f32_16x16x32_bf16 v[148:151], v[164:167], v[228:231], v[148:151]
v_mul_f32 v21, s53, v59
v_mfma_f32_16x16x32_bf16 v[148:151], v[168:171], v[244:247], v[148:151]
s_add_u32 m0, s52, 4096
ds_read_b64_tr_b16 v[160:161], v5 offset:57344
ds_read_b64_tr_b16 v[162:163], v5 offset:57856
v_mfma_f32_16x16x32_bf16 v[148:151], v[172:175], v[196:199], v[148:151]
buffer_load_dwordx4 v8, s[28:31], s51 offen lds
v_mfma_f32_16x16x32_bf16 v[152:155], v[164:167], v[232:235], v[152:155]
v_exp_f32 v18, v18
v_mfma_f32_16x16x32_bf16 v[152:155], v[168:171], v[248:251], v[152:155]
v_exp_f32 v19, v19
v_mfma_f32_16x16x32_bf16 v[152:155], v[172:175], v[200:203], v[152:155]
s_waitcnt lgkmcnt(8)
v_exp_f32 v20, v20
v_mfma_f32_16x16x32_bf16 v[156:159], v[164:167], v[236:239], v[156:159]
s_add_u32 s51, s51, 294912
v_exp_f32 v21, v21
v_mfma_f32_16x16x32_bf16 v[156:159], v[168:171], v[252:255], v[156:159]
s_add_u32 m0, s52, 8192
ds_read_b64_tr_b16 v[164:165], v7 offset:0
ds_read_b64_tr_b16 v[166:167], v7 offset:512
v_mfma_f32_16x16x32_bf16 v[156:159], v[172:175], v[204:207], v[156:159]
buffer_load_dwordx4 v8, s[24:27], s51 offen lds
v_mfma_f32_16x16x32_bf16 v[96:99], v[176:179], v[208:211], v[96:99]
s_waitcnt lgkmcnt(8)
v_mul_f32 v88, v56, v88
v_mul_f32 v89, v57, v89
v_mfma_f32_16x16x32_bf16 v[96:99], v[180:183], a[128:131], v[96:99]
s_waitcnt lgkmcnt(6)
ds_read_b64_tr_b16 v[168:169], v4 offset:53248
ds_read_b64_tr_b16 v[170:171], v4 offset:53760
v_mfma_f32_16x16x32_bf16 v[96:99], v[184:187], a[144:147], v[96:99]
v_mul_f32 v90, v58, v90
v_mul_f32 v91, v59, v91
v_mfma_f32_16x16x32_bf16 v[100:103], v[176:179], v[212:215], v[100:103]
v_add_f32 v18, 1.0, v18
v_add_f32 v19, 1.0, v19
v_mfma_f32_16x16x32_bf16 v[100:103], v[180:183], a[132:135], v[100:103]
s_add_u32 m0, s52, 12288
ds_read_b64_tr_b16 v[172:173], v4 offset:61440
ds_read_b64_tr_b16 v[174:175], v4 offset:61952
v_mfma_f32_16x16x32_bf16 v[100:103], v[184:187], a[148:151], v[100:103]
buffer_load_dwordx4 v8, s[28:31], s51 offen lds
v_mfma_f32_16x16x32_bf16 v[104:107], v[176:179], v[216:219], v[104:107]
v_xor_b32 v4, 64, v4
v_add_f32 v20, 1.0, v20
v_mfma_f32_16x16x32_bf16 v[104:107], v[180:183], a[136:139], v[104:107]
v_add_f32 v21, 1.0, v21
v_mfma_f32_16x16x32_bf16 v[104:107], v[184:187], a[152:155], v[104:107]
v_rcp_f32 v18, v18
v_mfma_f32_16x16x32_bf16 v[108:111], v[176:179], v[220:223], v[108:111]
v_rcp_f32 v19, v19
v_mfma_f32_16x16x32_bf16 v[108:111], v[180:183], a[140:143], v[108:111]
ds_read_b64_tr_b16 v[176:177], v6 offset:4096
ds_read_b64_tr_b16 v[178:179], v6 offset:4608
v_mfma_f32_16x16x32_bf16 v[108:111], v[184:187], a[156:159], v[108:111]
s_waitcnt lgkmcnt(6)
v_rcp_f32 v20, v20
v_mfma_f32_16x16x32_bf16 v[112:115], v[188:191], v[208:211], v[112:115]
s_add_u32 s51, s51, 294912
v_rcp_f32 v21, v21
v_mfma_f32_16x16x32_bf16 v[112:115], v[160:163], a[128:131], v[112:115]
s_add_u32 m0, s52, 16384
ds_read_b64_tr_b16 v[180:181], v5 offset:53248
ds_read_b64_tr_b16 v[182:183], v5 offset:53760
v_mfma_f32_16x16x32_bf16 v[112:115], v[164:167], a[144:147], v[112:115]
buffer_load_dwordx4 v8, s[24:27], s51 offen lds
v_mul_f32 v88, v88, v18
v_mfma_f32_16x16x32_bf16 v[116:119], v[188:191], v[212:215], v[116:119]
v_mul_f32 v89, v89, v19
v_mul_f32 v90, v90, v20
v_mfma_f32_16x16x32_bf16 v[116:119], v[160:163], a[132:135], v[116:119]
ds_read_b64_tr_b16 v[184:185], v5 offset:61440
ds_read_b64_tr_b16 v[186:187], v5 offset:61952
v_mfma_f32_16x16x32_bf16 v[116:119], v[164:167], a[148:151], v[116:119]
v_mul_f32 v91, v91, v21
v_cvt_pk_bf16_f32 v42, v88, v89
v_mfma_f32_16x16x32_bf16 v[120:123], v[188:191], v[216:219], v[120:123]
v_xor_b32 v5, 64, v5
v_cvt_pk_bf16_f32 v43, v90, v91
v_mfma_f32_16x16x32_bf16 v[120:123], v[160:163], a[136:139], v[120:123]
s_add_u32 m0, s52, 20480
v_mul_f32 v14, s53, v44
v_mul_f32 v15, s53, v45
v_mfma_f32_16x16x32_bf16 v[120:123], v[164:167], a[152:155], v[120:123]
buffer_load_dwordx4 v8, s[28:31], s51 offen lds
v_mfma_f32_16x16x32_bf16 v[124:127], v[188:191], v[220:223], v[124:127]
s_add_u32 s51, s51, 294912
v_mul_f32 v16, s53, v46
v_mul_f32 v17, s53, v47
v_mfma_f32_16x16x32_bf16 v[124:127], v[160:163], a[140:143], v[124:127]
ds_read_b64_tr_b16 v[188:189], v7 offset:4096
ds_read_b64_tr_b16 v[190:191], v7 offset:4608
v_mfma_f32_16x16x32_bf16 v[124:127], v[164:167], a[156:159], v[124:127]
s_waitcnt lgkmcnt(10)
v_exp_f32 v14, v14
v_mfma_f32_16x16x32_bf16 v[128:131], v[168:171], v[208:211], v[128:131]
s_waitcnt lgkmcnt(8)
v_exp_f32 v15, v15
v_mfma_f32_16x16x32_bf16 v[128:131], v[172:175], a[128:131], v[128:131]
s_waitcnt lgkmcnt(6)
ds_read_b64_tr_b16 v[160:161], v6 offset:8192
ds_read_b64_tr_b16 v[162:163], v6 offset:8704
v_mfma_f32_16x16x32_bf16 v[128:131], v[176:179], a[144:147], v[128:131]
v_exp_f32 v16, v16
v_mfma_f32_16x16x32_bf16 v[132:135], v[168:171], v[212:215], v[132:135]
v_exp_f32 v17, v17
v_mfma_f32_16x16x32_bf16 v[132:135], v[172:175], a[132:135], v[132:135]
ds_read_b64_tr_b16 v[164:165], v6 offset:16384
ds_read_b64_tr_b16 v[166:167], v6 offset:16896
v_mfma_f32_16x16x32_bf16 v[132:135], v[176:179], a[148:151], v[132:135]
v_mul_f32 v76, v44, v76
v_mul_f32 v77, v45, v77
v_mfma_f32_16x16x32_bf16 v[136:139], v[168:171], v[216:219], v[136:139]
v_mul_f32 v78, v46, v78
v_mul_f32 v79, v47, v79
v_mfma_f32_16x16x32_bf16 v[136:139], v[172:175], a[136:139], v[136:139]
v_add_f32 v14, 1.0, v14
v_add_f32 v15, 1.0, v15
v_mfma_f32_16x16x32_bf16 v[136:139], v[176:179], a[152:155], v[136:139]
v_add_f32 v16, 1.0, v16
v_add_f32 v17, 1.0, v17
v_mfma_f32_16x16x32_bf16 v[140:143], v[168:171], v[220:223], v[140:143]
v_rcp_f32 v14, v14
v_mfma_f32_16x16x32_bf16 v[140:143], v[172:175], a[140:143], v[140:143]
ds_read_b64_tr_b16 v[168:169], v6 offset:24576
ds_read_b64_tr_b16 v[170:171], v6 offset:25088
v_mfma_f32_16x16x32_bf16 v[140:143], v[176:179], a[156:159], v[140:143]
s_waitcnt lgkmcnt(10)
v_rcp_f32 v15, v15
v_mfma_f32_16x16x32_bf16 v[144:147], v[180:183], v[208:211], v[144:147]
s_waitcnt lgkmcnt(8)
v_rcp_f32 v16, v16
v_mfma_f32_16x16x32_bf16 v[144:147], v[184:187], a[128:131], v[144:147]
s_waitcnt lgkmcnt(6)
ds_read_b64_tr_b16 v[172:173], v7 offset:8192
ds_read_b64_tr_b16 v[174:175], v7 offset:8704
v_mfma_f32_16x16x32_bf16 v[144:147], v[188:191], a[144:147], v[144:147]
v_rcp_f32 v17, v17
v_mfma_f32_16x16x32_bf16 v[148:151], v[180:183], v[212:215], v[148:151]
s_barrier
v_mul_f32 v76, v76, v14
v_mul_f32 v77, v77, v15
v_mfma_f32_16x16x32_bf16 v[148:151], v[184:187], a[132:135], v[148:151]
ds_read_b64_tr_b16 v[176:177], v7 offset:16384
ds_read_b64_tr_b16 v[178:179], v7 offset:16896
v_mfma_f32_16x16x32_bf16 v[148:151], v[188:191], a[148:151], v[148:151]
v_mul_f32 v78, v78, v16
v_mul_f32 v79, v79, v17
v_mfma_f32_16x16x32_bf16 v[152:155], v[180:183], v[216:219], v[152:155]
v_cvt_pk_bf16_f32 v44, v76, v77
v_cvt_pk_bf16_f32 v45, v78, v79
v_mfma_f32_16x16x32_bf16 v[152:155], v[184:187], a[136:139], v[152:155]
s_add_u32 m0, s52, 24576
v_mul_f32 v18, s53, v60
v_mul_f32 v19, s53, v61
v_mfma_f32_16x16x32_bf16 v[152:155], v[188:191], a[152:155], v[152:155]
buffer_load_dwordx4 v8, s[24:27], s51 offen lds
v_mul_f32 v20, s53, v62
v_mfma_f32_16x16x32_bf16 v[156:159], v[180:183], v[220:223], v[156:159]
v_mul_f32 v21, s53, v63
v_mfma_f32_16x16x32_bf16 v[156:159], v[184:187], a[140:143], v[156:159]
ds_read_b64_tr_b16 v[180:181], v7 offset:24576
ds_read_b64_tr_b16 v[182:183], v7 offset:25088
v_mfma_f32_16x16x32_bf16 v[156:159], v[188:191], a[156:159], v[156:159]
s_waitcnt lgkmcnt(10)
v_exp_f32 v18, v18
v_mfma_f32_16x16x32_bf16 v[96:99], v[160:163], a[0:3], v[96:99]
s_waitcnt lgkmcnt(6)
v_exp_f32 v19, v19
v_mfma_f32_16x16x32_bf16 v[96:99], v[164:167], a[16:19], v[96:99]
s_add_u32 m0, s52, 28672
ds_read_b64_tr_b16 v[184:185], v6 offset:12288
ds_read_b64_tr_b16 v[186:187], v6 offset:12800
v_mfma_f32_16x16x32_bf16 v[96:99], v[168:171], a[32:35], v[96:99]
buffer_load_dwordx4 v8, s[28:31], s51 offen lds
v_mfma_f32_16x16x32_bf16 v[100:103], v[160:163], a[4:7], v[100:103]
v_exp_f32 v20, v20
v_mfma_f32_16x16x32_bf16 v[100:103], v[164:167], a[20:23], v[100:103]
ds_read_b64_tr_b16 v[188:189], v6 offset:20480
ds_read_b64_tr_b16 v[190:191], v6 offset:20992
v_mfma_f32_16x16x32_bf16 v[100:103], v[168:171], a[36:39], v[100:103]
v_exp_f32 v21, v21
v_mfma_f32_16x16x32_bf16 v[104:107], v[160:163], a[8:11], v[104:107]
s_add_u32 s51, s51, 294912
v_mul_f32 v92, v60, v92
v_mul_f32 v93, v61, v93
v_mfma_f32_16x16x32_bf16 v[104:107], v[164:167], a[24:27], v[104:107]
s_add_u32 m0, s52, 32768
v_mul_f32 v94, v62, v94
v_mul_f32 v95, v63, v95
v_mfma_f32_16x16x32_bf16 v[104:107], v[168:171], a[40:43], v[104:107]
buffer_load_dwordx4 v8, s[24:27], s51 offen lds
v_mfma_f32_16x16x32_bf16 v[108:111], v[160:163], a[12:15], v[108:111]
v_add_f32 v18, 1.0, v18
v_add_f32 v19, 1.0, v19
v_mfma_f32_16x16x32_bf16 v[108:111], v[164:167], a[28:31], v[108:111]
ds_read_b64_tr_b16 v[160:161], v6 offset:28672
ds_read_b64_tr_b16 v[162:163], v6 offset:29184
v_mfma_f32_16x16x32_bf16 v[108:111], v[168:171], a[44:47], v[108:111]
s_waitcnt lgkmcnt(10)
v_add_f32 v20, 1.0, v20
v_add_f32 v21, 1.0, v21
v_mfma_f32_16x16x32_bf16 v[112:115], v[172:175], a[0:3], v[112:115]
s_waitcnt lgkmcnt(6)
v_rcp_f32 v18, v18
v_mfma_f32_16x16x32_bf16 v[112:115], v[176:179], a[16:19], v[112:115]
s_add_u32 m0, s52, 36864
ds_read_b64_tr_b16 v[164:165], v7 offset:12288
ds_read_b64_tr_b16 v[166:167], v7 offset:12800
v_mfma_f32_16x16x32_bf16 v[112:115], v[180:183], a[32:35], v[112:115]
buffer_load_dwordx4 v8, s[28:31], s51 offen lds
v_mfma_f32_16x16x32_bf16 v[116:119], v[172:175], a[4:7], v[116:119]
v_rcp_f32 v19, v19
v_mfma_f32_16x16x32_bf16 v[116:119], v[176:179], a[20:23], v[116:119]
ds_read_b64_tr_b16 v[168:169], v7 offset:20480
ds_read_b64_tr_b16 v[170:171], v7 offset:20992
v_mfma_f32_16x16x32_bf16 v[116:119], v[180:183], a[36:39], v[116:119]
v_rcp_f32 v20, v20
v_mfma_f32_16x16x32_bf16 v[120:123], v[172:175], a[8:11], v[120:123]
v_rcp_f32 v21, v21
v_mfma_f32_16x16x32_bf16 v[120:123], v[176:179], a[24:27], v[120:123]
v_mul_f32 v92, v92, v18
v_mul_f32 v93, v93, v19
v_mfma_f32_16x16x32_bf16 v[120:123], v[180:183], a[40:43], v[120:123]
s_waitcnt lgkmcnt(8)
v_mul_f32 v94, v94, v20
v_mul_f32 v95, v95, v21
v_mfma_f32_16x16x32_bf16 v[124:127], v[172:175], a[12:15], v[124:127]
s_add_u32 s51, s51, 294912
v_cvt_pk_bf16_f32 v46, v92, v93
v_cvt_pk_bf16_f32 v47, v94, v95
v_mfma_f32_16x16x32_bf16 v[124:127], v[176:179], a[28:31], v[124:127]
s_add_u32 m0, s52, 40960
ds_read_b64_tr_b16 v[172:173], v7 offset:28672
ds_read_b64_tr_b16 v[174:175], v7 offset:29184
v_mfma_f32_16x16x32_bf16 v[124:127], v[180:183], a[44:47], v[124:127]
buffer_load_dwordx4 v8, s[24:27], s51 offen lds
v_mfma_f32_16x16x32_bf16 v[128:131], v[184:187], a[0:3], v[128:131]
s_waitcnt lgkmcnt(8)
v_lshrrev_b32 v22, 4, v2
v_and_b32 v23, 15, v2
v_mfma_f32_16x16x32_bf16 v[128:131], v[188:191], a[16:19], v[128:131]
s_waitcnt lgkmcnt(6)
ds_read_b64_tr_b16 v[176:177], v6 offset:32768
ds_read_b64_tr_b16 v[178:179], v6 offset:33280
v_mfma_f32_16x16x32_bf16 v[128:131], v[160:163], a[32:35], v[128:131]
buffer_store_dwordx4 v[32:35], v3, s[8:11], s56 offen sc1
v_mfma_f32_16x16x32_bf16 v[132:135], v[184:187], a[4:7], v[132:135]
s_add_u32 s56, s56, 16384
v_lshrrev_b32 v24, 2, v23
v_and_b32 v25, 3, v2
v_mfma_f32_16x16x32_bf16 v[132:135], v[188:191], a[20:23], v[132:135]
s_add_u32 m0, s52, 45056
ds_read_b64_tr_b16 v[180:181], v6 offset:40960
ds_read_b64_tr_b16 v[182:183], v6 offset:41472
v_mfma_f32_16x16x32_bf16 v[132:135], v[160:163], a[36:39], v[132:135]
buffer_load_dwordx4 v8, s[28:31], s51 offen lds
v_mfma_f32_16x16x32_bf16 v[136:139], v[184:187], a[8:11], v[136:139]
s_waitcnt lgkmcnt(8)
v_and_b32 v26, 1, v22
v_mfma_f32_16x16x32_bf16 v[136:139], v[188:191], a[24:27], v[136:139]
s_and_b32 s61, s32, 1
v_mfma_f32_16x16x32_bf16 v[136:139], v[160:163], a[40:43], v[136:139]
s_lshl_b32 s62, s61, 4
v_mfma_f32_16x16x32_bf16 v[140:143], v[184:187], a[12:15], v[140:143]
s_add_u32 s51, s51, 294912
s_lshl_b32 s63, s61, 9
v_lshl_add_u32 v27, v22, 3, v24
v_lshlrev_b32 v27, 6, v27
v_mfma_f32_16x16x32_bf16 v[140:143], v[188:191], a[28:31], v[140:143]
s_add_u32 m0, s52, 49152
ds_read_b64_tr_b16 v[184:185], v6 offset:49152
ds_read_b64_tr_b16 v[186:187], v6 offset:49664
v_mfma_f32_16x16x32_bf16 v[140:143], v[160:163], a[44:47], v[140:143]
buffer_load_dwordx4 v8, s[24:27], s51 offen lds
v_mfma_f32_16x16x32_bf16 v[144:147], v[164:167], a[0:3], v[144:147]
s_waitcnt lgkmcnt(8)
v_xor_b32 v10, v26, v25
v_and_b32 v10, 1, v10
v_mfma_f32_16x16x32_bf16 v[144:147], v[168:171], a[16:19], v[144:147]
s_waitcnt lgkmcnt(6)
ds_read_b64_tr_b16 v[188:189], v7 offset:32768
ds_read_b64_tr_b16 v[190:191], v7 offset:33280
v_mfma_f32_16x16x32_bf16 v[144:147], v[172:175], a[32:35], v[144:147]
buffer_store_dwordx4 v[36:39], v3, s[8:11], s57 offen sc1
v_mfma_f32_16x16x32_bf16 v[148:151], v[164:167], a[4:7], v[148:151]
s_add_u32 s57, s57, 16384
v_lshl_add_u32 v27, v10, 5, v27
v_lshrrev_b32 v10, 1, v25
v_mfma_f32_16x16x32_bf16 v[148:151], v[168:171], a[20:23], v[148:151]
s_add_u32 m0, s52, 53248
ds_read_b64_tr_b16 v[160:161], v7 offset:40960
ds_read_b64_tr_b16 v[162:163], v7 offset:41472
v_mfma_f32_16x16x32_bf16 v[148:151], v[172:175], a[36:39], v[148:151]
buffer_load_dwordx4 v8, s[28:31], s51 offen lds
v_mfma_f32_16x16x32_bf16 v[152:155], v[164:167], a[8:11], v[152:155]
v_lshl_add_u32 v27, v10, 3, v27
v_add_u32 v10, s62, v27
v_mfma_f32_16x16x32_bf16 v[152:155], v[168:171], a[24:27], v[152:155]
v_add_u32 v11, 0x20000, v10
v_mul_u32_u24 v12, 279552, v26
v_mfma_f32_16x16x32_bf16 v[152:155], v[172:175], a[40:43], v[152:155]
s_waitcnt lgkmcnt(8)
v_lshl_add_u32 v12, v23, 4, v12
v_lshrrev_b32 v27, 1, v22
v_mfma_f32_16x16x32_bf16 v[156:159], v[164:167], a[12:15], v[156:159]
s_add_u32 s51, s51, 294912
v_lshl_add_u32 v12, v27, 8, v12
v_add_u32 v12, s63, v12
v_mfma_f32_16x16x32_bf16 v[156:159], v[168:171], a[28:31], v[156:159]
s_add_u32 m0, s52, 57344
s_lshl_b32 s60, s3, 4
ds_read_b64_tr_b16 v[164:165], v7 offset:49152
ds_read_b64_tr_b16 v[166:167], v7 offset:49664
v_mfma_f32_16x16x32_bf16 v[156:159], v[172:175], a[44:47], v[156:159]
buffer_load_dwordx4 v8, s[24:27], s51 offen lds
v_mfma_f32_16x16x32_bf16 v[96:99], v[176:179], a[48:51], v[96:99]
s_waitcnt lgkmcnt(8)
v_lshrrev_b32 v26, 2, v2
v_add_u32 v26, s60, v26
v_mfma_f32_16x16x32_bf16 v[96:99], v[180:183], a[64:67], v[96:99]
s_waitcnt lgkmcnt(6)
ds_read_b64_tr_b16 v[168:169], v6 offset:36864
ds_read_b64_tr_b16 v[170:171], v6 offset:37376
v_mfma_f32_16x16x32_bf16 v[96:99], v[184:187], a[80:83], v[96:99]
buffer_store_dwordx4 v[40:43], v3, s[8:11], s58 offen sc1
v_mfma_f32_16x16x32_bf16 v[100:103], v[176:179], a[52:55], v[100:103]
s_add_u32 s58, s58, 16384
v_mul_u32_u24 v26, 9216, v26
v_lshlrev_b32 v27, 1, v27
v_mfma_f32_16x16x32_bf16 v[100:103], v[180:183], a[68:71], v[100:103]
s_add_u32 m0, s52, 61440
ds_read_b64_tr_b16 v[172:173], v6 offset:45056
ds_read_b64_tr_b16 v[174:175], v6 offset:45568
v_mfma_f32_16x16x32_bf16 v[100:103], v[184:187], a[84:87], v[100:103]
buffer_load_dwordx4 v8, s[28:31], s51 offen lds
v_mfma_f32_16x16x32_bf16 v[104:107], v[176:179], a[56:59], v[104:107]
v_xor_b32 v27, v27, v25
v_lshl_add_u32 v9, v27, 4, v26
v_mfma_f32_16x16x32_bf16 v[104:107], v[180:183], a[72:75], v[104:107]
v_mfma_f32_16x16x32_bf16 v[104:107], v[184:187], a[88:91], v[104:107]
v_mfma_f32_16x16x32_bf16 v[108:111], v[176:179], a[60:63], v[108:111]
v_mfma_f32_16x16x32_bf16 v[108:111], v[180:183], a[76:79], v[108:111]
ds_read_b64_tr_b16 v[176:177], v6 offset:53248
ds_read_b64_tr_b16 v[178:179], v6 offset:53760
v_mfma_f32_16x16x32_bf16 v[108:111], v[184:187], a[92:95], v[108:111]
s_waitcnt lgkmcnt(6)
v_mfma_f32_16x16x32_bf16 v[112:115], v[188:191], a[48:51], v[112:115]
s_add_u32 s51, s51, 294912
v_xor_b32 v6, 64, v6
v_mfma_f32_16x16x32_bf16 v[112:115], v[160:163], a[64:67], v[112:115]
s_add_u32 m0, s52, 65536
ds_read_b64_tr_b16 v[180:181], v7 offset:36864
ds_read_b64_tr_b16 v[182:183], v7 offset:37376
v_mfma_f32_16x16x32_bf16 v[112:115], v[164:167], a[80:83], v[112:115]
buffer_load_dwordx4 v8, s[24:27], s51 offen lds
v_mfma_f32_16x16x32_bf16 v[116:119], v[188:191], a[52:55], v[116:119]
v_mfma_f32_16x16x32_bf16 v[116:119], v[160:163], a[68:71], v[116:119]
ds_read_b64_tr_b16 v[184:185], v7 offset:45056
ds_read_b64_tr_b16 v[186:187], v7 offset:45568
v_mfma_f32_16x16x32_bf16 v[116:119], v[164:167], a[84:87], v[116:119]
buffer_store_dwordx4 v[44:47], v3, s[8:11], s59 offen sc1
v_mfma_f32_16x16x32_bf16 v[120:123], v[188:191], a[56:59], v[120:123]
s_add_u32 s59, s59, 16384
v_mfma_f32_16x16x32_bf16 v[120:123], v[160:163], a[72:75], v[120:123]
s_add_u32 m0, s52, 69632
v_mfma_f32_16x16x32_bf16 v[120:123], v[164:167], a[88:91], v[120:123]
buffer_load_dwordx4 v8, s[28:31], s51 offen lds
v_mfma_f32_16x16x32_bf16 v[124:127], v[188:191], a[60:63], v[124:127]
s_add_u32 s51, s51, 294912
v_mfma_f32_16x16x32_bf16 v[124:127], v[160:163], a[76:79], v[124:127]
ds_read_b64_tr_b16 v[188:189], v7 offset:53248
ds_read_b64_tr_b16 v[190:191], v7 offset:53760
v_mfma_f32_16x16x32_bf16 v[124:127], v[164:167], a[92:95], v[124:127]
s_waitcnt lgkmcnt(10)
v_mfma_f32_16x16x32_bf16 v[128:131], v[168:171], a[48:51], v[128:131]
s_waitcnt lgkmcnt(8)
v_xor_b32 v7, 64, v7
v_mfma_f32_16x16x32_bf16 v[128:131], v[172:175], a[64:67], v[128:131]
s_waitcnt lgkmcnt(6)
v_mfma_f32_16x16x32_bf16 v[128:131], v[176:179], a[80:83], v[128:131]
v_mfma_f32_16x16x32_bf16 v[132:135], v[168:171], a[52:55], v[132:135]
v_mfma_f32_16x16x32_bf16 v[132:135], v[172:175], a[68:71], v[132:135]
v_mfma_f32_16x16x32_bf16 v[132:135], v[176:179], a[84:87], v[132:135]
v_mfma_f32_16x16x32_bf16 v[136:139], v[168:171], a[56:59], v[136:139]
v_mfma_f32_16x16x32_bf16 v[136:139], v[172:175], a[72:75], v[136:139]
v_mfma_f32_16x16x32_bf16 v[136:139], v[176:179], a[88:91], v[136:139]
v_mfma_f32_16x16x32_bf16 v[140:143], v[168:171], a[60:63], v[140:143]
s_waitcnt lgkmcnt(0)
v_mfma_f32_16x16x32_bf16 v[140:143], v[172:175], a[76:79], v[140:143]
s_waitcnt vmcnt(16)
s_barrier
v_mfma_f32_16x16x32_bf16 v[140:143], v[176:179], a[92:95], v[140:143]
v_mfma_f32_16x16x32_bf16 v[144:147], v[180:183], a[48:51], v[144:147]
ds_read_b64_tr_b16 v[160:161], v28 offset:8192
ds_read_b64_tr_b16 v[162:163], v28 offset:8704
v_mfma_f32_16x16x32_bf16 v[144:147], v[184:187], a[64:67], v[144:147]
ds_read_b64_tr_b16 v[164:165], v28 offset:16384
ds_read_b64_tr_b16 v[166:167], v28 offset:16896
v_mfma_f32_16x16x32_bf16 v[144:147], v[188:191], a[80:83], v[144:147]
ds_read_b64_tr_b16 v[168:169], v28 offset:24576
ds_read_b64_tr_b16 v[170:171], v28 offset:25088
v_mfma_f32_16x16x32_bf16 v[148:151], v[180:183], a[52:55], v[148:151]
v_mfma_f32_16x16x32_bf16 v[148:151], v[184:187], a[68:71], v[148:151]
ds_read_b64_tr_b16 v[172:173], v29 offset:8192
ds_read_b64_tr_b16 v[174:175], v29 offset:8704
v_mfma_f32_16x16x32_bf16 v[148:151], v[188:191], a[84:87], v[148:151]
v_mfma_f32_16x16x32_bf16 v[152:155], v[180:183], a[56:59], v[152:155]
v_mfma_f32_16x16x32_bf16 v[152:155], v[184:187], a[72:75], v[152:155]
s_add_u32 m0, s52, 73728
ds_read_b64_tr_b16 v[176:177], v29 offset:16384
ds_read_b64_tr_b16 v[178:179], v29 offset:16896
v_mfma_f32_16x16x32_bf16 v[152:155], v[188:191], a[88:91], v[152:155]
buffer_load_dwordx4 v8, s[24:27], s51 offen lds
v_mfma_f32_16x16x32_bf16 v[156:159], v[180:183], a[60:63], v[156:159]
v_mfma_f32_16x16x32_bf16 v[156:159], v[184:187], a[76:79], v[156:159]
ds_read_b64_tr_b16 v[180:181], v29 offset:24576
ds_read_b64_tr_b16 v[182:183], v29 offset:25088
v_mfma_f32_16x16x32_bf16 v[156:159], v[188:191], a[92:95], v[156:159]
s_waitcnt lgkmcnt(10)
v_mfma_f32_16x16x32_bf16 v[32:35], v[160:163], a[160:163], 0
s_waitcnt lgkmcnt(6)
v_mfma_f32_16x16x32_bf16 v[32:35], v[164:167], a[176:179], v[32:35]
s_add_u32 m0, s52, 77824
ds_read_b64_tr_b16 v[184:185], v28 offset:12288
ds_read_b64_tr_b16 v[186:187], v28 offset:12800
v_mfma_f32_16x16x32_bf16 v[32:35], v[168:171], a[192:195], v[32:35]
buffer_load_dwordx4 v8, s[28:31], s51 offen lds
v_mfma_f32_16x16x32_bf16 v[36:39], v[160:163], a[164:167], 0
v_mfma_f32_16x16x32_bf16 v[36:39], v[164:167], a[180:183], v[36:39]
ds_read_b64_tr_b16 v[188:189], v28 offset:20480
ds_read_b64_tr_b16 v[190:191], v28 offset:20992
v_mfma_f32_16x16x32_bf16 v[36:39], v[168:171], a[196:199], v[36:39]
v_mul_f32 v14, s53, v96
v_mul_f32 v15, s53, v97
v_mfma_f32_16x16x32_bf16 v[40:43], v[160:163], a[168:171], 0
v_mul_f32 v16, s53, v98
v_mul_f32 v17, s53, v99
v_mfma_f32_16x16x32_bf16 v[40:43], v[164:167], a[184:187], v[40:43]
v_exp_f32 v14, v14
v_mfma_f32_16x16x32_bf16 v[40:43], v[168:171], a[200:203], v[40:43]
s_waitcnt lgkmcnt(8)
v_exp_f32 v15, v15
v_mfma_f32_16x16x32_bf16 v[44:47], v[160:163], a[172:175], 0
s_add_u32 s51, s51, 294912
v_exp_f32 v16, v16
v_mfma_f32_16x16x32_bf16 v[44:47], v[164:167], a[188:191], v[44:47]
s_add_u32 m0, s52, 81920
ds_read_b64_tr_b16 v[160:161], v28 offset:28672
ds_read_b64_tr_b16 v[162:163], v28 offset:29184
v_mfma_f32_16x16x32_bf16 v[44:47], v[168:171], a[204:207], v[44:47]
buffer_load_dwordx4 v8, s[24:27], s51 offen lds
v_mfma_f32_16x16x32_bf16 v[48:51], v[172:175], a[160:163], 0
s_waitcnt lgkmcnt(8)
v_xor_b32 v28, 64, v28
v_mfma_f32_16x16x32_bf16 v[48:51], v[176:179], a[176:179], v[48:51]
s_waitcnt lgkmcnt(6)
ds_read_b64_tr_b16 v[164:165], v29 offset:12288
ds_read_b64_tr_b16 v[166:167], v29 offset:12800
v_mfma_f32_16x16x32_bf16 v[48:51], v[180:183], a[192:195], v[48:51]
v_exp_f32 v17, v17
v_mfma_f32_16x16x32_bf16 v[52:55], v[172:175], a[164:167], 0
v_mul_f32 v128, v96, v128
v_mul_f32 v129, v97, v129
v_mfma_f32_16x16x32_bf16 v[52:55], v[176:179], a[180:183], v[52:55]
ds_read_b64_tr_b16 v[168:169], v29 offset:20480
ds_read_b64_tr_b16 v[170:171], v29 offset:20992
v_mfma_f32_16x16x32_bf16 v[52:55], v[180:183], a[196:199], v[52:55]
v_mul_f32 v130, v98, v130
v_mul_f32 v131, v99, v131
v_mfma_f32_16x16x32_bf16 v[56:59], v[172:175], a[168:171], 0
s_waitcnt lgkmcnt(6)
v_add_f32 v14, 1.0, v14
v_add_f32 v15, 1.0, v15
v_mfma_f32_16x16x32_bf16 v[56:59], v[176:179], a[184:187], v[56:59]
s_add_u32 m0, s52, 86016
v_add_f32 v16, 1.0, v16
v_add_f32 v17, 1.0, v17
v_mfma_f32_16x16x32_bf16 v[56:59], v[180:183], a[200:203], v[56:59]
buffer_load_dwordx4 v8, s[28:31], s51 offen lds
v_mfma_f32_16x16x32_bf16 v[60:63], v[172:175], a[172:175], 0
s_mov_b32 s36, 3276800
v_rcp_f32 v14, v14
v_mfma_f32_16x16x32_bf16 v[60:63], v[176:179], a[188:191], v[60:63]
s_add_u32 s37, s73, 1
ds_read_b64_tr_b16 v[172:173], v29 offset:28672
ds_read_b64_tr_b16 v[174:175], v29 offset:29184
v_mfma_f32_16x16x32_bf16 v[60:63], v[180:183], a[204:207], v[60:63]
buffer_load_dwordx2 v[22:23], off, s[8:11], s36 sc1
v_mfma_f32_16x16x32_bf16 v[64:67], v[184:187], a[160:163], 0
s_add_u32 s51, s51, 294912
v_xor_b32 v29, 64, v29
v_mfma_f32_16x16x32_bf16 v[64:67], v[188:191], a[176:179], v[64:67]
s_add_u32 m0, s52, 90112
ds_read_b64_tr_b16 v[176:177], v4 offset:0
ds_read_b64_tr_b16 v[178:179], v4 offset:512
s_waitcnt lgkmcnt(8)
v_mfma_f32_16x16x32_bf16 v[64:67], v[160:163], a[192:195], v[64:67]
buffer_load_dwordx4 v8, s[24:27], s51 offen lds
v_mfma_f32_16x16x32_bf16 v[68:71], v[184:187], a[164:167], 0
v_rcp_f32 v15, v15
v_mfma_f32_16x16x32_bf16 v[68:71], v[188:191], a[180:183], v[68:71]
ds_read_b64_tr_b16 v[180:181], v4 offset:8192
ds_read_b64_tr_b16 v[182:183], v4 offset:8704
v_mfma_f32_16x16x32_bf16 v[68:71], v[160:163], a[196:199], v[68:71]
v_rcp_f32 v16, v16
v_mfma_f32_16x16x32_bf16 v[72:75], v[184:187], a[168:171], 0
v_rcp_f32 v17, v17
v_mfma_f32_16x16x32_bf16 v[72:75], v[188:191], a[184:187], v[72:75]
v_mul_f32 v128, v128, v14
v_mul_f32 v129, v129, v15
v_mfma_f32_16x16x32_bf16 v[72:75], v[160:163], a[200:203], v[72:75]
v_mul_f32 v130, v130, v16
v_mul_f32 v131, v131, v17
v_mfma_f32_16x16x32_bf16 v[76:79], v[184:187], a[172:175], 0
s_waitcnt lgkmcnt(8)
v_cvt_pk_bf16_f32 v96, v128, v129
v_cvt_pk_bf16_f32 v97, v130, v131
v_mfma_f32_16x16x32_bf16 v[76:79], v[188:191], a[188:191], v[76:79]
s_add_u32 m0, s52, 94208
ds_read_b64_tr_b16 v[184:185], v4 offset:16384
ds_read_b64_tr_b16 v[186:187], v4 offset:16896
v_mfma_f32_16x16x32_bf16 v[76:79], v[160:163], a[204:207], v[76:79]
buffer_load_dwordx4 v8, s[28:31], s51 offen lds
v_mfma_f32_16x16x32_bf16 v[80:83], v[164:167], a[160:163], 0
s_waitcnt lgkmcnt(8)
v_mul_f32 v18, s53, v112
v_mul_f32 v19, s53, v113
v_mfma_f32_16x16x32_bf16 v[80:83], v[168:171], a[176:179], v[80:83]
s_waitcnt lgkmcnt(6)
ds_read_b64_tr_b16 v[188:189], v5 offset:0
ds_read_b64_tr_b16 v[190:191], v5 offset:512
v_mfma_f32_16x16x32_bf16 v[80:83], v[172:175], a[192:195], v[80:83]
v_mul_f32 v20, s53, v114
v_mul_f32 v21, s53, v115
v_mfma_f32_16x16x32_bf16 v[84:87], v[164:167], a[164:167], 0
v_exp_f32 v18, v18
v_mfma_f32_16x16x32_bf16 v[84:87], v[168:171], a[180:183], v[84:87]
ds_read_b64_tr_b16 v[160:161], v5 offset:8192
ds_read_b64_tr_b16 v[162:163], v5 offset:8704
v_mfma_f32_16x16x32_bf16 v[84:87], v[172:175], a[196:199], v[84:87]
v_exp_f32 v19, v19
v_mfma_f32_16x16x32_bf16 v[88:91], v[164:167], a[168:171], 0
s_add_u32 s51, s51, 294912
v_exp_f32 v20, v20
v_mfma_f32_16x16x32_bf16 v[88:91], v[168:171], a[184:187], v[88:91]
s_add_u32 m0, s52, 98304
v_exp_f32 v21, v21
v_mfma_f32_16x16x32_bf16 v[88:91], v[172:175], a[200:203], v[88:91]
buffer_load_dwordx4 v8, s[24:27], s51 offen lds
v_mfma_f32_16x16x32_bf16 v[92:95], v[164:167], a[172:175], 0
v_mul_f32 v144, v112, v144
v_mul_f32 v145, v113, v145
v_mfma_f32_16x16x32_bf16 v[92:95], v[168:171], a[188:191], v[92:95]
ds_read_b64_tr_b16 v[164:165], v5 offset:16384
ds_read_b64_tr_b16 v[166:167], v5 offset:16896
v_mfma_f32_16x16x32_bf16 v[92:95], v[172:175], a[204:207], v[92:95]
s_waitcnt lgkmcnt(10)
v_mul_f32 v146, v114, v146
v_mul_f32 v147, v115, v147
v_mfma_f32_16x16x32_bf16 v[32:35], v[176:179], a[208:211], v[32:35]
s_waitcnt lgkmcnt(6)
v_add_f32 v18, 1.0, v18
v_add_f32 v19, 1.0, v19
v_mfma_f32_16x16x32_bf16 v[32:35], v[180:183], a[224:227], v[32:35]
s_add_u32 m0, s52, 102400
ds_read_b64_tr_b16 v[168:169], v4 offset:4096
ds_read_b64_tr_b16 v[170:171], v4 offset:4608
v_mfma_f32_16x16x32_bf16 v[32:35], v[184:187], a[240:243], v[32:35]
buffer_load_dwordx4 v8, s[28:31], s51 offen lds
v_mfma_f32_16x16x32_bf16 v[36:39], v[176:179], a[212:215], v[36:39]
v_add_f32 v20, 1.0, v20
v_add_f32 v21, 1.0, v21
v_mfma_f32_16x16x32_bf16 v[36:39], v[180:183], a[228:231], v[36:39]
ds_read_b64_tr_b16 v[172:173], v4 offset:12288
ds_read_b64_tr_b16 v[174:175], v4 offset:12800
v_mfma_f32_16x16x32_bf16 v[36:39], v[184:187], a[244:247], v[36:39]
v_rcp_f32 v18, v18
v_mfma_f32_16x16x32_bf16 v[40:43], v[176:179], a[216:219], v[40:43]
v_rcp_f32 v19, v19
v_mfma_f32_16x16x32_bf16 v[40:43], v[180:183], a[232:235], v[40:43]
v_rcp_f32 v20, v20
v_mfma_f32_16x16x32_bf16 v[40:43], v[184:187], a[248:251], v[40:43]
s_waitcnt lgkmcnt(8)
v_rcp_f32 v21, v21
v_mfma_f32_16x16x32_bf16 v[44:47], v[176:179], a[220:223], v[44:47]
s_add_u32 s51, s51, 294912
v_mul_f32 v144, v144, v18
v_mul_f32 v145, v145, v19
v_mfma_f32_16x16x32_bf16 v[44:47], v[180:183], a[236:239], v[44:47]
s_add_u32 m0, s52, 106496
ds_read_b64_tr_b16 v[176:177], v4 offset:20480
ds_read_b64_tr_b16 v[178:179], v4 offset:20992
v_mfma_f32_16x16x32_bf16 v[44:47], v[184:187], a[252:255], v[44:47]
buffer_load_dwordx4 v8, s[24:27], s51 offen lds
v_mfma_f32_16x16x32_bf16 v[48:51], v[188:191], a[208:211], v[48:51]
s_waitcnt lgkmcnt(8)
v_mul_f32 v146, v146, v20
v_mul_f32 v147, v147, v21
v_mfma_f32_16x16x32_bf16 v[48:51], v[160:163], a[224:227], v[48:51]
s_waitcnt lgkmcnt(6)
ds_read_b64_tr_b16 v[180:181], v5 offset:4096
ds_read_b64_tr_b16 v[182:183], v5 offset:4608
v_mfma_f32_16x16x32_bf16 v[48:51], v[164:167], a[240:243], v[48:51]
v_cvt_pk_bf16_f32 v98, v144, v145
v_cvt_pk_bf16_f32 v99, v146, v147
v_mfma_f32_16x16x32_bf16 v[52:55], v[188:191], a[212:215], v[52:55]
v_mul_f32 v14, s53, v100
v_mul_f32 v15, s53, v101
v_mfma_f32_16x16x32_bf16 v[52:55], v[160:163], a[228:231], v[52:55]
ds_read_b64_tr_b16 v[184:185], v5 offset:12288
ds_read_b64_tr_b16 v[186:187], v5 offset:12800
v_mfma_f32_16x16x32_bf16 v[52:55], v[164:167], a[244:247], v[52:55]
v_mul_f32 v16, s53, v102
v_mul_f32 v17, s53, v103
v_mfma_f32_16x16x32_bf16 v[56:59], v[188:191], a[216:219], v[56:59]
v_exp_f32 v14, v14
v_mfma_f32_16x16x32_bf16 v[56:59], v[160:163], a[232:235], v[56:59]
s_add_u32 m0, s52, 110592
v_exp_f32 v15, v15
v_mfma_f32_16x16x32_bf16 v[56:59], v[164:167], a[248:251], v[56:59]
buffer_load_dwordx4 v8, s[28:31], s51 offen lds
v_mfma_f32_16x16x32_bf16 v[60:63], v[188:191], a[220:223], v[60:63]
v_exp_f32 v16, v16
v_mfma_f32_16x16x32_bf16 v[60:63], v[160:163], a[236:239], v[60:63]
ds_read_b64_tr_b16 v[188:189], v5 offset:20480
ds_read_b64_tr_b16 v[190:191], v5 offset:20992
v_mfma_f32_16x16x32_bf16 v[60:63], v[164:167], a[252:255], v[60:63]
s_waitcnt lgkmcnt(6)
v_exp_f32 v17, v17
v_mfma_f32_16x16x32_bf16 v[64:67], v[168:171], a[208:211], v[64:67]
s_add_u32 s51, s51, 294912
v_mul_f32 v132, v100, v132
v_mul_f32 v133, v101, v133
v_mfma_f32_16x16x32_bf16 v[64:67], v[172:175], a[224:227], v[64:67]
s_add_u32 m0, s52, 114688
v_mul_f32 v134, v102, v134
v_mul_f32 v135, v103, v135
v_mfma_f32_16x16x32_bf16 v[64:67], v[176:179], a[240:243], v[64:67]
buffer_load_dwordx4 v8, s[24:27], s51 offen lds
v_mfma_f32_16x16x32_bf16 v[68:71], v[168:171], a[212:215], v[68:71]
v_add_f32 v14, 1.0, v14
v_add_f32 v15, 1.0, v15
v_mfma_f32_16x16x32_bf16 v[68:71], v[172:175], a[228:231], v[68:71]
v_add_f32 v16, 1.0, v16
v_add_f32 v17, 1.0, v17
v_mfma_f32_16x16x32_bf16 v[68:71], v[176:179], a[244:247], v[68:71]
v_rcp_f32 v14, v14
v_mfma_f32_16x16x32_bf16 v[72:75], v[168:171], a[216:219], v[72:75]
v_rcp_f32 v15, v15
v_mfma_f32_16x16x32_bf16 v[72:75], v[172:175], a[232:235], v[72:75]
v_rcp_f32 v16, v16
v_mfma_f32_16x16x32_bf16 v[72:75], v[176:179], a[248:251], v[72:75]
v_rcp_f32 v17, v17
v_mfma_f32_16x16x32_bf16 v[76:79], v[168:171], a[220:223], v[76:79]
s_waitcnt lgkmcnt(0)
v_mul_f32 v132, v132, v14
v_mul_f32 v133, v133, v15
v_mfma_f32_16x16x32_bf16 v[76:79], v[172:175], a[236:239], v[76:79]
s_waitcnt vmcnt(12)
s_barrier
s_add_u32 m0, s52, 118784
v_mul_f32 v134, v134, v16
v_mul_f32 v135, v135, v17
v_mfma_f32_16x16x32_bf16 v[76:79], v[176:179], a[252:255], v[76:79]
buffer_load_dwordx4 v8, s[28:31], s51 offen lds
v_mfma_f32_16x16x32_bf16 v[80:83], v[180:183], a[208:211], v[80:83]
s_add_u32 s51, s51, 294912
ds_read_b64_tr_b16 v[160:161], v4 offset:24576
ds_read_b64_tr_b16 v[162:163], v4 offset:25088
v_mfma_f32_16x16x32_bf16 v[80:83], v[184:187], a[224:227], v[80:83]
ds_read_b64_tr_b16 v[164:165], v4 offset:32768
ds_read_b64_tr_b16 v[166:167], v4 offset:33280
v_mfma_f32_16x16x32_bf16 v[80:83], v[188:191], a[240:243], v[80:83]
ds_read_b64_tr_b16 v[168:169], v4 offset:40960
ds_read_b64_tr_b16 v[170:171], v4 offset:41472
v_mfma_f32_16x16x32_bf16 v[84:87], v[180:183], a[212:215], v[84:87]
v_cvt_pk_bf16_f32 v100, v132, v133
v_cvt_pk_bf16_f32 v101, v134, v135
v_mfma_f32_16x16x32_bf16 v[84:87], v[184:187], a[228:231], v[84:87]
ds_read_b64_tr_b16 v[172:173], v5 offset:24576
ds_read_b64_tr_b16 v[174:175], v5 offset:25088
v_mfma_f32_16x16x32_bf16 v[84:87], v[188:191], a[244:247], v[84:87]
v_mul_f32 v18, s53, v116
v_mul_f32 v19, s53, v117
v_mfma_f32_16x16x32_bf16 v[88:91], v[180:183], a[216:219], v[88:91]
v_add_u32_e64 v30, s73, 3
v_mul_f32 v20, s53, v118
v_mfma_f32_16x16x32_bf16 v[88:91], v[184:187], a[232:235], v[88:91]
ds_read_b64_tr_b16 v[176:177], v5 offset:32768
ds_read_b64_tr_b16 v[178:179], v5 offset:33280
v_mfma_f32_16x16x32_bf16 v[88:91], v[188:191], a[248:251], v[88:91]
buffer_store_dword v30, v31, s[8:11], s69 offen sc1
v_mfma_f32_16x16x32_bf16 v[92:95], v[180:183], a[220:223], v[92:95]
v_mul_f32 v21, s53, v119
v_mfma_f32_16x16x32_bf16 v[92:95], v[184:187], a[236:239], v[92:95]
ds_read_b64_tr_b16 v[180:181], v5 offset:40960
ds_read_b64_tr_b16 v[182:183], v5 offset:41472
v_mfma_f32_16x16x32_bf16 v[92:95], v[188:191], a[252:255], v[92:95]
s_waitcnt lgkmcnt(10)
v_exp_f32 v18, v18
v_mfma_f32_16x16x32_bf16 v[32:35], v[160:163], v[224:227], v[32:35]
s_waitcnt lgkmcnt(8)
v_exp_f32 v19, v19
v_mfma_f32_16x16x32_bf16 v[32:35], v[164:167], v[240:243], v[32:35]
s_waitcnt lgkmcnt(6)
ds_read_b64_tr_b16 v[184:185], v4 offset:28672
ds_read_b64_tr_b16 v[186:187], v4 offset:29184
v_mfma_f32_16x16x32_bf16 v[32:35], v[168:171], v[192:195], v[32:35]
v_exp_f32 v20, v20
v_mfma_f32_16x16x32_bf16 v[36:39], v[160:163], v[228:231], v[36:39]
v_exp_f32 v21, v21
v_mfma_f32_16x16x32_bf16 v[36:39], v[164:167], v[244:247], v[36:39]
ds_read_b64_tr_b16 v[188:189], v4 offset:36864
ds_read_b64_tr_b16 v[190:191], v4 offset:37376
v_mfma_f32_16x16x32_bf16 v[36:39], v[168:171], v[196:199], v[36:39]
v_mul_f32 v148, v116, v148
v_mul_f32 v149, v117, v149
v_mfma_f32_16x16x32_bf16 v[40:43], v[160:163], v[232:235], v[40:43]
v_mul_f32 v150, v118, v150
v_mul_f32 v151, v119, v151
v_mfma_f32_16x16x32_bf16 v[40:43], v[164:167], v[248:251], v[40:43]
v_add_f32 v18, 1.0, v18
v_add_f32 v19, 1.0, v19
v_mfma_f32_16x16x32_bf16 v[40:43], v[168:171], v[200:203], v[40:43]
v_add_f32 v20, 1.0, v20
v_add_f32 v21, 1.0, v21
v_mfma_f32_16x16x32_bf16 v[44:47], v[160:163], v[236:239], v[44:47]
v_rcp_f32 v18, v18
v_mfma_f32_16x16x32_bf16 v[44:47], v[164:167], v[252:255], v[44:47]
ds_read_b64_tr_b16 v[160:161], v4 offset:45056
ds_read_b64_tr_b16 v[162:163], v4 offset:45568
v_mfma_f32_16x16x32_bf16 v[44:47], v[168:171], v[204:207], v[44:47]
s_waitcnt lgkmcnt(10)
v_rcp_f32 v19, v19
v_mfma_f32_16x16x32_bf16 v[48:51], v[172:175], v[224:227], v[48:51]
s_waitcnt lgkmcnt(8)
v_rcp_f32 v20, v20
v_mfma_f32_16x16x32_bf16 v[48:51], v[176:179], v[240:243], v[48:51]
s_waitcnt lgkmcnt(6)
ds_read_b64_tr_b16 v[164:165], v5 offset:28672
ds_read_b64_tr_b16 v[166:167], v5 offset:29184
v_mfma_f32_16x16x32_bf16 v[48:51], v[180:183], v[192:195], v[48:51]
buffer_store_dwordx4 a[112:115], v3, s[8:11], s44 offen offset:3072 sc1
v_mfma_f32_16x16x32_bf16 v[52:55], v[172:175], v[228:231], v[52:55]
v_rcp_f32 v21, v21
v_mfma_f32_16x16x32_bf16 v[52:55], v[176:179], v[244:247], v[52:55]
ds_read_b64_tr_b16 v[168:169], v5 offset:36864
ds_read_b64_tr_b16 v[170:171], v5 offset:37376
v_mfma_f32_16x16x32_bf16 v[52:55], v[180:183], v[196:199], v[52:55]
v_mul_f32 v148, v148, v18
v_mul_f32 v149, v149, v19
v_mfma_f32_16x16x32_bf16 v[56:59], v[172:175], v[232:235], v[56:59]
v_mul_f32 v150, v150, v20
v_mul_f32 v151, v151, v21
v_mfma_f32_16x16x32_bf16 v[56:59], v[176:179], v[248:251], v[56:59]
v_cvt_pk_bf16_f32 v102, v148, v149
v_cvt_pk_bf16_f32 v103, v150, v151
v_mfma_f32_16x16x32_bf16 v[56:59], v[180:183], v[200:203], v[56:59]
v_mul_f32 v14, s53, v104
v_mul_f32 v15, s53, v105
v_mfma_f32_16x16x32_bf16 v[60:63], v[172:175], v[236:239], v[60:63]
v_mul_f32 v16, s53, v106
v_mul_f32 v17, s53, v107
v_mfma_f32_16x16x32_bf16 v[60:63], v[176:179], v[252:255], v[60:63]
ds_read_b64_tr_b16 v[172:173], v5 offset:45056
ds_read_b64_tr_b16 v[174:175], v5 offset:45568
v_mfma_f32_16x16x32_bf16 v[60:63], v[180:183], v[204:207], v[60:63]
s_waitcnt lgkmcnt(10)
v_exp_f32 v14, v14
v_mfma_f32_16x16x32_bf16 v[64:67], v[184:187], v[224:227], v[64:67]
s_waitcnt lgkmcnt(8)
v_exp_f32 v15, v15
v_mfma_f32_16x16x32_bf16 v[64:67], v[188:191], v[240:243], v[64:67]
s_waitcnt lgkmcnt(6)
ds_read_b64_tr_b16 v[176:177], v4 offset:49152
ds_read_b64_tr_b16 v[178:179], v4 offset:49664
v_mfma_f32_16x16x32_bf16 v[64:67], v[160:163], v[192:195], v[64:67]
buffer_store_dwordx4 a[116:119], v3, s[8:11], s45 offen offset:3072 sc1
v_mfma_f32_16x16x32_bf16 v[68:71], v[184:187], v[228:231], v[68:71]
v_exp_f32 v16, v16
v_mfma_f32_16x16x32_bf16 v[68:71], v[188:191], v[244:247], v[68:71]
ds_read_b64_tr_b16 v[180:181], v4 offset:57344
ds_read_b64_tr_b16 v[182:183], v4 offset:57856
v_mfma_f32_16x16x32_bf16 v[68:71], v[160:163], v[196:199], v[68:71]
v_exp_f32 v17, v17
v_mul_f32 v136, v104, v136
v_mfma_f32_16x16x32_bf16 v[72:75], v[184:187], v[232:235], v[72:75]
v_mul_f32 v137, v105, v137
v_mul_f32 v138, v106, v138
v_mfma_f32_16x16x32_bf16 v[72:75], v[188:191], v[248:251], v[72:75]
v_mul_f32 v139, v107, v139
v_add_f32 v14, 1.0, v14
v_mfma_f32_16x16x32_bf16 v[72:75], v[160:163], v[200:203], v[72:75]
v_add_f32 v15, 1.0, v15
v_add_f32 v16, 1.0, v16
v_mfma_f32_16x16x32_bf16 v[76:79], v[184:187], v[236:239], v[76:79]
v_add_f32 v17, 1.0, v17
v_mfma_f32_16x16x32_bf16 v[76:79], v[188:191], v[252:255], v[76:79]
ds_read_b64_tr_b16 v[184:185], v6 offset:0
ds_read_b64_tr_b16 v[186:187], v6 offset:512
v_mfma_f32_16x16x32_bf16 v[76:79], v[160:163], v[204:207], v[76:79]
s_waitcnt lgkmcnt(10)
v_rcp_f32 v14, v14
v_mfma_f32_16x16x32_bf16 v[80:83], v[164:167], v[224:227], v[80:83]
s_waitcnt lgkmcnt(8)
v_rcp_f32 v15, v15
v_mfma_f32_16x16x32_bf16 v[80:83], v[168:171], v[240:243], v[80:83]
s_waitcnt lgkmcnt(6)
ds_read_b64_tr_b16 v[188:189], v5 offset:49152
ds_read_b64_tr_b16 v[190:191], v5 offset:49664
v_mfma_f32_16x16x32_bf16 v[80:83], v[172:175], v[192:195], v[80:83]
buffer_store_dwordx4 a[120:123], v3, s[8:11], s46 offen offset:3072 sc1
v_mfma_f32_16x16x32_bf16 v[84:87], v[164:167], v[228:231], v[84:87]
v_rcp_f32 v16, v16
v_mfma_f32_16x16x32_bf16 v[84:87], v[168:171], v[244:247], v[84:87]
ds_read_b64_tr_b16 v[160:161], v5 offset:57344
ds_read_b64_tr_b16 v[162:163], v5 offset:57856
v_mfma_f32_16x16x32_bf16 v[84:87], v[172:175], v[196:199], v[84:87]
v_rcp_f32 v17, v17
v_mfma_f32_16x16x32_bf16 v[88:91], v[164:167], v[232:235], v[88:91]
v_mul_f32 v136, v136, v14
v_mul_f32 v137, v137, v15
v_mfma_f32_16x16x32_bf16 v[88:91], v[168:171], v[248:251], v[88:91]
s_waitcnt vmcnt(12)
v_subrev_u32 v22, s37, v22
v_subrev_u32 v23, s37, v23
v_mfma_f32_16x16x32_bf16 v[88:91], v[172:175], v[200:203], v[88:91]
v_max_u32 v22, v22, v23
v_cmp_le_u32 vcc, 2, v22
v_mfma_f32_16x16x32_bf16 v[92:95], v[164:167], v[236:239], v[92:95]
v_mul_f32 v138, v138, v16
v_mul_f32 v139, v139, v17
v_mfma_f32_16x16x32_bf16 v[92:95], v[168:171], v[252:255], v[92:95]
ds_read_b64_tr_b16 v[164:165], v7 offset:0
ds_read_b64_tr_b16 v[166:167], v7 offset:512
v_mfma_f32_16x16x32_bf16 v[92:95], v[172:175], v[204:207], v[92:95]
s_waitcnt lgkmcnt(10)
v_cvt_pk_bf16_f32 v104, v136, v137
v_cvt_pk_bf16_f32 v105, v138, v139
v_mfma_f32_16x16x32_bf16 v[32:35], v[176:179], v[208:211], v[32:35]
s_waitcnt lgkmcnt(8)
v_mul_f32 v18, s53, v120
v_mul_f32 v19, s53, v121
v_mfma_f32_16x16x32_bf16 v[32:35], v[180:183], a[128:131], v[32:35]
s_waitcnt lgkmcnt(6)
ds_read_b64_tr_b16 v[168:169], v4 offset:53248
ds_read_b64_tr_b16 v[170:171], v4 offset:53760
v_mfma_f32_16x16x32_bf16 v[32:35], v[184:187], a[144:147], v[32:35]
buffer_store_dwordx4 a[124:127], v3, s[8:11], s47 offen offset:3072 sc1
v_mfma_f32_16x16x32_bf16 v[36:39], v[176:179], v[212:215], v[36:39]
v_mul_f32 v20, s53, v122
v_mul_f32 v21, s53, v123
v_mfma_f32_16x16x32_bf16 v[36:39], v[180:183], a[132:135], v[36:39]
ds_read_b64_tr_b16 v[172:173], v4 offset:61440
ds_read_b64_tr_b16 v[174:175], v4 offset:61952
v_mfma_f32_16x16x32_bf16 v[36:39], v[184:187], a[148:151], v[36:39]
v_exp_f32 v18, v18
v_mfma_f32_16x16x32_bf16 v[40:43], v[176:179], v[216:219], v[40:43]
v_xor_b32 v4, 64, v4
v_mfma_f32_16x16x32_bf16 v[40:43], v[180:183], a[136:139], v[40:43]
v_exp_f32 v19, v19
v_mfma_f32_16x16x32_bf16 v[40:43], v[184:187], a[152:155], v[40:43]
v_exp_f32 v20, v20
v_mfma_f32_16x16x32_bf16 v[44:47], v[176:179], v[220:223], v[44:47]
v_exp_f32 v21, v21
v_mfma_f32_16x16x32_bf16 v[44:47], v[180:183], a[140:143], v[44:47]
ds_read_b64_tr_b16 v[176:177], v6 offset:4096
ds_read_b64_tr_b16 v[178:179], v6 offset:4608
v_mfma_f32_16x16x32_bf16 v[44:47], v[184:187], a[156:159], v[44:47]
s_waitcnt lgkmcnt(10)
v_mul_f32_e64 v152, v120, v152
v_mul_f32_e64 v153, v121, v153
v_mfma_f32_16x16x32_bf16 v[48:51], v[188:191], v[208:211], v[48:51]
s_waitcnt lgkmcnt(6)
v_mul_f32_e64 v154, v122, v154
v_mul_f32_e64 v155, v123, v155
v_mfma_f32_16x16x32_bf16 v[48:51], v[160:163], a[128:131], v[48:51]
s_cbranch_vccnz K1_prs
K1_prb:
ds_read_b64_tr_b16 v[180:181], v5 offset:53248
ds_read_b64_tr_b16 v[182:183], v5 offset:53760
v_mfma_f32_16x16x32_bf16 v[48:51], v[164:167], a[144:147], v[48:51]
v_add_f32 v18, 1.0, v18
v_add_f32 v19, 1.0, v19
v_mfma_f32_16x16x32_bf16 v[52:55], v[188:191], v[212:215], v[52:55]
v_readfirstlane_b32 s35, v22
v_add_f32 v20, 1.0, v20
v_mfma_f32_16x16x32_bf16 v[52:55], v[160:163], a[132:135], v[52:55]
ds_read_b64_tr_b16 v[184:185], v5 offset:61440
ds_read_b64_tr_b16 v[186:187], v5 offset:61952
v_mfma_f32_16x16x32_bf16 v[52:55], v[164:167], a[148:151], v[52:55]
v_add_f32 v21, 1.0, v21
v_mfma_f32_16x16x32_bf16 v[56:59], v[188:191], v[216:219], v[56:59]
v_xor_b32 v5, 64, v5
v_mfma_f32_16x16x32_bf16 v[56:59], v[160:163], a[136:139], v[56:59]
v_rcp_f32 v18, v18
v_mfma_f32_16x16x32_bf16 v[56:59], v[164:167], a[152:155], v[56:59]
v_rcp_f32 v19, v19
v_mfma_f32_16x16x32_bf16 v[60:63], v[188:191], v[220:223], v[60:63]
v_rcp_f32 v20, v20
v_mfma_f32_16x16x32_bf16 v[60:63], v[160:163], a[140:143], v[60:63]
ds_read_b64_tr_b16 v[188:189], v7 offset:4096
ds_read_b64_tr_b16 v[190:191], v7 offset:4608
v_mfma_f32_16x16x32_bf16 v[60:63], v[164:167], a[156:159], v[60:63]
s_waitcnt lgkmcnt(10)
v_rcp_f32 v21, v21
v_mfma_f32_16x16x32_bf16 v[64:67], v[168:171], v[208:211], v[64:67]
s_waitcnt lgkmcnt(8)
v_mul_f32 v152, v152, v18
v_mul_f32 v153, v153, v19
v_mfma_f32_16x16x32_bf16 v[64:67], v[172:175], a[128:131], v[64:67]
s_waitcnt lgkmcnt(6)
v_mul_f32 v154, v154, v20
v_mul_f32 v155, v155, v21
v_mfma_f32_16x16x32_bf16 v[64:67], v[176:179], a[144:147], v[64:67]
v_cvt_pk_bf16_f32 v106, v152, v153
v_cvt_pk_bf16_f32 v107, v154, v155
v_mfma_f32_16x16x32_bf16 v[68:71], v[168:171], v[212:215], v[68:71]
v_mul_f32 v14, s53, v108
v_mul_f32 v15, s53, v109
v_mfma_f32_16x16x32_bf16 v[68:71], v[172:175], a[132:135], v[68:71]
v_mul_f32 v16, s53, v110
v_mul_f32 v17, s53, v111
v_mfma_f32_16x16x32_bf16 v[68:71], v[176:179], a[148:151], v[68:71]
v_exp_f32 v14, v14
v_mfma_f32_16x16x32_bf16 v[72:75], v[168:171], v[216:219], v[72:75]
v_exp_f32 v15, v15
v_mfma_f32_16x16x32_bf16 v[72:75], v[172:175], a[136:139], v[72:75]
v_exp_f32 v16, v16
v_mfma_f32_16x16x32_bf16 v[72:75], v[176:179], a[152:155], v[72:75]
v_exp_f32 v17, v17
v_mfma_f32_16x16x32_bf16 v[76:79], v[168:171], v[220:223], v[76:79]
s_waitcnt lgkmcnt(0)
v_mul_f32 v140, v108, v140
v_mul_f32 v141, v109, v141
v_mfma_f32_16x16x32_bf16 v[76:79], v[172:175], a[140:143], v[76:79]
s_waitcnt vmcnt(5)
s_barrier
v_mul_f32 v142, v110, v142
v_mul_f32 v143, v111, v143
v_mfma_f32_16x16x32_bf16 v[76:79], v[176:179], a[156:159], v[76:79]
v_add_f32 v14, 1.0, v14
v_add_f32 v15, 1.0, v15
v_mfma_f32_16x16x32_bf16 v[80:83], v[180:183], v[208:211], v[80:83]
ds_read_b64_tr_b16 v[160:161], v6 offset:8192
ds_read_b64_tr_b16 v[162:163], v6 offset:8704
v_mfma_f32_16x16x32_bf16 v[80:83], v[184:187], a[128:131], v[80:83]
ds_read_b64_tr_b16 v[164:165], v6 offset:16384
ds_read_b64_tr_b16 v[166:167], v6 offset:16896
v_mfma_f32_16x16x32_bf16 v[80:83], v[188:191], a[144:147], v[80:83]
ds_read_b64_tr_b16 v[168:169], v6 offset:24576
ds_read_b64_tr_b16 v[170:171], v6 offset:25088
v_mfma_f32_16x16x32_bf16 v[84:87], v[180:183], v[212:215], v[84:87]
v_add_f32 v16, 1.0, v16
v_add_f32 v17, 1.0, v17
v_mfma_f32_16x16x32_bf16 v[84:87], v[184:187], a[132:135], v[84:87]
ds_read_b64_tr_b16 v[172:173], v7 offset:8192
ds_read_b64_tr_b16 v[174:175], v7 offset:8704
v_mfma_f32_16x16x32_bf16 v[84:87], v[188:191], a[148:151], v[84:87]
v_rcp_f32 v14, v14
v_mfma_f32_16x16x32_bf16 v[88:91], v[180:183], v[216:219], v[88:91]
v_rcp_f32 v15, v15
v_mfma_f32_16x16x32_bf16 v[88:91], v[184:187], a[136:139], v[88:91]
ds_read_b64_tr_b16 v[176:177], v7 offset:16384
ds_read_b64_tr_b16 v[178:179], v7 offset:16896
v_mfma_f32_16x16x32_bf16 v[88:91], v[188:191], a[152:155], v[88:91]
v_rcp_f32 v16, v16
v_mfma_f32_16x16x32_bf16 v[92:95], v[180:183], v[220:223], v[92:95]
v_rcp_f32 v17, v17
v_mfma_f32_16x16x32_bf16 v[92:95], v[184:187], a[140:143], v[92:95]
ds_read_b64_tr_b16 v[180:181], v7 offset:24576
ds_read_b64_tr_b16 v[182:183], v7 offset:25088
v_mfma_f32_16x16x32_bf16 v[92:95], v[188:191], a[156:159], v[92:95]
s_waitcnt lgkmcnt(10)
v_mul_f32 v140, v140, v14
v_mul_f32 v141, v141, v15
v_mfma_f32_16x16x32_bf16 v[32:35], v[160:163], a[0:3], v[32:35]
s_waitcnt lgkmcnt(8)
v_mul_f32 v142, v142, v16
v_mul_f32 v143, v143, v17
v_mfma_f32_16x16x32_bf16 v[32:35], v[164:167], a[16:19], v[32:35]
s_waitcnt lgkmcnt(6)
ds_read_b64_tr_b16 v[184:185], v6 offset:12288
ds_read_b64_tr_b16 v[186:187], v6 offset:12800
v_mfma_f32_16x16x32_bf16 v[32:35], v[168:171], a[32:35], v[32:35]
v_cvt_pk_bf16_f32 v108, v140, v141
v_cvt_pk_bf16_f32 v109, v142, v143
v_mfma_f32_16x16x32_bf16 v[36:39], v[160:163], a[4:7], v[36:39]
v_mul_f32 v18, s53, v124
v_mul_f32 v19, s53, v125
v_mfma_f32_16x16x32_bf16 v[36:39], v[164:167], a[20:23], v[36:39]
ds_read_b64_tr_b16 v[188:189], v6 offset:20480
ds_read_b64_tr_b16 v[190:191], v6 offset:20992
v_mfma_f32_16x16x32_bf16 v[36:39], v[168:171], a[36:39], v[36:39]
v_mul_f32 v20, s53, v126
v_mul_f32 v21, s53, v127
v_mfma_f32_16x16x32_bf16 v[40:43], v[160:163], a[8:11], v[40:43]
v_exp_f32 v18, v18
v_mfma_f32_16x16x32_bf16 v[40:43], v[164:167], a[24:27], v[40:43]
v_exp_f32 v19, v19
v_mfma_f32_16x16x32_bf16 v[40:43], v[168:171], a[40:43], v[40:43]
v_exp_f32 v20, v20
v_mfma_f32_16x16x32_bf16 v[44:47], v[160:163], a[12:15], v[44:47]
v_exp_f32 v21, v21
v_mfma_f32_16x16x32_bf16 v[44:47], v[164:167], a[28:31], v[44:47]
ds_read_b64_tr_b16 v[160:161], v6 offset:28672
ds_read_b64_tr_b16 v[162:163], v6 offset:29184
v_mfma_f32_16x16x32_bf16 v[44:47], v[168:171], a[44:47], v[44:47]
s_waitcnt lgkmcnt(10)
v_mul_f32 v156, v124, v156
v_mul_f32 v157, v125, v157
v_mfma_f32_16x16x32_bf16 v[48:51], v[172:175], a[0:3], v[48:51]
s_waitcnt lgkmcnt(8)
v_mul_f32 v158, v126, v158
v_mul_f32 v159, v127, v159
v_mfma_f32_16x16x32_bf16 v[48:51], v[176:179], a[16:19], v[48:51]
s_waitcnt lgkmcnt(6)
ds_read_b64_tr_b16 v[164:165], v7 offset:12288
ds_read_b64_tr_b16 v[166:167], v7 offset:12800
v_mfma_f32_16x16x32_bf16 v[48:51], v[180:183], a[32:35], v[48:51]
v_add_f32 v18, 1.0, v18
v_add_f32 v19, 1.0, v19
v_mfma_f32_16x16x32_bf16 v[52:55], v[172:175], a[4:7], v[52:55]
v_add_f32 v20, 1.0, v20
v_add_f32 v21, 1.0, v21
v_mfma_f32_16x16x32_bf16 v[52:55], v[176:179], a[20:23], v[52:55]
ds_read_b64_tr_b16 v[168:169], v7 offset:20480
ds_read_b64_tr_b16 v[170:171], v7 offset:20992
v_mfma_f32_16x16x32_bf16 v[52:55], v[180:183], a[36:39], v[52:55]
v_rcp_f32 v18, v18
v_mfma_f32_16x16x32_bf16 v[56:59], v[172:175], a[8:11], v[56:59]
v_rcp_f32 v19, v19
v_mfma_f32_16x16x32_bf16 v[56:59], v[176:179], a[24:27], v[56:59]
v_rcp_f32 v20, v20
v_mfma_f32_16x16x32_bf16 v[56:59], v[180:183], a[40:43], v[56:59]
v_rcp_f32 v21, v21
v_mfma_f32_16x16x32_bf16 v[60:63], v[172:175], a[12:15], v[60:63]
v_mul_f32 v156, v156, v18
v_mul_f32 v157, v157, v19
v_mfma_f32_16x16x32_bf16 v[60:63], v[176:179], a[28:31], v[60:63]
ds_read_b64_tr_b16 v[172:173], v7 offset:28672
ds_read_b64_tr_b16 v[174:175], v7 offset:29184
v_mfma_f32_16x16x32_bf16 v[60:63], v[180:183], a[44:47], v[60:63]
s_waitcnt lgkmcnt(10)
v_mul_f32 v158, v158, v20
v_mul_f32 v159, v159, v21
v_mfma_f32_16x16x32_bf16 v[64:67], v[184:187], a[0:3], v[64:67]
s_waitcnt lgkmcnt(8)
v_cvt_pk_bf16_f32 v110, v156, v157
v_cvt_pk_bf16_f32 v111, v158, v159
v_mfma_f32_16x16x32_bf16 v[64:67], v[188:191], a[16:19], v[64:67]
s_waitcnt lgkmcnt(6)
ds_read_b64_tr_b16 v[176:177], v6 offset:32768
ds_read_b64_tr_b16 v[178:179], v6 offset:33280
v_mfma_f32_16x16x32_bf16 v[64:67], v[160:163], a[32:35], v[64:67]
buffer_store_dwordx4 v[96:99], v3, s[8:11], s56 offen sc1
v_mfma_f32_16x16x32_bf16 v[68:71], v[184:187], a[4:7], v[68:71]
s_add_u32 s56, s56, 16384
v_mfma_f32_16x16x32_bf16 v[68:71], v[188:191], a[20:23], v[68:71]
ds_read_b64_tr_b16 v[180:181], v6 offset:40960
ds_read_b64_tr_b16 v[182:183], v6 offset:41472
v_mfma_f32_16x16x32_bf16 v[68:71], v[160:163], a[36:39], v[68:71]
v_mfma_f32_16x16x32_bf16 v[72:75], v[184:187], a[8:11], v[72:75]
v_mfma_f32_16x16x32_bf16 v[72:75], v[188:191], a[24:27], v[72:75]
v_mfma_f32_16x16x32_bf16 v[72:75], v[160:163], a[40:43], v[72:75]
v_mfma_f32_16x16x32_bf16 v[76:79], v[184:187], a[12:15], v[76:79]
v_mfma_f32_16x16x32_bf16 v[76:79], v[188:191], a[28:31], v[76:79]
ds_read_b64_tr_b16 v[184:185], v6 offset:49152
ds_read_b64_tr_b16 v[186:187], v6 offset:49664
v_mfma_f32_16x16x32_bf16 v[76:79], v[160:163], a[44:47], v[76:79]
s_waitcnt lgkmcnt(10)
v_mfma_f32_16x16x32_bf16 v[80:83], v[164:167], a[0:3], v[80:83]
s_waitcnt lgkmcnt(8)
v_mfma_f32_16x16x32_bf16 v[80:83], v[168:171], a[16:19], v[80:83]
s_waitcnt lgkmcnt(6)
ds_read_b64_tr_b16 v[188:189], v7 offset:32768
ds_read_b64_tr_b16 v[190:191], v7 offset:33280
v_mfma_f32_16x16x32_bf16 v[80:83], v[172:175], a[32:35], v[80:83]
buffer_store_dwordx4 v[100:103], v3, s[8:11], s57 offen sc1
v_mfma_f32_16x16x32_bf16 v[84:87], v[164:167], a[4:7], v[84:87]
s_add_u32 s57, s57, 16384
v_mfma_f32_16x16x32_bf16 v[84:87], v[168:171], a[20:23], v[84:87]
ds_read_b64_tr_b16 v[160:161], v7 offset:40960
ds_read_b64_tr_b16 v[162:163], v7 offset:41472
v_mfma_f32_16x16x32_bf16 v[84:87], v[172:175], a[36:39], v[84:87]
v_mfma_f32_16x16x32_bf16 v[88:91], v[164:167], a[8:11], v[88:91]
v_mfma_f32_16x16x32_bf16 v[88:91], v[168:171], a[24:27], v[88:91]
v_mfma_f32_16x16x32_bf16 v[88:91], v[172:175], a[40:43], v[88:91]
v_mfma_f32_16x16x32_bf16 v[92:95], v[164:167], a[12:15], v[92:95]
v_mfma_f32_16x16x32_bf16 v[92:95], v[168:171], a[28:31], v[92:95]
ds_read_b64_tr_b16 v[164:165], v7 offset:49152
ds_read_b64_tr_b16 v[166:167], v7 offset:49664
v_mfma_f32_16x16x32_bf16 v[92:95], v[172:175], a[44:47], v[92:95]
s_waitcnt lgkmcnt(10)
v_mfma_f32_16x16x32_bf16 v[32:35], v[176:179], a[48:51], v[32:35]
s_waitcnt lgkmcnt(8)
v_mfma_f32_16x16x32_bf16 v[32:35], v[180:183], a[64:67], v[32:35]
s_waitcnt lgkmcnt(6)
ds_read_b64_tr_b16 v[168:169], v6 offset:36864
ds_read_b64_tr_b16 v[170:171], v6 offset:37376
v_mfma_f32_16x16x32_bf16 v[32:35], v[184:187], a[80:83], v[32:35]
buffer_store_dwordx4 v[104:107], v3, s[8:11], s58 offen sc1
v_mfma_f32_16x16x32_bf16 v[36:39], v[176:179], a[52:55], v[36:39]
s_add_u32 s58, s58, 16384
v_mfma_f32_16x16x32_bf16 v[36:39], v[180:183], a[68:71], v[36:39]
ds_read_b64_tr_b16 v[172:173], v6 offset:45056
ds_read_b64_tr_b16 v[174:175], v6 offset:45568
v_mfma_f32_16x16x32_bf16 v[36:39], v[184:187], a[84:87], v[36:39]
v_mfma_f32_16x16x32_bf16 v[40:43], v[176:179], a[56:59], v[40:43]
v_mfma_f32_16x16x32_bf16 v[40:43], v[180:183], a[72:75], v[40:43]
v_mfma_f32_16x16x32_bf16 v[40:43], v[184:187], a[88:91], v[40:43]
v_mfma_f32_16x16x32_bf16 v[44:47], v[176:179], a[60:63], v[44:47]
v_mfma_f32_16x16x32_bf16 v[44:47], v[180:183], a[76:79], v[44:47]
ds_read_b64_tr_b16 v[176:177], v6 offset:53248
ds_read_b64_tr_b16 v[178:179], v6 offset:53760
v_mfma_f32_16x16x32_bf16 v[44:47], v[184:187], a[92:95], v[44:47]
s_waitcnt lgkmcnt(10)
v_mfma_f32_16x16x32_bf16 v[48:51], v[188:191], a[48:51], v[48:51]
s_waitcnt lgkmcnt(8)
v_xor_b32 v6, 64, v6
v_mfma_f32_16x16x32_bf16 v[48:51], v[160:163], a[64:67], v[48:51]
s_waitcnt lgkmcnt(6)
ds_read_b64_tr_b16 v[180:181], v7 offset:36864
ds_read_b64_tr_b16 v[182:183], v7 offset:37376
v_mfma_f32_16x16x32_bf16 v[48:51], v[164:167], a[80:83], v[48:51]
buffer_store_dwordx4 v[108:111], v3, s[8:11], s59 offen sc1
v_mfma_f32_16x16x32_bf16 v[52:55], v[188:191], a[52:55], v[52:55]
s_add_u32 s59, s59, 16384
v_mfma_f32_16x16x32_bf16 v[52:55], v[160:163], a[68:71], v[52:55]
ds_read_b64_tr_b16 v[184:185], v7 offset:45056
ds_read_b64_tr_b16 v[186:187], v7 offset:45568
v_mfma_f32_16x16x32_bf16 v[52:55], v[164:167], a[84:87], v[52:55]
v_mfma_f32_16x16x32_bf16 v[56:59], v[188:191], a[56:59], v[56:59]
v_mfma_f32_16x16x32_bf16 v[56:59], v[160:163], a[72:75], v[56:59]
v_mfma_f32_16x16x32_bf16 v[56:59], v[164:167], a[88:91], v[56:59]
v_mfma_f32_16x16x32_bf16 v[60:63], v[188:191], a[60:63], v[60:63]
v_mfma_f32_16x16x32_bf16 v[60:63], v[160:163], a[76:79], v[60:63]
ds_read_b64_tr_b16 v[188:189], v7 offset:53248
ds_read_b64_tr_b16 v[190:191], v7 offset:53760
v_mfma_f32_16x16x32_bf16 v[60:63], v[164:167], a[92:95], v[60:63]
s_waitcnt lgkmcnt(10)
v_mfma_f32_16x16x32_bf16 v[64:67], v[168:171], a[48:51], v[64:67]
s_waitcnt lgkmcnt(8)
v_xor_b32 v7, 64, v7
v_mfma_f32_16x16x32_bf16 v[64:67], v[172:175], a[64:67], v[64:67]
s_waitcnt lgkmcnt(6)
ds_read_b64_tr_b16 v[160:161], v28 offset:8192
ds_read_b64_tr_b16 v[162:163], v28 offset:8704
v_mfma_f32_16x16x32_bf16 v[64:67], v[176:179], a[80:83], v[64:67]
v_mfma_f32_16x16x32_bf16 v[68:71], v[168:171], a[52:55], v[68:71]
v_mfma_f32_16x16x32_bf16 v[68:71], v[172:175], a[68:71], v[68:71]
ds_read_b64_tr_b16 v[164:165], v28 offset:16384
ds_read_b64_tr_b16 v[166:167], v28 offset:16896
v_mfma_f32_16x16x32_bf16 v[68:71], v[176:179], a[84:87], v[68:71]
v_mfma_f32_16x16x32_bf16 v[72:75], v[168:171], a[56:59], v[72:75]
v_mfma_f32_16x16x32_bf16 v[72:75], v[172:175], a[72:75], v[72:75]
v_mfma_f32_16x16x32_bf16 v[72:75], v[176:179], a[88:91], v[72:75]
v_mfma_f32_16x16x32_bf16 v[76:79], v[168:171], a[60:63], v[76:79]
v_mfma_f32_16x16x32_bf16 v[76:79], v[172:175], a[76:79], v[76:79]
ds_read_b64_tr_b16 v[168:169], v28 offset:24576
ds_read_b64_tr_b16 v[170:171], v28 offset:25088
v_mfma_f32_16x16x32_bf16 v[76:79], v[176:179], a[92:95], v[76:79]
s_waitcnt lgkmcnt(10)
v_mfma_f32_16x16x32_bf16 v[80:83], v[180:183], a[48:51], v[80:83]
s_waitcnt lgkmcnt(8)
v_mfma_f32_16x16x32_bf16 v[80:83], v[184:187], a[64:67], v[80:83]
s_waitcnt lgkmcnt(6)
ds_read_b64_tr_b16 v[172:173], v29 offset:8192
ds_read_b64_tr_b16 v[174:175], v29 offset:8704
v_mfma_f32_16x16x32_bf16 v[80:83], v[188:191], a[80:83], v[80:83]
v_mfma_f32_16x16x32_bf16 v[84:87], v[180:183], a[52:55], v[84:87]
v_mfma_f32_16x16x32_bf16 v[84:87], v[184:187], a[68:71], v[84:87]
ds_read_b64_tr_b16 v[176:177], v29 offset:16384
ds_read_b64_tr_b16 v[178:179], v29 offset:16896
v_mfma_f32_16x16x32_bf16 v[84:87], v[188:191], a[84:87], v[84:87]
v_mfma_f32_16x16x32_bf16 v[88:91], v[180:183], a[56:59], v[88:91]
v_mfma_f32_16x16x32_bf16 v[88:91], v[184:187], a[72:75], v[88:91]
v_mfma_f32_16x16x32_bf16 v[88:91], v[188:191], a[88:91], v[88:91]
v_mfma_f32_16x16x32_bf16 v[92:95], v[180:183], a[60:63], v[92:95]
v_mfma_f32_16x16x32_bf16 v[92:95], v[184:187], a[76:79], v[92:95]
ds_read_b64_tr_b16 v[180:181], v29 offset:24576
ds_read_b64_tr_b16 v[182:183], v29 offset:25088
v_mfma_f32_16x16x32_bf16 v[92:95], v[188:191], a[92:95], v[92:95]
s_waitcnt lgkmcnt(10)
v_mfma_f32_16x16x32_bf16 v[96:99], v[160:163], a[160:163], 0
s_waitcnt lgkmcnt(8)
v_mfma_f32_16x16x32_bf16 v[96:99], v[164:167], a[176:179], v[96:99]
s_waitcnt lgkmcnt(6)
ds_read_b64_tr_b16 v[184:185], v28 offset:12288
ds_read_b64_tr_b16 v[186:187], v28 offset:12800
v_mfma_f32_16x16x32_bf16 v[96:99], v[168:171], a[192:195], v[96:99]
s_bfe_u32 s76, s2, 0x10001
v_mfma_f32_16x16x32_bf16 v[100:103], v[160:163], a[164:167], 0
s_xor_b32 s60, s35, s2
v_mfma_f32_16x16x32_bf16 v[100:103], v[164:167], a[180:183], v[100:103]
ds_read_b64_tr_b16 v[188:189], v28 offset:20480
ds_read_b64_tr_b16 v[190:191], v28 offset:20992
v_mfma_f32_16x16x32_bf16 v[100:103], v[168:171], a[196:199], v[100:103]
s_lshl_b32 s60, s60, 1
v_mul_f32 v14, s53, v32
v_mul_f32 v15, s53, v33
v_mfma_f32_16x16x32_bf16 v[104:107], v[160:163], a[168:171], 0
s_andn2_b32 s60, 2, s60
v_mul_f32 v16, s53, v34
v_mul_f32 v17, s53, v35
v_mfma_f32_16x16x32_bf16 v[104:107], v[164:167], a[184:187], v[104:107]
v_exp_f32 v14, v14
v_mfma_f32_16x16x32_bf16 v[104:107], v[168:171], a[200:203], v[104:107]
s_add_u32 s76, s76, s60
v_exp_f32 v15, v15
v_mfma_f32_16x16x32_bf16 v[108:111], v[160:163], a[172:175], 0
s_bfe_u32 s77, s2, 0x10002
v_exp_f32 v16, v16
v_mfma_f32_16x16x32_bf16 v[108:111], v[164:167], a[188:191], v[108:111]
s_waitcnt lgkmcnt(6)
ds_read_b64_tr_b16 v[160:161], v28 offset:28672
ds_read_b64_tr_b16 v[162:163], v28 offset:29184
v_mfma_f32_16x16x32_bf16 v[108:111], v[168:171], a[204:207], v[108:111]
s_lshr_b32 s60, s2, 5
v_exp_f32 v17, v17
v_mfma_f32_16x16x32_bf16 v[112:115], v[172:175], a[160:163], 0
s_lshl_b32 s77, s77, 3
v_mul_f32 v64, v32, v64
v_mul_f32 v65, v33, v65
v_mfma_f32_16x16x32_bf16 v[112:115], v[176:179], a[176:179], v[112:115]
s_waitcnt lgkmcnt(6)
ds_read_b64_tr_b16 v[164:165], v29 offset:12288
ds_read_b64_tr_b16 v[166:167], v29 offset:12800
v_mfma_f32_16x16x32_bf16 v[112:115], v[180:183], a[192:195], v[112:115]
s_add_u32 s77, s77, s60
v_mul_f32 v66, v34, v66
v_mul_f32 v67, v35, v67
v_mfma_f32_16x16x32_bf16 v[116:119], v[172:175], a[164:167], 0
s_bfe_u32 s78, s2, 0x20003
v_add_f32 v14, 1.0, v14
v_add_f32 v15, 1.0, v15
v_mfma_f32_16x16x32_bf16 v[116:119], v[176:179], a[180:183], v[116:119]
ds_read_b64_tr_b16 v[168:169], v29 offset:20480
ds_read_b64_tr_b16 v[170:171], v29 offset:20992
v_mfma_f32_16x16x32_bf16 v[116:119], v[180:183], a[196:199], v[116:119]
s_add_u32 s64, s77, s78
v_add_f32 v16, 1.0, v16
v_add_f32 v17, 1.0, v17
v_mfma_f32_16x16x32_bf16 v[120:123], v[172:175], a[168:171], 0
s_and_b32 s64, s64, 3
v_rcp_f32 v14, v14
v_mfma_f32_16x16x32_bf16 v[120:123], v[176:179], a[184:187], v[120:123]
v_rcp_f32 v15, v15
v_mfma_f32_16x16x32_bf16 v[120:123], v[180:183], a[200:203], v[120:123]
s_cmp_eq_u32 s64, 3
s_cselect_b32 s39, -3, 1
v_rcp_f32 v16, v16
v_mfma_f32_16x16x32_bf16 v[124:127], v[172:175], a[172:175], 0
v_rcp_f32 v17, v17
v_mfma_f32_16x16x32_bf16 v[124:127], v[176:179], a[188:191], v[124:127]
s_waitcnt lgkmcnt(8)
ds_read_b64_tr_b16 v[172:173], v29 offset:28672
ds_read_b64_tr_b16 v[174:175], v29 offset:29184
v_mfma_f32_16x16x32_bf16 v[124:127], v[180:183], a[204:207], v[124:127]
s_cmp_eq_u32 s64, 2
s_cselect_b32 s40, -3, 1
v_mul_f32 v64, v64, v14
v_mul_f32 v65, v65, v15
v_mfma_f32_16x16x32_bf16 v[128:131], v[184:187], a[160:163], 0
s_waitcnt lgkmcnt(8)
v_mul_f32 v66, v66, v16
v_mul_f32 v67, v67, v17
v_mfma_f32_16x16x32_bf16 v[128:131], v[188:191], a[176:179], v[128:131]
s_waitcnt lgkmcnt(6)
ds_read_b64_tr_b16 v[176:177], v4 offset:0
ds_read_b64_tr_b16 v[178:179], v4 offset:512
v_mfma_f32_16x16x32_bf16 v[128:131], v[160:163], a[192:195], v[128:131]
s_cmp_eq_u32 s64, 1
s_cselect_b32 s41, -3, 1
v_cvt_pk_bf16_f32 v32, v64, v65
v_cvt_pk_bf16_f32 v33, v66, v67
v_mfma_f32_16x16x32_bf16 v[132:135], v[184:187], a[164:167], 0
v_mul_f32 v18, s53, v48
v_mul_f32 v19, s53, v49
v_mfma_f32_16x16x32_bf16 v[132:135], v[188:191], a[180:183], v[132:135]
ds_read_b64_tr_b16 v[180:181], v4 offset:8192
ds_read_b64_tr_b16 v[182:183], v4 offset:8704
v_mfma_f32_16x16x32_bf16 v[132:135], v[160:163], a[196:199], v[132:135]
s_cmp_eq_u32 s64, 0
s_cselect_b32 s50, 1, 5
v_mul_f32 v20, s53, v50
v_mul_f32 v21, s53, v51
v_mfma_f32_16x16x32_bf16 v[136:139], v[184:187], a[168:171], 0
s_sub_u32 s72, s50, s64
v_exp_f32 v18, v18
v_mfma_f32_16x16x32_bf16 v[136:139], v[188:191], a[184:187], v[136:139]
v_exp_f32 v19, v19
v_mfma_f32_16x16x32_bf16 v[136:139], v[160:163], a[200:203], v[136:139]
s_mul_i32 s70, s72, 147456
v_exp_f32 v20, v20
v_mfma_f32_16x16x32_bf16 v[140:143], v[184:187], a[172:175], 0
s_sub_u32 s70, s70, 8192
v_exp_f32 v21, v21
v_mfma_f32_16x16x32_bf16 v[140:143], v[188:191], a[188:191], v[140:143]
s_waitcnt lgkmcnt(6)
ds_read_b64_tr_b16 v[184:185], v4 offset:16384
ds_read_b64_tr_b16 v[186:187], v4 offset:16896
v_mfma_f32_16x16x32_bf16 v[140:143], v[160:163], a[204:207], v[140:143]
s_lshl_b32 s72, s72, 12
v_mul_f32 v80, v48, v80
v_mul_f32 v81, v49, v81
v_mfma_f32_16x16x32_bf16 v[144:147], v[164:167], a[160:163], 0
s_mul_i32 s16, s39, 147456
v_mul_f32 v82, v50, v82
v_mul_f32 v83, v51, v83
v_mfma_f32_16x16x32_bf16 v[144:147], v[168:171], a[176:179], v[144:147]
s_waitcnt lgkmcnt(6)
ds_read_b64_tr_b16 v[188:189], v5 offset:0
ds_read_b64_tr_b16 v[190:191], v5 offset:512
v_mfma_f32_16x16x32_bf16 v[144:147], v[172:175], a[192:195], v[144:147]
s_mul_i32 s17, s40, 147456
v_add_f32 v18, 1.0, v18
v_add_f32 v19, 1.0, v19
v_mfma_f32_16x16x32_bf16 v[148:151], v[164:167], a[164:167], 0
s_mul_i32 s18, s41, 147456
v_add_f32 v20, 1.0, v20
v_add_f32 v21, 1.0, v21
v_mfma_f32_16x16x32_bf16 v[148:151], v[168:171], a[180:183], v[148:151]
ds_read_b64_tr_b16 v[160:161], v5 offset:8192
ds_read_b64_tr_b16 v[162:163], v5 offset:8704
v_mfma_f32_16x16x32_bf16 v[148:151], v[172:175], a[196:199], v[148:151]
s_mul_i32 s19, s50, 147456
v_rcp_f32 v18, v18
v_mfma_f32_16x16x32_bf16 v[152:155], v[164:167], a[168:171], 0
s_sub_u32 s16, s16, 8192
v_rcp_f32 v19, v19
v_mfma_f32_16x16x32_bf16 v[152:155], v[168:171], a[184:187], v[152:155]
v_rcp_f32 v20, v20
v_mfma_f32_16x16x32_bf16 v[152:155], v[172:175], a[200:203], v[152:155]
s_sub_u32 s17, s17, 8192
v_rcp_f32 v21, v21
v_mfma_f32_16x16x32_bf16 v[156:159], v[164:167], a[172:175], 0
s_sub_u32 s18, s18, 8192
v_mul_f32 v80, v80, v18
v_mul_f32 v81, v81, v19
v_mfma_f32_16x16x32_bf16 v[156:159], v[168:171], a[188:191], v[156:159]
s_waitcnt lgkmcnt(6)
ds_read_b64_tr_b16 v[164:165], v5 offset:16384
ds_read_b64_tr_b16 v[166:167], v5 offset:16896
v_mfma_f32_16x16x32_bf16 v[156:159], v[172:175], a[204:207], v[156:159]
s_sub_u32 s19, s19, 8192
v_mul_f32 v82, v82, v20
v_mul_f32 v83, v83, v21
v_mfma_f32_16x16x32_bf16 v[96:99], v[176:179], a[208:211], v[96:99]
s_lshl_b32 s39, s39, 12
v_cvt_pk_bf16_f32 v34, v80, v81
v_cvt_pk_bf16_f32 v35, v82, v83
v_mfma_f32_16x16x32_bf16 v[96:99], v[180:183], a[224:227], v[96:99]
s_waitcnt lgkmcnt(6)
ds_read_b64_tr_b16 v[168:169], v4 offset:4096
ds_read_b64_tr_b16 v[170:171], v4 offset:4608
v_mfma_f32_16x16x32_bf16 v[96:99], v[184:187], a[240:243], v[96:99]
s_lshl_b32 s40, s40, 12
v_mul_f32 v14, s53, v36
v_mul_f32 v15, s53, v37
v_mfma_f32_16x16x32_bf16 v[100:103], v[176:179], a[212:215], v[100:103]
s_lshl_b32 s41, s41, 12
v_mul_f32 v16, s53, v38
v_mul_f32 v17, s53, v39
v_mfma_f32_16x16x32_bf16 v[100:103], v[180:183], a[228:231], v[100:103]
ds_read_b64_tr_b16 v[172:173], v4 offset:12288
ds_read_b64_tr_b16 v[174:175], v4 offset:12800
v_mfma_f32_16x16x32_bf16 v[100:103], v[184:187], a[244:247], v[100:103]
s_lshl_b32 s50, s50, 12
v_exp_f32 v14, v14
v_mfma_f32_16x16x32_bf16 v[104:107], v[176:179], a[216:219], v[104:107]
v_exp_f32 v15, v15
v_mfma_f32_16x16x32_bf16 v[104:107], v[180:183], a[232:235], v[104:107]
v_exp_f32 v16, v16
v_mfma_f32_16x16x32_bf16 v[104:107], v[184:187], a[248:251], v[104:107]
s_cmp_lt_u32 s76, 2
s_cselect_b32 s61, 64, 72
s_cselect_b32 s62, 0, 128
s_cselect_b32 s65, 0, 1
v_exp_f32 v17, v17
v_mfma_f32_16x16x32_bf16 v[108:111], v[176:179], a[220:223], v[108:111]
v_mul_f32 v68, v36, v68
v_mul_f32 v69, v37, v69
v_mfma_f32_16x16x32_bf16 v[108:111], v[180:183], a[236:239], v[108:111]
s_waitcnt lgkmcnt(6)
ds_read_b64_tr_b16 v[176:177], v4 offset:20480
ds_read_b64_tr_b16 v[178:179], v4 offset:20992
v_mfma_f32_16x16x32_bf16 v[108:111], v[184:187], a[252:255], v[108:111]
s_cmp_lt_u32 s76, 2
s_cselect_b32 s70, 0x40000000, s70
s_cselect_b32 s46, 0, -1
v_mul_f32 v70, v38, v70
v_mul_f32 v71, v39, v71
v_mfma_f32_16x16x32_bf16 v[112:115], v[188:191], a[208:211], v[112:115]
s_and_b32 s63, s76, 1
v_add_f32 v14, 1.0, v14
v_add_f32 v15, 1.0, v15
v_mfma_f32_16x16x32_bf16 v[112:115], v[160:163], a[224:227], v[112:115]
s_waitcnt lgkmcnt(6)
ds_read_b64_tr_b16 v[180:181], v5 offset:4096
ds_read_b64_tr_b16 v[182:183], v5 offset:4608
v_mfma_f32_16x16x32_bf16 v[112:115], v[164:167], a[240:243], v[112:115]
s_mul_i32 s63, s63, s61
v_add_f32 v16, 1.0, v16
v_add_f32 v17, 1.0, v17
v_mfma_f32_16x16x32_bf16 v[116:119], v[188:191], a[212:215], v[116:119]
s_add_u32 s62, s62, s63
v_rcp_f32 v14, v14
v_mfma_f32_16x16x32_bf16 v[116:119], v[160:163], a[228:231], v[116:119]
ds_read_b64_tr_b16 v[184:185], v5 offset:12288
ds_read_b64_tr_b16 v[186:187], v5 offset:12800
v_mfma_f32_16x16x32_bf16 v[116:119], v[164:167], a[244:247], v[116:119]
s_add_u32 s38, s62, s3
v_rcp_f32 v15, v15
v_mfma_f32_16x16x32_bf16 v[120:123], v[188:191], a[216:219], v[120:123]
s_mul_i32 s38, s38, 36864
v_rcp_f32 v16, v16
v_mfma_f32_16x16x32_bf16 v[120:123], v[160:163], a[232:235], v[120:123]
v_rcp_f32 v17, v17
v_mfma_f32_16x16x32_bf16 v[120:123], v[164:167], a[248:251], v[120:123]
s_mul_i32 s60, s78, 9216
v_mul_f32 v68, v68, v14
v_mul_f32 v69, v69, v15
v_mfma_f32_16x16x32_bf16 v[124:127], v[188:191], a[220:223], v[124:127]
s_add_u32 s38, s38, s60
v_mul_f32 v70, v70, v16
v_mul_f32 v71, v71, v17
v_mfma_f32_16x16x32_bf16 v[124:127], v[160:163], a[236:239], v[124:127]
s_waitcnt lgkmcnt(6)
ds_read_b64_tr_b16 v[188:189], v5 offset:20480
ds_read_b64_tr_b16 v[190:191], v5 offset:20992
v_mfma_f32_16x16x32_bf16 v[124:127], v[164:167], a[252:255], v[124:127]
s_add_u32 s38, s38, 67108864
v_cvt_pk_bf16_f32 v36, v68, v69
v_cvt_pk_bf16_f32 v37, v70, v71
v_mfma_f32_16x16x32_bf16 v[128:131], v[168:171], a[208:211], v[128:131]
s_lshl_b32 s60, s77, 3
v_mul_f32 v18, s53, v52
v_mul_f32 v19, s53, v53
v_mfma_f32_16x16x32_bf16 v[128:131], v[172:175], a[224:227], v[128:131]
s_waitcnt lgkmcnt(6)
ds_read_b64_tr_b16 v[160:161], v4 offset:24576
ds_read_b64_tr_b16 v[162:163], v4 offset:25088
v_mfma_f32_16x16x32_bf16 v[128:131], v[176:179], a[240:243], v[128:131]
s_lshl_b32 s61, s3, 1
v_mul_f32 v20, s53, v54
v_mul_f32 v21, s53, v55
v_mfma_f32_16x16x32_bf16 v[132:135], v[168:171], a[212:215], v[132:135]
s_add_u32 s60, s60, s61
v_exp_f32 v18, v18
v_mfma_f32_16x16x32_bf16 v[132:135], v[172:175], a[228:231], v[132:135]
ds_read_b64_tr_b16 v[164:165], v4 offset:32768
ds_read_b64_tr_b16 v[166:167], v4 offset:33280
v_mfma_f32_16x16x32_bf16 v[132:135], v[176:179], a[244:247], v[132:135]
s_mul_i32 s44, s60, 273
v_exp_f32 v19, v19
v_mfma_f32_16x16x32_bf16 v[136:139], v[168:171], a[216:219], v[136:139]
s_add_u32 s44, s44, s62
v_exp_f32 v20, v20
v_mfma_f32_16x16x32_bf16 v[136:139], v[172:175], a[232:235], v[136:139]
v_exp_f32 v21, v21
v_mfma_f32_16x16x32_bf16 v[136:139], v[176:179], a[248:251], v[136:139]
s_lshl_b32 s44, s44, 10
v_mul_f32 v84, v52, v84
v_mul_f32 v85, v53, v85
v_mfma_f32_16x16x32_bf16 v[140:143], v[168:171], a[220:223], v[140:143]
s_add_u32 s44, s44, 4194304
v_mul_f32 v86, v54, v86
v_mul_f32 v87, v55, v87
v_mfma_f32_16x16x32_bf16 v[140:143], v[172:175], a[236:239], v[140:143]
s_waitcnt lgkmcnt(6)
ds_read_b64_tr_b16 v[168:169], v4 offset:40960
ds_read_b64_tr_b16 v[170:171], v4 offset:41472
v_mfma_f32_16x16x32_bf16 v[140:143], v[176:179], a[252:255], v[140:143]
s_add_u32 s45, s44, 279552
v_add_f32 v18, 1.0, v18
v_add_f32 v19, 1.0, v19
v_mfma_f32_16x16x32_bf16 v[144:147], v[180:183], a[208:211], v[144:147]
s_mul_i32 s60, s64, 147456
v_add_f32 v20, 1.0, v20
v_add_f32 v21, 1.0, v21
v_mfma_f32_16x16x32_bf16 v[144:147], v[184:187], a[224:227], v[144:147]
s_waitcnt lgkmcnt(6)
ds_read_b64_tr_b16 v[172:173], v5 offset:24576
ds_read_b64_tr_b16 v[174:175], v5 offset:25088
v_mfma_f32_16x16x32_bf16 v[144:147], v[188:191], a[240:243], v[144:147]
s_add_u32 s38, s38, s60
v_rcp_f32 v18, v18
v_mfma_f32_16x16x32_bf16 v[148:151], v[180:183], a[212:215], v[148:151]
s_waitcnt vmcnt(0)
s_barrier
v_rcp_f32 v19, v19
v_mfma_f32_16x16x32_bf16 v[148:151], v[184:187], a[228:231], v[148:151]
ds_read_b64_tr_b16 v[176:177], v5 offset:32768
ds_read_b64_tr_b16 v[178:179], v5 offset:33280
v_mfma_f32_16x16x32_bf16 v[148:151], v[188:191], a[244:247], v[148:151]
s_lshl_b32 s60, s64, 12
v_rcp_f32 v20, v20
v_mfma_f32_16x16x32_bf16 v[152:155], v[180:183], a[216:219], v[152:155]
s_add_u32 s44, s44, s60
v_rcp_f32 v21, v21
v_mfma_f32_16x16x32_bf16 v[152:155], v[184:187], a[232:235], v[152:155]
v_mul_f32 v84, v84, v18
v_mul_f32 v85, v85, v19
v_mfma_f32_16x16x32_bf16 v[152:155], v[188:191], a[248:251], v[152:155]
s_add_u32 s45, s45, s60
v_mul_f32 v86, v86, v20
v_mul_f32 v87, v87, v21
v_mfma_f32_16x16x32_bf16 v[156:159], v[180:183], a[220:223], v[156:159]
s_add_u32 s47, s73, 3
v_add_u32_e64 v30, s73, 4
v_cvt_pk_bf16_f32 v38, v84, v85
v_mfma_f32_16x16x32_bf16 v[156:159], v[184:187], a[236:239], v[156:159]
s_waitcnt lgkmcnt(4)
ds_read_b64_tr_b16 v[180:181], v5 offset:40960
ds_read_b64_tr_b16 v[182:183], v5 offset:41472
v_mfma_f32_16x16x32_bf16 v[156:159], v[188:191], a[252:255], v[156:159]
buffer_store_dword v30, v31, s[8:11], s69 offen sc1
v_mfma_f32_16x16x32_bf16 v[96:99], v[160:163], v[224:227], v[96:99]
s_mov_b32 s51, s55
v_cvt_pk_bf16_f32 v39, v86, v87
v_mul_f32 v14, s53, v40
v_mfma_f32_16x16x32_bf16 v[96:99], v[164:167], v[240:243], v[96:99]
s_add_u32 m0, s52, 139264
ds_read_b64_tr_b16 v[184:185], v4 offset:28672
ds_read_b64_tr_b16 v[186:187], v4 offset:29184
v_mfma_f32_16x16x32_bf16 v[96:99], v[168:171], v[192:195], v[96:99]
buffer_load_dwordx4 v9, s[24:27], s51 offen lds
v_mfma_f32_16x16x32_bf16 v[100:103], v[160:163], v[228:231], v[100:103]
s_mov_b32 s42, 3
v_mul_f32 v15, s53, v41
v_mul_f32 v16, s53, v42
v_mfma_f32_16x16x32_bf16 v[100:103], v[164:167], v[244:247], v[100:103]
ds_read_b64_tr_b16 v[188:189], v4 offset:36864
ds_read_b64_tr_b16 v[190:191], v4 offset:37376
v_mfma_f32_16x16x32_bf16 v[100:103], v[168:171], v[196:199], v[100:103]
s_lshr_b32 s60, s77, 1
v_mul_f32 v17, s53, v43
v_mfma_f32_16x16x32_bf16 v[104:107], v[160:163], v[232:235], v[104:107]
s_lshl_b32 s60, s60, 13
v_exp_f32 v14, v14
v_mfma_f32_16x16x32_bf16 v[104:107], v[164:167], v[248:251], v[104:107]
s_waitcnt lgkmcnt(6)
v_exp_f32 v15, v15
v_mfma_f32_16x16x32_bf16 v[104:107], v[168:171], v[200:203], v[104:107]
s_and_b32 s61, s76, 1
v_exp_f32 v16, v16
v_mfma_f32_16x16x32_bf16 v[108:111], v[160:163], v[236:239], v[108:111]
s_lshl_b32 s61, s61, 12
v_exp_f32 v17, v17
v_mfma_f32_16x16x32_bf16 v[108:111], v[164:167], v[252:255], v[108:111]
s_add_u32 m0, s52, 143360
ds_read_b64_tr_b16 v[160:161], v4 offset:45056
ds_read_b64_tr_b16 v[162:163], v4 offset:45568
v_mfma_f32_16x16x32_bf16 v[108:111], v[168:171], v[204:207], v[108:111]
buffer_load_dwordx4 v9, s[28:31], s51 offen lds
v_mfma_f32_16x16x32_bf16 v[112:115], v[172:175], v[224:227], v[112:115]
s_add_u32 s68, s60, s61
v_mul_f32 v72, v40, v72
v_mul_f32 v73, v41, v73
v_mfma_f32_16x16x32_bf16 v[112:115], v[176:179], v[240:243], v[112:115]
s_waitcnt lgkmcnt(6)
ds_read_b64_tr_b16 v[164:165], v5 offset:28672
ds_read_b64_tr_b16 v[166:167], v5 offset:29184
v_mfma_f32_16x16x32_bf16 v[112:115], v[180:183], v[192:195], v[112:115]
s_add_u32 s68, s68, 3145728
v_mul_f32 v74, v42, v74
v_mul_f32 v75, v43, v75
v_mfma_f32_16x16x32_bf16 v[116:119], v[172:175], v[228:231], v[116:119]
s_mov_b32 s71, 3145728
v_add_f32 v14, 1.0, v14
v_add_f32 v15, 1.0, v15
v_mfma_f32_16x16x32_bf16 v[116:119], v[176:179], v[244:247], v[116:119]
ds_read_b64_tr_b16 v[168:169], v5 offset:36864
ds_read_b64_tr_b16 v[170:171], v5 offset:37376
v_mfma_f32_16x16x32_bf16 v[116:119], v[180:183], v[196:199], v[116:119]
s_mul_i32 s36, s3, 18
v_add_f32 v16, 1.0, v16
v_add_f32 v17, 1.0, v17
v_mfma_f32_16x16x32_bf16 v[120:123], v[172:175], v[232:235], v[120:123]
s_add_u32 s36, s36, s62
v_rcp_f32 v14, v14
v_mfma_f32_16x16x32_bf16 v[120:123], v[176:179], v[248:251], v[120:123]
s_waitcnt lgkmcnt(6)
v_rcp_f32 v15, v15
v_mfma_f32_16x16x32_bf16 v[120:123], v[180:183], v[200:203], v[120:123]
s_mul_i32 s34, s3, 9216
v_rcp_f32 v16, v16
v_mfma_f32_16x16x32_bf16 v[124:127], v[172:175], v[236:239], v[124:127]
s_add_u32 s51, s51, 589824
v_rcp_f32 v17, v17
v_mfma_f32_16x16x32_bf16 v[124:127], v[176:179], v[252:255], v[124:127]
s_add_u32 m0, s52, 147456
ds_read_b64_tr_b16 v[172:173], v5 offset:45056
ds_read_b64_tr_b16 v[174:175], v5 offset:45568
v_mfma_f32_16x16x32_bf16 v[124:127], v[180:183], v[204:207], v[124:127]
buffer_load_dwordx4 v9, s[24:27], s51 offen lds
v_mul_f32 v72, v72, v14
v_mfma_f32_16x16x32_bf16 v[128:131], v[184:187], v[224:227], v[128:131]
s_lshl_b32 s37, s77, 2
v_mul_f32 v73, v73, v15
v_mul_f32 v74, v74, v16
v_mfma_f32_16x16x32_bf16 v[128:131], v[188:191], v[240:243], v[128:131]
s_waitcnt lgkmcnt(6)
ds_read_b64_tr_b16 v[176:177], v4 offset:49152
ds_read_b64_tr_b16 v[178:179], v4 offset:49664
v_mfma_f32_16x16x32_bf16 v[128:131], v[160:163], v[192:195], v[128:131]
s_add_u32 s37, s37, s78
v_mul_f32 v75, v75, v17
v_cvt_pk_bf16_f32 v40, v72, v73
v_mfma_f32_16x16x32_bf16 v[132:135], v[184:187], v[228:231], v[132:135]
s_lshl_b32 s37, s37, 2
v_cvt_pk_bf16_f32 v41, v74, v75
v_mul_f32 v18, s53, v56
v_mfma_f32_16x16x32_bf16 v[132:135], v[188:191], v[244:247], v[132:135]
ds_read_b64_tr_b16 v[180:181], v4 offset:57344
ds_read_b64_tr_b16 v[182:183], v4 offset:57856
v_mfma_f32_16x16x32_bf16 v[132:135], v[160:163], v[196:199], v[132:135]
s_mov_b32 s20, s6
v_mul_f32 v19, s53, v57
v_mul_f32 v20, s53, v58
v_mfma_f32_16x16x32_bf16 v[136:139], v[184:187], v[232:235], v[136:139]
s_mov_b32 s21, s7
v_mul_f32 v21, s53, v59
v_mfma_f32_16x16x32_bf16 v[136:139], v[188:191], v[248:251], v[136:139]
s_add_u32 m0, s52, 151552
v_exp_f32 v18, v18
v_mfma_f32_16x16x32_bf16 v[136:139], v[160:163], v[200:203], v[136:139]
buffer_load_dwordx4 v9, s[28:31], s51 offen lds
v_mfma_f32_16x16x32_bf16 v[140:143], v[184:187], v[236:239], v[140:143]
s_mov_b32 s22, 2359296
v_exp_f32 v19, v19
v_mfma_f32_16x16x32_bf16 v[140:143], v[188:191], v[252:255], v[140:143]
s_waitcnt lgkmcnt(6)
ds_read_b64_tr_b16 v[184:185], v6 offset:0
ds_read_b64_tr_b16 v[186:187], v6 offset:512
v_mfma_f32_16x16x32_bf16 v[140:143], v[160:163], v[204:207], v[140:143]
s_mov_b32 s23, 0x20000
v_exp_f32 v20, v20
v_mfma_f32_16x16x32_bf16 v[144:147], v[164:167], v[224:227], v[144:147]
s_mov_b32 s12, s100
v_exp_f32 v21, v21
v_mfma_f32_16x16x32_bf16 v[144:147], v[168:171], v[240:243], v[144:147]
s_waitcnt lgkmcnt(6)
ds_read_b64_tr_b16 v[188:189], v5 offset:49152
ds_read_b64_tr_b16 v[190:191], v5 offset:49664
v_mfma_f32_16x16x32_bf16 v[144:147], v[172:175], v[192:195], v[144:147]
s_mov_b32 s13, s101
v_mul_f32 v88, v56, v88
v_mul_f32 v89, v57, v89
v_mfma_f32_16x16x32_bf16 v[148:151], v[164:167], v[228:231], v[148:151]
s_add_u32 s51, s51, 589824
v_mul_f32 v90, v58, v90
v_mul_f32 v91, v59, v91
v_mfma_f32_16x16x32_bf16 v[148:151], v[168:171], v[244:247], v[148:151]
s_add_u32 m0, s52, 155648
ds_read_b64_tr_b16 v[160:161], v5 offset:57344
ds_read_b64_tr_b16 v[162:163], v5 offset:57856
v_mfma_f32_16x16x32_bf16 v[148:151], v[172:175], v[196:199], v[148:151]
buffer_load_dwordx4 v9, s[24:27], s51 offen lds
v_mfma_f32_16x16x32_bf16 v[152:155], v[164:167], v[232:235], v[152:155]
s_mov_b32 s14, 2359296
v_add_f32 v18, 1.0, v18
v_add_f32 v19, 1.0, v19
v_mfma_f32_16x16x32_bf16 v[152:155], v[168:171], v[248:251], v[152:155]
v_add_f32 v20, 1.0, v20
v_add_f32 v21, 1.0, v21
v_mfma_f32_16x16x32_bf16 v[152:155], v[172:175], v[200:203], v[152:155]
s_mov_b32 s15, 0x20000
v_rcp_f32 v18, v18
v_mfma_f32_16x16x32_bf16 v[156:159], v[164:167], v[236:239], v[156:159]
v_rcp_f32 v19, v19
v_mfma_f32_16x16x32_bf16 v[156:159], v[168:171], v[252:255], v[156:159]
ds_read_b64_tr_b16 v[164:165], v7 offset:0
ds_read_b64_tr_b16 v[166:167], v7 offset:512
v_mfma_f32_16x16x32_bf16 v[156:159], v[172:175], v[204:207], v[156:159]
s_waitcnt lgkmcnt(10)
v_min_u32 v26, 17, v2
v_add_u32 v26, s36, v26
v_mfma_f32_16x16x32_bf16 v[96:99], v[176:179], v[208:211], v[96:99]
s_waitcnt lgkmcnt(8)
v_min_u32 v26, 255, v26
v_and_b32 v27, 3, v2
v_mfma_f32_16x16x32_bf16 v[96:99], v[180:183], a[128:131], v[96:99]
s_waitcnt lgkmcnt(6)
ds_read_b64_tr_b16 v[168:169], v4 offset:53248
ds_read_b64_tr_b16 v[170:171], v4 offset:53760
v_mfma_f32_16x16x32_bf16 v[96:99], v[184:187], a[144:147], v[96:99]
v_add_u32 v27, s37, v27
v_cmp_gt_u32 vcc, 32, v2
v_mfma_f32_16x16x32_bf16 v[100:103], v[176:179], v[212:215], v[100:103]
v_mov_b32 v25, 0
v_cndmask_b32 v26, v27, v26, vcc
v_mfma_f32_16x16x32_bf16 v[100:103], v[180:183], a[132:135], v[100:103]
s_add_u32 m0, s52, 159744
ds_read_b64_tr_b16 v[172:173], v4 offset:61440
ds_read_b64_tr_b16 v[174:175], v4 offset:61952
v_mfma_f32_16x16x32_bf16 v[100:103], v[184:187], a[148:151], v[100:103]
buffer_load_dwordx4 v9, s[28:31], s51 offen lds
v_mfma_f32_16x16x32_bf16 v[104:107], v[176:179], v[216:219], v[104:107]
v_lshlrev_b32 v26, 8, v26
v_mfma_f32_16x16x32_bf16 v[104:107], v[180:183], a[136:139], v[104:107]
v_rcp_f32 v20, v20
v_mfma_f32_16x16x32_bf16 v[104:107], v[184:187], a[152:155], v[104:107]
buffer_load_dwordx2 v[24:25], v26, s[8:11], s71 offen sc1
v_mfma_f32_16x16x32_bf16 v[108:111], v[176:179], v[220:223], v[108:111]
v_rcp_f32 v21, v21
v_mfma_f32_16x16x32_bf16 v[108:111], v[180:183], a[140:143], v[108:111]
ds_read_b64_tr_b16 v[176:177], v6 offset:4096
ds_read_b64_tr_b16 v[178:179], v6 offset:4608
v_mfma_f32_16x16x32_bf16 v[108:111], v[184:187], a[156:159], v[108:111]
s_waitcnt lgkmcnt(6)
v_mul_f32 v88, v88, v18
v_mul_f32 v89, v89, v19
v_mfma_f32_16x16x32_bf16 v[112:115], v[188:191], v[208:211], v[112:115]
s_add_u32 s51, s51, 589824
v_mul_f32 v90, v90, v20
v_mul_f32 v91, v91, v21
v_mfma_f32_16x16x32_bf16 v[112:115], v[160:163], a[128:131], v[112:115]
s_add_u32 m0, s52, 0
ds_read_b64_tr_b16 v[180:181], v5 offset:53248
ds_read_b64_tr_b16 v[182:183], v5 offset:53760
v_mfma_f32_16x16x32_bf16 v[112:115], v[164:167], a[144:147], v[112:115]
buffer_load_dwordx4 v9, s[24:27], s51 offen lds
v_mfma_f32_16x16x32_bf16 v[116:119], v[188:191], v[212:215], v[116:119]
v_cvt_pk_bf16_f32 v42, v88, v89
v_cvt_pk_bf16_f32 v43, v90, v91
v_mfma_f32_16x16x32_bf16 v[116:119], v[160:163], a[132:135], v[116:119]
ds_read_b64_tr_b16 v[184:185], v5 offset:61440
ds_read_b64_tr_b16 v[186:187], v5 offset:61952
v_mfma_f32_16x16x32_bf16 v[116:119], v[164:167], a[148:151], v[116:119]
v_mul_f32 v14, s53, v44
v_mul_f32 v15, s53, v45
v_mfma_f32_16x16x32_bf16 v[120:123], v[188:191], v[216:219], v[120:123]
v_mul_f32 v16, s53, v46
v_mul_f32 v17, s53, v47
v_mfma_f32_16x16x32_bf16 v[120:123], v[160:163], a[136:139], v[120:123]
v_exp_f32 v14, v14
v_mfma_f32_16x16x32_bf16 v[120:123], v[164:167], a[152:155], v[120:123]
v_exp_f32 v15, v15
v_mfma_f32_16x16x32_bf16 v[124:127], v[188:191], v[220:223], v[124:127]
s_waitcnt lgkmcnt(8)
v_exp_f32 v16, v16
v_mfma_f32_16x16x32_bf16 v[124:127], v[160:163], a[140:143], v[124:127]
s_add_u32 m0, s52, 4096
ds_read_b64_tr_b16 v[188:189], v7 offset:4096
ds_read_b64_tr_b16 v[190:191], v7 offset:4608
v_mfma_f32_16x16x32_bf16 v[124:127], v[164:167], a[156:159], v[124:127]
buffer_load_dwordx4 v9, s[28:31], s51 offen lds
v_mfma_f32_16x16x32_bf16 v[128:131], v[168:171], v[208:211], v[128:131]
s_waitcnt lgkmcnt(8)
v_exp_f32 v17, v17
v_mfma_f32_16x16x32_bf16 v[128:131], v[172:175], a[128:131], v[128:131]
s_waitcnt lgkmcnt(6)
ds_read_b64_tr_b16 v[160:161], v6 offset:8192
ds_read_b64_tr_b16 v[162:163], v6 offset:8704
v_mfma_f32_16x16x32_bf16 v[128:131], v[176:179], a[144:147], v[128:131]
v_mul_f32 v76, v44, v76
v_mul_f32 v77, v45, v77
v_mfma_f32_16x16x32_bf16 v[132:135], v[168:171], v[212:215], v[132:135]
v_mul_f32 v78, v46, v78
v_mul_f32 v79, v47, v79
v_mfma_f32_16x16x32_bf16 v[132:135], v[172:175], a[132:135], v[132:135]
ds_read_b64_tr_b16 v[164:165], v6 offset:16384
ds_read_b64_tr_b16 v[166:167], v6 offset:16896
v_mfma_f32_16x16x32_bf16 v[132:135], v[176:179], a[148:151], v[132:135]
v_add_f32 v14, 1.0, v14
v_add_f32 v15, 1.0, v15
v_mfma_f32_16x16x32_bf16 v[136:139], v[168:171], v[216:219], v[136:139]
v_add_f32 v16, 1.0, v16
v_add_f32 v17, 1.0, v17
v_mfma_f32_16x16x32_bf16 v[136:139], v[172:175], a[136:139], v[136:139]
v_rcp_f32 v14, v14
v_mfma_f32_16x16x32_bf16 v[136:139], v[176:179], a[152:155], v[136:139]
s_waitcnt lgkmcnt(8)
v_rcp_f32 v15, v15
v_mfma_f32_16x16x32_bf16 v[140:143], v[168:171], v[220:223], v[140:143]
s_add_u32 s51, s51, 589824
v_rcp_f32 v16, v16
v_mfma_f32_16x16x32_bf16 v[140:143], v[172:175], a[140:143], v[140:143]
s_add_u32 m0, s52, 8192
ds_read_b64_tr_b16 v[168:169], v6 offset:24576
ds_read_b64_tr_b16 v[170:171], v6 offset:25088
v_mfma_f32_16x16x32_bf16 v[140:143], v[176:179], a[156:159], v[140:143]
buffer_load_dwordx4 v9, s[24:27], s51 offen lds
v_mfma_f32_16x16x32_bf16 v[144:147], v[180:183], v[208:211], v[144:147]
s_waitcnt lgkmcnt(8)
v_rcp_f32 v17, v17
v_mfma_f32_16x16x32_bf16 v[144:147], v[184:187], a[128:131], v[144:147]
s_waitcnt lgkmcnt(6)
ds_read_b64_tr_b16 v[172:173], v7 offset:8192
ds_read_b64_tr_b16 v[174:175], v7 offset:8704
v_mfma_f32_16x16x32_bf16 v[144:147], v[188:191], a[144:147], v[144:147]
v_mul_f32 v76, v76, v14
v_mul_f32 v77, v77, v15
v_mfma_f32_16x16x32_bf16 v[148:151], v[180:183], v[212:215], v[148:151]
s_barrier
v_mul_f32 v78, v78, v16
v_mul_f32 v79, v79, v17
v_mfma_f32_16x16x32_bf16 v[148:151], v[184:187], a[132:135], v[148:151]
ds_read_b64_tr_b16 v[176:177], v7 offset:16384
ds_read_b64_tr_b16 v[178:179], v7 offset:16896
v_mfma_f32_16x16x32_bf16 v[148:151], v[188:191], a[148:151], v[148:151]
v_cvt_pk_bf16_f32 v44, v76, v77
v_cvt_pk_bf16_f32 v45, v78, v79
v_mfma_f32_16x16x32_bf16 v[152:155], v[180:183], v[216:219], v[152:155]
v_mul_f32 v18, s53, v60
v_mul_f32 v19, s53, v61
v_mfma_f32_16x16x32_bf16 v[152:155], v[184:187], a[136:139], v[152:155]
s_add_u32 m0, s52, 12288
v_mul_f32 v20, s53, v62
v_mul_f32 v21, s53, v63
v_mfma_f32_16x16x32_bf16 v[152:155], v[188:191], a[152:155], v[152:155]
buffer_load_dwordx4 v9, s[28:31], s51 offen lds
v_mfma_f32_16x16x32_bf16 v[156:159], v[180:183], v[220:223], v[156:159]
v_exp_f32 v18, v18
v_mfma_f32_16x16x32_bf16 v[156:159], v[184:187], a[140:143], v[156:159]
ds_read_b64_tr_b16 v[180:181], v7 offset:24576
ds_read_b64_tr_b16 v[182:183], v7 offset:25088
v_mfma_f32_16x16x32_bf16 v[156:159], v[188:191], a[156:159], v[156:159]
s_waitcnt lgkmcnt(10)
v_exp_f32 v19, v19
v_mfma_f32_16x16x32_bf16 v[96:99], v[160:163], a[0:3], v[96:99]
s_waitcnt lgkmcnt(8)
v_exp_f32 v20, v20
v_mfma_f32_16x16x32_bf16 v[96:99], v[164:167], a[16:19], v[96:99]
s_waitcnt lgkmcnt(6)
ds_read_b64_tr_b16 v[184:185], v6 offset:12288
ds_read_b64_tr_b16 v[186:187], v6 offset:12800
v_mfma_f32_16x16x32_bf16 v[96:99], v[168:171], a[32:35], v[96:99]
v_exp_f32 v21, v21
v_mfma_f32_16x16x32_bf16 v[100:103], v[160:163], a[4:7], v[100:103]
s_add_u32 s51, s51, 589824
v_mul_f32 v92, v60, v92
v_mul_f32 v93, v61, v93
v_mfma_f32_16x16x32_bf16 v[100:103], v[164:167], a[20:23], v[100:103]
s_add_u32 m0, s52, 16384
ds_read_b64_tr_b16 v[188:189], v6 offset:20480
ds_read_b64_tr_b16 v[190:191], v6 offset:20992
v_mfma_f32_16x16x32_bf16 v[100:103], v[168:171], a[36:39], v[100:103]
buffer_load_dwordx4 v9, s[24:27], s51 offen lds
v_mfma_f32_16x16x32_bf16 v[104:107], v[160:163], a[8:11], v[104:107]
v_mul_f32 v94, v62, v94
v_mul_f32 v95, v63, v95
v_mfma_f32_16x16x32_bf16 v[104:107], v[164:167], a[24:27], v[104:107]
v_add_f32 v18, 1.0, v18
v_add_f32 v19, 1.0, v19
v_mfma_f32_16x16x32_bf16 v[104:107], v[168:171], a[40:43], v[104:107]
v_add_f32 v20, 1.0, v20
v_add_f32 v21, 1.0, v21
v_mfma_f32_16x16x32_bf16 v[108:111], v[160:163], a[12:15], v[108:111]
v_rcp_f32 v18, v18
v_mfma_f32_16x16x32_bf16 v[108:111], v[164:167], a[28:31], v[108:111]
ds_read_b64_tr_b16 v[160:161], v6 offset:28672
ds_read_b64_tr_b16 v[162:163], v6 offset:29184
v_mfma_f32_16x16x32_bf16 v[108:111], v[168:171], a[44:47], v[108:111]
s_waitcnt lgkmcnt(10)
v_rcp_f32 v19, v19
v_mfma_f32_16x16x32_bf16 v[112:115], v[172:175], a[0:3], v[112:115]
s_waitcnt lgkmcnt(8)
v_rcp_f32 v20, v20
v_mfma_f32_16x16x32_bf16 v[112:115], v[176:179], a[16:19], v[112:115]
s_waitcnt lgkmcnt(6)
ds_read_b64_tr_b16 v[164:165], v7 offset:12288
ds_read_b64_tr_b16 v[166:167], v7 offset:12800
v_mfma_f32_16x16x32_bf16 v[112:115], v[180:183], a[32:35], v[112:115]
v_rcp_f32 v21, v21
v_mfma_f32_16x16x32_bf16 v[116:119], v[172:175], a[4:7], v[116:119]
v_mul_f32 v92, v92, v18
v_mul_f32 v93, v93, v19
v_mfma_f32_16x16x32_bf16 v[116:119], v[176:179], a[20:23], v[116:119]
s_add_u32 m0, s52, 20480
ds_read_b64_tr_b16 v[168:169], v7 offset:20480
ds_read_b64_tr_b16 v[170:171], v7 offset:20992
v_mfma_f32_16x16x32_bf16 v[116:119], v[180:183], a[36:39], v[116:119]
buffer_load_dwordx4 v9, s[28:31], s51 offen lds
v_mfma_f32_16x16x32_bf16 v[120:123], v[172:175], a[8:11], v[120:123]
s_add_u32 s51, s51, 589824
v_mul_f32 v94, v94, v20
v_mul_f32 v95, v95, v21
v_mfma_f32_16x16x32_bf16 v[120:123], v[176:179], a[24:27], v[120:123]
v_cvt_pk_bf16_f32 v46, v92, v93
v_cvt_pk_bf16_f32 v47, v94, v95
v_mfma_f32_16x16x32_bf16 v[120:123], v[180:183], a[40:43], v[120:123]
v_add_u32 v48, 49152, v3
v_add_u32 v49, 86016, v3
v_mfma_f32_16x16x32_bf16 v[124:127], v[172:175], a[12:15], v[124:127]
s_waitcnt lgkmcnt(8)
v_add_u32 v50, 122880, v3
v_add_u32 v51, 0, v3
v_mfma_f32_16x16x32_bf16 v[124:127], v[176:179], a[28:31], v[124:127]
s_add_u32 m0, s52, 24576
ds_read_b64_tr_b16 v[172:173], v7 offset:28672
ds_read_b64_tr_b16 v[174:175], v7 offset:29184
v_mfma_f32_16x16x32_bf16 v[124:127], v[180:183], a[44:47], v[124:127]
buffer_load_dwordx4 v9, s[24:27], s51 offen lds
v_mfma_f32_16x16x32_bf16 v[128:131], v[184:187], a[0:3], v[128:131]
s_waitcnt lgkmcnt(8)
v_and_b32 v80, 15, v2
v_lshlrev_b32 v80, 8, v80
v_mfma_f32_16x16x32_bf16 v[128:131], v[188:191], a[16:19], v[128:131]
s_waitcnt lgkmcnt(6)
ds_read_b64_tr_b16 v[176:177], v6 offset:32768
ds_read_b64_tr_b16 v[178:179], v6 offset:33280
v_mfma_f32_16x16x32_bf16 v[128:131], v[160:163], a[32:35], v[128:131]
buffer_store_dwordx4 v[32:35], v3, s[8:11], s56 offen sc1
v_mfma_f32_16x16x32_bf16 v[132:135], v[184:187], a[4:7], v[132:135]
s_add_u32 s56, s56, 16384
v_mfma_f32_16x16x32_bf16 v[132:135], v[188:191], a[20:23], v[132:135]
ds_read_b64_tr_b16 v[180:181], v6 offset:40960
ds_read_b64_tr_b16 v[182:183], v6 offset:41472
v_mfma_f32_16x16x32_bf16 v[132:135], v[160:163], a[36:39], v[132:135]
v_mfma_f32_16x16x32_bf16 v[136:139], v[184:187], a[8:11], v[136:139]
v_mfma_f32_16x16x32_bf16 v[136:139], v[188:191], a[24:27], v[136:139]
v_mfma_f32_16x16x32_bf16 v[136:139], v[160:163], a[40:43], v[136:139]
v_mfma_f32_16x16x32_bf16 v[140:143], v[184:187], a[12:15], v[140:143]
s_waitcnt lgkmcnt(8)
v_mfma_f32_16x16x32_bf16 v[140:143], v[188:191], a[28:31], v[140:143]
s_add_u32 m0, s52, 28672
ds_read_b64_tr_b16 v[184:185], v6 offset:49152
ds_read_b64_tr_b16 v[186:187], v6 offset:49664
v_mfma_f32_16x16x32_bf16 v[140:143], v[160:163], a[44:47], v[140:143]
buffer_load_dwordx4 v9, s[28:31], s51 offen lds
v_mfma_f32_16x16x32_bf16 v[144:147], v[164:167], a[0:3], v[144:147]
s_waitcnt lgkmcnt(8)
v_mfma_f32_16x16x32_bf16 v[144:147], v[168:171], a[16:19], v[144:147]
s_waitcnt lgkmcnt(6)
ds_read_b64_tr_b16 v[188:189], v7 offset:32768
ds_read_b64_tr_b16 v[190:191], v7 offset:33280
v_mfma_f32_16x16x32_bf16 v[144:147], v[172:175], a[32:35], v[144:147]
buffer_store_dwordx4 v[36:39], v3, s[8:11], s57 offen sc1
v_mfma_f32_16x16x32_bf16 v[148:151], v[164:167], a[4:7], v[148:151]
s_add_u32 s57, s57, 16384
v_mfma_f32_16x16x32_bf16 v[148:151], v[168:171], a[20:23], v[148:151]
ds_read_b64_tr_b16 v[160:161], v7 offset:40960
ds_read_b64_tr_b16 v[162:163], v7 offset:41472
v_mfma_f32_16x16x32_bf16 v[148:151], v[172:175], a[36:39], v[148:151]
v_mfma_f32_16x16x32_bf16 v[152:155], v[164:167], a[8:11], v[152:155]
s_add_u32 s51, s51, 589824
v_mfma_f32_16x16x32_bf16 v[152:155], v[168:171], a[24:27], v[152:155]
s_add_u32 m0, s52, 32768
v_mfma_f32_16x16x32_bf16 v[152:155], v[172:175], a[40:43], v[152:155]
buffer_load_dwordx4 v9, s[24:27], s51 offen lds
v_mfma_f32_16x16x32_bf16 v[156:159], v[164:167], a[12:15], v[156:159]
v_mfma_f32_16x16x32_bf16 v[156:159], v[168:171], a[28:31], v[156:159]
ds_read_b64_tr_b16 v[164:165], v7 offset:49152
ds_read_b64_tr_b16 v[166:167], v7 offset:49664
v_mfma_f32_16x16x32_bf16 v[156:159], v[172:175], a[44:47], v[156:159]
s_waitcnt lgkmcnt(10)
v_mfma_f32_16x16x32_bf16 v[96:99], v[176:179], a[48:51], v[96:99]
s_waitcnt lgkmcnt(8)
v_mfma_f32_16x16x32_bf16 v[96:99], v[180:183], a[64:67], v[96:99]
s_waitcnt lgkmcnt(6)
ds_read_b64_tr_b16 v[168:169], v6 offset:36864
ds_read_b64_tr_b16 v[170:171], v6 offset:37376
v_mfma_f32_16x16x32_bf16 v[96:99], v[184:187], a[80:83], v[96:99]
buffer_store_dwordx4 v[40:43], v3, s[8:11], s58 offen sc1
v_mfma_f32_16x16x32_bf16 v[100:103], v[176:179], a[52:55], v[100:103]
s_add_u32 s58, s58, 16384
v_mfma_f32_16x16x32_bf16 v[100:103], v[180:183], a[68:71], v[100:103]
s_add_u32 m0, s52, 36864
ds_read_b64_tr_b16 v[172:173], v6 offset:45056
ds_read_b64_tr_b16 v[174:175], v6 offset:45568
v_mfma_f32_16x16x32_bf16 v[100:103], v[184:187], a[84:87], v[100:103]
buffer_load_dwordx4 v9, s[28:31], s51 offen lds
v_mfma_f32_16x16x32_bf16 v[104:107], v[176:179], a[56:59], v[104:107]
v_mfma_f32_16x16x32_bf16 v[104:107], v[180:183], a[72:75], v[104:107]
v_mfma_f32_16x16x32_bf16 v[104:107], v[184:187], a[88:91], v[104:107]
buffer_load_dwordx2 v[88:89], v80, s[8:11], s68 offen sc1
v_mfma_f32_16x16x32_bf16 v[108:111], v[176:179], a[60:63], v[108:111]
v_mfma_f32_16x16x32_bf16 v[108:111], v[180:183], a[76:79], v[108:111]
ds_read_b64_tr_b16 v[176:177], v6 offset:53248
ds_read_b64_tr_b16 v[178:179], v6 offset:53760
v_mfma_f32_16x16x32_bf16 v[108:111], v[184:187], a[92:95], v[108:111]
s_waitcnt lgkmcnt(10)
v_mfma_f32_16x16x32_bf16 v[112:115], v[188:191], a[48:51], v[112:115]
s_waitcnt lgkmcnt(8)
v_mfma_f32_16x16x32_bf16 v[112:115], v[160:163], a[64:67], v[112:115]
s_waitcnt vmcnt(14) lgkmcnt(6)
ds_read_b64_tr_b16 v[180:181], v7 offset:36864
ds_read_b64_tr_b16 v[182:183], v7 offset:37376
v_mfma_f32_16x16x32_bf16 v[112:115], v[164:167], a[80:83], v[112:115]
buffer_store_dwordx4 v[44:47], v3, s[8:11], s59 offen sc1
v_mfma_f32_16x16x32_bf16 v[116:119], v[188:191], a[52:55], v[116:119]
s_add_u32 s51, s51, 589824
s_add_u32 s59, s59, 16384
v_subrev_u32 v24, s47, v24
v_subrev_u32_e64 v25, s47, v25
v_mfma_f32_16x16x32_bf16 v[116:119], v[160:163], a[68:71], v[116:119]
s_add_u32 m0, s52, 40960
ds_read_b64_tr_b16 v[184:185], v7 offset:45056
ds_read_b64_tr_b16 v[186:187], v7 offset:45568
v_mfma_f32_16x16x32_bf16 v[116:119], v[164:167], a[84:87], v[116:119]
buffer_load_dwordx4 v9, s[24:27], s51 offen lds
v_mfma_f32_16x16x32_bf16 v[120:123], v[188:191], a[56:59], v[120:123]
v_max_u32_e64 v24, v24, v25
v_cmp_le_u32 vcc, 8, v24
v_mfma_f32_16x16x32_bf16 v[120:123], v[160:163], a[72:75], v[120:123]
v_mfma_f32_16x16x32_bf16 v[120:123], v[164:167], a[88:91], v[120:123]
v_mfma_f32_16x16x32_bf16 v[124:127], v[188:191], a[60:63], v[124:127]
v_mfma_f32_16x16x32_bf16 v[124:127], v[160:163], a[76:79], v[124:127]
ds_read_b64_tr_b16 v[188:189], v7 offset:53248
ds_read_b64_tr_b16 v[190:191], v7 offset:53760
v_mfma_f32_16x16x32_bf16 v[124:127], v[164:167], a[92:95], v[124:127]
s_waitcnt lgkmcnt(10)
v_mfma_f32_16x16x32_bf16 v[128:131], v[168:171], a[48:51], v[128:131]
s_waitcnt lgkmcnt(6)
v_mfma_f32_16x16x32_bf16 v[128:131], v[172:175], a[64:67], v[128:131]
s_add_u32 m0, s52, 45056
v_mfma_f32_16x16x32_bf16 v[128:131], v[176:179], a[80:83], v[128:131]
buffer_load_dwordx4 v9, s[28:31], s51 offen lds
v_mfma_f32_16x16x32_bf16 v[132:135], v[168:171], a[52:55], v[132:135]
s_add_u32 s51, s51, 589824
v_mfma_f32_16x16x32_bf16 v[132:135], v[172:175], a[68:71], v[132:135]
v_mfma_f32_16x16x32_bf16 v[132:135], v[176:179], a[84:87], v[132:135]
s_cbranch_vccnz K1_ps1
K1_pb1:
v_mfma_f32_16x16x32_bf16 v[136:139], v[168:171], a[56:59], v[136:139]
v_mfma_f32_16x16x32_bf16 v[136:139], v[172:175], a[72:75], v[136:139]
v_mfma_f32_16x16x32_bf16 v[136:139], v[176:179], a[88:91], v[136:139]
v_mfma_f32_16x16x32_bf16 v[140:143], v[168:171], a[60:63], v[140:143]
s_waitcnt lgkmcnt(0)
v_mfma_f32_16x16x32_bf16 v[140:143], v[172:175], a[76:79], v[140:143]
s_waitcnt vmcnt(11)
s_barrier
v_mfma_f32_16x16x32_bf16 v[140:143], v[176:179], a[92:95], v[140:143]
v_mfma_f32_16x16x32_bf16 v[144:147], v[180:183], a[48:51], v[144:147]
ds_read_b64_tr_b16 v[160:161], v11 offset:8192
ds_read_b64_tr_b16 v[162:163], v11 offset:8448
v_mfma_f32_16x16x32_bf16 v[144:147], v[184:187], a[64:67], v[144:147]
ds_read_b64_tr_b16 v[164:165], v11 offset:10240
ds_read_b64_tr_b16 v[166:167], v11 offset:10496
v_mfma_f32_16x16x32_bf16 v[144:147], v[188:191], a[80:83], v[144:147]
ds_read_b64_tr_b16 v[168:169], v11 offset:16384
ds_read_b64_tr_b16 v[170:171], v11 offset:16640
v_mfma_f32_16x16x32_bf16 v[148:151], v[180:183], a[52:55], v[148:151]
v_mfma_f32_16x16x32_bf16 v[148:151], v[184:187], a[68:71], v[148:151]
ds_read_b64_tr_b16 v[172:173], v11 offset:12288
ds_read_b64_tr_b16 v[174:175], v11 offset:12544
v_mfma_f32_16x16x32_bf16 v[148:151], v[188:191], a[84:87], v[148:151]
v_mfma_f32_16x16x32_bf16 v[152:155], v[180:183], a[56:59], v[152:155]
v_mfma_f32_16x16x32_bf16 v[152:155], v[184:187], a[72:75], v[152:155]
ds_read_b64_tr_b16 v[176:177], v11 offset:14336
ds_read_b64_tr_b16 v[178:179], v11 offset:14592
v_mfma_f32_16x16x32_bf16 v[152:155], v[188:191], a[88:91], v[152:155]
v_mfma_f32_16x16x32_bf16 v[156:159], v[180:183], a[60:63], v[156:159]
s_waitcnt lgkmcnt(8)
v_mfma_f32_16x16x32_bf16 v[156:159], v[184:187], a[76:79], v[156:159]
s_add_u32 m0, s34, 49152
ds_read_b64_tr_b16 v[180:181], v11 offset:20480
ds_read_b64_tr_b16 v[182:183], v11 offset:20736
v_mfma_f32_16x16x32_bf16 v[156:159], v[188:191], a[92:95], v[156:159]
buffer_load_dwordx4 v3, s[8:11], s38 offen offset:0 sc1 lds
v_mfma_f32_16x16x32_bf16 v[32:35], v[160:163], a[160:163], 0
s_waitcnt vmcnt(4) lgkmcnt(6)
v_mfma_f32_16x16x32_bf16 v[32:35], v[164:167], a[176:179], v[32:35]
s_add_u32 s47, s47, 1
ds_read_b64_tr_b16 v[184:185], v11 offset:18432
ds_read_b64_tr_b16 v[186:187], v11 offset:18688
v_mfma_f32_16x16x32_bf16 v[32:35], v[168:171], a[192:195], v[32:35]
buffer_load_dwordx4 v3, s[8:11], s38 offen offset:1024 sc1 lds
v_mfma_f32_16x16x32_bf16 v[36:39], v[160:163], a[164:167], 0
s_sub_u32 s47, s47, s65
v_subrev_u32 v88, s47, v88
v_mfma_f32_16x16x32_bf16 v[36:39], v[164:167], a[180:183], v[36:39]
ds_read_b64_tr_b16 v[188:189], v11 offset:24576
ds_read_b64_tr_b16 v[190:191], v11 offset:24832
v_mfma_f32_16x16x32_bf16 v[36:39], v[168:171], a[196:199], v[36:39]
v_subrev_u32 v89, s47, v89
v_mul_f32 v14, s53, v96
v_mul_f32 v15, s53, v97
v_mul_f32 v16, s53, v98
v_mfma_f32_16x16x32_bf16 v[40:43], v[160:163], a[168:171], 0
v_mul_f32 v17, s53, v99
v_mfma_f32_16x16x32_bf16 v[40:43], v[164:167], a[184:187], v[40:43]
v_max_u32 v88, v88, v89
v_mfma_f32_16x16x32_bf16 v[40:43], v[168:171], a[200:203], v[40:43]
buffer_load_dwordx4 v3, s[8:11], s38 offen offset:2048 sc1 lds
v_exp_f32 v14, v14
v_exp_f32 v15, v15
v_mfma_f32_16x16x32_bf16 v[44:47], v[160:163], a[172:175], 0
v_cmp_le_u32 vcc, 8, v88
v_mfma_f32_16x16x32_bf16 v[44:47], v[164:167], a[188:191], v[44:47]
s_waitcnt lgkmcnt(4)
ds_read_b64_tr_b16 v[160:161], v11 offset:26624
ds_read_b64_tr_b16 v[162:163], v11 offset:26880
v_mfma_f32_16x16x32_bf16 v[44:47], v[168:171], a[204:207], v[44:47]
buffer_load_dwordx4 v3, s[8:11], s38 offen offset:3072 sc1 lds
v_exp_f32 v16, v16
v_exp_f32 v17, v17
v_mfma_f32_16x16x32_bf16 v[64:67], v[172:175], a[160:163], 0
s_add_u32 s38, s38, 4096
v_mul_f32 v128, v96, v128
v_mul_f32_e64 v129, v97, v129
v_mfma_f32_16x16x32_bf16 v[64:67], v[176:179], a[176:179], v[64:67]
s_add_u32 m0, s34, 53248
ds_read_b64_tr_b16 v[164:165], v11 offset:22528
ds_read_b64_tr_b16 v[166:167], v11 offset:22784
v_mfma_f32_16x16x32_bf16 v[64:67], v[180:183], a[192:195], v[64:67]
s_cbranch_vccnz K1_ps2
K1_pb2:
buffer_load_dwordx4 v3, s[8:11], s38 offen offset:0 sc1 lds
v_mul_f32 v130, v98, v130
v_mul_f32 v131, v99, v131
v_add_f32 v14, 1.0, v14
v_add_f32 v15, 1.0, v15
v_mfma_f32_16x16x32_bf16 v[68:71], v[172:175], a[164:167], 0
v_add_f32 v16, 1.0, v16
v_add_f32 v17, 1.0, v17
v_mfma_f32_16x16x32_bf16 v[68:71], v[176:179], a[180:183], v[68:71]
ds_read_b64_tr_b16 v[168:169], v11 offset:28672
ds_read_b64_tr_b16 v[170:171], v11 offset:28928
v_mfma_f32_16x16x32_bf16 v[68:71], v[180:183], a[196:199], v[68:71]
buffer_load_dwordx4 v3, s[8:11], s38 offen offset:1024 sc1 lds
v_rcp_f32 v14, v14
v_mfma_f32_16x16x32_bf16 v[72:75], v[172:175], a[168:171], 0
v_rcp_f32 v15, v15
v_mfma_f32_16x16x32_bf16 v[72:75], v[176:179], a[184:187], v[72:75]
v_rcp_f32 v16, v16
v_mfma_f32_16x16x32_bf16 v[72:75], v[180:183], a[200:203], v[72:75]
buffer_load_dwordx4 v3, s[8:11], s38 offen offset:2048 sc1 lds
v_rcp_f32 v17, v17
v_mul_f32 v128, v128, v14
v_mul_f32 v129, v129, v15
v_mul_f32 v130, v130, v16
v_mfma_f32_16x16x32_bf16 v[76:79], v[172:175], a[172:175], 0
v_mul_f32 v131, v131, v17
v_cvt_pk_bf16_f32 v96, v128, v129
v_mfma_f32_16x16x32_bf16 v[76:79], v[176:179], a[188:191], v[76:79]
s_waitcnt lgkmcnt(8)
ds_read_b64_tr_b16 v[172:173], v11 offset:30720
ds_read_b64_tr_b16 v[174:175], v11 offset:30976
v_mfma_f32_16x16x32_bf16 v[76:79], v[180:183], a[204:207], v[76:79]
buffer_load_dwordx4 a[96:99], v3, s[8:11], s44 offen offset:0 sc1
v_cvt_pk_bf16_f32 v97, v130, v131
v_mul_f32 v18, s53, v112
v_mul_f32 v19, s53, v113
v_mul_f32 v20, s53, v114
v_mfma_f32_16x16x32_bf16 v[32:35], v[184:187], a[208:211], v[32:35]
s_waitcnt lgkmcnt(8)
v_mul_f32 v21, s53, v115
v_mfma_f32_16x16x32_bf16 v[32:35], v[188:191], a[224:227], v[32:35]
s_waitcnt lgkmcnt(6)
ds_read_b64_tr_b16 v[176:177], v10 offset:0
ds_read_b64_tr_b16 v[178:179], v10 offset:256
v_mfma_f32_16x16x32_bf16 v[32:35], v[160:163], a[240:243], v[32:35]
buffer_load_dwordx4 v3, s[8:11], s38 offen offset:3072 sc1 lds
v_exp_f32 v18, v18
v_exp_f32 v19, v19
v_mfma_f32_16x16x32_bf16 v[36:39], v[184:187], a[212:215], v[36:39]
v_exp_f32 v20, v20
v_mfma_f32_16x16x32_bf16 v[36:39], v[188:191], a[228:231], v[36:39]
ds_read_b64_tr_b16 v[180:181], v10 offset:2048
ds_read_b64_tr_b16 v[182:183], v10 offset:2304
v_mfma_f32_16x16x32_bf16 v[36:39], v[160:163], a[244:247], v[36:39]
buffer_load_dwordx4 a[100:103], v3, s[8:11], s45 offen offset:0 sc1
v_exp_f32 v21, v21
v_mul_f32 v144, v112, v144
v_mul_f32 v145, v113, v145
v_mfma_f32_16x16x32_bf16 v[40:43], v[184:187], a[216:219], v[40:43]
s_add_u32 s38, s38, 4096
v_mul_f32 v146, v114, v146
v_mul_f32 v147, v115, v147
v_mfma_f32_16x16x32_bf16 v[40:43], v[188:191], a[232:235], v[40:43]
s_add_u32 m0, s34, 57344
v_add_f32 v18, 1.0, v18
v_add_f32 v19, 1.0, v19
v_mfma_f32_16x16x32_bf16 v[40:43], v[160:163], a[248:251], v[40:43]
buffer_load_dwordx4 v3, s[8:11], s38 offen offset:0 sc1 lds
v_add_f32 v20, 1.0, v20
v_add_f32 v21, 1.0, v21
v_rcp_f32 v18, v18
v_mfma_f32_16x16x32_bf16 v[44:47], v[184:187], a[220:223], v[44:47]
v_rcp_f32 v19, v19
v_mfma_f32_16x16x32_bf16 v[44:47], v[188:191], a[236:239], v[44:47]
s_waitcnt lgkmcnt(4)
ds_read_b64_tr_b16 v[184:185], v10 offset:8192
ds_read_b64_tr_b16 v[186:187], v10 offset:8448
v_mfma_f32_16x16x32_bf16 v[44:47], v[160:163], a[252:255], v[44:47]
buffer_load_dwordx4 a[104:107], v3, s[8:11], s44 offen offset:1024 sc1
v_rcp_f32 v20, v20
v_rcp_f32 v21, v21
v_mfma_f32_16x16x32_bf16 v[64:67], v[164:167], a[208:211], v[64:67]
s_add_u32 s38, s38, s16
v_mul_f32 v144, v144, v18
v_mul_f32 v145, v145, v19
v_mfma_f32_16x16x32_bf16 v[64:67], v[168:171], a[224:227], v[64:67]
s_add_u32 m0, s34, 86016
ds_read_b64_tr_b16 v[188:189], v10 offset:4096
ds_read_b64_tr_b16 v[190:191], v10 offset:4352
v_mfma_f32_16x16x32_bf16 v[64:67], v[172:175], a[240:243], v[64:67]
buffer_load_dwordx4 v3, s[8:11], s38 offen offset:0 sc1 lds
v_mul_f32 v146, v146, v20
v_mul_f32 v147, v147, v21
v_cvt_pk_bf16_f32 v98, v144, v145
v_mfma_f32_16x16x32_bf16 v[68:71], v[164:167], a[212:215], v[68:71]
v_cvt_pk_bf16_f32 v99, v146, v147
v_mfma_f32_16x16x32_bf16 v[68:71], v[168:171], a[228:231], v[68:71]
ds_read_b64_tr_b16 v[160:161], v10 offset:6144
ds_read_b64_tr_b16 v[162:163], v10 offset:6400
v_mfma_f32_16x16x32_bf16 v[68:71], v[172:175], a[244:247], v[68:71]
buffer_load_dwordx4 a[108:111], v3, s[8:11], s45 offen offset:1024 sc1
v_mfma_f32_16x16x32_bf16 v[72:75], v[164:167], a[216:219], v[72:75]
buffer_store_dwordx4 v[96:99], v3, s[8:11], s56 offen sc1
v_mfma_f32_16x16x32_bf16 v[72:75], v[168:171], a[232:235], v[72:75]
v_mfma_f32_16x16x32_bf16 v[72:75], v[172:175], a[248:251], v[72:75]
buffer_load_dwordx4 v3, s[8:11], s38 offen offset:1024 sc1 lds
v_mul_f32 v14, s53, v100
v_mul_f32 v15, s53, v101
v_mul_f32 v16, s53, v102
v_mul_f32 v17, s53, v103
v_exp_f32 v14, v14
v_mfma_f32_16x16x32_bf16 v[76:79], v[164:167], a[220:223], v[76:79]
s_add_u32 s56, s56, s43
v_exp_f32 v15, v15
v_mfma_f32_16x16x32_bf16 v[76:79], v[168:171], a[236:239], v[76:79]
s_waitcnt lgkmcnt(8)
ds_read_b64_tr_b16 v[164:165], v10 offset:12288
ds_read_b64_tr_b16 v[166:167], v10 offset:12544
v_mfma_f32_16x16x32_bf16 v[76:79], v[172:175], a[252:255], v[76:79]
buffer_load_dwordx4 a[112:115], v3, s[8:11], s44 offen offset:2048 sc1
v_exp_f32 v16, v16
v_exp_f32 v17, v17
v_mfma_f32_16x16x32_bf16 v[32:35], v[176:179], v[224:227], v[32:35]
s_waitcnt lgkmcnt(8)
v_mul_f32 v132, v100, v132
v_mul_f32 v133, v101, v133
v_mfma_f32_16x16x32_bf16 v[32:35], v[180:183], v[240:243], v[32:35]
s_waitcnt lgkmcnt(6)
ds_read_b64_tr_b16 v[168:169], v10 offset:10240
ds_read_b64_tr_b16 v[170:171], v10 offset:10496
v_mfma_f32_16x16x32_bf16 v[32:35], v[184:187], v[192:195], v[32:35]
buffer_load_dwordx4 v3, s[8:11], s38 offen offset:2048 sc1 lds
v_mul_f32 v134, v102, v134
v_mul_f32 v135, v103, v135
v_add_f32 v14, 1.0, v14
v_add_f32 v15, 1.0, v15
v_mfma_f32_16x16x32_bf16 v[36:39], v[176:179], v[228:231], v[36:39]
v_add_f32 v16, 1.0, v16
v_add_f32 v17, 1.0, v17
v_mfma_f32_16x16x32_bf16 v[36:39], v[180:183], v[244:247], v[36:39]
ds_read_b64_tr_b16 v[172:173], v10 offset:16384
ds_read_b64_tr_b16 v[174:175], v10 offset:16640
v_mfma_f32_16x16x32_bf16 v[36:39], v[184:187], v[196:199], v[36:39]
buffer_load_dwordx4 a[116:119], v3, s[8:11], s45 offen offset:2048 sc1
v_rcp_f32 v14, v14
v_rcp_f32 v15, v15
v_mfma_f32_16x16x32_bf16 v[40:43], v[176:179], v[232:235], v[40:43]
v_rcp_f32 v16, v16
v_mfma_f32_16x16x32_bf16 v[40:43], v[180:183], v[248:251], v[40:43]
v_rcp_f32 v17, v17
v_mfma_f32_16x16x32_bf16 v[40:43], v[184:187], v[200:203], v[40:43]
buffer_load_dwordx4 v3, s[8:11], s38 offen offset:3072 sc1 lds
v_mul_f32 v132, v132, v14
v_mul_f32 v133, v133, v15
v_mul_f32 v134, v134, v16
v_mul_f32 v135, v135, v17
v_mfma_f32_16x16x32_bf16 v[44:47], v[176:179], v[236:239], v[44:47]
v_cvt_pk_bf16_f32 v100, v132, v133
v_cvt_pk_bf16_f32 v101, v134, v135
v_mfma_f32_16x16x32_bf16 v[44:47], v[180:183], v[252:255], v[44:47]
s_waitcnt lgkmcnt(4)
ds_read_b64_tr_b16 v[176:177], v10 offset:18432
ds_read_b64_tr_b16 v[178:179], v10 offset:18688
v_mfma_f32_16x16x32_bf16 v[44:47], v[184:187], v[204:207], v[44:47]
buffer_load_dwordx4 a[120:123], v3, s[8:11], s44 offen offset:3072 sc1
v_mul_f32 v18, s53, v116
v_mul_f32 v19, s53, v117
v_mul_f32 v20, s53, v118
v_mfma_f32_16x16x32_bf16 v[64:67], v[188:191], v[224:227], v[64:67]
s_add_u32 s38, s38, 4096
v_mul_f32 v21, s53, v119
v_mfma_f32_16x16x32_bf16 v[64:67], v[160:163], v[240:243], v[64:67]
s_add_u32 m0, s34, 90112
ds_read_b64_tr_b16 v[180:181], v10 offset:14336
ds_read_b64_tr_b16 v[182:183], v10 offset:14592
v_mfma_f32_16x16x32_bf16 v[64:67], v[164:167], v[192:195], v[64:67]
buffer_load_dwordx4 v3, s[8:11], s38 offen offset:0 sc1 lds
v_exp_f32 v18, v18
v_exp_f32 v19, v19
v_mfma_f32_16x16x32_bf16 v[68:71], v[188:191], v[228:231], v[68:71]
v_exp_f32 v20, v20
v_mfma_f32_16x16x32_bf16 v[68:71], v[160:163], v[244:247], v[68:71]
ds_read_b64_tr_b16 v[184:185], v10 offset:20480
ds_read_b64_tr_b16 v[186:187], v10 offset:20736
v_mfma_f32_16x16x32_bf16 v[68:71], v[164:167], v[196:199], v[68:71]
buffer_load_dwordx4 a[124:127], v3, s[8:11], s45 offen offset:3072 sc1
v_exp_f32 v21, v21
v_mul_f32 v148, v116, v148
v_mul_f32 v149, v117, v149
v_mfma_f32_16x16x32_bf16 v[72:75], v[188:191], v[232:235], v[72:75]
s_add_u32 s44, s44, s39
v_mul_f32 v150, v118, v150
v_mul_f32 v151, v119, v151
v_mfma_f32_16x16x32_bf16 v[72:75], v[160:163], v[248:251], v[72:75]
s_add_u32 s45, s45, s39
v_add_f32 v18, 1.0, v18
v_add_f32 v19, 1.0, v19
v_mfma_f32_16x16x32_bf16 v[72:75], v[164:167], v[200:203], v[72:75]
buffer_load_dwordx4 v3, s[8:11], s38 offen offset:1024 sc1 lds
v_add_f32 v20, 1.0, v20
v_add_f32 v21, 1.0, v21
v_rcp_f32 v18, v18
v_mfma_f32_16x16x32_bf16 v[76:79], v[188:191], v[236:239], v[76:79]
v_rcp_f32 v19, v19
v_mfma_f32_16x16x32_bf16 v[76:79], v[160:163], v[252:255], v[76:79]
ds_read_b64_tr_b16 v[188:189], v10 offset:22528
ds_read_b64_tr_b16 v[190:191], v10 offset:22784
v_mfma_f32_16x16x32_bf16 v[76:79], v[164:167], v[204:207], v[76:79]
s_waitcnt lgkmcnt(10)
v_rcp_f32 v20, v20
v_rcp_f32 v21, v21
v_mul_f32 v148, v148, v18
v_mul_f32 v149, v149, v19
v_mfma_f32_16x16x32_bf16 v[32:35], v[168:171], v[208:211], v[32:35]
s_waitcnt lgkmcnt(8)
v_mul_f32 v150, v150, v20
v_mul_f32 v151, v151, v21
v_mfma_f32_16x16x32_bf16 v[32:35], v[172:175], a[128:131], v[32:35]
s_waitcnt lgkmcnt(6)
v_cvt_pk_bf16_f32 v102, v148, v149
v_cvt_pk_bf16_f32 v103, v150, v151
v_mfma_f32_16x16x32_bf16 v[32:35], v[176:179], a[144:147], v[32:35]
buffer_load_dwordx4 v3, s[8:11], s38 offen offset:2048 sc1 lds
v_mfma_f32_16x16x32_bf16 v[36:39], v[168:171], v[212:215], v[36:39]
buffer_store_dwordx4 v[100:103], v3, s[8:11], s57 offen sc1
v_mfma_f32_16x16x32_bf16 v[36:39], v[172:175], a[132:135], v[36:39]
v_mfma_f32_16x16x32_bf16 v[36:39], v[176:179], a[148:151], v[36:39]
buffer_load_dwordx4 v[224:227], v3, s[8:11], s44 offen offset:0 sc1
v_mul_f32 v14, s53, v104
v_mul_f32 v15, s53, v105
v_mul_f32 v16, s53, v106
v_mul_f32 v17, s53, v107
v_exp_f32 v14, v14
v_mfma_f32_16x16x32_bf16 v[40:43], v[168:171], v[216:219], v[40:43]
s_add_u32 s57, s57, s43
v_exp_f32 v15, v15
v_mfma_f32_16x16x32_bf16 v[40:43], v[172:175], a[136:139], v[40:43]
v_exp_f32 v16, v16
v_mfma_f32_16x16x32_bf16 v[40:43], v[176:179], a[152:155], v[40:43]
buffer_load_dwordx4 v3, s[8:11], s38 offen offset:3072 sc1 lds
v_exp_f32 v17, v17
v_mul_f32 v136, v104, v136
v_mfma_f32_16x16x32_bf16 v[44:47], v[168:171], v[220:223], v[44:47]
s_waitcnt lgkmcnt(0)
v_mul_f32 v137, v105, v137
v_mul_f32 v138, v106, v138
v_mfma_f32_16x16x32_bf16 v[44:47], v[172:175], a[140:143], v[44:47]
s_waitcnt vmcnt(28)
s_barrier
v_mul_f32 v139, v107, v139
v_add_f32 v14, 1.0, v14
v_mfma_f32_16x16x32_bf16 v[44:47], v[176:179], a[156:159], v[44:47]
buffer_load_dwordx4 v[228:231], v3, s[8:11], s45 offen offset:0 sc1
v_add_f32 v15, 1.0, v15
v_add_f32 v16, 1.0, v16
v_add_f32 v17, 1.0, v17
v_mfma_f32_16x16x32_bf16 v[64:67], v[180:183], v[208:211], v[64:67]
s_add_u32 s38, s38, 4096
ds_read_b64_tr_b16 v[160:161], v10 offset:24576
ds_read_b64_tr_b16 v[162:163], v10 offset:24832
v_mfma_f32_16x16x32_bf16 v[64:67], v[184:187], a[128:131], v[64:67]
s_add_u32 m0, s34, 94208
ds_read_b64_tr_b16 v[164:165], v10 offset:26624
ds_read_b64_tr_b16 v[166:167], v10 offset:26880
v_mfma_f32_16x16x32_bf16 v[64:67], v[188:191], a[144:147], v[64:67]
ds_read_b64_tr_b16 v[168:169], v10 offset:32768
ds_read_b64_tr_b16 v[170:171], v10 offset:33024
v_rcp_f32 v14, v14
v_rcp_f32 v15, v15
v_mfma_f32_16x16x32_bf16 v[68:71], v[180:183], v[212:215], v[68:71]
v_rcp_f32 v16, v16
v_mfma_f32_16x16x32_bf16 v[68:71], v[184:187], a[132:135], v[68:71]
ds_read_b64_tr_b16 v[172:173], v10 offset:28672
ds_read_b64_tr_b16 v[174:175], v10 offset:28928
v_mfma_f32_16x16x32_bf16 v[68:71], v[188:191], a[148:151], v[68:71]
buffer_load_dwordx4 v3, s[8:11], s38 offen offset:0 sc1 lds
v_rcp_f32 v17, v17
v_mul_f32 v136, v136, v14
v_mul_f32 v137, v137, v15
v_mul_f32 v138, v138, v16
v_mfma_f32_16x16x32_bf16 v[72:75], v[180:183], v[216:219], v[72:75]
v_add_u32_e64 v30, s73, 5
v_mul_f32 v139, v139, v17
v_mfma_f32_16x16x32_bf16 v[72:75], v[184:187], a[136:139], v[72:75]
ds_read_b64_tr_b16 v[176:177], v10 offset:30720
ds_read_b64_tr_b16 v[178:179], v10 offset:30976
v_mfma_f32_16x16x32_bf16 v[72:75], v[188:191], a[152:155], v[72:75]
buffer_store_dword v30, v31, s[8:11], s69 offen sc1
v_cvt_pk_bf16_f32 v104, v136, v137
v_cvt_pk_bf16_f32 v105, v138, v139
v_mul_f32 v18, s53, v120
v_mul_f32 v19, s53, v121
v_mfma_f32_16x16x32_bf16 v[76:79], v[180:183], v[220:223], v[76:79]
s_add_u32 s38, s38, s17
v_mul_f32 v20, s53, v122
v_mul_f32 v21, s53, v123
v_mfma_f32_16x16x32_bf16 v[76:79], v[184:187], a[140:143], v[76:79]
s_waitcnt lgkmcnt(8)
ds_read_b64_tr_b16 v[180:181], v10 offset:36864
ds_read_b64_tr_b16 v[182:183], v10 offset:37120
v_mfma_f32_16x16x32_bf16 v[76:79], v[188:191], a[156:159], v[76:79]
buffer_load_dwordx4 v[232:235], v3, s[8:11], s44 offen offset:1024 sc1
v_exp_f32 v18, v18
v_exp_f32 v19, v19
v_mfma_f32_16x16x32_bf16 v[32:35], v[160:163], a[0:3], v[32:35]
s_waitcnt lgkmcnt(8)
v_exp_f32 v20, v20
v_mfma_f32_16x16x32_bf16 v[32:35], v[164:167], a[16:19], v[32:35]
s_waitcnt lgkmcnt(6)
ds_read_b64_tr_b16 v[184:185], v10 offset:34816
ds_read_b64_tr_b16 v[186:187], v10 offset:35072
v_mfma_f32_16x16x32_bf16 v[32:35], v[168:171], a[32:35], v[32:35]
buffer_load_dwordx4 v[236:239], v3, s[8:11], s45 offen offset:1024 sc1
v_exp_f32 v21, v21
v_mul_f32 v152, v120, v152
v_mul_f32 v153, v121, v153
v_mfma_f32_16x16x32_bf16 v[36:39], v[160:163], a[4:7], v[36:39]
v_mul_f32 v154, v122, v154
v_mul_f32 v155, v123, v155
v_mfma_f32_16x16x32_bf16 v[36:39], v[164:167], a[20:23], v[36:39]
ds_read_b64_tr_b16 v[188:189], v10 offset:40960
ds_read_b64_tr_b16 v[190:191], v10 offset:41216
v_mfma_f32_16x16x32_bf16 v[36:39], v[168:171], a[36:39], v[36:39]
buffer_load_dwordx4 v[240:243], v3, s[8:11], s44 offen offset:2048 sc1
v_add_f32 v18, 1.0, v18
v_add_f32 v19, 1.0, v19
v_add_f32 v20, 1.0, v20
v_mfma_f32_16x16x32_bf16 v[40:43], v[160:163], a[8:11], v[40:43]
v_add_f32 v21, 1.0, v21
v_mfma_f32_16x16x32_bf16 v[40:43], v[164:167], a[24:27], v[40:43]
v_rcp_f32 v18, v18
v_mfma_f32_16x16x32_bf16 v[40:43], v[168:171], a[40:43], v[40:43]
buffer_load_dwordx4 v[244:247], v3, s[8:11], s45 offen offset:2048 sc1
v_rcp_f32 v19, v19
v_rcp_f32 v20, v20
v_mfma_f32_16x16x32_bf16 v[44:47], v[160:163], a[12:15], v[44:47]
v_rcp_f32 v21, v21
v_mfma_f32_16x16x32_bf16 v[44:47], v[164:167], a[28:31], v[44:47]
s_waitcnt lgkmcnt(8)
ds_read_b64_tr_b16 v[160:161], v10 offset:43008
ds_read_b64_tr_b16 v[162:163], v10 offset:43264
v_mfma_f32_16x16x32_bf16 v[44:47], v[168:171], a[44:47], v[44:47]
buffer_load_dwordx4 v[248:251], v3, s[8:11], s44 offen offset:3072 sc1
v_mul_f32 v152, v152, v18
v_mul_f32 v153, v153, v19
v_mul_f32 v154, v154, v20
v_mul_f32 v155, v155, v21
v_mfma_f32_16x16x32_bf16 v[64:67], v[172:175], a[0:3], v[64:67]
s_waitcnt lgkmcnt(8)
v_cvt_pk_bf16_f32 v106, v152, v153
v_cvt_pk_bf16_f32 v107, v154, v155
v_mfma_f32_16x16x32_bf16 v[64:67], v[176:179], a[16:19], v[64:67]
s_waitcnt lgkmcnt(6)
ds_read_b64_tr_b16 v[164:165], v10 offset:38912
ds_read_b64_tr_b16 v[166:167], v10 offset:39168
v_mfma_f32_16x16x32_bf16 v[64:67], v[180:183], a[32:35], v[64:67]
buffer_load_dwordx4 v[252:255], v3, s[8:11], s45 offen offset:3072 sc1
v_mfma_f32_16x16x32_bf16 v[68:71], v[172:175], a[4:7], v[68:71]
s_add_u32 s44, s44, s40
v_mfma_f32_16x16x32_bf16 v[68:71], v[176:179], a[20:23], v[68:71]
s_add_u32 s45, s45, s40
ds_read_b64_tr_b16 v[168:169], v10 offset:45056
ds_read_b64_tr_b16 v[170:171], v10 offset:45312
v_mfma_f32_16x16x32_bf16 v[68:71], v[180:183], a[36:39], v[68:71]
buffer_store_dwordx4 v[104:107], v3, s[8:11], s58 offen sc1
v_mfma_f32_16x16x32_bf16 v[72:75], v[172:175], a[8:11], v[72:75]
v_mfma_f32_16x16x32_bf16 v[72:75], v[176:179], a[24:27], v[72:75]
s_add_u32 s58, s58, s43
v_mul_f32 v14, s53, v108
v_mul_f32 v15, s53, v109
v_mfma_f32_16x16x32_bf16 v[72:75], v[180:183], a[40:43], v[72:75]
v_mul_f32 v16, s53, v110
v_mul_f32 v17, s53, v111
v_exp_f32 v14, v14
v_exp_f32 v15, v15
v_exp_f32 v16, v16
v_exp_f32 v17, v17
v_mul_f32 v140, v108, v140
v_mul_f32 v141, v109, v141
v_mfma_f32_16x16x32_bf16 v[76:79], v[172:175], a[12:15], v[76:79]
v_mul_f32 v142, v110, v142
v_mul_f32 v143, v111, v143
v_mfma_f32_16x16x32_bf16 v[76:79], v[176:179], a[28:31], v[76:79]
ds_read_b64_tr_b16 v[172:173], v10 offset:47104
ds_read_b64_tr_b16 v[174:175], v10 offset:47360
v_mfma_f32_16x16x32_bf16 v[76:79], v[180:183], a[44:47], v[76:79]
s_waitcnt lgkmcnt(10)
v_add_f32 v14, 1.0, v14
v_add_f32 v15, 1.0, v15
v_add_f32 v16, 1.0, v16
v_add_f32 v17, 1.0, v17
v_rcp_f32 v14, v14
v_mfma_f32_16x16x32_bf16 v[32:35], v[184:187], a[48:51], v[32:35]
s_waitcnt lgkmcnt(8)
v_rcp_f32 v15, v15
v_mfma_f32_16x16x32_bf16 v[32:35], v[188:191], a[64:67], v[32:35]
s_waitcnt lgkmcnt(6)
v_rcp_f32 v16, v16
v_mfma_f32_16x16x32_bf16 v[32:35], v[160:163], a[80:83], v[32:35]
v_rcp_f32 v17, v17
v_mul_f32 v140, v140, v14
v_mul_f32 v141, v141, v15
v_mul_f32 v142, v142, v16
v_mfma_f32_16x16x32_bf16 v[36:39], v[184:187], a[52:55], v[36:39]
v_mul_f32 v143, v143, v17
v_cvt_pk_bf16_f32 v108, v140, v141
v_mfma_f32_16x16x32_bf16 v[36:39], v[188:191], a[68:71], v[36:39]
v_cvt_pk_bf16_f32 v109, v142, v143
v_mul_f32 v18, s53, v124
v_mfma_f32_16x16x32_bf16 v[36:39], v[160:163], a[84:87], v[36:39]
v_mul_f32 v19, s53, v125
v_mul_f32 v20, s53, v126
v_mul_f32 v21, s53, v127
v_exp_f32 v18, v18
v_mfma_f32_16x16x32_bf16 v[40:43], v[184:187], a[56:59], v[40:43]
v_exp_f32 v19, v19
v_mfma_f32_16x16x32_bf16 v[40:43], v[188:191], a[72:75], v[40:43]
v_exp_f32 v20, v20
v_mfma_f32_16x16x32_bf16 v[40:43], v[160:163], a[88:91], v[40:43]
v_exp_f32 v21, v21
v_mul_f32 v156, v124, v156
v_mul_f32 v157, v125, v157
v_mul_f32 v158, v126, v158
v_mul_f32 v159, v127, v159
v_add_f32 v18, 1.0, v18
v_mfma_f32_16x16x32_bf16 v[44:47], v[184:187], a[60:63], v[44:47]
s_waitcnt lgkmcnt(0)
v_add_f32 v19, 1.0, v19
v_add_f32 v20, 1.0, v20
v_mfma_f32_16x16x32_bf16 v[44:47], v[188:191], a[76:79], v[44:47]
s_waitcnt vmcnt(27)
s_barrier
v_add_f32 v21, 1.0, v21
v_mfma_f32_16x16x32_bf16 v[44:47], v[160:163], a[92:95], v[44:47]
v_rcp_f32 v18, v18
v_rcp_f32 v19, v19
v_rcp_f32 v20, v20
v_mfma_f32_16x16x32_bf16 v[64:67], v[164:167], a[48:51], v[64:67]
ds_read_b128 a[160:163], v48 offset:0
v_mfma_f32_16x16x32_bf16 v[64:67], v[168:171], a[64:67], v[64:67]
ds_read_b128 a[164:167], v48 offset:9216
v_mfma_f32_16x16x32_bf16 v[64:67], v[172:175], a[80:83], v[64:67]
ds_read_b128 a[168:171], v48 offset:18432
v_rcp_f32 v21, v21
v_mul_f32 v156, v156, v18
v_mul_f32 v157, v157, v19
v_mul_f32 v158, v158, v20
v_mfma_f32_16x16x32_bf16 v[68:71], v[164:167], a[52:55], v[68:71]
v_mul_f32 v159, v159, v21
v_cvt_pk_bf16_f32 v110, v156, v157
v_mfma_f32_16x16x32_bf16 v[68:71], v[168:171], a[68:71], v[68:71]
ds_read_b128 a[172:175], v48 offset:27648
v_cvt_pk_bf16_f32 v111, v158, v159
v_mfma_f32_16x16x32_bf16 v[68:71], v[172:175], a[84:87], v[68:71]
ds_read_b128 a[176:179], v48 offset:1024
v_mfma_f32_16x16x32_bf16 v[72:75], v[164:167], a[56:59], v[72:75]
ds_read_b128 a[180:183], v48 offset:10240
v_mfma_f32_16x16x32_bf16 v[72:75], v[168:171], a[72:75], v[72:75]
buffer_store_dwordx4 v[108:111], v3, s[8:11], s59 offen sc1
v_mfma_f32_16x16x32_bf16 v[72:75], v[172:175], a[88:91], v[72:75]
ds_read_b128 a[184:187], v48 offset:19456
v_mfma_f32_16x16x32_bf16 v[76:79], v[164:167], a[60:63], v[76:79]
s_add_u32 s59, s59, s43
ds_read_b128 a[188:191], v48 offset:28672
v_mfma_f32_16x16x32_bf16 v[76:79], v[168:171], a[76:79], v[76:79]
s_waitcnt lgkmcnt(7)
ds_read_b128 a[192:195], v48 offset:2048
v_mfma_f32_16x16x32_bf16 v[76:79], v[172:175], a[92:95], v[76:79]
buffer_load_dwordx2 v[84:85], v80, s[8:11], s68 offen sc1
v_mfma_f32_16x16x32_bf16 v[112:115], a[160:163], a[96:99], 0
s_waitcnt vmcnt(28) lgkmcnt(7)
ds_read_b128 a[196:199], v48 offset:11264
v_mfma_f32_16x16x32_bf16 v[112:115], a[164:167], a[104:107], v[112:115]
s_waitcnt vmcnt(23) lgkmcnt(7)
ds_read_b128 a[200:203], v48 offset:20480
v_mfma_f32_16x16x32_bf16 v[112:115], a[168:171], a[112:115], v[112:115]
s_waitcnt vmcnt(19) lgkmcnt(7)
ds_read_b128 a[204:207], v48 offset:29696
v_mfma_f32_16x16x32_bf16 v[112:115], a[172:175], a[120:123], v[112:115]
buffer_load_dwordx4 a[0:3], v3, s[8:11], s44 offen offset:0 sc1
v_mfma_f32_16x16x32_bf16 v[116:119], a[160:163], a[100:103], 0
ds_read_b128 a[208:211], v48 offset:3072
v_mfma_f32_16x16x32_bf16 v[116:119], a[164:167], a[108:111], v[116:119]
s_waitcnt vmcnt(18) lgkmcnt(8)
ds_read_b128 a[212:215], v48 offset:12288
v_mfma_f32_16x16x32_bf16 v[116:119], a[168:171], a[116:119], v[116:119]
s_add_u32 m0, s34, 122880
ds_read_b128 a[216:219], v48 offset:21504
v_mul_f32 v14, s53, v32
v_mfma_f32_16x16x32_bf16 v[116:119], a[172:175], a[124:127], v[116:119]
buffer_load_dwordx4 v3, s[8:11], s38 offen offset:0 sc1 lds
v_mul_f32 v15, s53, v33
v_mfma_f32_16x16x32_bf16 v[120:123], a[176:179], a[96:99], 0
s_waitcnt lgkmcnt(8)
ds_read_b128 a[220:223], v48 offset:30720
v_mul_f32 v16, s53, v34
v_mfma_f32_16x16x32_bf16 v[120:123], a[180:183], a[104:107], v[120:123]
buffer_load_dwordx4 v3, s[8:11], s38 offen offset:1024 sc1 lds
v_mfma_f32_16x16x32_bf16 v[120:123], a[184:187], a[112:115], v[120:123]
s_waitcnt lgkmcnt(8)
ds_read_b128 a[224:227], v48 offset:4096
v_mul_f32 v17, s53, v35
v_mfma_f32_16x16x32_bf16 v[120:123], a[188:191], a[120:123], v[120:123]
buffer_load_dwordx4 a[4:7], v3, s[8:11], s45 offen offset:0 sc1
v_exp_f32 v14, v14
v_exp_f32 v15, v15
v_mfma_f32_16x16x32_bf16 v[124:127], a[176:179], a[100:103], 0
ds_read_b128 a[228:231], v48 offset:13312
v_mfma_f32_16x16x32_bf16 v[124:127], a[180:183], a[108:111], v[124:127]
ds_read_b128 a[160:163], v48 offset:22528
v_mfma_f32_16x16x32_bf16 v[124:127], a[184:187], a[116:119], v[124:127]
s_waitcnt lgkmcnt(10)
ds_read_b128 a[164:167], v48 offset:31744
v_mfma_f32_16x16x32_bf16 v[124:127], a[188:191], a[124:127], v[124:127]
buffer_load_dwordx4 v3, s[8:11], s38 offen offset:2048 sc1 lds
v_exp_f32 v16, v16
v_mfma_f32_16x16x32_bf16 v[128:131], a[192:195], a[96:99], 0
s_waitcnt lgkmcnt(8)
ds_read_b128 a[168:171], v48 offset:5120
v_mfma_f32_16x16x32_bf16 v[128:131], a[196:199], a[104:107], v[128:131]
buffer_load_dwordx4 v3, s[8:11], s38 offen offset:3072 sc1 lds
v_mfma_f32_16x16x32_bf16 v[128:131], a[200:203], a[112:115], v[128:131]
s_add_u32 s38, s38, 4096
ds_read_b128 a[172:175], v48 offset:14336
v_mfma_f32_16x16x32_bf16 v[128:131], a[204:207], a[120:123], v[128:131]
buffer_load_dwordx4 a[8:11], v3, s[8:11], s44 offen offset:1024 sc1
v_exp_f32 v17, v17
v_mul_f32 v64, v32, v64
v_mul_f32 v65, v33, v65
v_mul_f32 v66, v34, v66
v_mfma_f32_16x16x32_bf16 v[132:135], a[192:195], a[100:103], 0
ds_read_b128 a[176:179], v48 offset:23552
v_mul_f32 v67, v35, v67
v_mfma_f32_16x16x32_bf16 v[132:135], a[196:199], a[108:111], v[132:135]
s_waitcnt lgkmcnt(10)
ds_read_b128 a[180:183], v48 offset:32768
v_add_f32 v14, 1.0, v14
v_mfma_f32_16x16x32_bf16 v[132:135], a[200:203], a[116:119], v[132:135]
s_add_u32 m0, s34, 126976
v_add_f32 v15, 1.0, v15
v_add_f32 v16, 1.0, v16
v_mfma_f32_16x16x32_bf16 v[132:135], a[204:207], a[124:127], v[132:135]
buffer_load_dwordx4 v3, s[8:11], s38 offen offset:0 sc1 lds
v_add_f32 v17, 1.0, v17
v_rcp_f32 v14, v14
v_mfma_f32_16x16x32_bf16 v[136:139], a[208:211], a[96:99], 0
s_waitcnt lgkmcnt(9)
ds_read_b128 a[184:187], v48 offset:6144
v_mfma_f32_16x16x32_bf16 v[136:139], a[212:215], a[104:107], v[136:139]
buffer_load_dwordx4 v3, s[8:11], s38 offen offset:1024 sc1 lds
v_mfma_f32_16x16x32_bf16 v[136:139], a[216:219], a[112:115], v[136:139]
s_waitcnt lgkmcnt(9)
ds_read_b128 a[188:191], v48 offset:15360
v_mfma_f32_16x16x32_bf16 v[136:139], a[220:223], a[120:123], v[136:139]
buffer_load_dwordx4 a[12:15], v3, s[8:11], s45 offen offset:1024 sc1
v_rcp_f32 v15, v15
v_rcp_f32 v16, v16
v_mfma_f32_16x16x32_bf16 v[140:143], a[208:211], a[100:103], 0
ds_read_b128 a[192:195], v48 offset:24576
v_mfma_f32_16x16x32_bf16 v[140:143], a[212:215], a[108:111], v[140:143]
ds_read_b128 a[196:199], v48 offset:33792
v_mfma_f32_16x16x32_bf16 v[140:143], a[216:219], a[116:119], v[140:143]
s_waitcnt lgkmcnt(11)
v_rcp_f32 v17, v17
v_mfma_f32_16x16x32_bf16 v[140:143], a[220:223], a[124:127], v[140:143]
buffer_load_dwordx4 v3, s[8:11], s38 offen offset:2048 sc1 lds
v_mul_f32 v64, v64, v14
v_mul_f32 v65, v65, v15
v_mul_f32 v66, v66, v16
v_mul_f32 v67, v67, v17
v_mfma_f32_16x16x32_bf16 v[144:147], a[224:227], a[96:99], 0
s_waitcnt lgkmcnt(8)
ds_read_b128 a[200:203], v48 offset:7168
v_cvt_pk_bf16_f32 v32, v64, v65
v_mfma_f32_16x16x32_bf16 v[144:147], a[228:231], a[104:107], v[144:147]
buffer_load_dwordx4 v3, s[8:11], s38 offen offset:3072 sc1 lds
v_mfma_f32_16x16x32_bf16 v[144:147], a[160:163], a[112:115], v[144:147]
s_add_u32 s38, s38, 4096
ds_read_b128 a[204:207], v48 offset:16384
v_cvt_pk_bf16_f32 v33, v66, v67
v_mfma_f32_16x16x32_bf16 v[144:147], a[164:167], a[120:123], v[144:147]
buffer_load_dwordx4 a[16:19], v3, s[8:11], s44 offen offset:2048 sc1
v_mul_f32 v18, s53, v36
v_mul_f32 v19, s53, v37
v_mul_f32 v20, s53, v38
v_mfma_f32_16x16x32_bf16 v[148:151], a[224:227], a[100:103], 0
ds_read_b128 a[208:211], v48 offset:25600
v_mul_f32 v21, s53, v39
v_mfma_f32_16x16x32_bf16 v[148:151], a[228:231], a[108:111], v[148:151]
s_waitcnt lgkmcnt(8)
ds_read_b128 a[212:215], v48 offset:34816
v_mfma_f32_16x16x32_bf16 v[148:151], a[160:163], a[116:119], v[148:151]
s_add_u32 m0, s34, 131072
v_exp_f32 v18, v18
v_mfma_f32_16x16x32_bf16 v[148:151], a[164:167], a[124:127], v[148:151]
buffer_load_dwordx4 v3, s[8:11], s38 offen offset:0 sc1 lds
v_exp_f32 v19, v19
v_exp_f32 v20, v20
v_mfma_f32_16x16x32_bf16 v[152:155], a[168:171], a[96:99], 0
s_add_u32 s38, s38, s18
s_add_u32 m0, s34, 0
ds_read_b128 a[216:219], v48 offset:8192
v_mfma_f32_16x16x32_bf16 v[152:155], a[172:175], a[104:107], v[152:155]
buffer_load_dwordx4 v3, s[8:11], s38 offen offset:0 sc1 lds
v_mfma_f32_16x16x32_bf16 v[152:155], a[176:179], a[112:115], v[152:155]
s_waitcnt lgkmcnt(9)
ds_read_b128 a[220:223], v48 offset:17408
v_mfma_f32_16x16x32_bf16 v[152:155], a[180:183], a[120:123], v[152:155]
buffer_load_dwordx4 a[20:23], v3, s[8:11], s45 offen offset:2048 sc1
v_exp_f32 v21, v21
v_mul_f32 v68, v36, v68
v_mfma_f32_16x16x32_bf16 v[156:159], a[168:171], a[100:103], 0
ds_read_b128 a[224:227], v48 offset:26624
v_mul_f32 v69, v37, v69
v_mfma_f32_16x16x32_bf16 v[156:159], a[172:175], a[108:111], v[156:159]
ds_read_b128 a[228:231], v48 offset:35840
v_mul_f32 v70, v38, v70
v_mfma_f32_16x16x32_bf16 v[156:159], a[176:179], a[116:119], v[156:159]
s_waitcnt lgkmcnt(11)
v_mul_f32 v71, v39, v71
v_add_f32 v18, 1.0, v18
v_mfma_f32_16x16x32_bf16 v[156:159], a[180:183], a[124:127], v[156:159]
buffer_load_dwordx4 v3, s[8:11], s38 offen offset:1024 sc1 lds
v_add_f32 v19, 1.0, v19
v_add_f32 v20, 1.0, v20
v_add_f32 v21, 1.0, v21
v_mfma_f32_16x16x32_bf16 v[160:163], a[184:187], a[96:99], 0
s_waitcnt lgkmcnt(9)
v_rcp_f32 v18, v18
v_mfma_f32_16x16x32_bf16 v[160:163], a[188:191], a[104:107], v[160:163]
buffer_load_dwordx4 v3, s[8:11], s38 offen offset:2048 sc1 lds
v_mfma_f32_16x16x32_bf16 v[160:163], a[192:195], a[112:115], v[160:163]
s_waitcnt lgkmcnt(8)
v_rcp_f32 v19, v19
v_mfma_f32_16x16x32_bf16 v[160:163], a[196:199], a[120:123], v[160:163]
buffer_load_dwordx4 a[24:27], v3, s[8:11], s44 offen offset:3072 sc1
v_rcp_f32 v20, v20
v_rcp_f32 v21, v21
v_mul_f32 v68, v68, v18
v_mfma_f32_16x16x32_bf16 v[164:167], a[184:187], a[100:103], 0
s_waitcnt lgkmcnt(7)
v_mul_f32 v69, v69, v19
v_mul_f32 v70, v70, v20
v_mfma_f32_16x16x32_bf16 v[164:167], a[188:191], a[108:111], v[164:167]
buffer_load_dwordx4 v3, s[8:11], s38 offen offset:3072 sc1 lds
v_mfma_f32_16x16x32_bf16 v[164:167], a[192:195], a[116:119], v[164:167]
s_add_u32 s38, s38, 4096
s_add_u32 m0, s34, 4096
v_mul_f32 v71, v71, v21
v_cvt_pk_bf16_f32 v34, v68, v69
v_mfma_f32_16x16x32_bf16 v[164:167], a[196:199], a[124:127], v[164:167]
buffer_load_dwordx4 v3, s[8:11], s38 offen offset:0 sc1 lds
v_cvt_pk_bf16_f32 v35, v70, v71
v_permlane16_swap_b32 v32, v34
s_nop 0
v_permlane16_swap_b32 v33, v35
v_mfma_f32_16x16x32_bf16 v[168:171], a[200:203], a[96:99], 0
s_waitcnt lgkmcnt(6)
v_mul_f32 v14, s53, v40
v_mul_f32 v15, s53, v41
v_mfma_f32_16x16x32_bf16 v[168:171], a[204:207], a[104:107], v[168:171]
s_waitcnt lgkmcnt(0)
buffer_load_dwordx4 a[28:31], v3, s[8:11], s45 offen offset:3072 sc1
v_mfma_f32_16x16x32_bf16 v[168:171], a[208:211], a[112:115], v[168:171]
s_waitcnt vmcnt(32)
s_barrier
s_add_u32 s44, s44, s41
s_add_u32 s45, s45, s41
v_mul_f32 v16, s53, v42
v_mul_f32 v17, s53, v43
v_mfma_f32_16x16x32_bf16 v[168:171], a[212:215], a[120:123], v[168:171]
buffer_load_dwordx4 v3, s[8:11], s38 offen offset:1024 sc1 lds
v_exp_f32 v14, v14
v_exp_f32 v15, v15
v_mfma_f32_16x16x32_bf16 v[172:175], a[200:203], a[100:103], 0
ds_read_b128 a[160:163], v49 offset:0
v_mfma_f32_16x16x32_bf16 v[172:175], a[204:207], a[108:111], v[172:175]
ds_read_b128 a[164:167], v49 offset:9216
v_mfma_f32_16x16x32_bf16 v[172:175], a[208:211], a[116:119], v[172:175]
ds_read_b128 a[168:171], v49 offset:18432
v_mfma_f32_16x16x32_bf16 v[172:175], a[212:215], a[124:127], v[172:175]
buffer_load_dwordx4 v3, s[8:11], s38 offen offset:2048 sc1 lds
v_exp_f32 v16, v16
v_mfma_f32_16x16x32_bf16 v[176:179], a[216:219], a[96:99], 0
ds_read_b128 a[172:175], v49 offset:27648
v_mfma_f32_16x16x32_bf16 v[176:179], a[220:223], a[104:107], v[176:179]
ds_read_b128 a[176:179], v49 offset:1024
v_mfma_f32_16x16x32_bf16 v[176:179], a[224:227], a[112:115], v[176:179]
ds_read_b128 a[180:183], v49 offset:10240
v_mfma_f32_16x16x32_bf16 v[176:179], a[228:231], a[120:123], v[176:179]
buffer_load_dwordx4 v3, s[8:11], s38 offen offset:3072 sc1 lds
v_exp_f32 v17, v17
v_mul_f32 v72, v40, v72
v_mul_f32 v73, v41, v73
v_mul_f32 v74, v42, v74
v_mfma_f32_16x16x32_bf16 v[180:183], a[216:219], a[100:103], 0
s_add_u32 s38, s38, 4096
ds_read_b128 a[184:187], v49 offset:19456
v_mul_f32 v75, v43, v75
v_mfma_f32_16x16x32_bf16 v[180:183], a[220:223], a[108:111], v[180:183]
s_waitcnt vmcnt(33) lgkmcnt(5)
ds_read_b128 a[188:191], v49 offset:28672
v_add_f32 v14, 1.0, v14
v_mfma_f32_16x16x32_bf16 v[180:183], a[224:227], a[116:119], v[180:183]
s_add_u32 m0, s34, 8192
ds_read_b128 a[192:195], v49 offset:2048
v_add_f32 v15, 1.0, v15
v_mfma_f32_16x16x32_bf16 v[180:183], a[228:231], a[124:127], v[180:183]
buffer_load_dwordx4 v3, s[8:11], s38 offen offset:0 sc1 lds
v_add_f32 v16, 1.0, v16
v_add_f32 v17, 1.0, v17
v_mfma_f32_16x16x32_bf16 v[112:115], a[160:163], v[224:227], v[112:115]
s_add_u32 s38, s38, s19
ds_read_b128 a[196:199], v49 offset:11264
v_mfma_f32_16x16x32_bf16 v[112:115], a[164:167], v[232:235], v[112:115]
s_waitcnt vmcnt(32) lgkmcnt(7)
ds_read_b128 a[200:203], v49 offset:20480
v_mfma_f32_16x16x32_bf16 v[112:115], a[168:171], v[240:243], v[112:115]
s_waitcnt vmcnt(30) lgkmcnt(7)
ds_read_b128 a[204:207], v49 offset:29696
v_mfma_f32_16x16x32_bf16 v[112:115], a[172:175], v[248:251], v[112:115]
buffer_load_dwordx4 a[32:35], v3, s[8:11], s44 offen offset:0 sc1
v_rcp_f32 v14, v14
v_rcp_f32 v15, v15
v_mfma_f32_16x16x32_bf16 v[116:119], a[160:163], v[228:231], v[116:119]
ds_read_b128 a[208:211], v49 offset:3072
v_mfma_f32_16x16x32_bf16 v[116:119], a[164:167], v[236:239], v[116:119]
s_waitcnt vmcnt(30) lgkmcnt(8)
ds_read_b128 a[212:215], v49 offset:12288
v_mfma_f32_16x16x32_bf16 v[116:119], a[168:171], v[244:247], v[116:119]
s_add_u32 m0, s34, 49152
ds_read_b128 a[216:219], v49 offset:21504
v_mfma_f32_16x16x32_bf16 v[116:119], a[172:175], v[252:255], v[116:119]
buffer_load_dwordx4 v3, s[8:11], s38 offen offset:0 sc1 lds
v_rcp_f32 v16, v16
v_rcp_f32 v17, v17
v_mfma_f32_16x16x32_bf16 v[120:123], a[176:179], v[224:227], v[120:123]
s_waitcnt lgkmcnt(9)
ds_read_b128 a[220:223], v49 offset:30720
v_mul_f32 v72, v72, v14
v_mfma_f32_16x16x32_bf16 v[120:123], a[180:183], v[232:235], v[120:123]
s_waitcnt lgkmcnt(9)
v_mul_f32 v73, v73, v15
v_mul_f32 v74, v74, v16
v_mfma_f32_16x16x32_bf16 v[120:123], a[184:187], v[240:243], v[120:123]
s_waitcnt lgkmcnt(8)
ds_read_b128 a[224:227], v49 offset:4096
v_mul_f32 v75, v75, v17
v_mfma_f32_16x16x32_bf16 v[120:123], a[188:191], v[248:251], v[120:123]
buffer_load_dwordx4 a[36:39], v3, s[8:11], s45 offen offset:0 sc1
v_cvt_pk_bf16_f32 v40, v72, v73
v_cvt_pk_bf16_f32 v41, v74, v75
v_mul_f32 v18, s53, v44
v_mul_f32 v19, s53, v45
v_mfma_f32_16x16x32_bf16 v[124:127], a[176:179], v[228:231], v[124:127]
ds_read_b128 a[228:231], v49 offset:13312
v_mul_f32 v20, s53, v46
v_mfma_f32_16x16x32_bf16 v[124:127], a[180:183], v[236:239], v[124:127]
ds_read_b128 a[160:163], v49 offset:22528
v_mul_f32 v21, s53, v47
v_mfma_f32_16x16x32_bf16 v[124:127], a[184:187], v[244:247], v[124:127]
s_waitcnt lgkmcnt(10)
ds_read_b128 a[164:167], v49 offset:31744
v_mfma_f32_16x16x32_bf16 v[124:127], a[188:191], v[252:255], v[124:127]
buffer_load_dwordx4 v3, s[8:11], s38 offen offset:1024 sc1 lds
v_exp_f32 v18, v18
v_exp_f32 v19, v19
v_mfma_f32_16x16x32_bf16 v[128:131], a[192:195], v[224:227], v[128:131]
s_waitcnt lgkmcnt(10)
ds_read_b128 a[168:171], v49 offset:5120
v_mfma_f32_16x16x32_bf16 v[128:131], a[196:199], v[232:235], v[128:131]
s_waitcnt lgkmcnt(10)
v_exp_f32 v20, v20
v_mfma_f32_16x16x32_bf16 v[128:131], a[200:203], v[240:243], v[128:131]
s_waitcnt lgkmcnt(9)
ds_read_b128 a[172:175], v49 offset:14336
v_mfma_f32_16x16x32_bf16 v[128:131], a[204:207], v[248:251], v[128:131]
buffer_load_dwordx4 a[40:43], v3, s[8:11], s44 offen offset:1024 sc1
v_exp_f32 v21, v21
v_mul_f32 v76, v44, v76
v_mfma_f32_16x16x32_bf16 v[132:135], a[192:195], v[228:231], v[132:135]
ds_read_b128 a[176:179], v49 offset:23552
v_mul_f32 v77, v45, v77
v_mfma_f32_16x16x32_bf16 v[132:135], a[196:199], v[236:239], v[132:135]
ds_read_b128 a[180:183], v49 offset:32768
v_mul_f32 v78, v46, v78
v_mfma_f32_16x16x32_bf16 v[132:135], a[200:203], v[244:247], v[132:135]
s_waitcnt lgkmcnt(11)
v_mul_f32 v79, v47, v79
v_add_f32 v18, 1.0, v18
v_mfma_f32_16x16x32_bf16 v[132:135], a[204:207], v[252:255], v[132:135]
buffer_load_dwordx4 v3, s[8:11], s38 offen offset:2048 sc1 lds
v_add_f32 v19, 1.0, v19
v_add_f32 v20, 1.0, v20
v_add_f32 v21, 1.0, v21
v_mfma_f32_16x16x32_bf16 v[136:139], a[208:211], v[224:227], v[136:139]
s_waitcnt lgkmcnt(10)
ds_read_b128 a[184:187], v49 offset:6144
v_mfma_f32_16x16x32_bf16 v[136:139], a[212:215], v[232:235], v[136:139]
s_waitcnt lgkmcnt(10)
v_rcp_f32 v18, v18
v_mfma_f32_16x16x32_bf16 v[136:139], a[216:219], v[240:243], v[136:139]
s_waitcnt lgkmcnt(9)
ds_read_b128 a[188:191], v49 offset:15360
v_mfma_f32_16x16x32_bf16 v[136:139], a[220:223], v[248:251], v[136:139]
buffer_load_dwordx4 a[44:47], v3, s[8:11], s45 offen offset:1024 sc1
v_rcp_f32 v19, v19
v_rcp_f32 v20, v20
v_mfma_f32_16x16x32_bf16 v[140:143], a[208:211], v[228:231], v[140:143]
ds_read_b128 a[192:195], v49 offset:24576
v_mfma_f32_16x16x32_bf16 v[140:143], a[212:215], v[236:239], v[140:143]
ds_read_b128 a[196:199], v49 offset:33792
v_mfma_f32_16x16x32_bf16 v[140:143], a[216:219], v[244:247], v[140:143]
s_waitcnt lgkmcnt(10)
v_rcp_f32 v21, v21
v_mfma_f32_16x16x32_bf16 v[140:143], a[220:223], v[252:255], v[140:143]
buffer_load_dwordx4 v3, s[8:11], s38 offen offset:3072 sc1 lds
v_mul_f32 v76, v76, v18
v_mul_f32 v77, v77, v19
v_mul_f32_e64 v78, v78, v20
v_mul_f32_e64 v79, v79, v21
v_mfma_f32_16x16x32_bf16 v[144:147], a[224:227], v[224:227], v[144:147]
s_add_u32 s38, s38, 4096
ds_read_b128 a[200:203], v49 offset:7168
v_cvt_pk_bf16_f32 v42, v76, v77
v_mfma_f32_16x16x32_bf16 v[144:147], a[228:231], v[232:235], v[144:147]
s_waitcnt lgkmcnt(10)
v_cvt_pk_bf16_f32 v43, v78, v79
v_permlane16_swap_b32 v40, v42
v_mfma_f32_16x16x32_bf16 v[144:147], a[160:163], v[240:243], v[144:147]
s_waitcnt lgkmcnt(9)
ds_read_b128 a[204:207], v49 offset:16384
v_permlane16_swap_b32 v41, v43
v_mfma_f32_16x16x32_bf16 v[144:147], a[164:167], v[248:251], v[144:147]
buffer_load_dwordx4 a[48:51], v3, s[8:11], s44 offen offset:2048 sc1
v_mfma_f32_16x16x32_bf16 v[148:151], a[224:227], v[228:231], v[148:151]
ds_read_b128 a[208:211], v49 offset:25600
buffer_store_dwordx4 v[32:35], v12, s[8:11], s56 offen sc1
v_mfma_f32_16x16x32_bf16 v[148:151], a[228:231], v[236:239], v[148:151]
s_waitcnt lgkmcnt(10)
ds_read_b128 a[212:215], v49 offset:34816
buffer_store_dwordx4 v[40:43], v12, s[8:11], s58 offen sc1
v_mfma_f32_16x16x32_bf16 v[148:151], a[160:163], v[244:247], v[148:151]
s_add_u32 m0, s34, 53248
v_mfma_f32_16x16x32_bf16 v[148:151], a[164:167], v[252:255], v[148:151]
buffer_load_dwordx4 v3, s[8:11], s38 offen offset:0 sc1 lds
v_mfma_f32_16x16x32_bf16 v[152:155], a[168:171], v[224:227], v[152:155]
s_waitcnt lgkmcnt(9)
ds_read_b128 a[216:219], v49 offset:8192
v_mfma_f32_16x16x32_bf16 v[152:155], a[172:175], v[232:235], v[152:155]
s_add_u32 s47, s47, s65
v_mfma_f32_16x16x32_bf16 v[152:155], a[176:179], v[240:243], v[152:155]
s_waitcnt vmcnt(38) lgkmcnt(9)
ds_read_b128 a[220:223], v49 offset:17408
v_subrev_u32_e64 v84, s47, v84
v_mfma_f32_16x16x32_bf16 v[152:155], a[180:183], v[248:251], v[152:155]
buffer_load_dwordx4 a[52:55], v3, s[8:11], s45 offen offset:2048 sc1
v_mfma_f32_16x16x32_bf16 v[156:159], a[168:171], v[228:231], v[156:159]
ds_read_b128 a[224:227], v49 offset:26624
v_subrev_u32_e64 v85, s47, v85
v_mfma_f32_16x16x32_bf16 v[156:159], a[172:175], v[236:239], v[156:159]
ds_read_b128 a[228:231], v49 offset:35840
v_max_u32_e64 v84, v84, v85
v_mfma_f32_16x16x32_bf16 v[156:159], a[176:179], v[244:247], v[156:159]
s_waitcnt lgkmcnt(11)
v_cmp_le_u32 vcc, 8, v84
v_mfma_f32_16x16x32_bf16 v[156:159], a[180:183], v[252:255], v[156:159]
buffer_load_dwordx4 v3, s[8:11], s38 offen offset:1024 sc1 lds
v_mfma_f32_16x16x32_bf16 v[160:163], a[184:187], v[224:227], v[160:163]
s_waitcnt lgkmcnt(10)
v_mfma_f32_16x16x32_bf16 v[160:163], a[188:191], v[232:235], v[160:163]
s_waitcnt lgkmcnt(9)
v_mfma_f32_16x16x32_bf16 v[160:163], a[192:195], v[240:243], v[160:163]
s_waitcnt lgkmcnt(8)
v_mfma_f32_16x16x32_bf16 v[160:163], a[196:199], v[248:251], v[160:163]
buffer_load_dwordx4 a[56:59], v3, s[8:11], s44 offen offset:3072 sc1
v_mfma_f32_16x16x32_bf16 v[164:167], a[184:187], v[228:231], v[164:167]
v_mfma_f32_16x16x32_bf16 v[164:167], a[188:191], v[236:239], v[164:167]
s_cbranch_vccnz K1_ps0
K1_pb0:
v_mfma_f32_16x16x32_bf16 v[164:167], a[192:195], v[244:247], v[164:167]
s_waitcnt lgkmcnt(7)
v_mfma_f32_16x16x32_bf16 v[164:167], a[196:199], v[252:255], v[164:167]
buffer_load_dwordx4 v3, s[8:11], s38 offen offset:2048 sc1 lds
v_mfma_f32_16x16x32_bf16 v[168:171], a[200:203], v[224:227], v[168:171]
s_waitcnt lgkmcnt(6)
v_mfma_f32_16x16x32_bf16 v[168:171], a[204:207], v[232:235], v[168:171]
s_waitcnt lgkmcnt(0)
v_mfma_f32_16x16x32_bf16 v[168:171], a[208:211], v[240:243], v[168:171]
s_waitcnt vmcnt(28)
s_barrier
v_mfma_f32_16x16x32_bf16 v[168:171], a[212:215], v[248:251], v[168:171]
buffer_load_dwordx4 a[60:63], v3, s[8:11], s45 offen offset:3072 sc1
v_mfma_f32_16x16x32_bf16 v[172:175], a[200:203], v[228:231], v[172:175]
s_add_u32 s44, s44, s50
s_add_u32 s45, s45, s50
ds_read_b128 a[160:163], v50 offset:0
v_mfma_f32_16x16x32_bf16 v[172:175], a[204:207], v[236:239], v[172:175]
ds_read_b128 a[164:167], v50 offset:9216
v_mfma_f32_16x16x32_bf16 v[172:175], a[208:211], v[244:247], v[172:175]
ds_read_b128 a[168:171], v50 offset:18432
v_mfma_f32_16x16x32_bf16 v[172:175], a[212:215], v[252:255], v[172:175]
buffer_load_dwordx4 v3, s[8:11], s38 offen offset:3072 sc1 lds
v_mfma_f32_16x16x32_bf16 v[176:179], a[216:219], v[224:227], v[176:179]
s_add_u32 s38, s38, 4096
ds_read_b128 a[172:175], v50 offset:27648
v_mfma_f32_16x16x32_bf16 v[176:179], a[220:223], v[232:235], v[176:179]
ds_read_b128 a[176:179], v50 offset:1024
v_mfma_f32_16x16x32_bf16 v[176:179], a[224:227], v[240:243], v[176:179]
s_add_u32 m0, s34, 57344
ds_read_b128 a[180:183], v50 offset:10240
v_mfma_f32_16x16x32_bf16 v[176:179], a[228:231], v[248:251], v[176:179]
buffer_load_dwordx4 v3, s[8:11], s38 offen offset:0 sc1 lds
v_mfma_f32_16x16x32_bf16 v[180:183], a[216:219], v[228:231], v[180:183]
s_add_u32 s38, s38, s16
ds_read_b128 a[184:187], v50 offset:19456
v_mfma_f32_16x16x32_bf16 v[180:183], a[220:223], v[236:239], v[180:183]
ds_read_b128 a[188:191], v50 offset:28672
v_mfma_f32_16x16x32_bf16 v[180:183], a[224:227], v[244:247], v[180:183]
ds_read_b128 a[192:195], v50 offset:2048
v_mfma_f32_16x16x32_bf16 v[180:183], a[228:231], v[252:255], v[180:183]
s_waitcnt lgkmcnt(8)
v_mfma_f32_16x16x32_bf16 v[112:115], a[160:163], a[0:3], v[112:115]
s_waitcnt lgkmcnt(7)
ds_read_b128 a[196:199], v50 offset:11264
v_mfma_f32_16x16x32_bf16 v[112:115], a[164:167], a[8:11], v[112:115]
s_waitcnt lgkmcnt(7)
ds_read_b128 a[200:203], v50 offset:20480
v_mfma_f32_16x16x32_bf16 v[112:115], a[168:171], a[16:19], v[112:115]
s_waitcnt vmcnt(26) lgkmcnt(7)
ds_read_b128 a[204:207], v50 offset:29696
v_mfma_f32_16x16x32_bf16 v[112:115], a[172:175], a[24:27], v[112:115]
buffer_load_dwordx4 a[96:99], v3, s[8:11], s44 offen offset:0 sc1
v_mfma_f32_16x16x32_bf16 v[116:119], a[160:163], a[4:7], v[116:119]
ds_read_b128 a[208:211], v50 offset:3072
v_mfma_f32_16x16x32_bf16 v[116:119], a[164:167], a[12:15], v[116:119]
s_waitcnt vmcnt(24) lgkmcnt(8)
ds_read_b128 a[212:215], v50 offset:12288
v_mfma_f32_16x16x32_bf16 v[116:119], a[168:171], a[20:23], v[116:119]
s_add_u32 m0, s34, 86016
ds_read_b128 a[216:219], v50 offset:21504
v_mfma_f32_16x16x32_bf16 v[116:119], a[172:175], a[28:31], v[116:119]
buffer_load_dwordx4 v3, s[8:11], s38 offen offset:0 sc1 lds
v_mfma_f32_16x16x32_bf16 v[120:123], a[176:179], a[0:3], v[120:123]
s_waitcnt lgkmcnt(9)
ds_read_b128 a[220:223], v50 offset:30720
v_mfma_f32_16x16x32_bf16 v[120:123], a[180:183], a[8:11], v[120:123]
s_waitcnt lgkmcnt(9)
v_mfma_f32_16x16x32_bf16 v[120:123], a[184:187], a[16:19], v[120:123]
s_waitcnt lgkmcnt(8)
ds_read_b128 a[224:227], v50 offset:4096
v_mfma_f32_16x16x32_bf16 v[120:123], a[188:191], a[24:27], v[120:123]
buffer_load_dwordx4 a[100:103], v3, s[8:11], s45 offen offset:0 sc1
v_mfma_f32_16x16x32_bf16 v[124:127], a[176:179], a[4:7], v[124:127]
ds_read_b128 a[228:231], v50 offset:13312
v_mfma_f32_16x16x32_bf16 v[124:127], a[180:183], a[12:15], v[124:127]
ds_read_b128 a[160:163], v50 offset:22528
v_mfma_f32_16x16x32_bf16 v[124:127], a[184:187], a[20:23], v[124:127]
s_waitcnt lgkmcnt(10)
ds_read_b128 a[164:167], v50 offset:31744
v_mfma_f32_16x16x32_bf16 v[124:127], a[188:191], a[28:31], v[124:127]
buffer_load_dwordx4 v3, s[8:11], s38 offen offset:1024 sc1 lds
v_mfma_f32_16x16x32_bf16 v[128:131], a[192:195], a[0:3], v[128:131]
s_waitcnt lgkmcnt(10)
ds_read_b128 a[168:171], v50 offset:5120
v_mfma_f32_16x16x32_bf16 v[128:131], a[196:199], a[8:11], v[128:131]
s_waitcnt lgkmcnt(10)
v_mfma_f32_16x16x32_bf16 v[128:131], a[200:203], a[16:19], v[128:131]
s_waitcnt lgkmcnt(9)
ds_read_b128 a[172:175], v50 offset:14336
v_mfma_f32_16x16x32_bf16 v[128:131], a[204:207], a[24:27], v[128:131]
buffer_load_dwordx4 a[104:107], v3, s[8:11], s44 offen offset:1024 sc1
v_mfma_f32_16x16x32_bf16 v[132:135], a[192:195], a[4:7], v[132:135]
ds_read_b128 a[176:179], v50 offset:23552
v_mfma_f32_16x16x32_bf16 v[132:135], a[196:199], a[12:15], v[132:135]
ds_read_b128 a[180:183], v50 offset:32768
v_mfma_f32_16x16x32_bf16 v[132:135], a[200:203], a[20:23], v[132:135]
s_waitcnt lgkmcnt(11)
v_mfma_f32_16x16x32_bf16 v[132:135], a[204:207], a[28:31], v[132:135]
buffer_load_dwordx4 v3, s[8:11], s38 offen offset:2048 sc1 lds
v_mfma_f32_16x16x32_bf16 v[136:139], a[208:211], a[0:3], v[136:139]
s_waitcnt lgkmcnt(10)
ds_read_b128 a[184:187], v50 offset:6144
v_mfma_f32_16x16x32_bf16 v[136:139], a[212:215], a[8:11], v[136:139]
s_waitcnt lgkmcnt(10)
v_mfma_f32_16x16x32_bf16 v[136:139], a[216:219], a[16:19], v[136:139]
s_waitcnt lgkmcnt(9)
ds_read_b128 a[188:191], v50 offset:15360
v_mfma_f32_16x16x32_bf16 v[136:139], a[220:223], a[24:27], v[136:139]
buffer_load_dwordx4 a[108:111], v3, s[8:11], s45 offen offset:1024 sc1
v_mfma_f32_16x16x32_bf16 v[140:143], a[208:211], a[4:7], v[140:143]
ds_read_b128 a[192:195], v50 offset:24576
v_mfma_f32_16x16x32_bf16 v[140:143], a[212:215], a[12:15], v[140:143]
ds_read_b128 a[196:199], v50 offset:33792
v_mfma_f32_16x16x32_bf16 v[140:143], a[216:219], a[20:23], v[140:143]
s_waitcnt lgkmcnt(10)
v_mfma_f32_16x16x32_bf16 v[140:143], a[220:223], a[28:31], v[140:143]
buffer_load_dwordx4 v3, s[8:11], s38 offen offset:3072 sc1 lds
v_mfma_f32_16x16x32_bf16 v[144:147], a[224:227], a[0:3], v[144:147]
s_add_u32 s38, s38, 4096
ds_read_b128 a[200:203], v50 offset:7168
v_mfma_f32_16x16x32_bf16 v[144:147], a[228:231], a[8:11], v[144:147]
s_waitcnt lgkmcnt(10)
v_mfma_f32_16x16x32_bf16 v[144:147], a[160:163], a[16:19], v[144:147]
s_waitcnt lgkmcnt(9)
ds_read_b128 a[204:207], v50 offset:16384
v_mfma_f32_16x16x32_bf16 v[144:147], a[164:167], a[24:27], v[144:147]
buffer_load_dwordx4 a[112:115], v3, s[8:11], s44 offen offset:2048 sc1
v_mfma_f32_16x16x32_bf16 v[148:151], a[224:227], a[4:7], v[148:151]
ds_read_b128 a[208:211], v50 offset:25600
v_mfma_f32_16x16x32_bf16 v[148:151], a[228:231], a[12:15], v[148:151]
s_waitcnt lgkmcnt(10)
ds_read_b128 a[212:215], v50 offset:34816
v_mfma_f32_16x16x32_bf16 v[148:151], a[160:163], a[20:23], v[148:151]
s_add_u32 m0, s34, 90112
v_mfma_f32_16x16x32_bf16 v[148:151], a[164:167], a[28:31], v[148:151]
buffer_load_dwordx4 v3, s[8:11], s38 offen offset:0 sc1 lds
v_mfma_f32_16x16x32_bf16 v[152:155], a[168:171], a[0:3], v[152:155]
s_waitcnt lgkmcnt(10)
ds_read_b128 a[216:219], v50 offset:8192
v_mfma_f32_16x16x32_bf16 v[152:155], a[172:175], a[8:11], v[152:155]
s_waitcnt lgkmcnt(10)
v_mfma_f32_16x16x32_bf16 v[152:155], a[176:179], a[16:19], v[152:155]
s_waitcnt lgkmcnt(9)
ds_read_b128 a[220:223], v50 offset:17408
v_mfma_f32_16x16x32_bf16 v[152:155], a[180:183], a[24:27], v[152:155]
buffer_load_dwordx4 a[116:119], v3, s[8:11], s45 offen offset:2048 sc1
v_mfma_f32_16x16x32_bf16 v[156:159], a[168:171], a[4:7], v[156:159]
ds_read_b128 a[224:227], v50 offset:26624
v_mfma_f32_16x16x32_bf16 v[156:159], a[172:175], a[12:15], v[156:159]
ds_read_b128 a[228:231], v50 offset:35840
v_mfma_f32_16x16x32_bf16 v[156:159], a[176:179], a[20:23], v[156:159]
s_waitcnt lgkmcnt(11)
v_mfma_f32_16x16x32_bf16 v[156:159], a[180:183], a[28:31], v[156:159]
buffer_load_dwordx4 v3, s[8:11], s38 offen offset:1024 sc1 lds
v_mfma_f32_16x16x32_bf16 v[160:163], a[184:187], a[0:3], v[160:163]
s_waitcnt lgkmcnt(10)
v_mfma_f32_16x16x32_bf16 v[160:163], a[188:191], a[8:11], v[160:163]
s_waitcnt lgkmcnt(9)
v_mfma_f32_16x16x32_bf16 v[160:163], a[192:195], a[16:19], v[160:163]
s_waitcnt lgkmcnt(8)
v_mfma_f32_16x16x32_bf16 v[160:163], a[196:199], a[24:27], v[160:163]
buffer_load_dwordx4 a[120:123], v3, s[8:11], s44 offen offset:3072 sc1
v_mfma_f32_16x16x32_bf16 v[164:167], a[184:187], a[4:7], v[164:167]
v_mfma_f32_16x16x32_bf16 v[164:167], a[188:191], a[12:15], v[164:167]
v_mfma_f32_16x16x32_bf16 v[164:167], a[192:195], a[20:23], v[164:167]
s_waitcnt lgkmcnt(7)
v_mfma_f32_16x16x32_bf16 v[164:167], a[196:199], a[28:31], v[164:167]
buffer_load_dwordx4 v3, s[8:11], s38 offen offset:2048 sc1 lds
v_mfma_f32_16x16x32_bf16 v[168:171], a[200:203], a[0:3], v[168:171]
s_waitcnt lgkmcnt(6)
v_mfma_f32_16x16x32_bf16 v[168:171], a[204:207], a[8:11], v[168:171]
s_waitcnt lgkmcnt(0)
v_mfma_f32_16x16x32_bf16 v[168:171], a[208:211], a[16:19], v[168:171]
s_waitcnt vmcnt(22)
s_barrier
v_mfma_f32_16x16x32_bf16 v[168:171], a[212:215], a[24:27], v[168:171]
buffer_load_dwordx4 a[124:127], v3, s[8:11], s45 offen offset:3072 sc1
v_mfma_f32_16x16x32_bf16 v[172:175], a[200:203], a[4:7], v[172:175]
s_add_u32 s44, s44, s39
s_add_u32 s45, s45, s39
ds_read_b128 a[160:163], v51 offset:0
v_mfma_f32_16x16x32_bf16 v[172:175], a[204:207], a[12:15], v[172:175]
ds_read_b128 a[164:167], v51 offset:9216
v_mfma_f32_16x16x32_bf16 v[172:175], a[208:211], a[20:23], v[172:175]
ds_read_b128 a[168:171], v51 offset:18432
v_mfma_f32_16x16x32_bf16 v[172:175], a[212:215], a[28:31], v[172:175]
buffer_load_dwordx4 v3, s[8:11], s38 offen offset:3072 sc1 lds
v_mfma_f32_16x16x32_bf16 v[176:179], a[216:219], a[0:3], v[176:179]
s_add_u32 s38, s38, 4096
ds_read_b128 a[172:175], v51 offset:27648
v_mfma_f32_16x16x32_bf16 v[176:179], a[220:223], a[8:11], v[176:179]
ds_read_b128 a[176:179], v51 offset:1024
v_mfma_f32_16x16x32_bf16 v[176:179], a[224:227], a[16:19], v[176:179]
s_add_u32 m0, s34, 94208
ds_read_b128 a[180:183], v51 offset:10240
v_mfma_f32_16x16x32_bf16 v[176:179], a[228:231], a[24:27], v[176:179]
buffer_load_dwordx4 v3, s[8:11], s38 offen offset:0 sc1 lds
v_mfma_f32_16x16x32_bf16 v[180:183], a[216:219], a[4:7], v[180:183]
s_add_u32 s38, s38, s17
ds_read_b128 a[184:187], v51 offset:19456
v_mfma_f32_16x16x32_bf16 v[180:183], a[220:223], a[12:15], v[180:183]
ds_read_b128 a[188:191], v51 offset:28672
v_mfma_f32_16x16x32_bf16 v[180:183], a[224:227], a[20:23], v[180:183]
ds_read_b128 a[192:195], v51 offset:2048
v_mfma_f32_16x16x32_bf16 v[180:183], a[228:231], a[28:31], v[180:183]
s_waitcnt lgkmcnt(8)
v_mfma_f32_16x16x32_bf16 v[112:115], a[160:163], a[32:35], v[112:115]
s_waitcnt lgkmcnt(7)
ds_read_b128 a[196:199], v51 offset:11264
v_mfma_f32_16x16x32_bf16 v[112:115], a[164:167], a[40:43], v[112:115]
s_waitcnt lgkmcnt(7)
ds_read_b128 a[200:203], v51 offset:20480
v_mfma_f32_16x16x32_bf16 v[112:115], a[168:171], a[48:51], v[112:115]
s_waitcnt vmcnt(21) lgkmcnt(7)
ds_read_b128 a[204:207], v51 offset:29696
v_mfma_f32_16x16x32_bf16 v[112:115], a[172:175], a[56:59], v[112:115]
buffer_load_dwordx4 v[224:227], v3, s[8:11], s44 offen offset:0 sc1
v_mfma_f32_16x16x32_bf16 v[116:119], a[160:163], a[36:39], v[116:119]
ds_read_b128 a[208:211], v51 offset:3072
v_mfma_f32_16x16x32_bf16 v[116:119], a[164:167], a[44:47], v[116:119]
s_waitcnt vmcnt(20) lgkmcnt(8)
ds_read_b128 a[212:215], v51 offset:12288
v_mfma_f32_16x16x32_bf16 v[116:119], a[168:171], a[52:55], v[116:119]
s_add_u32 m0, s34, 122880
ds_read_b128 a[216:219], v51 offset:21504
v_add_u32_e64 v82, s73, 7
v_mfma_f32_16x16x32_bf16 v[116:119], a[172:175], a[60:63], v[116:119]
buffer_load_dwordx4 v3, s[8:11], s38 offen offset:0 sc1 lds
v_mfma_f32_16x16x32_bf16 v[120:123], a[176:179], a[32:35], v[120:123]
s_waitcnt lgkmcnt(8)
ds_read_b128 a[220:223], v51 offset:30720
v_mfma_f32_16x16x32_bf16 v[120:123], a[180:183], a[40:43], v[120:123]
buffer_store_dword v82, v31, s[8:11], s69 offen sc1
v_mfma_f32_16x16x32_bf16 v[120:123], a[184:187], a[48:51], v[120:123]
s_waitcnt lgkmcnt(8)
ds_read_b128 a[224:227], v51 offset:4096
v_mfma_f32_16x16x32_bf16 v[120:123], a[188:191], a[56:59], v[120:123]
buffer_load_dwordx4 v[228:231], v3, s[8:11], s45 offen offset:0 sc1
v_mfma_f32_16x16x32_bf16 v[124:127], a[176:179], a[36:39], v[124:127]
ds_read_b128 a[228:231], v51 offset:13312
v_mfma_f32_16x16x32_bf16 v[124:127], a[180:183], a[44:47], v[124:127]
ds_read_b128 a[160:163], v51 offset:22528
v_mfma_f32_16x16x32_bf16 v[124:127], a[184:187], a[52:55], v[124:127]
s_waitcnt lgkmcnt(10)
ds_read_b128 a[164:167], v51 offset:31744
v_mfma_f32_16x16x32_bf16 v[124:127], a[188:191], a[60:63], v[124:127]
buffer_load_dwordx4 v3, s[8:11], s38 offen offset:1024 sc1 lds
v_mfma_f32_16x16x32_bf16 v[128:131], a[192:195], a[32:35], v[128:131]
s_waitcnt lgkmcnt(10)
ds_read_b128 a[168:171], v51 offset:5120
v_mfma_f32_16x16x32_bf16 v[128:131], a[196:199], a[40:43], v[128:131]
s_waitcnt lgkmcnt(10)
v_mfma_f32_16x16x32_bf16 v[128:131], a[200:203], a[48:51], v[128:131]
s_waitcnt lgkmcnt(9)
ds_read_b128 a[172:175], v51 offset:14336
v_mfma_f32_16x16x32_bf16 v[128:131], a[204:207], a[56:59], v[128:131]
buffer_load_dwordx4 v[232:235], v3, s[8:11], s44 offen offset:1024 sc1
v_mfma_f32_16x16x32_bf16 v[132:135], a[192:195], a[36:39], v[132:135]
ds_read_b128 a[176:179], v51 offset:23552
v_mfma_f32_16x16x32_bf16 v[132:135], a[196:199], a[44:47], v[132:135]
ds_read_b128 a[180:183], v51 offset:32768
v_mfma_f32_16x16x32_bf16 v[132:135], a[200:203], a[52:55], v[132:135]
s_waitcnt lgkmcnt(11)
v_mfma_f32_16x16x32_bf16 v[132:135], a[204:207], a[60:63], v[132:135]
buffer_load_dwordx4 v3, s[8:11], s38 offen offset:2048 sc1 lds
v_mfma_f32_16x16x32_bf16 v[136:139], a[208:211], a[32:35], v[136:139]
s_waitcnt lgkmcnt(10)
ds_read_b128 a[184:187], v51 offset:6144
v_mfma_f32_16x16x32_bf16 v[136:139], a[212:215], a[40:43], v[136:139]
s_waitcnt lgkmcnt(10)
v_mfma_f32_16x16x32_bf16 v[136:139], a[216:219], a[48:51], v[136:139]
s_waitcnt lgkmcnt(9)
ds_read_b128 a[188:191], v51 offset:15360
v_mfma_f32_16x16x32_bf16 v[136:139], a[220:223], a[56:59], v[136:139]
buffer_load_dwordx4 v[236:239], v3, s[8:11], s45 offen offset:1024 sc1
v_mfma_f32_16x16x32_bf16 v[140:143], a[208:211], a[36:39], v[140:143]
ds_read_b128 a[192:195], v51 offset:24576
v_mfma_f32_16x16x32_bf16 v[140:143], a[212:215], a[44:47], v[140:143]
ds_read_b128 a[196:199], v51 offset:33792
v_mfma_f32_16x16x32_bf16 v[140:143], a[216:219], a[52:55], v[140:143]
s_waitcnt lgkmcnt(10)
v_mfma_f32_16x16x32_bf16 v[140:143], a[220:223], a[60:63], v[140:143]
buffer_load_dwordx4 v3, s[8:11], s38 offen offset:3072 sc1 lds
v_mfma_f32_16x16x32_bf16 v[144:147], a[224:227], a[32:35], v[144:147]
s_add_u32 s38, s38, 4096
ds_read_b128 a[200:203], v51 offset:7168
v_mfma_f32_16x16x32_bf16 v[144:147], a[228:231], a[40:43], v[144:147]
s_waitcnt lgkmcnt(10)
v_mfma_f32_16x16x32_bf16 v[144:147], a[160:163], a[48:51], v[144:147]
s_waitcnt lgkmcnt(9)
ds_read_b128 a[204:207], v51 offset:16384
v_mfma_f32_16x16x32_bf16 v[144:147], a[164:167], a[56:59], v[144:147]
buffer_load_dwordx4 v[240:243], v3, s[8:11], s44 offen offset:2048 sc1
v_mfma_f32_16x16x32_bf16 v[148:151], a[224:227], a[36:39], v[148:151]
ds_read_b128 a[208:211], v51 offset:25600
v_mfma_f32_16x16x32_bf16 v[148:151], a[228:231], a[44:47], v[148:151]
s_waitcnt lgkmcnt(10)
ds_read_b128 a[212:215], v51 offset:34816
v_mfma_f32_16x16x32_bf16 v[148:151], a[160:163], a[52:55], v[148:151]
s_add_u32 m0, s34, 126976
v_mfma_f32_16x16x32_bf16 v[148:151], a[164:167], a[60:63], v[148:151]
buffer_load_dwordx4 v3, s[8:11], s38 offen offset:0 sc1 lds
v_mfma_f32_16x16x32_bf16 v[152:155], a[168:171], a[32:35], v[152:155]
s_waitcnt lgkmcnt(10)
ds_read_b128 a[216:219], v51 offset:8192
v_mfma_f32_16x16x32_bf16 v[152:155], a[172:175], a[40:43], v[152:155]
s_waitcnt lgkmcnt(10)
v_mfma_f32_16x16x32_bf16 v[152:155], a[176:179], a[48:51], v[152:155]
s_waitcnt lgkmcnt(9)
ds_read_b128 a[220:223], v51 offset:17408
v_mfma_f32_16x16x32_bf16 v[152:155], a[180:183], a[56:59], v[152:155]
buffer_load_dwordx4 v[244:247], v3, s[8:11], s45 offen offset:2048 sc1
v_mfma_f32_16x16x32_bf16 v[156:159], a[168:171], a[36:39], v[156:159]
ds_read_b128 a[224:227], v51 offset:26624
v_mfma_f32_16x16x32_bf16 v[156:159], a[172:175], a[44:47], v[156:159]
ds_read_b128 a[228:231], v51 offset:35840
v_mfma_f32_16x16x32_bf16 v[156:159], a[176:179], a[52:55], v[156:159]
s_waitcnt lgkmcnt(11)
v_mfma_f32_16x16x32_bf16 v[156:159], a[180:183], a[60:63], v[156:159]
buffer_load_dwordx4 v3, s[8:11], s38 offen offset:1024 sc1 lds
v_mfma_f32_16x16x32_bf16 v[160:163], a[184:187], a[32:35], v[160:163]
s_waitcnt lgkmcnt(10)
v_mfma_f32_16x16x32_bf16 v[160:163], a[188:191], a[40:43], v[160:163]
s_waitcnt lgkmcnt(9)
v_mfma_f32_16x16x32_bf16 v[160:163], a[192:195], a[48:51], v[160:163]
s_waitcnt lgkmcnt(8)
v_mfma_f32_16x16x32_bf16 v[160:163], a[196:199], a[56:59], v[160:163]
buffer_load_dwordx4 v[248:251], v3, s[8:11], s44 offen offset:3072 sc1
v_mfma_f32_16x16x32_bf16 v[164:167], a[184:187], a[36:39], v[164:167]
v_mfma_f32_16x16x32_bf16 v[164:167], a[188:191], a[44:47], v[164:167]
v_mfma_f32_16x16x32_bf16 v[164:167], a[192:195], a[52:55], v[164:167]
s_waitcnt lgkmcnt(7)
v_mfma_f32_16x16x32_bf16 v[164:167], a[196:199], a[60:63], v[164:167]
buffer_load_dwordx4 v3, s[8:11], s38 offen offset:2048 sc1 lds
v_mfma_f32_16x16x32_bf16 v[168:171], a[200:203], a[32:35], v[168:171]
s_waitcnt lgkmcnt(6)
v_mfma_f32_16x16x32_bf16 v[168:171], a[204:207], a[40:43], v[168:171]
s_waitcnt lgkmcnt(0)
v_mfma_f32_16x16x32_bf16 v[168:171], a[208:211], a[48:51], v[168:171]
s_waitcnt vmcnt(32)
s_barrier
v_mfma_f32_16x16x32_bf16 v[168:171], a[212:215], a[56:59], v[168:171]
buffer_load_dwordx4 v[252:255], v3, s[8:11], s45 offen offset:3072 sc1
v_mfma_f32_16x16x32_bf16 v[172:175], a[200:203], a[36:39], v[172:175]
s_add_u32 s44, s44, s40
s_add_u32 s45, s45, s40
ds_read_b128 a[160:163], v48 offset:0
v_mfma_f32_16x16x32_bf16 v[172:175], a[204:207], a[44:47], v[172:175]
ds_read_b128 a[164:167], v48 offset:9216
v_mfma_f32_16x16x32_bf16 v[172:175], a[208:211], a[52:55], v[172:175]
ds_read_b128 a[168:171], v48 offset:18432
v_mfma_f32_16x16x32_bf16 v[172:175], a[212:215], a[60:63], v[172:175]
buffer_load_dwordx4 v3, s[8:11], s38 offen offset:3072 sc1 lds
v_mfma_f32_16x16x32_bf16 v[176:179], a[216:219], a[32:35], v[176:179]
s_add_u32 s38, s38, 4096
ds_read_b128 a[172:175], v48 offset:27648
v_mfma_f32_16x16x32_bf16 v[176:179], a[220:223], a[40:43], v[176:179]
ds_read_b128 a[176:179], v48 offset:1024
v_mfma_f32_16x16x32_bf16 v[176:179], a[224:227], a[48:51], v[176:179]
s_add_u32 m0, s34, 131072
ds_read_b128 a[180:183], v48 offset:10240
v_mfma_f32_16x16x32_bf16 v[176:179], a[228:231], a[56:59], v[176:179]
buffer_load_dwordx4 v3, s[8:11], s38 offen offset:0 sc1 lds
v_mfma_f32_16x16x32_bf16 v[180:183], a[216:219], a[36:39], v[180:183]
s_add_u32 s38, s38, s18
ds_read_b128 a[184:187], v48 offset:19456
v_mfma_f32_16x16x32_bf16 v[180:183], a[220:223], a[44:47], v[180:183]
ds_read_b128 a[188:191], v48 offset:28672
v_mfma_f32_16x16x32_bf16 v[180:183], a[224:227], a[52:55], v[180:183]
ds_read_b128 a[192:195], v48 offset:2048
v_mfma_f32_16x16x32_bf16 v[180:183], a[228:231], a[60:63], v[180:183]
K1_gl:
s_cmp_eq_u32 s42, 1
s_cselect_b32 s19, s70, s19
s_cselect_b32 s16, 139264, s16
s_cselect_b32 s17, 0x40000000, s17
s_cselect_b32 s50, s72, s50
s_cselect_b32 s39, 4096, s39
s_sub_u32 s42, s42, 1
s_waitcnt vmcnt(33) lgkmcnt(8)
v_mfma_f32_16x16x32_bf16 v[112:115], a[160:163], a[96:99], v[112:115]
s_waitcnt vmcnt(29) lgkmcnt(7)
ds_read_b128 a[196:199], v48 offset:11264
v_mfma_f32_16x16x32_bf16 v[112:115], a[164:167], a[104:107], v[112:115]
s_waitcnt vmcnt(25) lgkmcnt(7)
ds_read_b128 a[200:203], v48 offset:20480
v_mfma_f32_16x16x32_bf16 v[112:115], a[168:171], a[112:115], v[112:115]
s_waitcnt vmcnt(21) lgkmcnt(7)
ds_read_b128 a[204:207], v48 offset:29696
v_mfma_f32_16x16x32_bf16 v[112:115], a[172:175], a[120:123], v[112:115]
buffer_load_dwordx2 v[84:85], v80, s[8:11], s68 offen sc1
v_mfma_f32_16x16x32_bf16 v[116:119], a[160:163], a[100:103], v[116:119]
ds_read_b128 a[208:211], v48 offset:3072
v_mfma_f32_16x16x32_bf16 v[116:119], a[164:167], a[108:111], v[116:119]
ds_read_b128 a[212:215], v48 offset:12288
v_mfma_f32_16x16x32_bf16 v[116:119], a[168:171], a[116:119], v[116:119]
s_waitcnt vmcnt(20) lgkmcnt(9)
ds_read_b128 a[216:219], v48 offset:21504
v_mfma_f32_16x16x32_bf16 v[116:119], a[172:175], a[124:127], v[116:119]
buffer_load_dwordx4 a[0:3], v3, s[8:11], s44 offen offset:0 sc1
v_mfma_f32_16x16x32_bf16 v[120:123], a[176:179], a[96:99], v[120:123]
s_waitcnt lgkmcnt(9)
ds_read_b128 a[220:223], v48 offset:30720
v_mfma_f32_16x16x32_bf16 v[120:123], a[180:183], a[104:107], v[120:123]
s_waitcnt lgkmcnt(8)
v_mfma_f32_16x16x32_bf16 v[120:123], a[184:187], a[112:115], v[120:123]
s_add_u32 m0, s34, 0
ds_read_b128 a[224:227], v48 offset:4096
v_mfma_f32_16x16x32_bf16 v[120:123], a[188:191], a[120:123], v[120:123]
buffer_load_dwordx4 v3, s[8:11], s38 offen offset:0 sc1 lds
v_mfma_f32_16x16x32_bf16 v[124:127], a[176:179], a[100:103], v[124:127]
ds_read_b128 a[228:231], v48 offset:13312
v_mfma_f32_16x16x32_bf16 v[124:127], a[180:183], a[108:111], v[124:127]
ds_read_b128 a[160:163], v48 offset:22528
v_mfma_f32_16x16x32_bf16 v[124:127], a[184:187], a[116:119], v[124:127]
s_waitcnt lgkmcnt(10)
ds_read_b128 a[164:167], v48 offset:31744
v_mfma_f32_16x16x32_bf16 v[124:127], a[188:191], a[124:127], v[124:127]
buffer_load_dwordx4 a[4:7], v3, s[8:11], s45 offen offset:0 sc1
v_mfma_f32_16x16x32_bf16 v[128:131], a[192:195], a[96:99], v[128:131]
s_waitcnt lgkmcnt(10)
ds_read_b128 a[168:171], v48 offset:5120
v_mfma_f32_16x16x32_bf16 v[128:131], a[196:199], a[104:107], v[128:131]
s_waitcnt lgkmcnt(10)
v_mfma_f32_16x16x32_bf16 v[128:131], a[200:203], a[112:115], v[128:131]
s_waitcnt lgkmcnt(9)
ds_read_b128 a[172:175], v48 offset:14336
v_mfma_f32_16x16x32_bf16 v[128:131], a[204:207], a[120:123], v[128:131]
buffer_load_dwordx4 v3, s[8:11], s38 offen offset:1024 sc1 lds
v_mfma_f32_16x16x32_bf16 v[132:135], a[192:195], a[100:103], v[132:135]
ds_read_b128 a[176:179], v48 offset:23552
v_mfma_f32_16x16x32_bf16 v[132:135], a[196:199], a[108:111], v[132:135]
ds_read_b128 a[180:183], v48 offset:32768
v_mfma_f32_16x16x32_bf16 v[132:135], a[200:203], a[116:119], v[132:135]
s_waitcnt lgkmcnt(11)
v_mfma_f32_16x16x32_bf16 v[132:135], a[204:207], a[124:127], v[132:135]
buffer_load_dwordx4 a[8:11], v3, s[8:11], s44 offen offset:1024 sc1
v_mfma_f32_16x16x32_bf16 v[136:139], a[208:211], a[96:99], v[136:139]
s_waitcnt lgkmcnt(10)
ds_read_b128 a[184:187], v48 offset:6144
v_mfma_f32_16x16x32_bf16 v[136:139], a[212:215], a[104:107], v[136:139]
s_waitcnt lgkmcnt(10)
v_mfma_f32_16x16x32_bf16 v[136:139], a[216:219], a[112:115], v[136:139]
s_waitcnt lgkmcnt(9)
ds_read_b128 a[188:191], v48 offset:15360
v_mfma_f32_16x16x32_bf16 v[136:139], a[220:223], a[120:123], v[136:139]
buffer_load_dwordx4 v3, s[8:11], s38 offen offset:2048 sc1 lds
v_mfma_f32_16x16x32_bf16 v[140:143], a[208:211], a[100:103], v[140:143]
ds_read_b128 a[192:195], v48 offset:24576
v_mfma_f32_16x16x32_bf16 v[140:143], a[212:215], a[108:111], v[140:143]
ds_read_b128 a[196:199], v48 offset:33792
v_mfma_f32_16x16x32_bf16 v[140:143], a[216:219], a[116:119], v[140:143]
s_waitcnt lgkmcnt(11)
v_mfma_f32_16x16x32_bf16 v[140:143], a[220:223], a[124:127], v[140:143]
buffer_load_dwordx4 a[12:15], v3, s[8:11], s45 offen offset:1024 sc1
v_mfma_f32_16x16x32_bf16 v[144:147], a[224:227], a[96:99], v[144:147]
s_waitcnt lgkmcnt(10)
ds_read_b128 a[200:203], v48 offset:7168
v_mfma_f32_16x16x32_bf16 v[144:147], a[228:231], a[104:107], v[144:147]
s_waitcnt lgkmcnt(10)
v_mfma_f32_16x16x32_bf16 v[144:147], a[160:163], a[112:115], v[144:147]
s_waitcnt lgkmcnt(9)
ds_read_b128 a[204:207], v48 offset:16384
v_mfma_f32_16x16x32_bf16 v[144:147], a[164:167], a[120:123], v[144:147]
buffer_load_dwordx4 v3, s[8:11], s38 offen offset:3072 sc1 lds
v_mfma_f32_16x16x32_bf16 v[148:151], a[224:227], a[100:103], v[148:151]
s_add_u32 s38, s38, 4096
ds_read_b128 a[208:211], v48 offset:25600
v_mfma_f32_16x16x32_bf16 v[148:151], a[228:231], a[108:111], v[148:151]
ds_read_b128 a[212:215], v48 offset:34816
v_mfma_f32_16x16x32_bf16 v[148:151], a[160:163], a[116:119], v[148:151]
s_waitcnt lgkmcnt(11)
v_mfma_f32_16x16x32_bf16 v[148:151], a[164:167], a[124:127], v[148:151]
buffer_load_dwordx4 a[16:19], v3, s[8:11], s44 offen offset:2048 sc1
v_mfma_f32_16x16x32_bf16 v[152:155], a[168:171], a[96:99], v[152:155]
s_waitcnt lgkmcnt(10)
ds_read_b128 a[216:219], v48 offset:8192
v_mfma_f32_16x16x32_bf16 v[152:155], a[172:175], a[104:107], v[152:155]
s_waitcnt lgkmcnt(9)
v_mfma_f32_16x16x32_bf16 v[152:155], a[176:179], a[112:115], v[152:155]
s_add_u32 m0, s34, 4096
ds_read_b128 a[220:223], v48 offset:17408
v_mfma_f32_16x16x32_bf16 v[152:155], a[180:183], a[120:123], v[152:155]
buffer_load_dwordx4 v3, s[8:11], s38 offen offset:0 sc1 lds
v_mfma_f32_16x16x32_bf16 v[156:159], a[168:171], a[100:103], v[156:159]
ds_read_b128 a[224:227], v48 offset:26624
v_mfma_f32_16x16x32_bf16 v[156:159], a[172:175], a[108:111], v[156:159]
ds_read_b128 a[228:231], v48 offset:35840
v_mfma_f32_16x16x32_bf16 v[156:159], a[176:179], a[116:119], v[156:159]
s_waitcnt lgkmcnt(11)
v_mfma_f32_16x16x32_bf16 v[156:159], a[180:183], a[124:127], v[156:159]
buffer_load_dwordx4 a[20:23], v3, s[8:11], s45 offen offset:2048 sc1
v_mfma_f32_16x16x32_bf16 v[160:163], a[184:187], a[96:99], v[160:163]
s_waitcnt lgkmcnt(10)
v_mfma_f32_16x16x32_bf16 v[160:163], a[188:191], a[104:107], v[160:163]
s_waitcnt lgkmcnt(9)
v_mfma_f32_16x16x32_bf16 v[160:163], a[192:195], a[112:115], v[160:163]
s_waitcnt lgkmcnt(8)
v_mfma_f32_16x16x32_bf16 v[160:163], a[196:199], a[120:123], v[160:163]
buffer_load_dwordx4 v3, s[8:11], s38 offen offset:1024 sc1 lds
v_mfma_f32_16x16x32_bf16 v[164:167], a[184:187], a[100:103], v[164:167]
v_mfma_f32_16x16x32_bf16 v[164:167], a[188:191], a[108:111], v[164:167]
v_mfma_f32_16x16x32_bf16 v[164:167], a[192:195], a[116:119], v[164:167]
s_waitcnt lgkmcnt(7)
v_mfma_f32_16x16x32_bf16 v[164:167], a[196:199], a[124:127], v[164:167]
buffer_load_dwordx4 a[24:27], v3, s[8:11], s44 offen offset:3072 sc1
v_mfma_f32_16x16x32_bf16 v[168:171], a[200:203], a[96:99], v[168:171]
s_waitcnt lgkmcnt(6)
v_mfma_f32_16x16x32_bf16 v[168:171], a[204:207], a[104:107], v[168:171]
s_waitcnt lgkmcnt(0)
v_mfma_f32_16x16x32_bf16 v[168:171], a[208:211], a[112:115], v[168:171]
s_waitcnt vmcnt(31)
s_barrier
v_mfma_f32_16x16x32_bf16 v[168:171], a[212:215], a[120:123], v[168:171]
buffer_load_dwordx4 v3, s[8:11], s38 offen offset:2048 sc1 lds
v_mfma_f32_16x16x32_bf16 v[172:175], a[200:203], a[100:103], v[172:175]
ds_read_b128 a[160:163], v49 offset:0
v_mfma_f32_16x16x32_bf16 v[172:175], a[204:207], a[108:111], v[172:175]
ds_read_b128 a[164:167], v49 offset:9216
v_mfma_f32_16x16x32_bf16 v[172:175], a[208:211], a[116:119], v[172:175]
ds_read_b128 a[168:171], v49 offset:18432
v_mfma_f32_16x16x32_bf16 v[172:175], a[212:215], a[124:127], v[172:175]
buffer_load_dwordx4 a[28:31], v3, s[8:11], s45 offen offset:3072 sc1
v_mfma_f32_16x16x32_bf16 v[176:179], a[216:219], a[96:99], v[176:179]
s_add_u32 s44, s44, s41
s_add_u32 s45, s45, s41
ds_read_b128 a[172:175], v49 offset:27648
v_mfma_f32_16x16x32_bf16 v[176:179], a[220:223], a[104:107], v[176:179]
ds_read_b128 a[176:179], v49 offset:1024
v_mfma_f32_16x16x32_bf16 v[176:179], a[224:227], a[112:115], v[176:179]
ds_read_b128 a[180:183], v49 offset:10240
v_mfma_f32_16x16x32_bf16 v[176:179], a[228:231], a[120:123], v[176:179]
buffer_load_dwordx4 v3, s[8:11], s38 offen offset:3072 sc1 lds
v_mfma_f32_16x16x32_bf16 v[180:183], a[216:219], a[100:103], v[180:183]
s_add_u32 s38, s38, 4096
ds_read_b128 a[184:187], v49 offset:19456
v_mfma_f32_16x16x32_bf16 v[180:183], a[220:223], a[108:111], v[180:183]
s_waitcnt vmcnt(29) lgkmcnt(5)
ds_read_b128 a[188:191], v49 offset:28672
v_mfma_f32_16x16x32_bf16 v[180:183], a[224:227], a[116:119], v[180:183]
s_add_u32 m0, s34, 8192
ds_read_b128 a[192:195], v49 offset:2048
v_mfma_f32_16x16x32_bf16 v[180:183], a[228:231], a[124:127], v[180:183]
buffer_load_dwordx4 v3, s[8:11], s38 offen offset:0 sc1 lds
v_mfma_f32_16x16x32_bf16 v[112:115], a[160:163], v[224:227], v[112:115]
s_add_u32 s38, s38, s19
ds_read_b128 a[196:199], v49 offset:11264
v_mfma_f32_16x16x32_bf16 v[112:115], a[164:167], v[232:235], v[112:115]
s_waitcnt vmcnt(26) lgkmcnt(7)
ds_read_b128 a[200:203], v49 offset:20480
v_mfma_f32_16x16x32_bf16 v[112:115], a[168:171], v[240:243], v[112:115]
s_waitcnt vmcnt(22) lgkmcnt(7)
ds_read_b128 a[204:207], v49 offset:29696
v_mfma_f32_16x16x32_bf16 v[112:115], a[172:175], v[248:251], v[112:115]
buffer_load_dwordx4 a[32:35], v3, s[8:11], s44 offen offset:0 sc1
v_mfma_f32_16x16x32_bf16 v[116:119], a[160:163], v[228:231], v[116:119]
ds_read_b128 a[208:211], v49 offset:3072
v_mfma_f32_16x16x32_bf16 v[116:119], a[164:167], v[236:239], v[116:119]
s_waitcnt vmcnt(21) lgkmcnt(8)
ds_read_b128 a[212:215], v49 offset:12288
v_mfma_f32_16x16x32_bf16 v[116:119], a[168:171], v[244:247], v[116:119]
s_add_u32 m0, s34, 49152
ds_read_b128 a[216:219], v49 offset:21504
v_mfma_f32_16x16x32_bf16 v[116:119], a[172:175], v[252:255], v[116:119]
buffer_load_dwordx4 v3, s[8:11], s38 offen offset:0 sc1 lds
v_mfma_f32_16x16x32_bf16 v[120:123], a[176:179], v[224:227], v[120:123]
s_waitcnt lgkmcnt(9)
ds_read_b128 a[220:223], v49 offset:30720
v_mfma_f32_16x16x32_bf16 v[120:123], a[180:183], v[232:235], v[120:123]
s_waitcnt lgkmcnt(9)
v_mfma_f32_16x16x32_bf16 v[120:123], a[184:187], v[240:243], v[120:123]
s_waitcnt lgkmcnt(8)
ds_read_b128 a[224:227], v49 offset:4096
v_mfma_f32_16x16x32_bf16 v[120:123], a[188:191], v[248:251], v[120:123]
buffer_load_dwordx4 a[36:39], v3, s[8:11], s45 offen offset:0 sc1
v_mfma_f32_16x16x32_bf16 v[124:127], a[176:179], v[228:231], v[124:127]
ds_read_b128 a[228:231], v49 offset:13312
v_mfma_f32_16x16x32_bf16 v[124:127], a[180:183], v[236:239], v[124:127]
ds_read_b128 a[160:163], v49 offset:22528
v_mfma_f32_16x16x32_bf16 v[124:127], a[184:187], v[244:247], v[124:127]
s_waitcnt lgkmcnt(10)
ds_read_b128 a[164:167], v49 offset:31744
v_mfma_f32_16x16x32_bf16 v[124:127], a[188:191], v[252:255], v[124:127]
buffer_load_dwordx4 v3, s[8:11], s38 offen offset:1024 sc1 lds
v_mfma_f32_16x16x32_bf16 v[128:131], a[192:195], v[224:227], v[128:131]
s_waitcnt lgkmcnt(10)
ds_read_b128 a[168:171], v49 offset:5120
v_mfma_f32_16x16x32_bf16 v[128:131], a[196:199], v[232:235], v[128:131]
s_waitcnt lgkmcnt(10)
v_mfma_f32_16x16x32_bf16 v[128:131], a[200:203], v[240:243], v[128:131]
s_waitcnt lgkmcnt(9)
ds_read_b128 a[172:175], v49 offset:14336
v_mfma_f32_16x16x32_bf16 v[128:131], a[204:207], v[248:251], v[128:131]
buffer_load_dwordx4 a[40:43], v3, s[8:11], s44 offen offset:1024 sc1
v_mfma_f32_16x16x32_bf16 v[132:135], a[192:195], v[228:231], v[132:135]
ds_read_b128 a[176:179], v49 offset:23552
v_mfma_f32_16x16x32_bf16 v[132:135], a[196:199], v[236:239], v[132:135]
ds_read_b128 a[180:183], v49 offset:32768
v_mfma_f32_16x16x32_bf16 v[132:135], a[200:203], v[244:247], v[132:135]
s_waitcnt lgkmcnt(11)
v_mfma_f32_16x16x32_bf16 v[132:135], a[204:207], v[252:255], v[132:135]
buffer_load_dwordx4 v3, s[8:11], s38 offen offset:2048 sc1 lds
v_mfma_f32_16x16x32_bf16 v[136:139], a[208:211], v[224:227], v[136:139]
s_waitcnt lgkmcnt(10)
ds_read_b128 a[184:187], v49 offset:6144
v_mfma_f32_16x16x32_bf16 v[136:139], a[212:215], v[232:235], v[136:139]
s_waitcnt lgkmcnt(10)
v_mfma_f32_16x16x32_bf16 v[136:139], a[216:219], v[240:243], v[136:139]
s_waitcnt lgkmcnt(9)
ds_read_b128 a[188:191], v49 offset:15360
v_mfma_f32_16x16x32_bf16 v[136:139], a[220:223], v[248:251], v[136:139]
buffer_load_dwordx4 a[44:47], v3, s[8:11], s45 offen offset:1024 sc1
v_mfma_f32_16x16x32_bf16 v[140:143], a[208:211], v[228:231], v[140:143]
ds_read_b128 a[192:195], v49 offset:24576
v_mfma_f32_16x16x32_bf16 v[140:143], a[212:215], v[236:239], v[140:143]
ds_read_b128 a[196:199], v49 offset:33792
v_mfma_f32_16x16x32_bf16 v[140:143], a[216:219], v[244:247], v[140:143]
s_waitcnt lgkmcnt(10)
v_mfma_f32_16x16x32_bf16 v[140:143], a[220:223], v[252:255], v[140:143]
buffer_load_dwordx4 v3, s[8:11], s38 offen offset:3072 sc1 lds
v_mfma_f32_16x16x32_bf16 v[144:147], a[224:227], v[224:227], v[144:147]
s_add_u32 s38, s38, 4096
ds_read_b128 a[200:203], v49 offset:7168
v_mfma_f32_16x16x32_bf16 v[144:147], a[228:231], v[232:235], v[144:147]
s_waitcnt lgkmcnt(10)
v_mfma_f32_16x16x32_bf16 v[144:147], a[160:163], v[240:243], v[144:147]
s_waitcnt lgkmcnt(9)
ds_read_b128 a[204:207], v49 offset:16384
v_mfma_f32_16x16x32_bf16 v[144:147], a[164:167], v[248:251], v[144:147]
buffer_load_dwordx4 a[48:51], v3, s[8:11], s44 offen offset:2048 sc1
v_mfma_f32_16x16x32_bf16 v[148:151], a[224:227], v[228:231], v[148:151]
ds_read_b128 a[208:211], v49 offset:25600
v_mfma_f32_16x16x32_bf16 v[148:151], a[228:231], v[236:239], v[148:151]
s_waitcnt lgkmcnt(10)
ds_read_b128 a[212:215], v49 offset:34816
v_mfma_f32_16x16x32_bf16 v[148:151], a[160:163], v[244:247], v[148:151]
s_add_u32 m0, s34, 53248
v_mfma_f32_16x16x32_bf16 v[148:151], a[164:167], v[252:255], v[148:151]
buffer_load_dwordx4 v3, s[8:11], s38 offen offset:0 sc1 lds
v_mfma_f32_16x16x32_bf16 v[152:155], a[168:171], v[224:227], v[152:155]
s_waitcnt lgkmcnt(9)
ds_read_b128 a[216:219], v49 offset:8192
v_mfma_f32_16x16x32_bf16 v[152:155], a[172:175], v[232:235], v[152:155]
s_add_u32 s47, s47, s65
v_mfma_f32_16x16x32_bf16 v[152:155], a[176:179], v[240:243], v[152:155]
s_waitcnt vmcnt(27) lgkmcnt(9)
ds_read_b128 a[220:223], v49 offset:17408
v_subrev_u32 v84, s47, v84
v_mfma_f32_16x16x32_bf16 v[152:155], a[180:183], v[248:251], v[152:155]
buffer_load_dwordx4 a[52:55], v3, s[8:11], s45 offen offset:2048 sc1
v_mfma_f32_16x16x32_bf16 v[156:159], a[168:171], v[228:231], v[156:159]
ds_read_b128 a[224:227], v49 offset:26624
v_subrev_u32 v85, s47, v85
v_mfma_f32_16x16x32_bf16 v[156:159], a[172:175], v[236:239], v[156:159]
ds_read_b128 a[228:231], v49 offset:35840
v_max_u32 v84, v84, v85
v_mfma_f32_16x16x32_bf16 v[156:159], a[176:179], v[244:247], v[156:159]
s_waitcnt lgkmcnt(11)
v_cmp_le_u32 vcc, 8, v84
v_mfma_f32_16x16x32_bf16 v[156:159], a[180:183], v[252:255], v[156:159]
buffer_load_dwordx4 v3, s[8:11], s38 offen offset:1024 sc1 lds
v_mfma_f32_16x16x32_bf16 v[160:163], a[184:187], v[224:227], v[160:163]
s_waitcnt lgkmcnt(10)
v_mfma_f32_16x16x32_bf16 v[160:163], a[188:191], v[232:235], v[160:163]
s_waitcnt lgkmcnt(9)
v_mfma_f32_16x16x32_bf16 v[160:163], a[192:195], v[240:243], v[160:163]
s_waitcnt lgkmcnt(8)
v_mfma_f32_16x16x32_bf16 v[160:163], a[196:199], v[248:251], v[160:163]
buffer_load_dwordx4 a[56:59], v3, s[8:11], s44 offen offset:3072 sc1
v_mfma_f32_16x16x32_bf16 v[164:167], a[184:187], v[228:231], v[164:167]
v_mfma_f32_16x16x32_bf16 v[164:167], a[188:191], v[236:239], v[164:167]
s_cbranch_vccnz K1_ps3
K1_pb3:
v_mfma_f32_16x16x32_bf16 v[164:167], a[192:195], v[244:247], v[164:167]
s_waitcnt lgkmcnt(7)
v_mfma_f32_16x16x32_bf16 v[164:167], a[196:199], v[252:255], v[164:167]
buffer_load_dwordx4 v3, s[8:11], s38 offen offset:2048 sc1 lds
v_mfma_f32_16x16x32_bf16 v[168:171], a[200:203], v[224:227], v[168:171]
s_waitcnt lgkmcnt(6)
v_mfma_f32_16x16x32_bf16 v[168:171], a[204:207], v[232:235], v[168:171]
s_waitcnt lgkmcnt(0)
v_mfma_f32_16x16x32_bf16 v[168:171], a[208:211], v[240:243], v[168:171]
s_barrier
v_mfma_f32_16x16x32_bf16 v[168:171], a[212:215], v[248:251], v[168:171]
buffer_load_dwordx4 a[60:63], v3, s[8:11], s45 offen offset:3072 sc1
v_mfma_f32_16x16x32_bf16 v[172:175], a[200:203], v[228:231], v[172:175]
s_add_u32 s44, s44, s50
s_add_u32 s45, s45, s50
ds_read_b128 a[160:163], v50 offset:0
v_mfma_f32_16x16x32_bf16 v[172:175], a[204:207], v[236:239], v[172:175]
ds_read_b128 a[164:167], v50 offset:9216
v_mfma_f32_16x16x32_bf16 v[172:175], a[208:211], v[244:247], v[172:175]
ds_read_b128 a[168:171], v50 offset:18432
v_mfma_f32_16x16x32_bf16 v[172:175], a[212:215], v[252:255], v[172:175]
buffer_load_dwordx4 v3, s[8:11], s38 offen offset:3072 sc1 lds
v_mfma_f32_16x16x32_bf16 v[176:179], a[216:219], v[224:227], v[176:179]
s_add_u32 s38, s38, 4096
ds_read_b128 a[172:175], v50 offset:27648
v_mfma_f32_16x16x32_bf16 v[176:179], a[220:223], v[232:235], v[176:179]
ds_read_b128 a[176:179], v50 offset:1024
v_mfma_f32_16x16x32_bf16 v[176:179], a[224:227], v[240:243], v[176:179]
s_add_u32 m0, s34, 57344
ds_read_b128 a[180:183], v50 offset:10240
v_mfma_f32_16x16x32_bf16 v[176:179], a[228:231], v[248:251], v[176:179]
buffer_load_dwordx4 v3, s[8:11], s38 offen offset:0 sc1 lds
v_mfma_f32_16x16x32_bf16 v[180:183], a[216:219], v[228:231], v[180:183]
s_add_u32 s38, s38, s16
ds_read_b128 a[184:187], v50 offset:19456
v_mfma_f32_16x16x32_bf16 v[180:183], a[220:223], v[236:239], v[180:183]
s_waitcnt vmcnt(33) lgkmcnt(6)
ds_read_b128 a[188:191], v50 offset:28672
v_mfma_f32_16x16x32_bf16 v[180:183], a[224:227], v[244:247], v[180:183]
s_cmp_eq_u32 s42, s46
ds_read_b128 a[192:195], v50 offset:2048
v_mfma_f32_16x16x32_bf16 v[180:183], a[228:231], v[252:255], v[180:183]
s_cbranch_scc1 K1_tail2
v_mfma_f32_16x16x32_bf16 v[112:115], a[160:163], a[0:3], v[112:115]
s_waitcnt vmcnt(29) lgkmcnt(7)
ds_read_b128 a[196:199], v50 offset:11264
v_mfma_f32_16x16x32_bf16 v[112:115], a[164:167], a[8:11], v[112:115]
s_waitcnt vmcnt(25) lgkmcnt(7)
ds_read_b128 a[200:203], v50 offset:20480
v_mfma_f32_16x16x32_bf16 v[112:115], a[168:171], a[16:19], v[112:115]
s_waitcnt vmcnt(21) lgkmcnt(7)
ds_read_b128 a[204:207], v50 offset:29696
v_mfma_f32_16x16x32_bf16 v[112:115], a[172:175], a[24:27], v[112:115]
buffer_load_dwordx4 a[96:99], v3, s[8:11], s44 offen offset:0 sc1
v_mfma_f32_16x16x32_bf16 v[116:119], a[160:163], a[4:7], v[116:119]
ds_read_b128 a[208:211], v50 offset:3072
v_mfma_f32_16x16x32_bf16 v[116:119], a[164:167], a[12:15], v[116:119]
s_waitcnt vmcnt(20) lgkmcnt(8)
ds_read_b128 a[212:215], v50 offset:12288
v_mfma_f32_16x16x32_bf16 v[116:119], a[168:171], a[20:23], v[116:119]
s_add_u32 m0, s34, 86016
ds_read_b128 a[216:219], v50 offset:21504
v_mfma_f32_16x16x32_bf16 v[116:119], a[172:175], a[28:31], v[116:119]
buffer_load_dwordx4 v3, s[8:11], s38 offen offset:0 sc1 lds
v_mfma_f32_16x16x32_bf16 v[120:123], a[176:179], a[0:3], v[120:123]
s_waitcnt lgkmcnt(9)
ds_read_b128 a[220:223], v50 offset:30720
v_mfma_f32_16x16x32_bf16 v[120:123], a[180:183], a[8:11], v[120:123]
s_waitcnt lgkmcnt(9)
v_mfma_f32_16x16x32_bf16 v[120:123], a[184:187], a[16:19], v[120:123]
s_waitcnt lgkmcnt(8)
ds_read_b128 a[224:227], v50 offset:4096
v_mfma_f32_16x16x32_bf16 v[120:123], a[188:191], a[24:27], v[120:123]
buffer_load_dwordx4 a[100:103], v3, s[8:11], s45 offen offset:0 sc1
v_mfma_f32_16x16x32_bf16 v[124:127], a[176:179], a[4:7], v[124:127]
ds_read_b128 a[228:231], v50 offset:13312
v_mfma_f32_16x16x32_bf16 v[124:127], a[180:183], a[12:15], v[124:127]
ds_read_b128 a[160:163], v50 offset:22528
v_mfma_f32_16x16x32_bf16 v[124:127], a[184:187], a[20:23], v[124:127]
s_waitcnt lgkmcnt(10)
ds_read_b128 a[164:167], v50 offset:31744
v_mfma_f32_16x16x32_bf16 v[124:127], a[188:191], a[28:31], v[124:127]
buffer_load_dwordx4 v3, s[8:11], s38 offen offset:1024 sc1 lds
v_mfma_f32_16x16x32_bf16 v[128:131], a[192:195], a[0:3], v[128:131]
s_waitcnt lgkmcnt(10)
ds_read_b128 a[168:171], v50 offset:5120
v_mfma_f32_16x16x32_bf16 v[128:131], a[196:199], a[8:11], v[128:131]
s_waitcnt lgkmcnt(10)
v_mfma_f32_16x16x32_bf16 v[128:131], a[200:203], a[16:19], v[128:131]
s_waitcnt lgkmcnt(9)
ds_read_b128 a[172:175], v50 offset:14336
v_mfma_f32_16x16x32_bf16 v[128:131], a[204:207], a[24:27], v[128:131]
buffer_load_dwordx4 a[104:107], v3, s[8:11], s44 offen offset:1024 sc1
v_mfma_f32_16x16x32_bf16 v[132:135], a[192:195], a[4:7], v[132:135]
ds_read_b128 a[176:179], v50 offset:23552
v_mfma_f32_16x16x32_bf16 v[132:135], a[196:199], a[12:15], v[132:135]
ds_read_b128 a[180:183], v50 offset:32768
v_mfma_f32_16x16x32_bf16 v[132:135], a[200:203], a[20:23], v[132:135]
s_waitcnt lgkmcnt(11)
v_mfma_f32_16x16x32_bf16 v[132:135], a[204:207], a[28:31], v[132:135]
buffer_load_dwordx4 v3, s[8:11], s38 offen offset:2048 sc1 lds
v_mfma_f32_16x16x32_bf16 v[136:139], a[208:211], a[0:3], v[136:139]
s_waitcnt lgkmcnt(10)
ds_read_b128 a[184:187], v50 offset:6144
v_mfma_f32_16x16x32_bf16 v[136:139], a[212:215], a[8:11], v[136:139]
s_waitcnt lgkmcnt(10)
v_mfma_f32_16x16x32_bf16 v[136:139], a[216:219], a[16:19], v[136:139]
s_waitcnt lgkmcnt(9)
ds_read_b128 a[188:191], v50 offset:15360
v_mfma_f32_16x16x32_bf16 v[136:139], a[220:223], a[24:27], v[136:139]
buffer_load_dwordx4 a[108:111], v3, s[8:11], s45 offen offset:1024 sc1
v_mfma_f32_16x16x32_bf16 v[140:143], a[208:211], a[4:7], v[140:143]
ds_read_b128 a[192:195], v50 offset:24576
v_mfma_f32_16x16x32_bf16 v[140:143], a[212:215], a[12:15], v[140:143]
ds_read_b128 a[196:199], v50 offset:33792
v_mfma_f32_16x16x32_bf16 v[140:143], a[216:219], a[20:23], v[140:143]
s_waitcnt lgkmcnt(10)
v_mfma_f32_16x16x32_bf16 v[140:143], a[220:223], a[28:31], v[140:143]
buffer_load_dwordx4 v3, s[8:11], s38 offen offset:3072 sc1 lds
v_mfma_f32_16x16x32_bf16 v[144:147], a[224:227], a[0:3], v[144:147]
s_add_u32 s38, s38, 4096
ds_read_b128 a[200:203], v50 offset:7168
v_mfma_f32_16x16x32_bf16 v[144:147], a[228:231], a[8:11], v[144:147]
s_waitcnt lgkmcnt(10)
v_mfma_f32_16x16x32_bf16 v[144:147], a[160:163], a[16:19], v[144:147]
s_waitcnt lgkmcnt(9)
ds_read_b128 a[204:207], v50 offset:16384
v_mfma_f32_16x16x32_bf16 v[144:147], a[164:167], a[24:27], v[144:147]
buffer_load_dwordx4 a[112:115], v3, s[8:11], s44 offen offset:2048 sc1
v_mfma_f32_16x16x32_bf16 v[148:151], a[224:227], a[4:7], v[148:151]
ds_read_b128 a[208:211], v50 offset:25600
v_mfma_f32_16x16x32_bf16 v[148:151], a[228:231], a[12:15], v[148:151]
s_waitcnt lgkmcnt(10)
ds_read_b128 a[212:215], v50 offset:34816
v_mfma_f32_16x16x32_bf16 v[148:151], a[160:163], a[20:23], v[148:151]
s_add_u32 m0, s34, 90112
v_mfma_f32_16x16x32_bf16 v[148:151], a[164:167], a[28:31], v[148:151]
buffer_load_dwordx4 v3, s[8:11], s38 offen offset:0 sc1 lds
v_mfma_f32_16x16x32_bf16 v[152:155], a[168:171], a[0:3], v[152:155]
s_waitcnt lgkmcnt(10)
ds_read_b128 a[216:219], v50 offset:8192
v_mfma_f32_16x16x32_bf16 v[152:155], a[172:175], a[8:11], v[152:155]
s_waitcnt lgkmcnt(10)
v_mfma_f32_16x16x32_bf16 v[152:155], a[176:179], a[16:19], v[152:155]
s_waitcnt lgkmcnt(9)
ds_read_b128 a[220:223], v50 offset:17408
v_mfma_f32_16x16x32_bf16 v[152:155], a[180:183], a[24:27], v[152:155]
buffer_load_dwordx4 a[116:119], v3, s[8:11], s45 offen offset:2048 sc1
v_mfma_f32_16x16x32_bf16 v[156:159], a[168:171], a[4:7], v[156:159]
ds_read_b128 a[224:227], v50 offset:26624
v_mfma_f32_16x16x32_bf16 v[156:159], a[172:175], a[12:15], v[156:159]
ds_read_b128 a[228:231], v50 offset:35840
v_mfma_f32_16x16x32_bf16 v[156:159], a[176:179], a[20:23], v[156:159]
s_waitcnt lgkmcnt(11)
v_mfma_f32_16x16x32_bf16 v[156:159], a[180:183], a[28:31], v[156:159]
buffer_load_dwordx4 v3, s[8:11], s38 offen offset:1024 sc1 lds
v_mfma_f32_16x16x32_bf16 v[160:163], a[184:187], a[0:3], v[160:163]
s_waitcnt lgkmcnt(10)
v_mfma_f32_16x16x32_bf16 v[160:163], a[188:191], a[8:11], v[160:163]
s_waitcnt lgkmcnt(9)
v_mfma_f32_16x16x32_bf16 v[160:163], a[192:195], a[16:19], v[160:163]
s_waitcnt lgkmcnt(8)
v_mfma_f32_16x16x32_bf16 v[160:163], a[196:199], a[24:27], v[160:163]
buffer_load_dwordx4 a[120:123], v3, s[8:11], s44 offen offset:3072 sc1
v_mfma_f32_16x16x32_bf16 v[164:167], a[184:187], a[4:7], v[164:167]
v_mfma_f32_16x16x32_bf16 v[164:167], a[188:191], a[12:15], v[164:167]
v_mfma_f32_16x16x32_bf16 v[164:167], a[192:195], a[20:23], v[164:167]
s_waitcnt lgkmcnt(7)
v_mfma_f32_16x16x32_bf16 v[164:167], a[196:199], a[28:31], v[164:167]
buffer_load_dwordx4 v3, s[8:11], s38 offen offset:2048 sc1 lds
v_mfma_f32_16x16x32_bf16 v[168:171], a[200:203], a[0:3], v[168:171]
s_waitcnt lgkmcnt(6)
v_mfma_f32_16x16x32_bf16 v[168:171], a[204:207], a[8:11], v[168:171]
s_waitcnt lgkmcnt(0)
v_mfma_f32_16x16x32_bf16 v[168:171], a[208:211], a[16:19], v[168:171]
s_waitcnt vmcnt(31)
s_barrier
v_mfma_f32_16x16x32_bf16 v[168:171], a[212:215], a[24:27], v[168:171]
buffer_load_dwordx4 a[124:127], v3, s[8:11], s45 offen offset:3072 sc1
v_mfma_f32_16x16x32_bf16 v[172:175], a[200:203], a[4:7], v[172:175]
s_add_u32 s44, s44, s39
s_add_u32 s45, s45, s39
ds_read_b128 a[160:163], v51 offset:0
v_mfma_f32_16x16x32_bf16 v[172:175], a[204:207], a[12:15], v[172:175]
ds_read_b128 a[164:167], v51 offset:9216
v_mfma_f32_16x16x32_bf16 v[172:175], a[208:211], a[20:23], v[172:175]
ds_read_b128 a[168:171], v51 offset:18432
v_mfma_f32_16x16x32_bf16 v[172:175], a[212:215], a[28:31], v[172:175]
buffer_load_dwordx4 v3, s[8:11], s38 offen offset:3072 sc1 lds
v_mfma_f32_16x16x32_bf16 v[176:179], a[216:219], a[0:3], v[176:179]
s_add_u32 s38, s38, 4096
ds_read_b128 a[172:175], v51 offset:27648
v_mfma_f32_16x16x32_bf16 v[176:179], a[220:223], a[8:11], v[176:179]
ds_read_b128 a[176:179], v51 offset:1024
v_mfma_f32_16x16x32_bf16 v[176:179], a[224:227], a[16:19], v[176:179]
s_add_u32 m0, s34, 94208
ds_read_b128 a[180:183], v51 offset:10240
v_mfma_f32_16x16x32_bf16 v[176:179], a[228:231], a[24:27], v[176:179]
buffer_load_dwordx4 v3, s[8:11], s38 offen offset:0 sc1 lds
v_mfma_f32_16x16x32_bf16 v[180:183], a[216:219], a[4:7], v[180:183]
s_add_u32 s38, s38, s17
ds_read_b128 a[184:187], v51 offset:19456
v_mfma_f32_16x16x32_bf16 v[180:183], a[220:223], a[12:15], v[180:183]
ds_read_b128 a[188:191], v51 offset:28672
v_mfma_f32_16x16x32_bf16 v[180:183], a[224:227], a[20:23], v[180:183]
ds_read_b128 a[192:195], v51 offset:2048
v_mfma_f32_16x16x32_bf16 v[180:183], a[228:231], a[28:31], v[180:183]
s_waitcnt vmcnt(33) lgkmcnt(8)
v_mfma_f32_16x16x32_bf16 v[112:115], a[160:163], a[32:35], v[112:115]
s_waitcnt vmcnt(29) lgkmcnt(7)
ds_read_b128 a[196:199], v51 offset:11264
v_mfma_f32_16x16x32_bf16 v[112:115], a[164:167], a[40:43], v[112:115]
s_waitcnt vmcnt(25) lgkmcnt(7)
ds_read_b128 a[200:203], v51 offset:20480
v_mfma_f32_16x16x32_bf16 v[112:115], a[168:171], a[48:51], v[112:115]
s_waitcnt vmcnt(21) lgkmcnt(7)
ds_read_b128 a[204:207], v51 offset:29696
v_mfma_f32_16x16x32_bf16 v[112:115], a[172:175], a[56:59], v[112:115]
buffer_load_dwordx4 v[224:227], v3, s[8:11], s44 offen offset:0 sc1
v_mfma_f32_16x16x32_bf16 v[116:119], a[160:163], a[36:39], v[116:119]
ds_read_b128 a[208:211], v51 offset:3072
v_mfma_f32_16x16x32_bf16 v[116:119], a[164:167], a[44:47], v[116:119]
s_waitcnt vmcnt(20) lgkmcnt(8)
ds_read_b128 a[212:215], v51 offset:12288
v_mfma_f32_16x16x32_bf16 v[116:119], a[168:171], a[52:55], v[116:119]
s_add_u32 m0, s34, 122880
ds_read_b128 a[216:219], v51 offset:21504
v_mfma_f32_16x16x32_bf16 v[116:119], a[172:175], a[60:63], v[116:119]
buffer_load_dwordx4 v3, s[8:11], s38 offen offset:0 sc1 lds
v_mfma_f32_16x16x32_bf16 v[120:123], a[176:179], a[32:35], v[120:123]
s_waitcnt lgkmcnt(9)
ds_read_b128 a[220:223], v51 offset:30720
v_mfma_f32_16x16x32_bf16 v[120:123], a[180:183], a[40:43], v[120:123]
s_waitcnt lgkmcnt(9)
v_mfma_f32_16x16x32_bf16 v[120:123], a[184:187], a[48:51], v[120:123]
s_waitcnt lgkmcnt(8)
ds_read_b128 a[224:227], v51 offset:4096
v_mfma_f32_16x16x32_bf16 v[120:123], a[188:191], a[56:59], v[120:123]
buffer_load_dwordx4 v[228:231], v3, s[8:11], s45 offen offset:0 sc1
v_mfma_f32_16x16x32_bf16 v[124:127], a[176:179], a[36:39], v[124:127]
ds_read_b128 a[228:231], v51 offset:13312
v_mfma_f32_16x16x32_bf16 v[124:127], a[180:183], a[44:47], v[124:127]
ds_read_b128 a[160:163], v51 offset:22528
v_mfma_f32_16x16x32_bf16 v[124:127], a[184:187], a[52:55], v[124:127]
s_waitcnt lgkmcnt(10)
ds_read_b128 a[164:167], v51 offset:31744
v_mfma_f32_16x16x32_bf16 v[124:127], a[188:191], a[60:63], v[124:127]
buffer_load_dwordx4 v3, s[8:11], s38 offen offset:1024 sc1 lds
v_mfma_f32_16x16x32_bf16 v[128:131], a[192:195], a[32:35], v[128:131]
s_waitcnt lgkmcnt(10)
ds_read_b128 a[168:171], v51 offset:5120
v_mfma_f32_16x16x32_bf16 v[128:131], a[196:199], a[40:43], v[128:131]
s_waitcnt lgkmcnt(10)
v_mfma_f32_16x16x32_bf16 v[128:131], a[200:203], a[48:51], v[128:131]
s_waitcnt lgkmcnt(9)
ds_read_b128 a[172:175], v51 offset:14336
v_mfma_f32_16x16x32_bf16 v[128:131], a[204:207], a[56:59], v[128:131]
buffer_load_dwordx4 v[232:235], v3, s[8:11], s44 offen offset:1024 sc1
v_mfma_f32_16x16x32_bf16 v[132:135], a[192:195], a[36:39], v[132:135]
ds_read_b128 a[176:179], v51 offset:23552
v_mfma_f32_16x16x32_bf16 v[132:135], a[196:199], a[44:47], v[132:135]
ds_read_b128 a[180:183], v51 offset:32768
v_mfma_f32_16x16x32_bf16 v[132:135], a[200:203], a[52:55], v[132:135]
s_waitcnt lgkmcnt(11)
v_mfma_f32_16x16x32_bf16 v[132:135], a[204:207], a[60:63], v[132:135]
buffer_load_dwordx4 v3, s[8:11], s38 offen offset:2048 sc1 lds
v_mfma_f32_16x16x32_bf16 v[136:139], a[208:211], a[32:35], v[136:139]
s_waitcnt lgkmcnt(10)
ds_read_b128 a[184:187], v51 offset:6144
v_mfma_f32_16x16x32_bf16 v[136:139], a[212:215], a[40:43], v[136:139]
s_waitcnt lgkmcnt(10)
v_mfma_f32_16x16x32_bf16 v[136:139], a[216:219], a[48:51], v[136:139]
s_waitcnt lgkmcnt(9)
ds_read_b128 a[188:191], v51 offset:15360
v_mfma_f32_16x16x32_bf16 v[136:139], a[220:223], a[56:59], v[136:139]
buffer_load_dwordx4 v[236:239], v3, s[8:11], s45 offen offset:1024 sc1
v_mfma_f32_16x16x32_bf16 v[140:143], a[208:211], a[36:39], v[140:143]
ds_read_b128 a[192:195], v51 offset:24576
v_mfma_f32_16x16x32_bf16 v[140:143], a[212:215], a[44:47], v[140:143]
ds_read_b128 a[196:199], v51 offset:33792
v_mfma_f32_16x16x32_bf16 v[140:143], a[216:219], a[52:55], v[140:143]
s_waitcnt lgkmcnt(10)
v_mfma_f32_16x16x32_bf16 v[140:143], a[220:223], a[60:63], v[140:143]
buffer_load_dwordx4 v3, s[8:11], s38 offen offset:3072 sc1 lds
v_mfma_f32_16x16x32_bf16 v[144:147], a[224:227], a[32:35], v[144:147]
s_add_u32 s38, s38, 4096
ds_read_b128 a[200:203], v51 offset:7168
v_mfma_f32_16x16x32_bf16 v[144:147], a[228:231], a[40:43], v[144:147]
s_waitcnt lgkmcnt(10)
v_mfma_f32_16x16x32_bf16 v[144:147], a[160:163], a[48:51], v[144:147]
s_waitcnt lgkmcnt(9)
ds_read_b128 a[204:207], v51 offset:16384
v_mfma_f32_16x16x32_bf16 v[144:147], a[164:167], a[56:59], v[144:147]
buffer_load_dwordx4 v[240:243], v3, s[8:11], s44 offen offset:2048 sc1
v_mfma_f32_16x16x32_bf16 v[148:151], a[224:227], a[36:39], v[148:151]
ds_read_b128 a[208:211], v51 offset:25600
v_mfma_f32_16x16x32_bf16 v[148:151], a[228:231], a[44:47], v[148:151]
s_waitcnt lgkmcnt(10)
ds_read_b128 a[212:215], v51 offset:34816
v_mfma_f32_16x16x32_bf16 v[148:151], a[160:163], a[52:55], v[148:151]
s_add_u32 m0, s34, 126976
v_mfma_f32_16x16x32_bf16 v[148:151], a[164:167], a[60:63], v[148:151]
buffer_load_dwordx4 v3, s[8:11], s38 offen offset:0 sc1 lds
v_mfma_f32_16x16x32_bf16 v[152:155], a[168:171], a[32:35], v[152:155]
s_waitcnt lgkmcnt(10)
ds_read_b128 a[216:219], v51 offset:8192
v_mfma_f32_16x16x32_bf16 v[152:155], a[172:175], a[40:43], v[152:155]
s_waitcnt lgkmcnt(10)
v_mfma_f32_16x16x32_bf16 v[152:155], a[176:179], a[48:51], v[152:155]
s_waitcnt lgkmcnt(9)
ds_read_b128 a[220:223], v51 offset:17408
v_mfma_f32_16x16x32_bf16 v[152:155], a[180:183], a[56:59], v[152:155]
buffer_load_dwordx4 v[244:247], v3, s[8:11], s45 offen offset:2048 sc1
v_mfma_f32_16x16x32_bf16 v[156:159], a[168:171], a[36:39], v[156:159]
ds_read_b128 a[224:227], v51 offset:26624
v_mfma_f32_16x16x32_bf16 v[156:159], a[172:175], a[44:47], v[156:159]
ds_read_b128 a[228:231], v51 offset:35840
v_mfma_f32_16x16x32_bf16 v[156:159], a[176:179], a[52:55], v[156:159]
s_waitcnt lgkmcnt(11)
v_mfma_f32_16x16x32_bf16 v[156:159], a[180:183], a[60:63], v[156:159]
buffer_load_dwordx4 v3, s[8:11], s38 offen offset:1024 sc1 lds
v_mfma_f32_16x16x32_bf16 v[160:163], a[184:187], a[32:35], v[160:163]
s_waitcnt lgkmcnt(10)
v_mfma_f32_16x16x32_bf16 v[160:163], a[188:191], a[40:43], v[160:163]
s_waitcnt lgkmcnt(9)
v_mfma_f32_16x16x32_bf16 v[160:163], a[192:195], a[48:51], v[160:163]
s_waitcnt lgkmcnt(8)
v_mfma_f32_16x16x32_bf16 v[160:163], a[196:199], a[56:59], v[160:163]
buffer_load_dwordx4 v[248:251], v3, s[8:11], s44 offen offset:3072 sc1
v_mfma_f32_16x16x32_bf16 v[164:167], a[184:187], a[36:39], v[164:167]
v_mfma_f32_16x16x32_bf16 v[164:167], a[188:191], a[44:47], v[164:167]
v_mfma_f32_16x16x32_bf16 v[164:167], a[192:195], a[52:55], v[164:167]
s_waitcnt lgkmcnt(7)
v_mfma_f32_16x16x32_bf16 v[164:167], a[196:199], a[60:63], v[164:167]
buffer_load_dwordx4 v3, s[8:11], s38 offen offset:2048 sc1 lds
v_mfma_f32_16x16x32_bf16 v[168:171], a[200:203], a[32:35], v[168:171]
s_waitcnt lgkmcnt(6)
v_mfma_f32_16x16x32_bf16 v[168:171], a[204:207], a[40:43], v[168:171]
s_waitcnt lgkmcnt(0)
v_mfma_f32_16x16x32_bf16 v[168:171], a[208:211], a[48:51], v[168:171]
s_waitcnt vmcnt(31)
s_barrier
v_mfma_f32_16x16x32_bf16 v[168:171], a[212:215], a[56:59], v[168:171]
buffer_load_dwordx4 v[252:255], v3, s[8:11], s45 offen offset:3072 sc1
v_mfma_f32_16x16x32_bf16 v[172:175], a[200:203], a[36:39], v[172:175]
s_add_u32 s44, s44, s40
s_add_u32 s45, s45, s40
ds_read_b128 a[160:163], v48 offset:0
v_mfma_f32_16x16x32_bf16 v[172:175], a[204:207], a[44:47], v[172:175]
ds_read_b128 a[164:167], v48 offset:9216
v_mfma_f32_16x16x32_bf16 v[172:175], a[208:211], a[52:55], v[172:175]
ds_read_b128 a[168:171], v48 offset:18432
v_mfma_f32_16x16x32_bf16 v[172:175], a[212:215], a[60:63], v[172:175]
buffer_load_dwordx4 v3, s[8:11], s38 offen offset:3072 sc1 lds
v_mfma_f32_16x16x32_bf16 v[176:179], a[216:219], a[32:35], v[176:179]
s_add_u32 s38, s38, 4096
ds_read_b128 a[172:175], v48 offset:27648
v_mfma_f32_16x16x32_bf16 v[176:179], a[220:223], a[40:43], v[176:179]
ds_read_b128 a[176:179], v48 offset:1024
v_mfma_f32_16x16x32_bf16 v[176:179], a[224:227], a[48:51], v[176:179]
s_add_u32 m0, s34, 131072
ds_read_b128 a[180:183], v48 offset:10240
v_mfma_f32_16x16x32_bf16 v[176:179], a[228:231], a[56:59], v[176:179]
buffer_load_dwordx4 v3, s[8:11], s38 offen offset:0 sc1 lds
v_mfma_f32_16x16x32_bf16 v[180:183], a[216:219], a[36:39], v[180:183]
s_add_u32 s38, s38, s18
ds_read_b128 a[184:187], v48 offset:19456
v_mfma_f32_16x16x32_bf16 v[180:183], a[220:223], a[44:47], v[180:183]
ds_read_b128 a[188:191], v48 offset:28672
v_mfma_f32_16x16x32_bf16 v[180:183], a[224:227], a[52:55], v[180:183]
ds_read_b128 a[192:195], v48 offset:2048
v_mfma_f32_16x16x32_bf16 v[180:183], a[228:231], a[60:63], v[180:183]
s_cmp_lg_u32 s42, 0
s_cbranch_scc1 K1_gl
K1_tail0:
s_waitcnt vmcnt(33) lgkmcnt(8)
v_mfma_f32_16x16x32_bf16 v[112:115], a[160:163], a[96:99], v[112:115]
s_waitcnt vmcnt(29) lgkmcnt(7)
ds_read_b128 a[196:199], v48 offset:11264
v_mfma_f32_16x16x32_bf16 v[112:115], a[164:167], a[104:107], v[112:115]
s_waitcnt vmcnt(25) lgkmcnt(7)
ds_read_b128 a[200:203], v48 offset:20480
v_mfma_f32_16x16x32_bf16 v[112:115], a[168:171], a[112:115], v[112:115]
s_waitcnt vmcnt(19) lgkmcnt(6)
ds_read_b128 a[204:207], v48 offset:29696
v_and_b32 v32, 31, v2
v_mfma_f32_16x16x32_bf16 v[112:115], a[172:175], a[120:123], v[112:115]
s_lshl_b32 s60, s77, 2
v_mul_u32_u24 v32, 1152, v32
v_lshrrev_b32 v33, 5, v2
v_mfma_f32_16x16x32_bf16 v[116:119], a[160:163], a[100:103], v[116:119]
s_add_u32 s60, s60, s78
ds_read_b128 a[208:211], v48 offset:3072
v_lshl_add_u32 v32, v33, 4, v32
v_mfma_f32_16x16x32_bf16 v[116:119], a[164:167], a[108:111], v[116:119]
s_lshl_b32 s61, s60, 4
ds_read_b128 a[212:215], v48 offset:12288
v_add_u32_e64 v83, s73, 16
v_mfma_f32_16x16x32_bf16 v[116:119], a[168:171], a[116:119], v[116:119]
s_lshl_b32 s62, s76, 2
ds_read_b128 a[216:219], v48 offset:21504
v_mfma_f32_16x16x32_bf16 v[116:119], a[172:175], a[124:127], v[116:119]
s_add_u32 s39, s61, s62
v_mfma_f32_16x16x32_bf16 v[120:123], a[176:179], a[96:99], v[120:123]
s_add_u32 s39, s39, s3
ds_read_b128 a[220:223], v48 offset:30720
s_waitcnt lgkmcnt(10)
v_mfma_f32_16x16x32_bf16 v[120:123], a[180:183], a[104:107], v[120:123]
s_mul_i32 s39, s39, 10240
s_waitcnt lgkmcnt(9)
v_mfma_f32_16x16x32_bf16 v[120:123], a[184:187], a[112:115], v[120:123]
s_add_u32 s39, s39, 50331648
ds_read_b128 a[224:227], v48 offset:4096
s_waitcnt lgkmcnt(9)
v_mfma_f32_16x16x32_bf16 v[120:123], a[188:191], a[120:123], v[120:123]
s_cmp_eq_u32 s3, 0
s_cselect_b32 s46, 0, 0x40000000
v_mfma_f32_16x16x32_bf16 v[124:127], a[176:179], a[100:103], v[124:127]
s_cmp_eq_u32 s3, s76
s_cselect_b32 s39, 0x40000000, s39
ds_read_b128 a[228:231], v48 offset:13312
v_mfma_f32_16x16x32_bf16 v[124:127], a[180:183], a[108:111], v[124:127]
s_add_u32 s40, s61, s76
ds_read_b128 a[160:163], v48 offset:22528
v_mfma_f32_16x16x32_bf16 v[124:127], a[184:187], a[116:119], v[124:127]
s_mul_i32 s40, s40, 10
ds_read_b128 a[164:167], v48 offset:31744
v_mfma_f32_16x16x32_bf16 v[124:127], a[188:191], a[124:127], v[124:127]
s_add_u32 s40, s40, s3
s_waitcnt lgkmcnt(11)
v_mfma_f32_16x16x32_bf16 v[128:131], a[192:195], a[96:99], v[128:131]
s_lshl_b32 s40, s40, 10
ds_read_b128 a[168:171], v48 offset:5120
s_waitcnt lgkmcnt(11)
v_mfma_f32_16x16x32_bf16 v[128:131], a[196:199], a[104:107], v[128:131]
s_add_u32 s40, s40, 50331648
s_waitcnt lgkmcnt(10)
v_mfma_f32_16x16x32_bf16 v[128:131], a[200:203], a[112:115], v[128:131]
s_lshl_b32 s50, s77, 7
ds_read_b128 a[172:175], v48 offset:14336
s_waitcnt lgkmcnt(10)
v_mfma_f32_16x16x32_bf16 v[128:131], a[204:207], a[120:123], v[128:131]
s_lshl_b32 s63, s76, 5
v_mfma_f32_16x16x32_bf16 v[132:135], a[192:195], a[100:103], v[132:135]
s_add_u32 s50, s50, s63
ds_read_b128 a[176:179], v48 offset:23552
v_mfma_f32_16x16x32_bf16 v[132:135], a[196:199], a[108:111], v[132:135]
s_mul_i32 s50, s50, 1152
ds_read_b128 a[180:183], v48 offset:32768
v_mfma_f32_16x16x32_bf16 v[132:135], a[200:203], a[116:119], v[132:135]
s_mul_i32 s63, s78, 288
v_mfma_f32_16x16x32_bf16 v[132:135], a[204:207], a[124:127], v[132:135]
s_add_u32 s50, s50, s63
s_waitcnt lgkmcnt(11)
v_mfma_f32_16x16x32_bf16 v[136:139], a[208:211], a[96:99], v[136:139]
s_lshl_b32 s63, s3, 5
ds_read_b128 a[184:187], v48 offset:6144
s_waitcnt lgkmcnt(11)
v_mfma_f32_16x16x32_bf16 v[136:139], a[212:215], a[104:107], v[136:139]
s_add_u32 s50, s50, s63
s_waitcnt lgkmcnt(10)
v_mfma_f32_16x16x32_bf16 v[136:139], a[216:219], a[112:115], v[136:139]
s_add_u32 s65, s50, s46
ds_read_b128 a[188:191], v48 offset:15360
s_waitcnt lgkmcnt(10)
v_mfma_f32_16x16x32_bf16 v[136:139], a[220:223], a[120:123], v[136:139]
s_add_u32 s46, s46, 8192
v_mfma_f32_16x16x32_bf16 v[140:143], a[208:211], a[100:103], v[140:143]
s_lshl_b32 s41, 1, s76
ds_read_b128 a[192:195], v48 offset:24576
v_mfma_f32_16x16x32_bf16 v[140:143], a[212:215], a[108:111], v[140:143]
s_lshl_b32 s47, s3, 10
ds_read_b128 a[196:199], v48 offset:33792
v_mfma_f32_16x16x32_bf16 v[140:143], a[216:219], a[116:119], v[140:143]
s_mov_b32 s70, 0xffff0000
v_mfma_f32_16x16x32_bf16 v[140:143], a[220:223], a[124:127], v[140:143]
s_mov_b32 s79, 200000
s_waitcnt lgkmcnt(11)
v_mfma_f32_16x16x32_bf16 v[144:147], a[224:227], a[96:99], v[144:147]
s_waitcnt lgkmcnt(10)
ds_read_b128 a[200:203], v48 offset:7168
v_mfma_f32_16x16x32_bf16 v[144:147], a[228:231], a[104:107], v[144:147]
s_waitcnt lgkmcnt(10)
v_mfma_f32_16x16x32_bf16 v[144:147], a[160:163], a[112:115], v[144:147]
s_waitcnt lgkmcnt(9)
ds_read_b128 a[204:207], v48 offset:16384
v_mfma_f32_16x16x32_bf16 v[144:147], a[164:167], a[120:123], v[144:147]
buffer_load_dwordx4 v[36:39], v32, s[20:23], s50 offen offset:0
v_mfma_f32_16x16x32_bf16 v[148:151], a[224:227], a[100:103], v[148:151]
ds_read_b128 a[208:211], v48 offset:25600
v_mfma_f32_16x16x32_bf16 v[148:151], a[228:231], a[108:111], v[148:151]
ds_read_b128 a[212:215], v48 offset:34816
v_mfma_f32_16x16x32_bf16 v[148:151], a[160:163], a[116:119], v[148:151]
s_waitcnt lgkmcnt(11)
v_mfma_f32_16x16x32_bf16 v[148:151], a[164:167], a[124:127], v[148:151]
buffer_load_dwordx4 v[40:43], v32, s[20:23], s50 offen offset:128
v_mfma_f32_16x16x32_bf16 v[152:155], a[168:171], a[96:99], v[152:155]
s_waitcnt lgkmcnt(10)
ds_read_b128 a[216:219], v48 offset:8192
v_mfma_f32_16x16x32_bf16 v[152:155], a[172:175], a[104:107], v[152:155]
s_waitcnt lgkmcnt(10)
v_mfma_f32_16x16x32_bf16 v[152:155], a[176:179], a[112:115], v[152:155]
s_waitcnt lgkmcnt(9)
ds_read_b128 a[220:223], v48 offset:17408
v_mfma_f32_16x16x32_bf16 v[152:155], a[180:183], a[120:123], v[152:155]
buffer_load_dwordx4 v[44:47], v32, s[20:23], s65 offen offset:256
v_mfma_f32_16x16x32_bf16 v[156:159], a[168:171], a[100:103], v[156:159]
ds_read_b128 a[224:227], v48 offset:26624
v_mfma_f32_16x16x32_bf16 v[156:159], a[172:175], a[108:111], v[156:159]
ds_read_b128 a[228:231], v48 offset:35840
v_add_u32 v33, s47, v3
v_mfma_f32_16x16x32_bf16 v[156:159], a[176:179], a[116:119], v[156:159]
v_mfma_f32_16x16x32_bf16 v[156:159], a[180:183], a[124:127], v[156:159]
s_waitcnt lgkmcnt(11)
v_mfma_f32_16x16x32_bf16 v[160:163], a[184:187], a[96:99], v[160:163]
s_waitcnt lgkmcnt(10)
v_mfma_f32_16x16x32_bf16 v[160:163], a[188:191], a[104:107], v[160:163]
s_waitcnt lgkmcnt(9)
v_mfma_f32_16x16x32_bf16 v[160:163], a[192:195], a[112:115], v[160:163]
s_waitcnt lgkmcnt(8)
v_mfma_f32_16x16x32_bf16 v[160:163], a[196:199], a[120:123], v[160:163]
v_mfma_f32_16x16x32_bf16 v[164:167], a[184:187], a[100:103], v[164:167]
v_mfma_f32_16x16x32_bf16 v[164:167], a[188:191], a[108:111], v[164:167]
v_mfma_f32_16x16x32_bf16 v[164:167], a[192:195], a[116:119], v[164:167]
v_mfma_f32_16x16x32_bf16 v[164:167], a[196:199], a[124:127], v[164:167]
s_waitcnt lgkmcnt(5)
v_mfma_f32_16x16x32_bf16 v[168:171], a[200:203], a[96:99], v[168:171]
s_add_u32 s60, s40, 81920
v_mfma_f32_16x16x32_bf16 v[168:171], a[204:207], a[104:107], v[168:171]
s_add_u32 s61, s60, 4096
v_mfma_f32_16x16x32_bf16 v[168:171], a[208:211], a[112:115], v[168:171]
s_waitcnt vmcnt(20)
s_barrier
s_add_u32 s62, s60, s46
s_waitcnt lgkmcnt(4)
v_mfma_f32_16x16x32_bf16 v[168:171], a[212:215], a[120:123], v[168:171]
buffer_load_dwordx4 v[88:91], v3, s[8:11], s60 offen sc1
v_mfma_f32_16x16x32_bf16 v[172:175], a[200:203], a[100:103], v[172:175]
ds_read_b128 a[160:163], v49 offset:0
v_mfma_f32_16x16x32_bf16 v[172:175], a[204:207], a[108:111], v[172:175]
ds_read_b128 a[164:167], v49 offset:9216
v_mfma_f32_16x16x32_bf16 v[172:175], a[208:211], a[116:119], v[172:175]
s_waitcnt lgkmcnt(5)
ds_read_b128 a[168:171], v49 offset:18432
v_mfma_f32_16x16x32_bf16 v[172:175], a[212:215], a[124:127], v[172:175]
buffer_load_dwordx4 v[92:95], v3, s[8:11], s61 offen sc1
v_mfma_f32_16x16x32_bf16 v[176:179], a[216:219], a[96:99], v[176:179]
s_waitcnt lgkmcnt(5)
ds_read_b128 a[172:175], v49 offset:27648
v_mfma_f32_16x16x32_bf16 v[176:179], a[220:223], a[104:107], v[176:179]
s_waitcnt lgkmcnt(5)
ds_read_b128 a[176:179], v49 offset:1024
v_mfma_f32_16x16x32_bf16 v[176:179], a[224:227], a[112:115], v[176:179]
s_waitcnt vmcnt(21) lgkmcnt(4)
ds_read_b128 a[180:183], v49 offset:10240
v_mfma_f32_16x16x32_bf16 v[176:179], a[228:231], a[120:123], v[176:179]
buffer_load_dwordx4 v[96:99], v3, s[8:11], s62 offen sc1
v_mfma_f32_16x16x32_bf16 v[180:183], a[216:219], a[100:103], v[180:183]
s_add_u32 s60, s40, 122880
ds_read_b128 a[184:187], v49 offset:19456
v_mfma_f32_16x16x32_bf16 v[180:183], a[220:223], a[108:111], v[180:183]
s_add_u32 s61, s60, 4096
ds_read_b128 a[188:191], v49 offset:28672
v_mfma_f32_16x16x32_bf16 v[180:183], a[224:227], a[116:119], v[180:183]
s_add_u32 s62, s60, s46
ds_read_b128 a[192:195], v49 offset:2048
v_mfma_f32_16x16x32_bf16 v[180:183], a[228:231], a[124:127], v[180:183]
buffer_load_dwordx4 v[100:103], v3, s[8:11], s60 offen sc1
v_mfma_f32_16x16x32_bf16 v[112:115], a[160:163], v[224:227], v[112:115]
s_waitcnt vmcnt(19) lgkmcnt(7)
ds_read_b128 a[196:199], v49 offset:11264
v_mfma_f32_16x16x32_bf16 v[112:115], a[164:167], v[232:235], v[112:115]
s_waitcnt vmcnt(15) lgkmcnt(7)
ds_read_b128 a[200:203], v49 offset:20480
v_mfma_f32_16x16x32_bf16 v[112:115], a[168:171], v[240:243], v[112:115]
s_waitcnt vmcnt(11) lgkmcnt(7)
ds_read_b128 a[204:207], v49 offset:29696
v_mfma_f32_16x16x32_bf16 v[112:115], a[172:175], v[248:251], v[112:115]
buffer_load_dwordx4 v[104:107], v3, s[8:11], s61 offen sc1
v_mfma_f32_16x16x32_bf16 v[116:119], a[160:163], v[228:231], v[116:119]
ds_read_b128 a[208:211], v49 offset:3072
v_mfma_f32_16x16x32_bf16 v[116:119], a[164:167], v[236:239], v[116:119]
ds_read_b128 a[212:215], v49 offset:12288
v_mfma_f32_16x16x32_bf16 v[116:119], a[168:171], v[244:247], v[116:119]
s_waitcnt vmcnt(10) lgkmcnt(6)
ds_read_b128 a[216:219], v49 offset:21504
v_mfma_f32_16x16x32_bf16 v[116:119], a[172:175], v[252:255], v[116:119]
buffer_load_dwordx4 v[108:111], v3, s[8:11], s62 offen sc1
v_mfma_f32_16x16x32_bf16 v[120:123], a[176:179], v[224:227], v[120:123]
s_add_u32 s60, s40, 0
ds_read_b128 a[220:223], v49 offset:30720
v_mfma_f32_16x16x32_bf16 v[120:123], a[180:183], v[232:235], v[120:123]
s_add_u32 s61, s60, 4096
v_mfma_f32_16x16x32_bf16 v[120:123], a[184:187], v[240:243], v[120:123]
s_add_u32 s62, s60, s46
ds_read_b128 a[224:227], v49 offset:4096
v_cvt_pk_bf16_f32 v184, v112, v113
v_mfma_f32_16x16x32_bf16 v[120:123], a[188:191], v[248:251], v[120:123]
buffer_load_dwordx4 v[4:7], v3, s[8:11], s60 offen sc1
v_cvt_pk_bf16_f32 v185, v114, v115
v_mfma_f32_16x16x32_bf16 v[124:127], a[176:179], v[228:231], v[124:127]
ds_read_b128 a[228:231], v49 offset:13312
v_cvt_pk_bf16_f32 v186, v116, v117
v_mfma_f32_16x16x32_bf16 v[124:127], a[180:183], v[236:239], v[124:127]
ds_read_b128 a[160:163], v49 offset:22528
v_cvt_pk_bf16_f32 v187, v118, v119
v_mfma_f32_16x16x32_bf16 v[124:127], a[184:187], v[244:247], v[124:127]
s_waitcnt lgkmcnt(10)
ds_read_b128 a[164:167], v49 offset:31744
buffer_store_dwordx4 v[184:187], v3, s[8:11], s39 offen offset:0 sc1
v_mfma_f32_16x16x32_bf16 v[124:127], a[188:191], v[252:255], v[124:127]
buffer_load_dwordx4 v[8:11], v3, s[8:11], s61 offen sc1
v_mfma_f32_16x16x32_bf16 v[128:131], a[192:195], v[224:227], v[128:131]
s_waitcnt lgkmcnt(8)
ds_read_b128 a[168:171], v49 offset:5120
v_mfma_f32_16x16x32_bf16 v[128:131], a[196:199], v[232:235], v[128:131]
buffer_load_dwordx4 v[12:15], v3, s[8:11], s62 offen sc1
v_mfma_f32_16x16x32_bf16 v[128:131], a[200:203], v[240:243], v[128:131]
s_add_u32 s60, s40, 40960
ds_read_b128 a[172:175], v49 offset:14336
v_cvt_pk_bf16_f32 v188, v120, v121
v_mfma_f32_16x16x32_bf16 v[128:131], a[204:207], v[248:251], v[128:131]
s_add_u32 s61, s60, 4096
v_cvt_pk_bf16_f32 v189, v122, v123
v_cvt_pk_bf16_f32 v190, v124, v125
v_cvt_pk_bf16_f32 v191, v126, v127
v_mfma_f32_16x16x32_bf16 v[132:135], a[192:195], v[228:231], v[132:135]
s_waitcnt lgkmcnt(9)
ds_read_b128 a[176:179], v49 offset:23552
buffer_store_dwordx4 v[188:191], v3, s[8:11], s39 offen offset:1024 sc1
v_mfma_f32_16x16x32_bf16 v[132:135], a[196:199], v[236:239], v[132:135]
s_add_u32 s62, s60, s46
ds_read_b128 a[180:183], v49 offset:32768
v_mfma_f32_16x16x32_bf16 v[132:135], a[200:203], v[244:247], v[132:135]
buffer_load_dwordx4 v[16:19], v3, s[8:11], s60 offen sc1
v_mfma_f32_16x16x32_bf16 v[132:135], a[204:207], v[252:255], v[132:135]
buffer_load_dwordx4 v[20:23], v3, s[8:11], s61 offen sc1
v_mfma_f32_16x16x32_bf16 v[136:139], a[208:211], v[224:227], v[136:139]
s_waitcnt lgkmcnt(9)
ds_read_b128 a[184:187], v49 offset:6144
v_mfma_f32_16x16x32_bf16 v[136:139], a[212:215], v[232:235], v[136:139]
buffer_load_dwordx4 v[24:27], v3, s[8:11], s62 offen sc1
v_mfma_f32_16x16x32_bf16 v[136:139], a[216:219], v[240:243], v[136:139]
s_waitcnt lgkmcnt(9)
ds_read_b128 a[188:191], v49 offset:15360
v_cvt_pk_bf16_f32 v192, v128, v129
v_mfma_f32_16x16x32_bf16 v[136:139], a[220:223], v[248:251], v[136:139]
v_cvt_pk_bf16_f32 v193, v130, v131
v_cvt_pk_bf16_f32 v194, v132, v133
v_mfma_f32_16x16x32_bf16 v[140:143], a[208:211], v[228:231], v[140:143]
ds_read_b128 a[192:195], v49 offset:24576
v_cvt_pk_bf16_f32 v195, v134, v135
v_mfma_f32_16x16x32_bf16 v[140:143], a[212:215], v[236:239], v[140:143]
s_waitcnt vmcnt(16)
ds_read_b128 a[196:199], v49 offset:33792
v_permlane16_swap_b32 v36, v38
v_mfma_f32_16x16x32_bf16 v[140:143], a[216:219], v[244:247], v[140:143]
s_waitcnt vmcnt(15) lgkmcnt(11)
v_permlane16_swap_b32 v37, v39
v_permlane16_swap_b32 v40, v42
v_mfma_f32_16x16x32_bf16 v[140:143], a[220:223], v[252:255], v[140:143]
buffer_store_dwordx4 v[192:195], v3, s[8:11], s39 offen offset:2048 sc1
v_mfma_f32_16x16x32_bf16 v[144:147], a[224:227], v[224:227], v[144:147]
s_waitcnt lgkmcnt(10)
ds_read_b128 a[200:203], v49 offset:7168
v_permlane16_swap_b32 v41, v43
v_mfma_f32_16x16x32_bf16 v[144:147], a[228:231], v[232:235], v[144:147]
s_waitcnt vmcnt(15) lgkmcnt(10)
v_permlane16_swap_b32 v44, v46
v_permlane16_swap_b32 v45, v47
v_mfma_f32_16x16x32_bf16 v[144:147], a[160:163], v[240:243], v[144:147]
s_waitcnt lgkmcnt(9)
ds_read_b128 a[204:207], v49 offset:16384
v_cvt_pk_bf16_f32 v196, v136, v137
v_mfma_f32_16x16x32_bf16 v[144:147], a[164:167], v[248:251], v[144:147]
v_cvt_pk_bf16_f32 v197, v138, v139
v_cvt_pk_bf16_f32 v198, v140, v141
v_mfma_f32_16x16x32_bf16 v[148:151], a[224:227], v[228:231], v[148:151]
ds_read_b128 a[208:211], v49 offset:25600
v_cvt_pk_bf16_f32 v199, v142, v143
v_mfma_f32_16x16x32_bf16 v[148:151], a[228:231], v[236:239], v[148:151]
ds_read_b128 a[212:215], v49 offset:34816
v_lshlrev_b32 v52, 16, v36
v_mfma_f32_16x16x32_bf16 v[148:151], a[160:163], v[244:247], v[148:151]
s_waitcnt lgkmcnt(11)
v_and_b32 v53, s70, v36
v_lshlrev_b32 v54, 16, v37
v_mfma_f32_16x16x32_bf16 v[148:151], a[164:167], v[252:255], v[148:151]
buffer_store_dwordx4 v[196:199], v3, s[8:11], s39 offen offset:3072 sc1
v_mfma_f32_16x16x32_bf16 v[152:155], a[168:171], v[224:227], v[152:155]
s_waitcnt lgkmcnt(10)
ds_read_b128 a[216:219], v49 offset:8192
v_and_b32 v55, s70, v37
v_mfma_f32_16x16x32_bf16 v[152:155], a[172:175], v[232:235], v[152:155]
s_waitcnt lgkmcnt(10)
v_lshlrev_b32 v56, 16, v38
v_and_b32 v57, s70, v38
v_mfma_f32_16x16x32_bf16 v[152:155], a[176:179], v[240:243], v[152:155]
s_waitcnt lgkmcnt(9)
ds_read_b128 a[220:223], v49 offset:17408
v_cvt_pk_bf16_f32 v200, v144, v145
v_mfma_f32_16x16x32_bf16 v[152:155], a[180:183], v[248:251], v[152:155]
v_cvt_pk_bf16_f32 v201, v146, v147
v_cvt_pk_bf16_f32 v202, v148, v149
v_mfma_f32_16x16x32_bf16 v[156:159], a[168:171], v[228:231], v[156:159]
ds_read_b128 a[224:227], v49 offset:26624
v_cvt_pk_bf16_f32 v203, v150, v151
v_mfma_f32_16x16x32_bf16 v[156:159], a[172:175], v[236:239], v[156:159]
s_add_u32 s39, s39, 4096
ds_read_b128 a[228:231], v49 offset:35840
v_lshlrev_b32 v58, 16, v39
v_mfma_f32_16x16x32_bf16 v[156:159], a[176:179], v[244:247], v[156:159]
s_waitcnt lgkmcnt(11)
v_and_b32 v59, s70, v39
v_lshlrev_b32 v60, 16, v40
v_mfma_f32_16x16x32_bf16 v[156:159], a[180:183], v[252:255], v[156:159]
buffer_store_dwordx4 v[200:203], v3, s[8:11], s39 offen offset:0 sc1
v_mfma_f32_16x16x32_bf16 v[160:163], a[184:187], v[224:227], v[160:163]
s_waitcnt lgkmcnt(10)
v_and_b32 v61, s70, v40
v_lshlrev_b32 v62, 16, v41
v_mfma_f32_16x16x32_bf16 v[160:163], a[188:191], v[232:235], v[160:163]
s_waitcnt lgkmcnt(9)
v_and_b32 v63, s70, v41
v_lshlrev_b32 v64, 16, v42
v_mfma_f32_16x16x32_bf16 v[160:163], a[192:195], v[240:243], v[160:163]
s_waitcnt lgkmcnt(8)
v_cvt_pk_bf16_f32 v204, v152, v153
v_cvt_pk_bf16_f32 v205, v154, v155
v_mfma_f32_16x16x32_bf16 v[160:163], a[196:199], v[248:251], v[160:163]
v_cvt_pk_bf16_f32 v206, v156, v157
v_cvt_pk_bf16_f32 v207, v158, v159
v_mfma_f32_16x16x32_bf16 v[164:167], a[184:187], v[228:231], v[164:167]
v_and_b32 v65, s70, v42
v_lshlrev_b32 v66, 16, v43
v_mfma_f32_16x16x32_bf16 v[164:167], a[188:191], v[236:239], v[164:167]
v_and_b32 v67, s70, v43
v_lshlrev_b32 v68, 16, v44
v_mfma_f32_16x16x32_bf16 v[164:167], a[192:195], v[244:247], v[164:167]
s_waitcnt lgkmcnt(7)
v_and_b32 v69, s70, v44
v_lshlrev_b32 v70, 16, v45
v_mfma_f32_16x16x32_bf16 v[164:167], a[196:199], v[252:255], v[164:167]
buffer_store_dwordx4 v[204:207], v3, s[8:11], s39 offen offset:1024 sc1
v_mfma_f32_16x16x32_bf16 v[168:171], a[200:203], v[224:227], v[168:171]
s_waitcnt lgkmcnt(6)
v_and_b32 v71, s70, v45
v_lshlrev_b32 v72, 16, v46
v_mfma_f32_16x16x32_bf16 v[168:171], a[204:207], v[232:235], v[168:171]
s_waitcnt lgkmcnt(5)
v_and_b32 v73, s70, v46
v_lshlrev_b32 v74, 16, v47
v_mfma_f32_16x16x32_bf16 v[168:171], a[208:211], v[240:243], v[168:171]
s_waitcnt lgkmcnt(4)
v_cvt_pk_bf16_f32 v208, v160, v161
v_cvt_pk_bf16_f32 v209, v162, v163
v_mfma_f32_16x16x32_bf16 v[168:171], a[212:215], v[248:251], v[168:171]
v_cvt_pk_bf16_f32 v210, v164, v165
v_cvt_pk_bf16_f32 v211, v166, v167
v_mfma_f32_16x16x32_bf16 v[172:175], a[200:203], v[228:231], v[172:175]
v_and_b32 v75, s70, v47
v_mfma_f32_16x16x32_bf16 v[172:175], a[204:207], v[236:239], v[172:175]
v_mfma_f32_16x16x32_bf16 v[172:175], a[208:211], v[244:247], v[172:175]
s_waitcnt lgkmcnt(3)
v_mfma_f32_16x16x32_bf16 v[172:175], a[212:215], v[252:255], v[172:175]
buffer_store_dwordx4 v[208:211], v3, s[8:11], s39 offen offset:2048 sc1
v_mfma_f32_16x16x32_bf16 v[176:179], a[216:219], v[224:227], v[176:179]
s_waitcnt lgkmcnt(2)
v_mfma_f32_16x16x32_bf16 v[176:179], a[220:223], v[232:235], v[176:179]
s_waitcnt lgkmcnt(1)
v_mfma_f32_16x16x32_bf16 v[176:179], a[224:227], v[240:243], v[176:179]
s_waitcnt lgkmcnt(0)
v_mfma_f32_16x16x32_bf16 v[176:179], a[228:231], v[248:251], v[176:179]
v_cvt_pk_bf16_f32 v212, v168, v169
v_mfma_f32_16x16x32_bf16 v[180:183], a[216:219], v[228:231], v[180:183]
v_cvt_pk_bf16_f32 v213, v170, v171
v_mfma_f32_16x16x32_bf16 v[180:183], a[220:223], v[236:239], v[180:183]
v_cvt_pk_bf16_f32 v214, v172, v173
v_mfma_f32_16x16x32_bf16 v[180:183], a[224:227], v[244:247], v[180:183]
v_cvt_pk_bf16_f32 v215, v174, v175
v_mfma_f32_16x16x32_bf16 v[180:183], a[228:231], v[252:255], v[180:183]
buffer_store_dwordx4 v[212:215], v3, s[8:11], s39 offen offset:3072 sc1
v_cvt_pk_bf16_f32 v216, v176, v177
v_cvt_pk_bf16_f32 v217, v178, v179
s_nop 4
v_cvt_pk_bf16_f32 v218, v180, v181
v_cvt_pk_bf16_f32 v219, v182, v183
s_add_u32 s39, s39, 4096
buffer_store_dwordx4 v[216:219], v3, s[8:11], s39 offen offset:0 sc1
K1_tw0:
s_waitcnt vmcnt(7)
K1_p5:
s_cmp_lg_u32 s3, s76
s_cbranch_scc1 K1_h0
ds_write_b128 v3, v[184:187] offset:36864
ds_write_b128 v3, v[188:191] offset:37888
ds_write_b128 v3, v[192:195] offset:38912
ds_write_b128 v3, v[196:199] offset:39936
ds_write_b128 v3, v[200:203] offset:40960
ds_write_b128 v3, v[204:207] offset:41984
ds_write_b128 v3, v[208:211] offset:43008
ds_write_b128 v3, v[212:215] offset:44032
ds_write_b128 v3, v[216:219] offset:45056
K1_h0:
s_waitcnt lgkmcnt(0)
s_barrier
s_cmp_lg_u32 s76, 0
s_cbranch_scc1 K1_h1
ds_read_b128 v[4:7], v33 offset:36864
ds_read_b128 v[8:11], v33 offset:40960
ds_read_b128 v[12:15], v33 offset:45056
K1_h1:
s_cmp_lg_u32 s76, 1
s_cbranch_scc1 K1_h2
ds_read_b128 v[16:19], v33 offset:36864
ds_read_b128 v[20:23], v33 offset:40960
ds_read_b128 v[24:27], v33 offset:45056
K1_h2:
s_cmp_lg_u32 s76, 2
s_cbranch_scc1 K1_h3
ds_read_b128 v[88:91], v33 offset:36864
ds_read_b128 v[92:95], v33 offset:40960
ds_read_b128 v[96:99], v33 offset:45056
K1_h3:
s_cmp_lg_u32 s76, 3
s_cbranch_scc1 K1_h4
ds_read_b128 v[100:103], v33 offset:36864
ds_read_b128 v[104:107], v33 offset:40960
ds_read_b128 v[108:111], v33 offset:45056
K1_h4:
K1_e0:
s_bitcmp1_b32 s41, 0
s_cbranch_scc1 K1_c0
v_max3_u32 v120, v4, v5, v6
v_max3_u32 v121, v7, v8, v9
v_max3_u32 v120, v120, v10, v11
v_max3_u32 v121, v121, v12, v13
v_max3_u32 v120, v120, v14, v15
v_max_u32 v120, v120, v121
v_cmp_eq_u32 vcc, -1, v120
s_cbranch_vccnz K1_r0
s_bitset1_b32 s41, 0
s_branch K1_c0
K1_r0:
s_add_u32 s60, s40, 0
s_add_u32 s61, s60, 4096
s_add_u32 s62, s60, s46
buffer_load_dwordx4 v[4:7], v3, s[8:11], s60 offen sc1
buffer_load_dwordx4 v[8:11], v3, s[8:11], s61 offen sc1
buffer_load_dwordx4 v[12:15], v3, s[8:11], s62 offen sc1
K1_c0:
s_bitcmp1_b32 s41, 1
s_cbranch_scc1 K1_c1
v_max3_u32 v120, v16, v17, v18
v_max3_u32 v121, v19, v20, v21
v_max3_u32 v120, v120, v22, v23
v_max3_u32 v121, v121, v24, v25
v_max3_u32 v120, v120, v26, v27
v_max_u32 v120, v120, v121
v_cmp_eq_u32 vcc, -1, v120
s_cbranch_vccnz K1_r1
s_bitset1_b32 s41, 1
s_branch K1_c1
K1_r1:
s_add_u32 s60, s40, 40960
s_add_u32 s61, s60, 4096
s_add_u32 s62, s60, s46
buffer_load_dwordx4 v[16:19], v3, s[8:11], s60 offen sc1
buffer_load_dwordx4 v[20:23], v3, s[8:11], s61 offen sc1
buffer_load_dwordx4 v[24:27], v3, s[8:11], s62 offen sc1
K1_c1:
s_bitcmp1_b32 s41, 2
s_cbranch_scc1 K1_c2
v_max3_u32 v120, v88, v89, v90
v_max3_u32 v121, v91, v92, v93
v_max3_u32 v120, v120, v94, v95
v_max3_u32 v121, v121, v96, v97
v_max3_u32 v120, v120, v98, v99
v_max_u32 v120, v120, v121
v_cmp_eq_u32 vcc, -1, v120
s_cbranch_vccnz K1_r2
s_bitset1_b32 s41, 2
s_branch K1_c2
K1_r2:
s_add_u32 s60, s40, 81920
s_add_u32 s61, s60, 4096
s_add_u32 s62, s60, s46
buffer_load_dwordx4 v[88:91], v3, s[8:11], s60 offen sc1
buffer_load_dwordx4 v[92:95], v3, s[8:11], s61 offen sc1
buffer_load_dwordx4 v[96:99], v3, s[8:11], s62 offen sc1
K1_c2:
s_bitcmp1_b32 s41, 3
s_cbranch_scc1 K1_c3
v_max3_u32 v120, v100, v101, v102
v_max3_u32 v121, v103, v104, v105
v_max3_u32 v120, v120, v106, v107
v_max3_u32 v121, v121, v108, v109
v_max3_u32 v120, v120, v110, v111
v_max_u32 v120, v120, v121
v_cmp_eq_u32 vcc, -1, v120
s_cbranch_vccnz K1_r3
s_bitset1_b32 s41, 3
s_branch K1_c3
K1_r3:
s_add_u32 s60, s40, 122880
s_add_u32 s61, s60, 4096
s_add_u32 s62, s60, s46
buffer_load_dwordx4 v[100:103], v3, s[8:11], s60 offen sc1
buffer_load_dwordx4 v[104:107], v3, s[8:11], s61 offen sc1
buffer_load_dwordx4 v[108:111], v3, s[8:11], s62 offen sc1
K1_c3:
s_waitcnt lgkmcnt(0)
s_and_b32 s60, s41, 28
s_cmp_lg_u32 s60, 12
s_cbranch_scc1 K1_e4
s_bitset1_b32 s41, 4
v_lshlrev_b32 v160, 16, v88
v_lshlrev_b32 v112, 16, v100
v_and_b32 v161, s70, v88
v_and_b32 v113, s70, v100
v_lshlrev_b32 v162, 16, v89
v_lshlrev_b32 v114, 16, v101
v_and_b32 v163, s70, v89
v_and_b32 v115, s70, v101
v_lshlrev_b32 v164, 16, v90
v_lshlrev_b32 v116, 16, v102
v_and_b32 v165, s70, v90
v_and_b32 v117, s70, v102
v_lshlrev_b32 v166, 16, v91
v_lshlrev_b32 v118, 16, v103
v_and_b32 v167, s70, v91
v_and_b32 v119, s70, v103
v_add_f32 v160, v160, v112
v_add_f32 v161, v161, v113
v_add_f32 v162, v162, v114
v_add_f32 v163, v163, v115
v_add_f32 v164, v164, v116
v_add_f32 v165, v165, v117
v_add_f32 v166, v166, v118
v_add_f32 v167, v167, v119
v_mul_f32 v112, s53, v160
v_mul_f32 v113, s53, v161
v_mul_f32 v114, s53, v162
v_mul_f32 v115, s53, v163
v_mul_f32 v116, s53, v164
v_mul_f32 v117, s53, v165
v_mul_f32 v118, s53, v166
v_mul_f32 v119, s53, v167
v_exp_f32 v112, v112
v_exp_f32 v113, v113
v_exp_f32 v114, v114
v_exp_f32 v115, v115
v_exp_f32 v116, v116
v_exp_f32 v117, v117
v_exp_f32 v118, v118
v_exp_f32 v119, v119
v_add_f32 v112, 1.0, v112
v_add_f32 v113, 1.0, v113
v_add_f32 v114, 1.0, v114
v_add_f32 v115, 1.0, v115
v_add_f32 v116, 1.0, v116
v_add_f32 v117, 1.0, v117
v_add_f32 v118, 1.0, v118
v_add_f32 v119, 1.0, v119
v_rcp_f32 v112, v112
v_rcp_f32 v113, v113
v_rcp_f32 v114, v114
v_rcp_f32 v115, v115
v_rcp_f32 v116, v116
v_rcp_f32 v117, v117
v_rcp_f32 v118, v118
v_rcp_f32 v119, v119
v_mul_f32 v160, v160, v112
v_mul_f32 v161, v161, v113
v_mul_f32 v162, v162, v114
v_mul_f32 v163, v163, v115
v_mul_f32 v164, v164, v116
v_mul_f32 v165, v165, v117
v_mul_f32 v166, v166, v118
v_mul_f32 v167, v167, v119
v_lshlrev_b32 v168, 16, v92
v_lshlrev_b32 v112, 16, v104
v_and_b32 v169, s70, v92
v_and_b32 v113, s70, v104
v_lshlrev_b32 v170, 16, v93
v_lshlrev_b32 v114, 16, v105
v_and_b32 v171, s70, v93
v_and_b32 v115, s70, v105
v_lshlrev_b32 v172, 16, v94
v_lshlrev_b32 v116, 16, v106
v_and_b32 v173, s70, v94
v_and_b32 v117, s70, v106
v_lshlrev_b32 v174, 16, v95
v_lshlrev_b32 v118, 16, v107
v_and_b32 v175, s70, v95
v_and_b32 v119, s70, v107
v_add_f32 v168, v168, v112
v_add_f32 v169, v169, v113
v_add_f32 v170, v170, v114
v_add_f32 v171, v171, v115
v_add_f32 v172, v172, v116
v_add_f32 v173, v173, v117
v_add_f32 v174, v174, v118
v_add_f32 v175, v175, v119
v_mul_f32 v112, s53, v168
v_mul_f32 v113, s53, v169
v_mul_f32 v114, s53, v170
v_mul_f32 v115, s53, v171
v_mul_f32 v116, s53, v172
v_mul_f32 v117, s53, v173
v_mul_f32 v118, s53, v174
v_mul_f32 v119, s53, v175
v_exp_f32 v112, v112
v_exp_f32 v113, v113
v_exp_f32 v114, v114
v_exp_f32 v115, v115
v_exp_f32 v116, v116
v_exp_f32 v117, v117
v_exp_f32 v118, v118
v_exp_f32 v119, v119
v_add_f32 v112, 1.0, v112
v_add_f32 v113, 1.0, v113
v_add_f32 v114, 1.0, v114
v_add_f32 v115, 1.0, v115
v_add_f32 v116, 1.0, v116
v_add_f32 v117, 1.0, v117
v_add_f32 v118, 1.0, v118
v_add_f32 v119, 1.0, v119
v_rcp_f32 v112, v112
v_rcp_f32 v113, v113
v_rcp_f32 v114, v114
v_rcp_f32 v115, v115
v_rcp_f32 v116, v116
v_rcp_f32 v117, v117
v_rcp_f32 v118, v118
v_rcp_f32 v119, v119
v_mul_f32 v168, v168, v112
v_mul_f32 v169, v169, v113
v_mul_f32 v170, v170, v114
v_mul_f32 v171, v171, v115
v_mul_f32 v172, v172, v116
v_mul_f32 v173, v173, v117
v_mul_f32 v174, v174, v118
v_mul_f32 v175, v175, v119
v_lshlrev_b32 v176, 16, v96
v_lshlrev_b32 v112, 16, v108
v_and_b32 v177, s70, v96
v_and_b32 v113, s70, v108
v_lshlrev_b32 v178, 16, v97
v_lshlrev_b32 v114, 16, v109
v_and_b32 v179, s70, v97
v_and_b32 v115, s70, v109
v_lshlrev_b32 v180, 16, v98
v_lshlrev_b32 v116, 16, v110
v_and_b32 v181, s70, v98
v_and_b32 v117, s70, v110
v_lshlrev_b32 v182, 16, v99
v_lshlrev_b32 v118, 16, v111
v_and_b32 v183, s70, v99
v_and_b32 v119, s70, v111
v_add_f32 v176, v176, v112
v_add_f32 v177, v177, v113
v_add_f32 v178, v178, v114
v_add_f32 v179, v179, v115
v_add_f32 v180, v180, v116
v_add_f32 v181, v181, v117
v_add_f32 v182, v182, v118
v_add_f32 v183, v183, v119
v_mul_f32 v112, s53, v176
v_mul_f32 v113, s53, v177
v_mul_f32 v114, s53, v178
v_mul_f32 v115, s53, v179
v_mul_f32 v116, s53, v180
v_mul_f32 v117, s53, v181
v_mul_f32 v118, s53, v182
v_mul_f32 v119, s53, v183
v_exp_f32 v112, v112
v_exp_f32 v113, v113
v_exp_f32 v114, v114
v_exp_f32 v115, v115
v_exp_f32 v116, v116
v_exp_f32 v117, v117
v_exp_f32 v118, v118
v_exp_f32 v119, v119
v_add_f32 v112, 1.0, v112
v_add_f32 v113, 1.0, v113
v_add_f32 v114, 1.0, v114
v_add_f32 v115, 1.0, v115
v_add_f32 v116, 1.0, v116
v_add_f32 v117, 1.0, v117
v_add_f32 v118, 1.0, v118
v_add_f32 v119, 1.0, v119
v_rcp_f32 v112, v112
v_rcp_f32 v113, v113
v_rcp_f32 v114, v114
v_rcp_f32 v115, v115
v_rcp_f32 v116, v116
v_rcp_f32 v117, v117
v_rcp_f32 v118, v118
v_rcp_f32 v119, v119
v_mul_f32 v176, v176, v112
v_mul_f32 v177, v177, v113
v_mul_f32 v178, v178, v114
v_mul_f32 v179, v179, v115
v_mul_f32 v180, v180, v116
v_mul_f32 v181, v181, v117
v_mul_f32 v182, v182, v118
v_mul_f32 v183, v183, v119
K1_e4:
s_cmp_eq_u32 s41, 31
s_cbranch_scc1 K1_e5
s_waitcnt vmcnt(0)
s_sub_u32 s79, s79, 1
s_cmp_lg_u32 s79, 0
s_cbranch_scc1 K1_e0
K1_e5:
v_lshlrev_b32 v112, 16, v4
v_and_b32 v113, s70, v4
v_lshlrev_b32 v114, 16, v5
v_and_b32 v115, s70, v5
v_lshlrev_b32 v116, 16, v6
v_and_b32 v117, s70, v6
v_lshlrev_b32 v118, 16, v7
v_and_b32 v119, s70, v7
v_fmac_f32 v52, v112, v160
v_fmac_f32 v53, v113, v161
v_fmac_f32 v54, v114, v162
v_fmac_f32 v55, v115, v163
v_fmac_f32 v56, v116, v164
v_fmac_f32 v57, v117, v165
v_fmac_f32 v58, v118, v166
v_fmac_f32 v59, v119, v167
v_lshlrev_b32 v112, 16, v16
v_and_b32 v113, s70, v16
v_lshlrev_b32 v114, 16, v17
v_and_b32 v115, s70, v17
v_lshlrev_b32 v116, 16, v18
v_and_b32 v117, s70, v18
v_lshlrev_b32 v118, 16, v19
v_and_b32 v119, s70, v19
v_fmac_f32 v52, v112, v160
v_fmac_f32 v53, v113, v161
v_fmac_f32 v54, v114, v162
v_fmac_f32 v55, v115, v163
v_fmac_f32 v56, v116, v164
v_fmac_f32 v57, v117, v165
v_fmac_f32 v58, v118, v166
v_fmac_f32 v59, v119, v167
v_cvt_pk_bf16_f32 v36, v52, v53
v_cvt_pk_bf16_f32 v37, v54, v55
v_cvt_pk_bf16_f32 v38, v56, v57
v_cvt_pk_bf16_f32 v39, v58, v59
s_nop 0
v_permlane16_swap_b32 v36, v38
v_permlane16_swap_b32 v37, v39
buffer_store_dwordx4 v[36:39], v32, s[12:15], s50 offen offset:0
v_lshlrev_b32 v112, 16, v8
v_and_b32 v113, s70, v8
v_lshlrev_b32 v114, 16, v9
v_and_b32 v115, s70, v9
v_lshlrev_b32 v116, 16, v10
v_and_b32 v117, s70, v10
v_lshlrev_b32 v118, 16, v11
v_and_b32 v119, s70, v11
v_fmac_f32 v60, v112, v168
v_fmac_f32 v61, v113, v169
v_fmac_f32 v62, v114, v170
v_fmac_f32 v63, v115, v171
v_fmac_f32 v64, v116, v172
v_fmac_f32 v65, v117, v173
v_fmac_f32 v66, v118, v174
v_fmac_f32 v67, v119, v175
v_lshlrev_b32 v112, 16, v20
v_and_b32 v113, s70, v20
v_lshlrev_b32 v114, 16, v21
v_and_b32 v115, s70, v21
v_lshlrev_b32 v116, 16, v22
v_and_b32 v117, s70, v22
v_lshlrev_b32 v118, 16, v23
v_and_b32 v119, s70, v23
v_fmac_f32 v60, v112, v168
v_fmac_f32 v61, v113, v169
v_fmac_f32 v62, v114, v170
v_fmac_f32 v63, v115, v171
v_fmac_f32 v64, v116, v172
v_fmac_f32 v65, v117, v173
v_fmac_f32 v66, v118, v174
v_fmac_f32 v67, v119, v175
v_cvt_pk_bf16_f32 v40, v60, v61
v_cvt_pk_bf16_f32 v41, v62, v63
v_cvt_pk_bf16_f32 v42, v64, v65
v_cvt_pk_bf16_f32 v43, v66, v67
s_nop 0
v_permlane16_swap_b32 v40, v42
v_permlane16_swap_b32 v41, v43
buffer_store_dwordx4 v[40:43], v32, s[12:15], s50 offen offset:128
v_lshlrev_b32 v112, 16, v12
v_and_b32 v113, s70, v12
v_lshlrev_b32 v114, 16, v13
v_and_b32 v115, s70, v13
v_lshlrev_b32 v116, 16, v14
v_and_b32 v117, s70, v14
v_lshlrev_b32 v118, 16, v15
v_and_b32 v119, s70, v15
v_fmac_f32 v68, v112, v176
v_fmac_f32 v69, v113, v177
v_fmac_f32 v70, v114, v178
v_fmac_f32 v71, v115, v179
v_fmac_f32 v72, v116, v180
v_fmac_f32 v73, v117, v181
v_fmac_f32 v74, v118, v182
v_fmac_f32 v75, v119, v183
v_lshlrev_b32 v112, 16, v24
v_and_b32 v113, s70, v24
v_lshlrev_b32 v114, 16, v25
v_and_b32 v115, s70, v25
v_lshlrev_b32 v116, 16, v26
v_and_b32 v117, s70, v26
v_lshlrev_b32 v118, 16, v27
v_and_b32 v119, s70, v27
v_fmac_f32 v68, v112, v176
v_fmac_f32 v69, v113, v177
v_fmac_f32 v70, v114, v178
v_fmac_f32 v71, v115, v179
v_fmac_f32 v72, v116, v180
v_fmac_f32 v73, v117, v181
v_fmac_f32 v74, v118, v182
v_fmac_f32 v75, v119, v183
v_cvt_pk_bf16_f32 v44, v68, v69
v_cvt_pk_bf16_f32 v45, v70, v71
v_cvt_pk_bf16_f32 v46, v72, v73
v_cvt_pk_bf16_f32 v47, v74, v75
s_nop 0
v_permlane16_swap_b32 v44, v46
v_permlane16_swap_b32 v45, v47
buffer_store_dwordx4 v[44:47], v32, s[12:15], s65 offen offset:256
s_or_b32 s60, s2, s3
s_mov_b32 s61, 3277824
s_cmp_eq_u32 s60, 0
s_cselect_b32 s69, s61, 0x40000000
buffer_store_dword v83, v31, s[8:11], s69 offen sc1
K1_end:
s_endpgm
K1_tail2:
v_mfma_f32_16x16x32_bf16 v[112:115], a[160:163], a[0:3], v[112:115]
s_waitcnt vmcnt(29) lgkmcnt(7)
ds_read_b128 a[196:199], v50 offset:11264
v_mfma_f32_16x16x32_bf16 v[112:115], a[164:167], a[8:11], v[112:115]
s_waitcnt vmcnt(25) lgkmcnt(7)
ds_read_b128 a[200:203], v50 offset:20480
v_mfma_f32_16x16x32_bf16 v[112:115], a[168:171], a[16:19], v[112:115]
s_waitcnt vmcnt(19) lgkmcnt(6)
ds_read_b128 a[204:207], v50 offset:29696
v_and_b32 v32, 31, v2
v_mfma_f32_16x16x32_bf16 v[112:115], a[172:175], a[24:27], v[112:115]
s_lshl_b32 s60, s77, 2
v_mul_u32_u24 v32, 1152, v32
v_lshrrev_b32 v33, 5, v2
v_mfma_f32_16x16x32_bf16 v[116:119], a[160:163], a[4:7], v[116:119]
s_add_u32 s60, s60, s78
ds_read_b128 a[208:211], v50 offset:3072
v_lshl_add_u32 v32, v33, 4, v32
v_mfma_f32_16x16x32_bf16 v[116:119], a[164:167], a[12:15], v[116:119]
s_lshl_b32 s61, s60, 4
ds_read_b128 a[212:215], v50 offset:12288
v_add_u32_e64 v83, s73, 16
v_mfma_f32_16x16x32_bf16 v[116:119], a[168:171], a[20:23], v[116:119]
s_lshl_b32 s62, s76, 2
ds_read_b128 a[216:219], v50 offset:21504
v_mfma_f32_16x16x32_bf16 v[116:119], a[172:175], a[28:31], v[116:119]
s_add_u32 s39, s61, s62
v_mfma_f32_16x16x32_bf16 v[120:123], a[176:179], a[0:3], v[120:123]
s_add_u32 s39, s39, s3
ds_read_b128 a[220:223], v50 offset:30720
s_waitcnt lgkmcnt(10)
v_mfma_f32_16x16x32_bf16 v[120:123], a[180:183], a[8:11], v[120:123]
s_mul_i32 s39, s39, 10240
s_waitcnt lgkmcnt(9)
v_mfma_f32_16x16x32_bf16 v[120:123], a[184:187], a[16:19], v[120:123]
s_add_u32 s39, s39, 50331648
ds_read_b128 a[224:227], v50 offset:4096
s_waitcnt lgkmcnt(9)
v_mfma_f32_16x16x32_bf16 v[120:123], a[188:191], a[24:27], v[120:123]
s_cmp_eq_u32 s3, 0
s_cselect_b32 s46, 0, 0x40000000
v_mfma_f32_16x16x32_bf16 v[124:127], a[176:179], a[4:7], v[124:127]
s_cmp_eq_u32 s3, s76
s_cselect_b32 s39, 0x40000000, s39
ds_read_b128 a[228:231], v50 offset:13312
v_mfma_f32_16x16x32_bf16 v[124:127], a[180:183], a[12:15], v[124:127]
s_add_u32 s40, s61, s76
ds_read_b128 a[160:163], v50 offset:22528
v_mfma_f32_16x16x32_bf16 v[124:127], a[184:187], a[20:23], v[124:127]
s_mul_i32 s40, s40, 10
ds_read_b128 a[164:167], v50 offset:31744
v_mfma_f32_16x16x32_bf16 v[124:127], a[188:191], a[28:31], v[124:127]
s_add_u32 s40, s40, s3
s_waitcnt lgkmcnt(11)
v_mfma_f32_16x16x32_bf16 v[128:131], a[192:195], a[0:3], v[128:131]
s_lshl_b32 s40, s40, 10
ds_read_b128 a[168:171], v50 offset:5120
s_waitcnt lgkmcnt(11)
v_mfma_f32_16x16x32_bf16 v[128:131], a[196:199], a[8:11], v[128:131]
s_add_u32 s40, s40, 50331648
s_waitcnt lgkmcnt(10)
v_mfma_f32_16x16x32_bf16 v[128:131], a[200:203], a[16:19], v[128:131]
s_lshl_b32 s50, s77, 7
ds_read_b128 a[172:175], v50 offset:14336
s_waitcnt lgkmcnt(10)
v_mfma_f32_16x16x32_bf16 v[128:131], a[204:207], a[24:27], v[128:131]
s_lshl_b32 s63, s76, 5
v_mfma_f32_16x16x32_bf16 v[132:135], a[192:195], a[4:7], v[132:135]
s_add_u32 s50, s50, s63
ds_read_b128 a[176:179], v50 offset:23552
v_mfma_f32_16x16x32_bf16 v[132:135], a[196:199], a[12:15], v[132:135]
s_mul_i32 s50, s50, 1152
ds_read_b128 a[180:183], v50 offset:32768
v_mfma_f32_16x16x32_bf16 v[132:135], a[200:203], a[20:23], v[132:135]
s_mul_i32 s63, s78, 288
v_mfma_f32_16x16x32_bf16 v[132:135], a[204:207], a[28:31], v[132:135]
s_add_u32 s50, s50, s63
s_waitcnt lgkmcnt(11)
v_mfma_f32_16x16x32_bf16 v[136:139], a[208:211], a[0:3], v[136:139]
s_lshl_b32 s63, s3, 5
ds_read_b128 a[184:187], v50 offset:6144
s_waitcnt lgkmcnt(11)
v_mfma_f32_16x16x32_bf16 v[136:139], a[212:215], a[8:11], v[136:139]
s_add_u32 s50, s50, s63
s_waitcnt lgkmcnt(10)
v_mfma_f32_16x16x32_bf16 v[136:139], a[216:219], a[16:19], v[136:139]
s_add_u32 s65, s50, s46
ds_read_b128 a[188:191], v50 offset:15360
s_waitcnt lgkmcnt(10)
v_mfma_f32_16x16x32_bf16 v[136:139], a[220:223], a[24:27], v[136:139]
s_add_u32 s46, s46, 8192
v_mfma_f32_16x16x32_bf16 v[140:143], a[208:211], a[4:7], v[140:143]
s_lshl_b32 s41, 1, s76
ds_read_b128 a[192:195], v50 offset:24576
v_mfma_f32_16x16x32_bf16 v[140:143], a[212:215], a[12:15], v[140:143]
s_lshl_b32 s47, s3, 10
ds_read_b128 a[196:199], v50 offset:33792
v_mfma_f32_16x16x32_bf16 v[140:143], a[216:219], a[20:23], v[140:143]
s_mov_b32 s70, 0xffff0000
v_mfma_f32_16x16x32_bf16 v[140:143], a[220:223], a[28:31], v[140:143]
s_mov_b32 s79, 200000
s_waitcnt lgkmcnt(11)
v_mfma_f32_16x16x32_bf16 v[144:147], a[224:227], a[0:3], v[144:147]
s_waitcnt lgkmcnt(10)
ds_read_b128 a[200:203], v50 offset:7168
v_mfma_f32_16x16x32_bf16 v[144:147], a[228:231], a[8:11], v[144:147]
s_waitcnt lgkmcnt(10)
v_mfma_f32_16x16x32_bf16 v[144:147], a[160:163], a[16:19], v[144:147]
s_waitcnt lgkmcnt(9)
ds_read_b128 a[204:207], v50 offset:16384
v_mfma_f32_16x16x32_bf16 v[144:147], a[164:167], a[24:27], v[144:147]
buffer_load_dwordx4 v[36:39], v32, s[20:23], s50 offen offset:0
v_mfma_f32_16x16x32_bf16 v[148:151], a[224:227], a[4:7], v[148:151]
ds_read_b128 a[208:211], v50 offset:25600
v_mfma_f32_16x16x32_bf16 v[148:151], a[228:231], a[12:15], v[148:151]
ds_read_b128 a[212:215], v50 offset:34816
v_mfma_f32_16x16x32_bf16 v[148:151], a[160:163], a[20:23], v[148:151]
s_waitcnt lgkmcnt(11)
v_mfma_f32_16x16x32_bf16 v[148:151], a[164:167], a[28:31], v[148:151]
buffer_load_dwordx4 v[40:43], v32, s[20:23], s50 offen offset:128
v_mfma_f32_16x16x32_bf16 v[152:155], a[168:171], a[0:3], v[152:155]
s_waitcnt lgkmcnt(10)
ds_read_b128 a[216:219], v50 offset:8192
v_mfma_f32_16x16x32_bf16 v[152:155], a[172:175], a[8:11], v[152:155]
s_waitcnt lgkmcnt(10)
v_mfma_f32_16x16x32_bf16 v[152:155], a[176:179], a[16:19], v[152:155]
s_waitcnt lgkmcnt(9)
ds_read_b128 a[220:223], v50 offset:17408
v_mfma_f32_16x16x32_bf16 v[152:155], a[180:183], a[24:27], v[152:155]
buffer_load_dwordx4 v[44:47], v32, s[20:23], s65 offen offset:256
v_mfma_f32_16x16x32_bf16 v[156:159], a[168:171], a[4:7], v[156:159]
ds_read_b128 a[224:227], v50 offset:26624
v_mfma_f32_16x16x32_bf16 v[156:159], a[172:175], a[12:15], v[156:159]
ds_read_b128 a[228:231], v50 offset:35840
v_add_u32 v33, s47, v3
v_mfma_f32_16x16x32_bf16 v[156:159], a[176:179], a[20:23], v[156:159]
v_mfma_f32_16x16x32_bf16 v[156:159], a[180:183], a[28:31], v[156:159]
s_waitcnt lgkmcnt(11)
v_mfma_f32_16x16x32_bf16 v[160:163], a[184:187], a[0:3], v[160:163]
s_waitcnt lgkmcnt(10)
v_mfma_f32_16x16x32_bf16 v[160:163], a[188:191], a[8:11], v[160:163]
s_waitcnt lgkmcnt(9)
v_mfma_f32_16x16x32_bf16 v[160:163], a[192:195], a[16:19], v[160:163]
s_waitcnt lgkmcnt(8)
v_mfma_f32_16x16x32_bf16 v[160:163], a[196:199], a[24:27], v[160:163]
v_mfma_f32_16x16x32_bf16 v[164:167], a[184:187], a[4:7], v[164:167]
v_mfma_f32_16x16x32_bf16 v[164:167], a[188:191], a[12:15], v[164:167]
v_mfma_f32_16x16x32_bf16 v[164:167], a[192:195], a[20:23], v[164:167]
v_mfma_f32_16x16x32_bf16 v[164:167], a[196:199], a[28:31], v[164:167]
s_waitcnt lgkmcnt(5)
v_mfma_f32_16x16x32_bf16 v[168:171], a[200:203], a[0:3], v[168:171]
s_add_u32 s60, s40, 81920
v_mfma_f32_16x16x32_bf16 v[168:171], a[204:207], a[8:11], v[168:171]
s_add_u32 s61, s60, 4096
v_mfma_f32_16x16x32_bf16 v[168:171], a[208:211], a[16:19], v[168:171]
s_waitcnt vmcnt(20)
s_barrier
s_add_u32 s62, s60, s46
s_waitcnt lgkmcnt(4)
v_mfma_f32_16x16x32_bf16 v[168:171], a[212:215], a[24:27], v[168:171]
buffer_load_dwordx4 v[88:91], v3, s[8:11], s60 offen sc1
v_mfma_f32_16x16x32_bf16 v[172:175], a[200:203], a[4:7], v[172:175]
ds_read_b128 a[160:163], v51 offset:0
v_mfma_f32_16x16x32_bf16 v[172:175], a[204:207], a[12:15], v[172:175]
ds_read_b128 a[164:167], v51 offset:9216
v_mfma_f32_16x16x32_bf16 v[172:175], a[208:211], a[20:23], v[172:175]
s_waitcnt lgkmcnt(5)
ds_read_b128 a[168:171], v51 offset:18432
v_mfma_f32_16x16x32_bf16 v[172:175], a[212:215], a[28:31], v[172:175]
buffer_load_dwordx4 v[92:95], v3, s[8:11], s61 offen sc1
v_mfma_f32_16x16x32_bf16 v[176:179], a[216:219], a[0:3], v[176:179]
s_waitcnt lgkmcnt(5)
ds_read_b128 a[172:175], v51 offset:27648
v_mfma_f32_16x16x32_bf16 v[176:179], a[220:223], a[8:11], v[176:179]
s_waitcnt lgkmcnt(5)
ds_read_b128 a[176:179], v51 offset:1024
v_mfma_f32_16x16x32_bf16 v[176:179], a[224:227], a[16:19], v[176:179]
s_waitcnt vmcnt(21) lgkmcnt(4)
ds_read_b128 a[180:183], v51 offset:10240
v_mfma_f32_16x16x32_bf16 v[176:179], a[228:231], a[24:27], v[176:179]
buffer_load_dwordx4 v[96:99], v3, s[8:11], s62 offen sc1
v_mfma_f32_16x16x32_bf16 v[180:183], a[216:219], a[4:7], v[180:183]
s_add_u32 s60, s40, 122880
ds_read_b128 a[184:187], v51 offset:19456
v_mfma_f32_16x16x32_bf16 v[180:183], a[220:223], a[12:15], v[180:183]
s_add_u32 s61, s60, 4096
ds_read_b128 a[188:191], v51 offset:28672
v_mfma_f32_16x16x32_bf16 v[180:183], a[224:227], a[20:23], v[180:183]
s_add_u32 s62, s60, s46
ds_read_b128 a[192:195], v51 offset:2048
v_mfma_f32_16x16x32_bf16 v[180:183], a[228:231], a[28:31], v[180:183]
buffer_load_dwordx4 v[100:103], v3, s[8:11], s60 offen sc1
v_mfma_f32_16x16x32_bf16 v[112:115], a[160:163], a[32:35], v[112:115]
s_waitcnt vmcnt(19) lgkmcnt(7)
ds_read_b128 a[196:199], v51 offset:11264
v_mfma_f32_16x16x32_bf16 v[112:115], a[164:167], a[40:43], v[112:115]
s_waitcnt vmcnt(15) lgkmcnt(7)
ds_read_b128 a[200:203], v51 offset:20480
v_mfma_f32_16x16x32_bf16 v[112:115], a[168:171], a[48:51], v[112:115]
s_waitcnt vmcnt(11) lgkmcnt(7)
ds_read_b128 a[204:207], v51 offset:29696
v_mfma_f32_16x16x32_bf16 v[112:115], a[172:175], a[56:59], v[112:115]
buffer_load_dwordx4 v[104:107], v3, s[8:11], s61 offen sc1
v_mfma_f32_16x16x32_bf16 v[116:119], a[160:163], a[36:39], v[116:119]
ds_read_b128 a[208:211], v51 offset:3072
v_mfma_f32_16x16x32_bf16 v[116:119], a[164:167], a[44:47], v[116:119]
ds_read_b128 a[212:215], v51 offset:12288
v_mfma_f32_16x16x32_bf16 v[116:119], a[168:171], a[52:55], v[116:119]
s_waitcnt vmcnt(10) lgkmcnt(6)
ds_read_b128 a[216:219], v51 offset:21504
v_mfma_f32_16x16x32_bf16 v[116:119], a[172:175], a[60:63], v[116:119]
buffer_load_dwordx4 v[108:111], v3, s[8:11], s62 offen sc1
v_mfma_f32_16x16x32_bf16 v[120:123], a[176:179], a[32:35], v[120:123]
s_add_u32 s60, s40, 0
ds_read_b128 a[220:223], v51 offset:30720
v_mfma_f32_16x16x32_bf16 v[120:123], a[180:183], a[40:43], v[120:123]
s_add_u32 s61, s60, 4096
v_mfma_f32_16x16x32_bf16 v[120:123], a[184:187], a[48:51], v[120:123]
s_add_u32 s62, s60, s46
ds_read_b128 a[224:227], v51 offset:4096
v_cvt_pk_bf16_f32 v184, v112, v113
v_mfma_f32_16x16x32_bf16 v[120:123], a[188:191], a[56:59], v[120:123]
buffer_load_dwordx4 v[4:7], v3, s[8:11], s60 offen sc1
v_cvt_pk_bf16_f32 v185, v114, v115
v_mfma_f32_16x16x32_bf16 v[124:127], a[176:179], a[36:39], v[124:127]
ds_read_b128 a[228:231], v51 offset:13312
v_cvt_pk_bf16_f32 v186, v116, v117
v_mfma_f32_16x16x32_bf16 v[124:127], a[180:183], a[44:47], v[124:127]
ds_read_b128 a[160:163], v51 offset:22528
v_cvt_pk_bf16_f32 v187, v118, v119
v_mfma_f32_16x16x32_bf16 v[124:127], a[184:187], a[52:55], v[124:127]
s_waitcnt lgkmcnt(10)
ds_read_b128 a[164:167], v51 offset:31744
buffer_store_dwordx4 v[184:187], v3, s[8:11], s39 offen offset:0 sc1
v_mfma_f32_16x16x32_bf16 v[124:127], a[188:191], a[60:63], v[124:127]
buffer_load_dwordx4 v[8:11], v3, s[8:11], s61 offen sc1
v_mfma_f32_16x16x32_bf16 v[128:131], a[192:195], a[32:35], v[128:131]
s_waitcnt lgkmcnt(8)
ds_read_b128 a[168:171], v51 offset:5120
v_mfma_f32_16x16x32_bf16 v[128:131], a[196:199], a[40:43], v[128:131]
buffer_load_dwordx4 v[12:15], v3, s[8:11], s62 offen sc1
v_mfma_f32_16x16x32_bf16 v[128:131], a[200:203], a[48:51], v[128:131]
s_add_u32 s60, s40, 40960
ds_read_b128 a[172:175], v51 offset:14336
v_cvt_pk_bf16_f32 v188, v120, v121
v_mfma_f32_16x16x32_bf16 v[128:131], a[204:207], a[56:59], v[128:131]
s_add_u32 s61, s60, 4096
v_cvt_pk_bf16_f32 v189, v122, v123
v_cvt_pk_bf16_f32 v190, v124, v125
v_cvt_pk_bf16_f32 v191, v126, v127
v_mfma_f32_16x16x32_bf16 v[132:135], a[192:195], a[36:39], v[132:135]
s_waitcnt lgkmcnt(9)
ds_read_b128 a[176:179], v51 offset:23552
buffer_store_dwordx4 v[188:191], v3, s[8:11], s39 offen offset:1024 sc1
v_mfma_f32_16x16x32_bf16 v[132:135], a[196:199], a[44:47], v[132:135]
s_add_u32 s62, s60, s46
ds_read_b128 a[180:183], v51 offset:32768
v_mfma_f32_16x16x32_bf16 v[132:135], a[200:203], a[52:55], v[132:135]
buffer_load_dwordx4 v[16:19], v3, s[8:11], s60 offen sc1
v_mfma_f32_16x16x32_bf16 v[132:135], a[204:207], a[60:63], v[132:135]
buffer_load_dwordx4 v[20:23], v3, s[8:11], s61 offen sc1
v_mfma_f32_16x16x32_bf16 v[136:139], a[208:211], a[32:35], v[136:139]
s_waitcnt lgkmcnt(9)
ds_read_b128 a[184:187], v51 offset:6144
v_mfma_f32_16x16x32_bf16 v[136:139], a[212:215], a[40:43], v[136:139]
buffer_load_dwordx4 v[24:27], v3, s[8:11], s62 offen sc1
v_mfma_f32_16x16x32_bf16 v[136:139], a[216:219], a[48:51], v[136:139]
s_waitcnt lgkmcnt(9)
ds_read_b128 a[188:191], v51 offset:15360
v_cvt_pk_bf16_f32 v192, v128, v129
v_mfma_f32_16x16x32_bf16 v[136:139], a[220:223], a[56:59], v[136:139]
v_cvt_pk_bf16_f32 v193, v130, v131
v_cvt_pk_bf16_f32 v194, v132, v133
v_mfma_f32_16x16x32_bf16 v[140:143], a[208:211], a[36:39], v[140:143]
ds_read_b128 a[192:195], v51 offset:24576
v_cvt_pk_bf16_f32 v195, v134, v135
v_mfma_f32_16x16x32_bf16 v[140:143], a[212:215], a[44:47], v[140:143]
s_waitcnt vmcnt(16)
ds_read_b128 a[196:199], v51 offset:33792
v_permlane16_swap_b32 v36, v38
v_mfma_f32_16x16x32_bf16 v[140:143], a[216:219], a[52:55], v[140:143]
s_waitcnt vmcnt(15) lgkmcnt(11)
v_permlane16_swap_b32 v37, v39
v_permlane16_swap_b32 v40, v42
v_mfma_f32_16x16x32_bf16 v[140:143], a[220:223], a[60:63], v[140:143]
buffer_store_dwordx4 v[192:195], v3, s[8:11], s39 offen offset:2048 sc1
v_mfma_f32_16x16x32_bf16 v[144:147], a[224:227], a[32:35], v[144:147]
s_waitcnt lgkmcnt(10)
ds_read_b128 a[200:203], v51 offset:7168
v_permlane16_swap_b32 v41, v43
v_mfma_f32_16x16x32_bf16 v[144:147], a[228:231], a[40:43], v[144:147]
s_waitcnt vmcnt(15) lgkmcnt(10)
v_permlane16_swap_b32 v44, v46
v_permlane16_swap_b32 v45, v47
v_mfma_f32_16x16x32_bf16 v[144:147], a[160:163], a[48:51], v[144:147]
s_waitcnt lgkmcnt(9)
ds_read_b128 a[204:207], v51 offset:16384
v_cvt_pk_bf16_f32 v196, v136, v137
v_mfma_f32_16x16x32_bf16 v[144:147], a[164:167], a[56:59], v[144:147]
v_cvt_pk_bf16_f32 v197, v138, v139
v_cvt_pk_bf16_f32 v198, v140, v141
v_mfma_f32_16x16x32_bf16 v[148:151], a[224:227], a[36:39], v[148:151]
ds_read_b128 a[208:211], v51 offset:25600
v_cvt_pk_bf16_f32 v199, v142, v143
v_mfma_f32_16x16x32_bf16 v[148:151], a[228:231], a[44:47], v[148:151]
ds_read_b128 a[212:215], v51 offset:34816
v_lshlrev_b32 v52, 16, v36
v_mfma_f32_16x16x32_bf16 v[148:151], a[160:163], a[52:55], v[148:151]
s_waitcnt lgkmcnt(11)
v_and_b32 v53, s70, v36
v_lshlrev_b32 v54, 16, v37
v_mfma_f32_16x16x32_bf16 v[148:151], a[164:167], a[60:63], v[148:151]
buffer_store_dwordx4 v[196:199], v3, s[8:11], s39 offen offset:3072 sc1
v_mfma_f32_16x16x32_bf16 v[152:155], a[168:171], a[32:35], v[152:155]
s_waitcnt lgkmcnt(10)
ds_read_b128 a[216:219], v51 offset:8192
v_and_b32 v55, s70, v37
v_mfma_f32_16x16x32_bf16 v[152:155], a[172:175], a[40:43], v[152:155]
s_waitcnt lgkmcnt(10)
v_lshlrev_b32 v56, 16, v38
v_and_b32 v57, s70, v38
v_mfma_f32_16x16x32_bf16 v[152:155], a[176:179], a[48:51], v[152:155]
s_waitcnt lgkmcnt(9)
ds_read_b128 a[220:223], v51 offset:17408
v_cvt_pk_bf16_f32 v200, v144, v145
v_mfma_f32_16x16x32_bf16 v[152:155], a[180:183], a[56:59], v[152:155]
v_cvt_pk_bf16_f32 v201, v146, v147
v_cvt_pk_bf16_f32 v202, v148, v149
v_mfma_f32_16x16x32_bf16 v[156:159], a[168:171], a[36:39], v[156:159]
ds_read_b128 a[224:227], v51 offset:26624
v_cvt_pk_bf16_f32 v203, v150, v151
v_mfma_f32_16x16x32_bf16 v[156:159], a[172:175], a[44:47], v[156:159]
s_add_u32 s39, s39, 4096
ds_read_b128 a[228:231], v51 offset:35840
v_lshlrev_b32 v58, 16, v39
v_mfma_f32_16x16x32_bf16 v[156:159], a[176:179], a[52:55], v[156:159]
s_waitcnt lgkmcnt(11)
v_and_b32 v59, s70, v39
v_lshlrev_b32 v60, 16, v40
v_mfma_f32_16x16x32_bf16 v[156:159], a[180:183], a[60:63], v[156:159]
buffer_store_dwordx4 v[200:203], v3, s[8:11], s39 offen offset:0 sc1
v_mfma_f32_16x16x32_bf16 v[160:163], a[184:187], a[32:35], v[160:163]
s_waitcnt lgkmcnt(10)
v_and_b32 v61, s70, v40
v_lshlrev_b32 v62, 16, v41
v_mfma_f32_16x16x32_bf16 v[160:163], a[188:191], a[40:43], v[160:163]
s_waitcnt lgkmcnt(9)
v_and_b32 v63, s70, v41
v_lshlrev_b32 v64, 16, v42
v_mfma_f32_16x16x32_bf16 v[160:163], a[192:195], a[48:51], v[160:163]
s_waitcnt lgkmcnt(8)
v_cvt_pk_bf16_f32 v204, v152, v153
v_cvt_pk_bf16_f32 v205, v154, v155
v_mfma_f32_16x16x32_bf16 v[160:163], a[196:199], a[56:59], v[160:163]
v_cvt_pk_bf16_f32 v206, v156, v157
v_cvt_pk_bf16_f32 v207, v158, v159
v_mfma_f32_16x16x32_bf16 v[164:167], a[184:187], a[36:39], v[164:167]
v_and_b32 v65, s70, v42
v_lshlrev_b32 v66, 16, v43
v_mfma_f32_16x16x32_bf16 v[164:167], a[188:191], a[44:47], v[164:167]
v_and_b32 v67, s70, v43
v_lshlrev_b32 v68, 16, v44
v_mfma_f32_16x16x32_bf16 v[164:167], a[192:195], a[52:55], v[164:167]
s_waitcnt lgkmcnt(7)
v_and_b32 v69, s70, v44
v_lshlrev_b32 v70, 16, v45
v_mfma_f32_16x16x32_bf16 v[164:167], a[196:199], a[60:63], v[164:167]
buffer_store_dwordx4 v[204:207], v3, s[8:11], s39 offen offset:1024 sc1
v_mfma_f32_16x16x32_bf16 v[168:171], a[200:203], a[32:35], v[168:171]
s_waitcnt lgkmcnt(6)
v_and_b32 v71, s70, v45
v_lshlrev_b32 v72, 16, v46
v_mfma_f32_16x16x32_bf16 v[168:171], a[204:207], a[40:43], v[168:171]
s_waitcnt lgkmcnt(5)
v_and_b32 v73, s70, v46
v_lshlrev_b32 v74, 16, v47
v_mfma_f32_16x16x32_bf16 v[168:171], a[208:211], a[48:51], v[168:171]
s_waitcnt lgkmcnt(4)
v_cvt_pk_bf16_f32 v208, v160, v161
v_cvt_pk_bf16_f32 v209, v162, v163
v_mfma_f32_16x16x32_bf16 v[168:171], a[212:215], a[56:59], v[168:171]
v_cvt_pk_bf16_f32 v210, v164, v165
v_cvt_pk_bf16_f32 v211, v166, v167
v_mfma_f32_16x16x32_bf16 v[172:175], a[200:203], a[36:39], v[172:175]
v_and_b32 v75, s70, v47
v_mfma_f32_16x16x32_bf16 v[172:175], a[204:207], a[44:47], v[172:175]
v_mfma_f32_16x16x32_bf16 v[172:175], a[208:211], a[52:55], v[172:175]
s_waitcnt lgkmcnt(3)
v_mfma_f32_16x16x32_bf16 v[172:175], a[212:215], a[60:63], v[172:175]
buffer_store_dwordx4 v[208:211], v3, s[8:11], s39 offen offset:2048 sc1
v_mfma_f32_16x16x32_bf16 v[176:179], a[216:219], a[32:35], v[176:179]
s_waitcnt lgkmcnt(2)
v_mfma_f32_16x16x32_bf16 v[176:179], a[220:223], a[40:43], v[176:179]
s_waitcnt lgkmcnt(1)
v_mfma_f32_16x16x32_bf16 v[176:179], a[224:227], a[48:51], v[176:179]
s_waitcnt lgkmcnt(0)
v_mfma_f32_16x16x32_bf16 v[176:179], a[228:231], a[56:59], v[176:179]
v_cvt_pk_bf16_f32 v212, v168, v169
v_mfma_f32_16x16x32_bf16 v[180:183], a[216:219], a[36:39], v[180:183]
v_cvt_pk_bf16_f32 v213, v170, v171
v_mfma_f32_16x16x32_bf16 v[180:183], a[220:223], a[44:47], v[180:183]
v_cvt_pk_bf16_f32 v214, v172, v173
v_mfma_f32_16x16x32_bf16 v[180:183], a[224:227], a[52:55], v[180:183]
v_cvt_pk_bf16_f32 v215, v174, v175
v_mfma_f32_16x16x32_bf16 v[180:183], a[228:231], a[60:63], v[180:183]
buffer_store_dwordx4 v[212:215], v3, s[8:11], s39 offen offset:3072 sc1
v_cvt_pk_bf16_f32 v216, v176, v177
v_cvt_pk_bf16_f32 v217, v178, v179
s_nop 4
v_cvt_pk_bf16_f32 v218, v180, v181
v_cvt_pk_bf16_f32 v219, v182, v183
s_add_u32 s39, s39, 4096
buffer_store_dwordx4 v[216:219], v3, s[8:11], s39 offen offset:0 sc1
K1_tw2:
s_waitcnt vmcnt(7)
s_branch K1_p5
K1_slow0:
s_call_b64 s[48:49], K1_fix0
s_branch K1_back0
K1_slow1:
s_call_b64 s[48:49], K1_fix1
s_branch K1_back1
K1_slow2:
s_call_b64 s[48:49], K1_fix0
s_branch K1_back2
K1_slow3:
s_call_b64 s[48:49], K1_fix1
s_branch K1_back3
K1_slow4:
s_call_b64 s[48:49], K1_fix0
s_branch K1_back4
K1_slow5:
s_call_b64 s[48:49], K1_fix1
s_branch K1_back5
K1_slow6:
s_call_b64 s[48:49], K1_fix0
s_branch K1_back6
K1_slow7:
s_call_b64 s[48:49], K1_fix1
s_branch K1_back7
K1_ps0:
s_call_b64 s[48:49], K1_spin0
s_branch K1_pb0
K1_prs:
s_mov_b32 s35, 200000
K1_prl:
buffer_load_dwordx2 v[22:23], off, s[8:11], s36 sc1
s_waitcnt vmcnt(0)
v_subrev_u32 v22, s37, v22
v_subrev_u32 v23, s37, v23
v_max_u32 v22, v22, v23
v_cmp_le_u32 vcc, 2, v22
s_cbranch_vccz K1_prb
s_sub_u32 s35, s35, 1
s_cmp_lg_u32 s35, 0
s_cbranch_scc1 K1_prl
s_branch K1_prb
K1_ps1:
s_call_b64 s[48:49], K1_spin1
s_branch K1_pb1
K1_ps2:
s_call_b64 s[48:49], K1_spin0
s_branch K1_pb2
K1_ps3:
s_call_b64 s[48:49], K1_spin0
s_branch K1_pb3
K1_spin0:
s_mov_b32 s79, 200000
K1_spin_l0:
buffer_load_dwordx2 v[84:85], v80, s[8:11], s68 offen sc1
s_waitcnt vmcnt(0)
v_subrev_u32 v84, s47, v84
v_subrev_u32 v85, s47, v85
v_max_u32 v84, v84, v85
v_cmp_le_u32 vcc, 8, v84
s_cbranch_vccz K1_spin_r0
s_sleep 1
s_sub_u32 s79, s79, 1
s_cmp_lg_u32 s79, 0
s_cbranch_scc1 K1_spin_l0
K1_spin_r0:
s_setpc_b64 s[48:49]
K1_spin1:
s_mov_b32 s79, 200000
K1_spin_l1:
buffer_load_dwordx2 v[24:25], v26, s[8:11], s71 offen sc1
s_waitcnt vmcnt(0)
v_subrev_u32 v24, s47, v24
v_subrev_u32 v25, s47, v25
v_max_u32 v24, v24, v25
v_cmp_le_u32 vcc, 8, v24
s_cbranch_vccz K1_spin_r1
s_sleep 1
s_sub_u32 s79, s79, 1
s_cmp_lg_u32 s79, 0
s_cbranch_scc1 K1_spin_l1
K1_spin_r1:
s_setpc_b64 s[48:49]
K1_code_end:
K1_fix0:
s_nop 15
v_max3_f32 v4, v32, v33, v34
v_max3_f32 v4, v4, v35, v48
v_max3_f32 v4, v4, v49, v50
v_max_f32 v4, v4, v51
v_max3_f32 v5, v36, v37, v38
v_max3_f32 v5, v5, v39, v52
v_max3_f32 v5, v5, v53, v54
v_max_f32 v5, v5, v55
v_max3_f32 v6, v40, v41, v42
v_max3_f32 v6, v6, v43, v56
v_max3_f32 v6, v6, v57, v58
v_max_f32 v6, v6, v59
v_max3_f32 v7, v44, v45, v46
v_max3_f32 v7, v7, v47, v60
v_max3_f32 v7, v7, v61, v62
v_max_f32 v7, v7, v63
v_mov_b32 v144, v4
s_nop 1
v_permlane16_swap_b32 v4, v144
v_max_f32 v4, v4, v144
v_mov_b32 v144, v4
s_nop 1
v_permlane32_swap_b32 v4, v144
v_max_f32 v4, v4, v144
v_mov_b32 v145, v5
s_nop 1
v_permlane16_swap_b32 v5, v145
v_max_f32 v5, v5, v145
v_mov_b32 v145, v5
s_nop 1
v_permlane32_swap_b32 v5, v145
v_max_f32 v5, v5, v145
v_mov_b32 v146, v6
s_nop 1
v_permlane16_swap_b32 v6, v146
v_max_f32 v6, v6, v146
v_mov_b32 v146, v6
s_nop 1
v_permlane32_swap_b32 v6, v146
v_max_f32 v6, v6, v146
v_mov_b32 v147, v7
s_nop 1
v_permlane16_swap_b32 v7, v147
v_max_f32 v7, v7, v147
v_mov_b32 v147, v7
s_nop 1
v_permlane32_swap_b32 v7, v147
v_max_f32 v7, v7, v147
v_max_f32 v4, 0, v4
v_sub_f32 v149, 0, v4
v_exp_f32 v149, v149
v_max_f32 v5, 0, v5
v_sub_f32 v151, 0, v5
v_exp_f32 v151, v151
v_max_f32 v6, 0, v6
v_sub_f32 v153, 0, v6
v_exp_f32 v153, v153
v_max_f32 v7, 0, v7
v_sub_f32 v155, 0, v7
v_exp_f32 v155, v155
v_sub_f32 v128, v128, v4
v_sub_f32 v129, v129, v4
v_sub_f32 v130, v130, v4
v_sub_f32 v131, v131, v4
v_sub_f32 v64, v64, v4
v_sub_f32 v32, v32, v4
v_exp_f32 v32, v32
v_sub_f32 v65, v65, v4
v_sub_f32 v33, v33, v4
v_exp_f32 v33, v33
v_sub_f32 v66, v66, v4
v_sub_f32 v34, v34, v4
v_exp_f32 v34, v34
v_sub_f32 v67, v67, v4
v_sub_f32 v35, v35, v4
v_exp_f32 v35, v35
v_sub_f32 v80, v80, v4
v_sub_f32 v48, v48, v4
v_exp_f32 v48, v48
v_sub_f32 v81, v81, v4
v_sub_f32 v49, v49, v4
v_exp_f32 v49, v49
v_sub_f32 v82, v82, v4
v_sub_f32 v50, v50, v4
v_exp_f32 v50, v50
v_sub_f32 v83, v83, v4
v_sub_f32 v51, v51, v4
v_exp_f32 v51, v51
v_mul_f32 v156, v156, v149
v_add_f32 v148, v32, v33
v_add_f32 v148, v148, v34
v_add_f32 v148, v148, v35
v_add_f32 v148, v148, v48
v_add_f32 v148, v148, v49
v_add_f32 v148, v148, v50
v_add_f32 v148, v148, v51
v_mov_b32 v144, v148
s_nop 1
v_permlane16_swap_b32 v148, v144
v_add_f32 v148, v148, v144
v_mov_b32 v144, v148
s_nop 1
v_permlane32_swap_b32 v148, v144
v_add_f32 v148, v148, v144
v_cvt_pk_bf16_f32 v96, v32, v33
v_cvt_pk_bf16_f32 v97, v34, v35
v_cvt_pk_bf16_f32 v98, v48, v49
v_cvt_pk_bf16_f32 v99, v50, v51
v_accvgpr_read_b32 v144, a0
v_accvgpr_read_b32 v145, a1
v_accvgpr_read_b32 v146, a2
v_accvgpr_read_b32 v147, a3
v_mul_f32 v144, v144, v149
v_mul_f32 v145, v145, v149
v_mul_f32 v146, v146, v149
v_mul_f32 v147, v147, v149
v_accvgpr_write_b32 a0, v144
v_accvgpr_write_b32 a1, v145
v_accvgpr_write_b32 a2, v146
v_accvgpr_write_b32 a3, v147
v_accvgpr_read_b32 v144, a16
v_accvgpr_read_b32 v145, a17
v_accvgpr_read_b32 v146, a18
v_accvgpr_read_b32 v147, a19
v_mul_f32 v144, v144, v149
v_mul_f32 v145, v145, v149
v_mul_f32 v146, v146, v149
v_mul_f32 v147, v147, v149
v_accvgpr_write_b32 a16, v144
v_accvgpr_write_b32 a17, v145
v_accvgpr_write_b32 a18, v146
v_accvgpr_write_b32 a19, v147
v_accvgpr_read_b32 v144, a32
v_accvgpr_read_b32 v145, a33
v_accvgpr_read_b32 v146, a34
v_accvgpr_read_b32 v147, a35
v_mul_f32 v144, v144, v149
v_mul_f32 v145, v145, v149
v_mul_f32 v146, v146, v149
v_mul_f32 v147, v147, v149
v_accvgpr_write_b32 a32, v144
v_accvgpr_write_b32 a33, v145
v_accvgpr_write_b32 a34, v146
v_accvgpr_write_b32 a35, v147
v_accvgpr_read_b32 v144, a48
v_accvgpr_read_b32 v145, a49
v_accvgpr_read_b32 v146, a50
v_accvgpr_read_b32 v147, a51
v_mul_f32 v144, v144, v149
v_mul_f32 v145, v145, v149
v_mul_f32 v146, v146, v149
v_mul_f32 v147, v147, v149
v_accvgpr_write_b32 a48, v144
v_accvgpr_write_b32 a49, v145
v_accvgpr_write_b32 a50, v146
v_accvgpr_write_b32 a51, v147
v_accvgpr_read_b32 v144, a64
v_accvgpr_read_b32 v145, a65
v_accvgpr_read_b32 v146, a66
v_accvgpr_read_b32 v147, a67
v_mul_f32 v144, v144, v149
v_mul_f32 v145, v145, v149
v_mul_f32 v146, v146, v149
v_mul_f32 v147, v147, v149
v_accvgpr_write_b32 a64, v144
v_accvgpr_write_b32 a65, v145
v_accvgpr_write_b32 a66, v146
v_accvgpr_write_b32 a67, v147
v_accvgpr_read_b32 v144, a80
v_accvgpr_read_b32 v145, a81
v_accvgpr_read_b32 v146, a82
v_accvgpr_read_b32 v147, a83
v_mul_f32 v144, v144, v149
v_mul_f32 v145, v145, v149
v_mul_f32 v146, v146, v149
v_mul_f32 v147, v147, v149
v_accvgpr_write_b32 a80, v144
v_accvgpr_write_b32 a81, v145
v_accvgpr_write_b32 a82, v146
v_accvgpr_write_b32 a83, v147
v_accvgpr_read_b32 v144, a96
v_accvgpr_read_b32 v145, a97
v_accvgpr_read_b32 v146, a98
v_accvgpr_read_b32 v147, a99
v_mul_f32 v144, v144, v149
v_mul_f32 v145, v145, v149
v_mul_f32 v146, v146, v149
v_mul_f32 v147, v147, v149
v_accvgpr_write_b32 a96, v144
v_accvgpr_write_b32 a97, v145
v_accvgpr_write_b32 a98, v146
v_accvgpr_write_b32 a99, v147
v_accvgpr_read_b32 v144, a112
v_accvgpr_read_b32 v145, a113
v_accvgpr_read_b32 v146, a114
v_accvgpr_read_b32 v147, a115
v_mul_f32 v144, v144, v149
v_mul_f32 v145, v145, v149
v_mul_f32 v146, v146, v149
v_mul_f32 v147, v147, v149
v_accvgpr_write_b32 a112, v144
v_accvgpr_write_b32 a113, v145
v_accvgpr_write_b32 a114, v146
v_accvgpr_write_b32 a115, v147
v_sub_f32 v132, v132, v5
v_sub_f32 v133, v133, v5
v_sub_f32 v134, v134, v5
v_sub_f32 v135, v135, v5
v_sub_f32 v68, v68, v5
v_sub_f32 v36, v36, v5
v_exp_f32 v36, v36
v_sub_f32 v69, v69, v5
v_sub_f32 v37, v37, v5
v_exp_f32 v37, v37
v_sub_f32 v70, v70, v5
v_sub_f32 v38, v38, v5
v_exp_f32 v38, v38
v_sub_f32 v71, v71, v5
v_sub_f32 v39, v39, v5
v_exp_f32 v39, v39
v_sub_f32 v84, v84, v5
v_sub_f32 v52, v52, v5
v_exp_f32 v52, v52
v_sub_f32 v85, v85, v5
v_sub_f32 v53, v53, v5
v_exp_f32 v53, v53
v_sub_f32 v86, v86, v5
v_sub_f32 v54, v54, v5
v_exp_f32 v54, v54
v_sub_f32 v87, v87, v5
v_sub_f32 v55, v55, v5
v_exp_f32 v55, v55
v_mul_f32 v157, v157, v151
v_add_f32 v150, v36, v37
v_add_f32 v150, v150, v38
v_add_f32 v150, v150, v39
v_add_f32 v150, v150, v52
v_add_f32 v150, v150, v53
v_add_f32 v150, v150, v54
v_add_f32 v150, v150, v55
v_mov_b32 v144, v150
s_nop 1
v_permlane16_swap_b32 v150, v144
v_add_f32 v150, v150, v144
v_mov_b32 v144, v150
s_nop 1
v_permlane32_swap_b32 v150, v144
v_add_f32 v150, v150, v144
v_cvt_pk_bf16_f32 v100, v36, v37
v_cvt_pk_bf16_f32 v101, v38, v39
v_cvt_pk_bf16_f32 v102, v52, v53
v_cvt_pk_bf16_f32 v103, v54, v55
v_accvgpr_read_b32 v144, a4
v_accvgpr_read_b32 v145, a5
v_accvgpr_read_b32 v146, a6
v_accvgpr_read_b32 v147, a7
v_mul_f32 v144, v144, v151
v_mul_f32 v145, v145, v151
v_mul_f32 v146, v146, v151
v_mul_f32 v147, v147, v151
v_accvgpr_write_b32 a4, v144
v_accvgpr_write_b32 a5, v145
v_accvgpr_write_b32 a6, v146
v_accvgpr_write_b32 a7, v147
v_accvgpr_read_b32 v144, a20
v_accvgpr_read_b32 v145, a21
v_accvgpr_read_b32 v146, a22
v_accvgpr_read_b32 v147, a23
v_mul_f32 v144, v144, v151
v_mul_f32 v145, v145, v151
v_mul_f32 v146, v146, v151
v_mul_f32 v147, v147, v151
v_accvgpr_write_b32 a20, v144
v_accvgpr_write_b32 a21, v145
v_accvgpr_write_b32 a22, v146
v_accvgpr_write_b32 a23, v147
v_accvgpr_read_b32 v144, a36
v_accvgpr_read_b32 v145, a37
v_accvgpr_read_b32 v146, a38
v_accvgpr_read_b32 v147, a39
v_mul_f32 v144, v144, v151
v_mul_f32 v145, v145, v151
v_mul_f32 v146, v146, v151
v_mul_f32 v147, v147, v151
v_accvgpr_write_b32 a36, v144
v_accvgpr_write_b32 a37, v145
v_accvgpr_write_b32 a38, v146
v_accvgpr_write_b32 a39, v147
v_accvgpr_read_b32 v144, a52
v_accvgpr_read_b32 v145, a53
v_accvgpr_read_b32 v146, a54
v_accvgpr_read_b32 v147, a55
v_mul_f32 v144, v144, v151
v_mul_f32 v145, v145, v151
v_mul_f32 v146, v146, v151
v_mul_f32 v147, v147, v151
v_accvgpr_write_b32 a52, v144
v_accvgpr_write_b32 a53, v145
v_accvgpr_write_b32 a54, v146
v_accvgpr_write_b32 a55, v147
v_accvgpr_read_b32 v144, a68
v_accvgpr_read_b32 v145, a69
v_accvgpr_read_b32 v146, a70
v_accvgpr_read_b32 v147, a71
v_mul_f32 v144, v144, v151
v_mul_f32 v145, v145, v151
v_mul_f32 v146, v146, v151
v_mul_f32 v147, v147, v151
v_accvgpr_write_b32 a68, v144
v_accvgpr_write_b32 a69, v145
v_accvgpr_write_b32 a70, v146
v_accvgpr_write_b32 a71, v147
v_accvgpr_read_b32 v144, a84
v_accvgpr_read_b32 v145, a85
v_accvgpr_read_b32 v146, a86
v_accvgpr_read_b32 v147, a87
v_mul_f32 v144, v144, v151
v_mul_f32 v145, v145, v151
v_mul_f32 v146, v146, v151
v_mul_f32 v147, v147, v151
v_accvgpr_write_b32 a84, v144
v_accvgpr_write_b32 a85, v145
v_accvgpr_write_b32 a86, v146
v_accvgpr_write_b32 a87, v147
v_accvgpr_read_b32 v144, a100
v_accvgpr_read_b32 v145, a101
v_accvgpr_read_b32 v146, a102
v_accvgpr_read_b32 v147, a103
v_mul_f32 v144, v144, v151
v_mul_f32 v145, v145, v151
v_mul_f32 v146, v146, v151
v_mul_f32 v147, v147, v151
v_accvgpr_write_b32 a100, v144
v_accvgpr_write_b32 a101, v145
v_accvgpr_write_b32 a102, v146
v_accvgpr_write_b32 a103, v147
v_accvgpr_read_b32 v144, a116
v_accvgpr_read_b32 v145, a117
v_accvgpr_read_b32 v146, a118
v_accvgpr_read_b32 v147, a119
v_mul_f32 v144, v144, v151
v_mul_f32 v145, v145, v151
v_mul_f32 v146, v146, v151
v_mul_f32 v147, v147, v151
v_accvgpr_write_b32 a116, v144
v_accvgpr_write_b32 a117, v145
v_accvgpr_write_b32 a118, v146
v_accvgpr_write_b32 a119, v147
v_sub_f32 v136, v136, v6
v_sub_f32 v137, v137, v6
v_sub_f32 v138, v138, v6
v_sub_f32 v139, v139, v6
v_sub_f32 v72, v72, v6
v_sub_f32 v40, v40, v6
v_exp_f32 v40, v40
v_sub_f32 v73, v73, v6
v_sub_f32 v41, v41, v6
v_exp_f32 v41, v41
v_sub_f32 v74, v74, v6
v_sub_f32 v42, v42, v6
v_exp_f32 v42, v42
v_sub_f32 v75, v75, v6
v_sub_f32 v43, v43, v6
v_exp_f32 v43, v43
v_sub_f32 v88, v88, v6
v_sub_f32 v56, v56, v6
v_exp_f32 v56, v56
v_sub_f32 v89, v89, v6
v_sub_f32 v57, v57, v6
v_exp_f32 v57, v57
v_sub_f32 v90, v90, v6
v_sub_f32 v58, v58, v6
v_exp_f32 v58, v58
v_sub_f32 v91, v91, v6
v_sub_f32 v59, v59, v6
v_exp_f32 v59, v59
v_mul_f32 v158, v158, v153
v_add_f32 v152, v40, v41
v_add_f32 v152, v152, v42
v_add_f32 v152, v152, v43
v_add_f32 v152, v152, v56
v_add_f32 v152, v152, v57
v_add_f32 v152, v152, v58
v_add_f32 v152, v152, v59
v_mov_b32 v144, v152
s_nop 1
v_permlane16_swap_b32 v152, v144
v_add_f32 v152, v152, v144
v_mov_b32 v144, v152
s_nop 1
v_permlane32_swap_b32 v152, v144
v_add_f32 v152, v152, v144
v_cvt_pk_bf16_f32 v104, v40, v41
v_cvt_pk_bf16_f32 v105, v42, v43
v_cvt_pk_bf16_f32 v106, v56, v57
v_cvt_pk_bf16_f32 v107, v58, v59
v_accvgpr_read_b32 v144, a8
v_accvgpr_read_b32 v145, a9
v_accvgpr_read_b32 v146, a10
v_accvgpr_read_b32 v147, a11
v_mul_f32 v144, v144, v153
v_mul_f32 v145, v145, v153
v_mul_f32 v146, v146, v153
v_mul_f32 v147, v147, v153
v_accvgpr_write_b32 a8, v144
v_accvgpr_write_b32 a9, v145
v_accvgpr_write_b32 a10, v146
v_accvgpr_write_b32 a11, v147
v_accvgpr_read_b32 v144, a24
v_accvgpr_read_b32 v145, a25
v_accvgpr_read_b32 v146, a26
v_accvgpr_read_b32 v147, a27
v_mul_f32 v144, v144, v153
v_mul_f32 v145, v145, v153
v_mul_f32 v146, v146, v153
v_mul_f32 v147, v147, v153
v_accvgpr_write_b32 a24, v144
v_accvgpr_write_b32 a25, v145
v_accvgpr_write_b32 a26, v146
v_accvgpr_write_b32 a27, v147
v_accvgpr_read_b32 v144, a40
v_accvgpr_read_b32 v145, a41
v_accvgpr_read_b32 v146, a42
v_accvgpr_read_b32 v147, a43
v_mul_f32 v144, v144, v153
v_mul_f32 v145, v145, v153
v_mul_f32 v146, v146, v153
v_mul_f32 v147, v147, v153
v_accvgpr_write_b32 a40, v144
v_accvgpr_write_b32 a41, v145
v_accvgpr_write_b32 a42, v146
v_accvgpr_write_b32 a43, v147
v_accvgpr_read_b32 v144, a56
v_accvgpr_read_b32 v145, a57
v_accvgpr_read_b32 v146, a58
v_accvgpr_read_b32 v147, a59
v_mul_f32 v144, v144, v153
v_mul_f32 v145, v145, v153
v_mul_f32 v146, v146, v153
v_mul_f32 v147, v147, v153
v_accvgpr_write_b32 a56, v144
v_accvgpr_write_b32 a57, v145
v_accvgpr_write_b32 a58, v146
v_accvgpr_write_b32 a59, v147
v_accvgpr_read_b32 v144, a72
v_accvgpr_read_b32 v145, a73
v_accvgpr_read_b32 v146, a74
v_accvgpr_read_b32 v147, a75
v_mul_f32 v144, v144, v153
v_mul_f32 v145, v145, v153
v_mul_f32 v146, v146, v153
v_mul_f32 v147, v147, v153
v_accvgpr_write_b32 a72, v144
v_accvgpr_write_b32 a73, v145
v_accvgpr_write_b32 a74, v146
v_accvgpr_write_b32 a75, v147
v_accvgpr_read_b32 v144, a88
v_accvgpr_read_b32 v145, a89
v_accvgpr_read_b32 v146, a90
v_accvgpr_read_b32 v147, a91
v_mul_f32 v144, v144, v153
v_mul_f32 v145, v145, v153
v_mul_f32 v146, v146, v153
v_mul_f32 v147, v147, v153
v_accvgpr_write_b32 a88, v144
v_accvgpr_write_b32 a89, v145
v_accvgpr_write_b32 a90, v146
v_accvgpr_write_b32 a91, v147
v_accvgpr_read_b32 v144, a104
v_accvgpr_read_b32 v145, a105
v_accvgpr_read_b32 v146, a106
v_accvgpr_read_b32 v147, a107
v_mul_f32 v144, v144, v153
v_mul_f32 v145, v145, v153
v_mul_f32 v146, v146, v153
v_mul_f32 v147, v147, v153
v_accvgpr_write_b32 a104, v144
v_accvgpr_write_b32 a105, v145
v_accvgpr_write_b32 a106, v146
v_accvgpr_write_b32 a107, v147
v_accvgpr_read_b32 v144, a120
v_accvgpr_read_b32 v145, a121
v_accvgpr_read_b32 v146, a122
v_accvgpr_read_b32 v147, a123
v_mul_f32 v144, v144, v153
v_mul_f32 v145, v145, v153
v_mul_f32 v146, v146, v153
v_mul_f32 v147, v147, v153
v_accvgpr_write_b32 a120, v144
v_accvgpr_write_b32 a121, v145
v_accvgpr_write_b32 a122, v146
v_accvgpr_write_b32 a123, v147
v_sub_f32 v140, v140, v7
v_sub_f32 v141, v141, v7
v_sub_f32 v142, v142, v7
v_sub_f32 v143, v143, v7
v_sub_f32 v76, v76, v7
v_sub_f32 v44, v44, v7
v_exp_f32 v44, v44
v_sub_f32 v77, v77, v7
v_sub_f32 v45, v45, v7
v_exp_f32 v45, v45
v_sub_f32 v78, v78, v7
v_sub_f32 v46, v46, v7
v_exp_f32 v46, v46
v_sub_f32 v79, v79, v7
v_sub_f32 v47, v47, v7
v_exp_f32 v47, v47
v_sub_f32 v92, v92, v7
v_sub_f32 v60, v60, v7
v_exp_f32 v60, v60
v_sub_f32 v93, v93, v7
v_sub_f32 v61, v61, v7
v_exp_f32 v61, v61
v_sub_f32 v94, v94, v7
v_sub_f32 v62, v62, v7
v_exp_f32 v62, v62
v_sub_f32 v95, v95, v7
v_sub_f32 v63, v63, v7
v_exp_f32 v63, v63
v_mul_f32 v159, v159, v155
v_add_f32 v2, v44, v45
v_add_f32 v2, v2, v46
v_add_f32 v2, v2, v47
v_add_f32 v2, v2, v60
v_add_f32 v2, v2, v61
v_add_f32 v2, v2, v62
v_add_f32 v2, v2, v63
v_cvt_pk_bf16_f32 v108, v44, v45
v_cvt_pk_bf16_f32 v109, v46, v47
v_cvt_pk_bf16_f32 v110, v60, v61
v_cvt_pk_bf16_f32 v111, v62, v63
v_accvgpr_read_b32 v144, a12
v_accvgpr_read_b32 v145, a13
v_accvgpr_read_b32 v146, a14
v_accvgpr_read_b32 v147, a15
v_mul_f32 v144, v144, v155
v_mul_f32 v145, v145, v155
v_mul_f32 v146, v146, v155
v_mul_f32 v147, v147, v155
v_accvgpr_write_b32 a12, v144
v_accvgpr_write_b32 a13, v145
v_accvgpr_write_b32 a14, v146
v_accvgpr_write_b32 a15, v147
v_accvgpr_read_b32 v144, a28
v_accvgpr_read_b32 v145, a29
v_accvgpr_read_b32 v146, a30
v_accvgpr_read_b32 v147, a31
v_mul_f32 v144, v144, v155
v_mul_f32 v145, v145, v155
v_mul_f32 v146, v146, v155
v_mul_f32 v147, v147, v155
v_accvgpr_write_b32 a28, v144
v_accvgpr_write_b32 a29, v145
v_accvgpr_write_b32 a30, v146
v_accvgpr_write_b32 a31, v147
v_accvgpr_read_b32 v144, a44
v_accvgpr_read_b32 v145, a45
v_accvgpr_read_b32 v146, a46
v_accvgpr_read_b32 v147, a47
v_mul_f32 v144, v144, v155
v_mul_f32 v145, v145, v155
v_mul_f32 v146, v146, v155
v_mul_f32 v147, v147, v155
v_accvgpr_write_b32 a44, v144
v_accvgpr_write_b32 a45, v145
v_accvgpr_write_b32 a46, v146
v_accvgpr_write_b32 a47, v147
v_accvgpr_read_b32 v144, a60
v_accvgpr_read_b32 v145, a61
v_accvgpr_read_b32 v146, a62
v_accvgpr_read_b32 v147, a63
v_mul_f32 v144, v144, v155
v_mul_f32 v145, v145, v155
v_mul_f32 v146, v146, v155
v_mul_f32 v147, v147, v155
v_accvgpr_write_b32 a60, v144
v_accvgpr_write_b32 a61, v145
v_accvgpr_write_b32 a62, v146
v_accvgpr_write_b32 a63, v147
v_accvgpr_read_b32 v144, a76
v_accvgpr_read_b32 v145, a77
v_accvgpr_read_b32 v146, a78
v_accvgpr_read_b32 v147, a79
v_mul_f32 v144, v144, v155
v_mul_f32 v145, v145, v155
v_mul_f32 v146, v146, v155
v_mul_f32 v147, v147, v155
v_accvgpr_write_b32 a76, v144
v_accvgpr_write_b32 a77, v145
v_accvgpr_write_b32 a78, v146
v_accvgpr_write_b32 a79, v147
v_accvgpr_read_b32 v144, a92
v_accvgpr_read_b32 v145, a93
v_accvgpr_read_b32 v146, a94
v_accvgpr_read_b32 v147, a95
v_mul_f32 v144, v144, v155
v_mul_f32 v145, v145, v155
v_mul_f32 v146, v146, v155
v_mul_f32 v147, v147, v155
v_accvgpr_write_b32 a92, v144
v_accvgpr_write_b32 a93, v145
v_accvgpr_write_b32 a94, v146
v_accvgpr_write_b32 a95, v147
v_accvgpr_read_b32 v144, a108
v_accvgpr_read_b32 v145, a109
v_accvgpr_read_b32 v146, a110
v_accvgpr_read_b32 v147, a111
v_mul_f32 v144, v144, v155
v_mul_f32 v145, v145, v155
v_mul_f32 v146, v146, v155
v_mul_f32 v147, v147, v155
v_accvgpr_write_b32 a108, v144
v_accvgpr_write_b32 a109, v145
v_accvgpr_write_b32 a110, v146
v_accvgpr_write_b32 a111, v147
v_accvgpr_read_b32 v144, a124
v_accvgpr_read_b32 v145, a125
v_accvgpr_read_b32 v146, a126
v_accvgpr_read_b32 v147, a127
v_mul_f32 v144, v144, v155
v_mul_f32 v145, v145, v155
v_mul_f32 v146, v146, v155
v_mul_f32 v147, v147, v155
v_accvgpr_write_b32 a124, v144
v_accvgpr_write_b32 a125, v145
v_accvgpr_write_b32 a126, v146
v_accvgpr_write_b32 a127, v147
v_and_b32 v4, 48, v3
v_min_u32 v4, 1, v4
v_add_u32 v4, -1, v4
v_and_b32 v4, 0x3f803f80, v4
v_mov_b32 v5, v4
v_mov_b32 v6, v4
v_mov_b32 v7, v4
s_nop 3
s_setpc_b64 s[48:49]
K1_fix1:
s_nop 15
v_max3_f32 v4, v64, v65, v66
v_max3_f32 v4, v4, v67, v80
v_max3_f32 v4, v4, v81, v82
v_max_f32 v4, v4, v83
v_max3_f32 v5, v68, v69, v70
v_max3_f32 v5, v5, v71, v84
v_max3_f32 v5, v5, v85, v86
v_max_f32 v5, v5, v87
v_max3_f32 v6, v72, v73, v74
v_max3_f32 v6, v6, v75, v88
v_max3_f32 v6, v6, v89, v90
v_max_f32 v6, v6, v91
v_max3_f32 v7, v76, v77, v78
v_max3_f32 v7, v7, v79, v92
v_max3_f32 v7, v7, v93, v94
v_max_f32 v7, v7, v95
v_mov_b32 v144, v4
s_nop 1
v_permlane16_swap_b32 v4, v144
v_max_f32 v4, v4, v144
v_mov_b32 v144, v4
s_nop 1
v_permlane32_swap_b32 v4, v144
v_max_f32 v4, v4, v144
v_mov_b32 v145, v5
s_nop 1
v_permlane16_swap_b32 v5, v145
v_max_f32 v5, v5, v145
v_mov_b32 v145, v5
s_nop 1
v_permlane32_swap_b32 v5, v145
v_max_f32 v5, v5, v145
v_mov_b32 v146, v6
s_nop 1
v_permlane16_swap_b32 v6, v146
v_max_f32 v6, v6, v146
v_mov_b32 v146, v6
s_nop 1
v_permlane32_swap_b32 v6, v146
v_max_f32 v6, v6, v146
v_mov_b32 v147, v7
s_nop 1
v_permlane16_swap_b32 v7, v147
v_max_f32 v7, v7, v147
v_mov_b32 v147, v7
s_nop 1
v_permlane32_swap_b32 v7, v147
v_max_f32 v7, v7, v147
v_max_f32 v4, 0, v4
v_sub_f32 v149, 0, v4
v_exp_f32 v149, v149
v_max_f32 v5, 0, v5
v_sub_f32 v151, 0, v5
v_exp_f32 v151, v151
v_max_f32 v6, 0, v6
v_sub_f32 v153, 0, v6
v_exp_f32 v153, v153
v_max_f32 v7, 0, v7
v_sub_f32 v155, 0, v7
v_exp_f32 v155, v155
v_sub_f32 v128, v128, v4
v_sub_f32 v129, v129, v4
v_sub_f32 v130, v130, v4
v_sub_f32 v131, v131, v4
v_sub_f32 v32, v32, v4
v_sub_f32 v64, v64, v4
v_exp_f32 v64, v64
v_sub_f32 v33, v33, v4
v_sub_f32 v65, v65, v4
v_exp_f32 v65, v65
v_sub_f32 v34, v34, v4
v_sub_f32 v66, v66, v4
v_exp_f32 v66, v66
v_sub_f32 v35, v35, v4
v_sub_f32 v67, v67, v4
v_exp_f32 v67, v67
v_sub_f32 v48, v48, v4
v_sub_f32 v80, v80, v4
v_exp_f32 v80, v80
v_sub_f32 v49, v49, v4
v_sub_f32 v81, v81, v4
v_exp_f32 v81, v81
v_sub_f32 v50, v50, v4
v_sub_f32 v82, v82, v4
v_exp_f32 v82, v82
v_sub_f32 v51, v51, v4
v_sub_f32 v83, v83, v4
v_exp_f32 v83, v83
v_mul_f32 v156, v156, v149
v_add_f32 v148, v64, v65
v_add_f32 v148, v148, v66
v_add_f32 v148, v148, v67
v_add_f32 v148, v148, v80
v_add_f32 v148, v148, v81
v_add_f32 v148, v148, v82
v_add_f32 v148, v148, v83
v_mov_b32 v144, v148
s_nop 1
v_permlane16_swap_b32 v148, v144
v_add_f32 v148, v148, v144
v_mov_b32 v144, v148
s_nop 1
v_permlane32_swap_b32 v148, v144
v_add_f32 v148, v148, v144
v_cvt_pk_bf16_f32 v112, v64, v65
v_cvt_pk_bf16_f32 v113, v66, v67
v_cvt_pk_bf16_f32 v114, v80, v81
v_cvt_pk_bf16_f32 v115, v82, v83
v_accvgpr_read_b32 v144, a0
v_accvgpr_read_b32 v145, a1
v_accvgpr_read_b32 v146, a2
v_accvgpr_read_b32 v147, a3
v_mul_f32 v144, v144, v149
v_mul_f32 v145, v145, v149
v_mul_f32 v146, v146, v149
v_mul_f32 v147, v147, v149
v_accvgpr_write_b32 a0, v144
v_accvgpr_write_b32 a1, v145
v_accvgpr_write_b32 a2, v146
v_accvgpr_write_b32 a3, v147
v_accvgpr_read_b32 v144, a16
v_accvgpr_read_b32 v145, a17
v_accvgpr_read_b32 v146, a18
v_accvgpr_read_b32 v147, a19
v_mul_f32 v144, v144, v149
v_mul_f32 v145, v145, v149
v_mul_f32 v146, v146, v149
v_mul_f32 v147, v147, v149
v_accvgpr_write_b32 a16, v144
v_accvgpr_write_b32 a17, v145
v_accvgpr_write_b32 a18, v146
v_accvgpr_write_b32 a19, v147
v_accvgpr_read_b32 v144, a32
v_accvgpr_read_b32 v145, a33
v_accvgpr_read_b32 v146, a34
v_accvgpr_read_b32 v147, a35
v_mul_f32 v144, v144, v149
v_mul_f32 v145, v145, v149
v_mul_f32 v146, v146, v149
v_mul_f32 v147, v147, v149
v_accvgpr_write_b32 a32, v144
v_accvgpr_write_b32 a33, v145
v_accvgpr_write_b32 a34, v146
v_accvgpr_write_b32 a35, v147
v_accvgpr_read_b32 v144, a48
v_accvgpr_read_b32 v145, a49
v_accvgpr_read_b32 v146, a50
v_accvgpr_read_b32 v147, a51
v_mul_f32 v144, v144, v149
v_mul_f32 v145, v145, v149
v_mul_f32 v146, v146, v149
v_mul_f32 v147, v147, v149
v_accvgpr_write_b32 a48, v144
v_accvgpr_write_b32 a49, v145
v_accvgpr_write_b32 a50, v146
v_accvgpr_write_b32 a51, v147
v_accvgpr_read_b32 v144, a64
v_accvgpr_read_b32 v145, a65
v_accvgpr_read_b32 v146, a66
v_accvgpr_read_b32 v147, a67
v_mul_f32 v144, v144, v149
v_mul_f32 v145, v145, v149
v_mul_f32 v146, v146, v149
v_mul_f32 v147, v147, v149
v_accvgpr_write_b32 a64, v144
v_accvgpr_write_b32 a65, v145
v_accvgpr_write_b32 a66, v146
v_accvgpr_write_b32 a67, v147
v_accvgpr_read_b32 v144, a80
v_accvgpr_read_b32 v145, a81
v_accvgpr_read_b32 v146, a82
v_accvgpr_read_b32 v147, a83
v_mul_f32 v144, v144, v149
v_mul_f32 v145, v145, v149
v_mul_f32 v146, v146, v149
v_mul_f32 v147, v147, v149
v_accvgpr_write_b32 a80, v144
v_accvgpr_write_b32 a81, v145
v_accvgpr_write_b32 a82, v146
v_accvgpr_write_b32 a83, v147
v_accvgpr_read_b32 v144, a96
v_accvgpr_read_b32 v145, a97
v_accvgpr_read_b32 v146, a98
v_accvgpr_read_b32 v147, a99
v_mul_f32 v144, v144, v149
v_mul_f32 v145, v145, v149
v_mul_f32 v146, v146, v149
v_mul_f32 v147, v147, v149
v_accvgpr_write_b32 a96, v144
v_accvgpr_write_b32 a97, v145
v_accvgpr_write_b32 a98, v146
v_accvgpr_write_b32 a99, v147
v_accvgpr_read_b32 v144, a112
v_accvgpr_read_b32 v145, a113
v_accvgpr_read_b32 v146, a114
v_accvgpr_read_b32 v147, a115
v_mul_f32 v144, v144, v149
v_mul_f32 v145, v145, v149
v_mul_f32 v146, v146, v149
v_mul_f32 v147, v147, v149
v_accvgpr_write_b32 a112, v144
v_accvgpr_write_b32 a113, v145
v_accvgpr_write_b32 a114, v146
v_accvgpr_write_b32 a115, v147
v_sub_f32 v132, v132, v5
v_sub_f32 v133, v133, v5
v_sub_f32 v134, v134, v5
v_sub_f32 v135, v135, v5
v_sub_f32 v36, v36, v5
v_sub_f32 v68, v68, v5
v_exp_f32 v68, v68
v_sub_f32 v37, v37, v5
v_sub_f32 v69, v69, v5
v_exp_f32 v69, v69
v_sub_f32 v38, v38, v5
v_sub_f32 v70, v70, v5
v_exp_f32 v70, v70
v_sub_f32 v39, v39, v5
v_sub_f32 v71, v71, v5
v_exp_f32 v71, v71
v_sub_f32 v52, v52, v5
v_sub_f32 v84, v84, v5
v_exp_f32 v84, v84
v_sub_f32 v53, v53, v5
v_sub_f32 v85, v85, v5
v_exp_f32 v85, v85
v_sub_f32 v54, v54, v5
v_sub_f32 v86, v86, v5
v_exp_f32 v86, v86
v_sub_f32 v55, v55, v5
v_sub_f32 v87, v87, v5
v_exp_f32 v87, v87
v_mul_f32 v157, v157, v151
v_add_f32 v150, v68, v69
v_add_f32 v150, v150, v70
v_add_f32 v150, v150, v71
v_add_f32 v150, v150, v84
v_add_f32 v150, v150, v85
v_add_f32 v150, v150, v86
v_add_f32 v150, v150, v87
v_mov_b32 v144, v150
s_nop 1
v_permlane16_swap_b32 v150, v144
v_add_f32 v150, v150, v144
v_mov_b32 v144, v150
s_nop 1
v_permlane32_swap_b32 v150, v144
v_add_f32 v150, v150, v144
v_cvt_pk_bf16_f32 v116, v68, v69
v_cvt_pk_bf16_f32 v117, v70, v71
v_cvt_pk_bf16_f32 v118, v84, v85
v_cvt_pk_bf16_f32 v119, v86, v87
v_accvgpr_read_b32 v144, a4
v_accvgpr_read_b32 v145, a5
v_accvgpr_read_b32 v146, a6
v_accvgpr_read_b32 v147, a7
v_mul_f32 v144, v144, v151
v_mul_f32 v145, v145, v151
v_mul_f32 v146, v146, v151
v_mul_f32 v147, v147, v151
v_accvgpr_write_b32 a4, v144
v_accvgpr_write_b32 a5, v145
v_accvgpr_write_b32 a6, v146
v_accvgpr_write_b32 a7, v147
v_accvgpr_read_b32 v144, a20
v_accvgpr_read_b32 v145, a21
v_accvgpr_read_b32 v146, a22
v_accvgpr_read_b32 v147, a23
v_mul_f32 v144, v144, v151
v_mul_f32 v145, v145, v151
v_mul_f32 v146, v146, v151
v_mul_f32 v147, v147, v151
v_accvgpr_write_b32 a20, v144
v_accvgpr_write_b32 a21, v145
v_accvgpr_write_b32 a22, v146
v_accvgpr_write_b32 a23, v147
v_accvgpr_read_b32 v144, a36
v_accvgpr_read_b32 v145, a37
v_accvgpr_read_b32 v146, a38
v_accvgpr_read_b32 v147, a39
v_mul_f32 v144, v144, v151
v_mul_f32 v145, v145, v151
v_mul_f32 v146, v146, v151
v_mul_f32 v147, v147, v151
v_accvgpr_write_b32 a36, v144
v_accvgpr_write_b32 a37, v145
v_accvgpr_write_b32 a38, v146
v_accvgpr_write_b32 a39, v147
v_accvgpr_read_b32 v144, a52
v_accvgpr_read_b32 v145, a53
v_accvgpr_read_b32 v146, a54
v_accvgpr_read_b32 v147, a55
v_mul_f32 v144, v144, v151
v_mul_f32 v145, v145, v151
v_mul_f32 v146, v146, v151
v_mul_f32 v147, v147, v151
v_accvgpr_write_b32 a52, v144
v_accvgpr_write_b32 a53, v145
v_accvgpr_write_b32 a54, v146
v_accvgpr_write_b32 a55, v147
v_accvgpr_read_b32 v144, a68
v_accvgpr_read_b32 v145, a69
v_accvgpr_read_b32 v146, a70
v_accvgpr_read_b32 v147, a71
v_mul_f32 v144, v144, v151
v_mul_f32 v145, v145, v151
v_mul_f32 v146, v146, v151
v_mul_f32 v147, v147, v151
v_accvgpr_write_b32 a68, v144
v_accvgpr_write_b32 a69, v145
v_accvgpr_write_b32 a70, v146
v_accvgpr_write_b32 a71, v147
v_accvgpr_read_b32 v144, a84
v_accvgpr_read_b32 v145, a85
v_accvgpr_read_b32 v146, a86
v_accvgpr_read_b32 v147, a87
v_mul_f32 v144, v144, v151
v_mul_f32 v145, v145, v151
v_mul_f32 v146, v146, v151
v_mul_f32 v147, v147, v151
v_accvgpr_write_b32 a84, v144
v_accvgpr_write_b32 a85, v145
v_accvgpr_write_b32 a86, v146
v_accvgpr_write_b32 a87, v147
v_accvgpr_read_b32 v144, a100
v_accvgpr_read_b32 v145, a101
v_accvgpr_read_b32 v146, a102
v_accvgpr_read_b32 v147, a103
v_mul_f32 v144, v144, v151
v_mul_f32 v145, v145, v151
v_mul_f32 v146, v146, v151
v_mul_f32 v147, v147, v151
v_accvgpr_write_b32 a100, v144
v_accvgpr_write_b32 a101, v145
v_accvgpr_write_b32 a102, v146
v_accvgpr_write_b32 a103, v147
v_accvgpr_read_b32 v144, a116
v_accvgpr_read_b32 v145, a117
v_accvgpr_read_b32 v146, a118
v_accvgpr_read_b32 v147, a119
v_mul_f32 v144, v144, v151
v_mul_f32 v145, v145, v151
v_mul_f32 v146, v146, v151
v_mul_f32 v147, v147, v151
v_accvgpr_write_b32 a116, v144
v_accvgpr_write_b32 a117, v145
v_accvgpr_write_b32 a118, v146
v_accvgpr_write_b32 a119, v147
v_sub_f32 v136, v136, v6
v_sub_f32 v137, v137, v6
v_sub_f32 v138, v138, v6
v_sub_f32 v139, v139, v6
v_sub_f32 v40, v40, v6
v_sub_f32 v72, v72, v6
v_exp_f32 v72, v72
v_sub_f32 v41, v41, v6
v_sub_f32 v73, v73, v6
v_exp_f32 v73, v73
v_sub_f32 v42, v42, v6
v_sub_f32 v74, v74, v6
v_exp_f32 v74, v74
v_sub_f32 v43, v43, v6
v_sub_f32 v75, v75, v6
v_exp_f32 v75, v75
v_sub_f32 v56, v56, v6
v_sub_f32 v88, v88, v6
v_exp_f32 v88, v88
v_sub_f32 v57, v57, v6
v_sub_f32 v89, v89, v6
v_exp_f32 v89, v89
v_sub_f32 v58, v58, v6
v_sub_f32 v90, v90, v6
v_exp_f32 v90, v90
v_sub_f32 v59, v59, v6
v_sub_f32 v91, v91, v6
v_exp_f32 v91, v91
v_mul_f32 v158, v158, v153
v_add_f32 v152, v72, v73
v_add_f32 v152, v152, v74
v_add_f32 v152, v152, v75
v_add_f32 v152, v152, v88
v_add_f32 v152, v152, v89
v_add_f32 v152, v152, v90
v_add_f32 v152, v152, v91
v_mov_b32 v144, v152
s_nop 1
v_permlane16_swap_b32 v152, v144
v_add_f32 v152, v152, v144
v_mov_b32 v144, v152
s_nop 1
v_permlane32_swap_b32 v152, v144
v_add_f32 v152, v152, v144
v_cvt_pk_bf16_f32 v120, v72, v73
v_cvt_pk_bf16_f32 v121, v74, v75
v_cvt_pk_bf16_f32 v122, v88, v89
v_cvt_pk_bf16_f32 v123, v90, v91
v_accvgpr_read_b32 v144, a8
v_accvgpr_read_b32 v145, a9
v_accvgpr_read_b32 v146, a10
v_accvgpr_read_b32 v147, a11
v_mul_f32 v144, v144, v153
v_mul_f32 v145, v145, v153
v_mul_f32 v146, v146, v153
v_mul_f32 v147, v147, v153
v_accvgpr_write_b32 a8, v144
v_accvgpr_write_b32 a9, v145
v_accvgpr_write_b32 a10, v146
v_accvgpr_write_b32 a11, v147
v_accvgpr_read_b32 v144, a24
v_accvgpr_read_b32 v145, a25
v_accvgpr_read_b32 v146, a26
v_accvgpr_read_b32 v147, a27
v_mul_f32 v144, v144, v153
v_mul_f32 v145, v145, v153
v_mul_f32 v146, v146, v153
v_mul_f32 v147, v147, v153
v_accvgpr_write_b32 a24, v144
v_accvgpr_write_b32 a25, v145
v_accvgpr_write_b32 a26, v146
v_accvgpr_write_b32 a27, v147
v_accvgpr_read_b32 v144, a40
v_accvgpr_read_b32 v145, a41
v_accvgpr_read_b32 v146, a42
v_accvgpr_read_b32 v147, a43
v_mul_f32 v144, v144, v153
v_mul_f32 v145, v145, v153
v_mul_f32 v146, v146, v153
v_mul_f32 v147, v147, v153
v_accvgpr_write_b32 a40, v144
v_accvgpr_write_b32 a41, v145
v_accvgpr_write_b32 a42, v146
v_accvgpr_write_b32 a43, v147
v_accvgpr_read_b32 v144, a56
v_accvgpr_read_b32 v145, a57
v_accvgpr_read_b32 v146, a58
v_accvgpr_read_b32 v147, a59
v_mul_f32 v144, v144, v153
v_mul_f32 v145, v145, v153
v_mul_f32 v146, v146, v153
v_mul_f32 v147, v147, v153
v_accvgpr_write_b32 a56, v144
v_accvgpr_write_b32 a57, v145
v_accvgpr_write_b32 a58, v146
v_accvgpr_write_b32 a59, v147
v_accvgpr_read_b32 v144, a72
v_accvgpr_read_b32 v145, a73
v_accvgpr_read_b32 v146, a74
v_accvgpr_read_b32 v147, a75
v_mul_f32 v144, v144, v153
v_mul_f32 v145, v145, v153
v_mul_f32 v146, v146, v153
v_mul_f32 v147, v147, v153
v_accvgpr_write_b32 a72, v144
v_accvgpr_write_b32 a73, v145
v_accvgpr_write_b32 a74, v146
v_accvgpr_write_b32 a75, v147
v_accvgpr_read_b32 v144, a88
v_accvgpr_read_b32 v145, a89
v_accvgpr_read_b32 v146, a90
v_accvgpr_read_b32 v147, a91
v_mul_f32 v144, v144, v153
v_mul_f32 v145, v145, v153
v_mul_f32 v146, v146, v153
v_mul_f32 v147, v147, v153
v_accvgpr_write_b32 a88, v144
v_accvgpr_write_b32 a89, v145
v_accvgpr_write_b32 a90, v146
v_accvgpr_write_b32 a91, v147
v_accvgpr_read_b32 v144, a104
v_accvgpr_read_b32 v145, a105
v_accvgpr_read_b32 v146, a106
v_accvgpr_read_b32 v147, a107
v_mul_f32 v144, v144, v153
v_mul_f32 v145, v145, v153
v_mul_f32 v146, v146, v153
v_mul_f32 v147, v147, v153
v_accvgpr_write_b32 a104, v144
v_accvgpr_write_b32 a105, v145
v_accvgpr_write_b32 a106, v146
v_accvgpr_write_b32 a107, v147
v_accvgpr_read_b32 v144, a120
v_accvgpr_read_b32 v145, a121
v_accvgpr_read_b32 v146, a122
v_accvgpr_read_b32 v147, a123
v_mul_f32 v144, v144, v153
v_mul_f32 v145, v145, v153
v_mul_f32 v146, v146, v153
v_mul_f32 v147, v147, v153
v_accvgpr_write_b32 a120, v144
v_accvgpr_write_b32 a121, v145
v_accvgpr_write_b32 a122, v146
v_accvgpr_write_b32 a123, v147
v_sub_f32 v140, v140, v7
v_sub_f32 v141, v141, v7
v_sub_f32 v142, v142, v7
v_sub_f32 v143, v143, v7
v_sub_f32 v44, v44, v7
v_sub_f32 v76, v76, v7
v_exp_f32 v76, v76
v_sub_f32 v45, v45, v7
v_sub_f32 v77, v77, v7
v_exp_f32 v77, v77
v_sub_f32 v46, v46, v7
v_sub_f32 v78, v78, v7
v_exp_f32 v78, v78
v_sub_f32 v47, v47, v7
v_sub_f32 v79, v79, v7
v_exp_f32 v79, v79
v_sub_f32 v60, v60, v7
v_sub_f32 v92, v92, v7
v_exp_f32 v92, v92
v_sub_f32 v61, v61, v7
v_sub_f32 v93, v93, v7
v_exp_f32 v93, v93
v_sub_f32 v62, v62, v7
v_sub_f32 v94, v94, v7
v_exp_f32 v94, v94
v_sub_f32 v63, v63, v7
v_sub_f32 v95, v95, v7
v_exp_f32 v95, v95
v_mul_f32 v159, v159, v155
v_add_f32 v2, v76, v77
v_add_f32 v2, v2, v78
v_add_f32 v2, v2, v79
v_add_f32 v2, v2, v92
v_add_f32 v2, v2, v93
v_add_f32 v2, v2, v94
v_add_f32 v2, v2, v95
v_cvt_pk_bf16_f32 v124, v76, v77
v_cvt_pk_bf16_f32 v125, v78, v79
v_cvt_pk_bf16_f32 v126, v92, v93
v_cvt_pk_bf16_f32 v127, v94, v95
v_accvgpr_read_b32 v144, a12
v_accvgpr_read_b32 v145, a13
v_accvgpr_read_b32 v146, a14
v_accvgpr_read_b32 v147, a15
v_mul_f32 v144, v144, v155
v_mul_f32 v145, v145, v155
v_mul_f32 v146, v146, v155
v_mul_f32 v147, v147, v155
v_accvgpr_write_b32 a12, v144
v_accvgpr_write_b32 a13, v145
v_accvgpr_write_b32 a14, v146
v_accvgpr_write_b32 a15, v147
v_accvgpr_read_b32 v144, a28
v_accvgpr_read_b32 v145, a29
v_accvgpr_read_b32 v146, a30
v_accvgpr_read_b32 v147, a31
v_mul_f32 v144, v144, v155
v_mul_f32 v145, v145, v155
v_mul_f32 v146, v146, v155
v_mul_f32 v147, v147, v155
v_accvgpr_write_b32 a28, v144
v_accvgpr_write_b32 a29, v145
v_accvgpr_write_b32 a30, v146
v_accvgpr_write_b32 a31, v147
v_accvgpr_read_b32 v144, a44
v_accvgpr_read_b32 v145, a45
v_accvgpr_read_b32 v146, a46
v_accvgpr_read_b32 v147, a47
v_mul_f32 v144, v144, v155
v_mul_f32 v145, v145, v155
v_mul_f32 v146, v146, v155
v_mul_f32 v147, v147, v155
v_accvgpr_write_b32 a44, v144
v_accvgpr_write_b32 a45, v145
v_accvgpr_write_b32 a46, v146
v_accvgpr_write_b32 a47, v147
v_accvgpr_read_b32 v144, a60
v_accvgpr_read_b32 v145, a61
v_accvgpr_read_b32 v146, a62
v_accvgpr_read_b32 v147, a63
v_mul_f32 v144, v144, v155
v_mul_f32 v145, v145, v155
v_mul_f32 v146, v146, v155
v_mul_f32 v147, v147, v155
v_accvgpr_write_b32 a60, v144
v_accvgpr_write_b32 a61, v145
v_accvgpr_write_b32 a62, v146
v_accvgpr_write_b32 a63, v147
v_accvgpr_read_b32 v144, a76
v_accvgpr_read_b32 v145, a77
v_accvgpr_read_b32 v146, a78
v_accvgpr_read_b32 v147, a79
v_mul_f32 v144, v144, v155
v_mul_f32 v145, v145, v155
v_mul_f32 v146, v146, v155
v_mul_f32 v147, v147, v155
v_accvgpr_write_b32 a76, v144
v_accvgpr_write_b32 a77, v145
v_accvgpr_write_b32 a78, v146
v_accvgpr_write_b32 a79, v147
v_accvgpr_read_b32 v144, a92
v_accvgpr_read_b32 v145, a93
v_accvgpr_read_b32 v146, a94
v_accvgpr_read_b32 v147, a95
v_mul_f32 v144, v144, v155
v_mul_f32 v145, v145, v155
v_mul_f32 v146, v146, v155
v_mul_f32 v147, v147, v155
v_accvgpr_write_b32 a92, v144
v_accvgpr_write_b32 a93, v145
v_accvgpr_write_b32 a94, v146
v_accvgpr_write_b32 a95, v147
v_accvgpr_read_b32 v144, a108
v_accvgpr_read_b32 v145, a109
v_accvgpr_read_b32 v146, a110
v_accvgpr_read_b32 v147, a111
v_mul_f32 v144, v144, v155
v_mul_f32 v145, v145, v155
v_mul_f32 v146, v146, v155
v_mul_f32 v147, v147, v155
v_accvgpr_write_b32 a108, v144
v_accvgpr_write_b32 a109, v145
v_accvgpr_write_b32 a110, v146
v_accvgpr_write_b32 a111, v147
v_accvgpr_read_b32 v144, a124
v_accvgpr_read_b32 v145, a125
v_accvgpr_read_b32 v146, a126
v_accvgpr_read_b32 v147, a127
v_mul_f32 v144, v144, v155
v_mul_f32 v145, v145, v155
v_mul_f32 v146, v146, v155
v_mul_f32 v147, v147, v155
v_accvgpr_write_b32 a124, v144
v_accvgpr_write_b32 a125, v145
v_accvgpr_write_b32 a126, v146
v_accvgpr_write_b32 a127, v147
v_and_b32 v4, 48, v3
v_min_u32 v4, 1, v4
v_add_u32 v4, -1, v4
v_and_b32 v4, 0x3f803f80, v4
v_mov_b32 v5, v4
v_mov_b32 v6, v4
v_mov_b32 v7, v4
s_nop 3
s_setpc_b64 s[48:49]
.section .rodata,"a"
.p2align 6
.amdhsa_kernel recurrent_scan__mha_block_cached__glu_gated_swiglu__prompt_kernel
  .amdhsa_next_free_vgpr 512
  .amdhsa_next_free_sgpr 102
  .amdhsa_accum_offset 256
  .amdhsa_group_segment_fixed_size 0
  .amdhsa_kernarg_size 96
  .amdhsa_user_sgpr_count 2
  .amdhsa_user_sgpr_kernarg_segment_ptr 1
  .amdhsa_system_sgpr_workgroup_id_x 1
.end_amdhsa_kernel
```
